```python
import torch

def _softmax(x, axis=-1):
    return torch.softmax(x, dim=axis)
def _gelu(x):
    return torch.nn.functional.gelu(x, approximate="tanh")
def _silu(x):
    return torch.nn.functional.silu(x)
def _sigmoid(x):
    return torch.sigmoid(x)
def _layernorm(x, axis=-1, eps=1e-5):
    m = x.mean(dim=axis, keepdim=True)
    v = x.var(dim=axis, keepdim=True, unbiased=False)
    return (x - m) / torch.sqrt(v + eps)
def _scatter_add(tgt, idx, src, axis=0):
    return tgt.clone().index_add_(axis, idx, src)
def _segment_sum(src, seg, n):
    out = torch.zeros((n,) + src.shape[1:], dtype=src.dtype)
    return out.index_add_(0, seg, src)
def _pad(x, pw):
    flat = tuple(v for pair in reversed(pw) for v in pair)
    return torch.nn.functional.pad(x, flat)

kernel_name = 'parallel_sum__ssm_conv_h3__swiglu_ffn__prompt'

def setup_inputs():

    _w = (lambda a: (lambda t: t.to(torch.bfloat16) if t.is_floating_point() else t)(torch.as_tensor(a)))
    def _A_setup():
        B, S, D = 1, 2048, 1024
        ks = 4
        return {
            "q": _w((lambda *s: torch.randn(*s, dtype=torch.bfloat16) * 0.05)(B, S, D)),
            "k": _w((lambda *s: torch.randn(*s, dtype=torch.bfloat16) * 0.8)(B, S, D)),
            "v": _w((lambda *s: torch.randn(*s, dtype=torch.bfloat16) * 0.8)(B, S, D)),
            "shift_k": _w((lambda *s: torch.randn(*s, dtype=torch.bfloat16) * 0.8)(D, ks) * 0.5),
            "ssm_k": _w((lambda *s: torch.randn(*s, dtype=torch.bfloat16) * 0.8)(D, S) * (1.0 / S ** 0.5)),
            "ssm_D": _w((lambda *s: torch.randn(*s, dtype=torch.bfloat16) * 0.8)(D)),
        }
    _A_in = _A_setup()

    def _B_setup():
        B, S, D, F = 1, 2048, 1024, 3584
        return {
            "x": _w((lambda *s: torch.randn(*s, dtype=torch.bfloat16) * 0.05)(B, S, D)),
            "w_gate": _w((lambda *s: torch.randn(*s, dtype=torch.bfloat16) * 0.05)(D, F)),
            "w_up": _w((lambda *s: torch.randn(*s, dtype=torch.bfloat16) * 0.05)(D, F)),
            "w_down": _w((lambda *s: torch.randn(*s, dtype=torch.bfloat16) * 0.05)(F, D)),
        }
    _B_in = _B_setup()

    return {
        "A_q": _A_in["q"],
        "A_k": _A_in["k"],
        "A_v": _A_in["v"],
        "A_shift_k": _A_in["shift_k"],
        "A_ssm_k": _A_in["ssm_k"],
        "A_ssm_D": _A_in["ssm_D"],
        "B_x": _B_in["x"],
        "B_w_gate": _B_in["w_gate"],
        "B_w_up": _B_in["w_up"],
        "B_w_down": _B_in["w_down"],
    }

def reference(A_q, A_k, A_v, A_shift_k, A_ssm_k, A_ssm_D, B_x, B_w_gate, B_w_up, B_w_down):
    def _A_ref(q, k, v, shift_k, ssm_k, ssm_D):
        B, S, D = q.shape
        ks = shift_k.shape[-1]
        k_pad = _pad(k, ((0, 0), (ks - 1, 0), (0, 0)))
        k_shift = torch.zeros_like(k)
        for t in range(ks):
            k_shift = k_shift + k_pad[:, t:t + S, :] * shift_k[:, ks - 1 - t][None, None, :]
        kv = k_shift * v
        L = 2 * S
        kv_pad = _pad(kv, ((0, 0), (0, S), (0, 0)))
        kf_pad = _pad(ssm_k, ((0, 0), (0, S)))
        kv_f = (lambda x, axes=(-2,-1): torch.fft.rfft2(x.float(), dim=axes))(kv_pad[:, None, :, :], axes=(1, 2))
        kf_f = (lambda x, axes=(-2,-1): torch.fft.rfft2(x.float(), dim=axes))(kf_pad[:, None, :], axes=(1, 2))
        kf_f = (lambda x, *d: x.permute(*d))(kf_f, 1, 2, 0)
        y_f = kv_f * kf_f[None, :, :, :]
        y = (lambda x, s, axes=(-2,-1): torch.fft.irfft2(x, s=s, dim=axes).to(torch.bfloat16))(y_f, (1, L), axes=(1, 2))[:, 0, :S, :]
        y = y + kv * ssm_D[None, None, :]
        return q * y

    def _B_ref(x, w_gate, w_up, w_down):
        g = _silu(x @ w_gate)
        u = x @ w_up
        return (g * u) @ w_down

    x = A_q
    xn = _layernorm(x, axis=-1)
    return x + _A_ref(xn, A_k, A_v, A_shift_k, A_ssm_k, A_ssm_D) + _B_ref(xn, B_w_gate, B_w_up, B_w_down)
```

```asm
; @launch grid=(256,1,1) block=(256,1,1) lds=159744
.amdgcn_target "amdgcn-amd-amdhsa--gfx950"
.text
.globl parallel_sum__ssm_conv_h3__swiglu_ffn__prompt_kernel
.p2align 8
.type parallel_sum__ssm_conv_h3__swiglu_ffn__prompt_kernel,@function
parallel_sum__ssm_conv_h3__swiglu_ffn__prompt_kernel:
    s_cmp_ge_u32 s2, 256
    s_cbranch_scc1 M_END
    s_load_dwordx16 s[36:51], s[0:1], 0
    s_load_dwordx8 s[52:59], s[0:1], 64
    s_load_dwordx2 s[60:61], s[0:1], 96
    v_lshrrev_b32 v2, 6, v0
    v_and_b32 v1, 63, v0
    v_readfirstlane_b32 s3, v2
    v_lshlrev_b32 v14, 4, v1
    v_mov_b32 v4, 0
    v_mov_b32_e64 v5, 1
    s_bfe_u32 s4, s2, 0x20001
    s_mov_b32 s8, 0xd090501
    s_mov_b32 s9, 0x30200
    s_cmp_eq_u32 s4, 1
    s_cselect_b32 s8, 0x4191511, s8
    s_cselect_b32 s9, 0x80706, s9
    s_cmp_eq_u32 s4, 2
    s_cselect_b32 s8, 0xe0c0b0a, s8
    s_cselect_b32 s9, 0x12100f, s9
    s_cmp_eq_u32 s4, 3
    s_cselect_b32 s8, 0x17161413, s8
    s_cselect_b32 s9, 0x1b1a18, s9
    s_cmp_ge_u32 s2, 224
    s_cbranch_scc1 SIDE
    s_and_b32 s4, s2, 1
    s_lshl_b32 s4, s4, 2
    s_bfe_u32 s5, s2, 0x20003
    s_add_u32 s62, s4, s5
    s_bfe_u32 s4, s2, 0x20001
    s_lshr_b32 s6, s2, 5
    s_lshl_b32 s6, s6, 3
    s_lshr_b64 s[10:11], s[8:9], s6
    s_and_b32 s63, s10, 31
    s_and_b32 s69, s62, 4
    s_and_b32 s32, s62, 3
    v_lshrrev_b32 v32, 3, v1
    v_and_b32 v33, 7, v1
    v_lshrrev_b32 v34, 1, v32
    v_xor_b32 v33, v33, v34
    v_lshlrev_b32 v32, 12, v32
    v_lshl_add_u32 v2, v33, 4, v32
    v_xor_b32_e64 v33, 4, v33
    v_lshl_add_u32 v3, v33, 4, v32
    v_add_u32 v3, 0x7c00, v3
    v_lshrrev_b32_e64 v32, 5, v1
    v_bfe_u32 v33, v1, 4, 1
    v_lshl_add_u32 v32, v32, 2, v33
    v_mul_u32_u24 v32, 28672, v32
    v_and_b32_e64 v33, 15, v1
    v_lshl_add_u32 v6, v33, 4, v32
    v_add_u32 v7, 0x17e0, v6
    v_add_u32 v8, 0x2fc0, v6
    v_add_u32 v9, 0x47a0, v6
    s_lshl_b32 s27, s62, 19
    s_lshl_b32 s5, s3, 17
    s_add_u32 s27, s27, s5
    s_and_b32 s4, s3, 1
    s_mul_i32 s4, s4, 57344
    s_lshl_b32 s28, s63, 8
    s_add_u32 s28, s28, s4
    s_lshr_b32 s4, s3, 1
    s_mul_i32 s4, s4, 229376
    s_add_u32 s28, s28, s4
    s_mul_i32 s30, s3, 18432
    s_add_u32 s30, s30, 0x10800
    s_mul_i32 s31, s3, 4224
    s_mov_b32 s33, s69
    s_and_b32 s4, s33, 7
    s_mul_i32 s5, s4, 0xe0000
    s_add_u32 s25, s28, s5
    s_lshl_b32 s4, s4, 8
    s_add_u32 s24, s27, s4
    s_add_u32 s35, s24, 0x10000
    s_add_u32 s33, s33, 1
    s_waitcnt lgkmcnt(0)
    s_mov_b64 s[48:49], s[8:9]
    s_mov_b32 s8, s36
    s_mov_b32 s9, s37
    s_mov_b32 s10, 0x400000
    s_mov_b32 s11, 0x00020000
    s_mov_b32 s12, s50
    s_mov_b32 s13, s51
    s_mov_b32 s14, 0x700000
    s_mov_b32 s15, 0x00020000
    s_mov_b32 s16, s52
    s_mov_b32 s17, s53
    s_mov_b32 s18, 0x700000
    s_mov_b32 s19, 0x00020000
    s_add_u32 m0, s31, 0x0
    s_nop 0
    buffer_load_dwordx4 v6, s[12:15], s25 offen offset:0 lds
    buffer_load_dwordx4 v7, s[12:15], s25 offen offset:1056 lds
    buffer_load_dwordx4 v8, s[12:15], s25 offen offset:2112 lds
    buffer_load_dwordx4 v9, s[12:15], s25 offen offset:3168 lds
    s_add_u32 m0, s30, 0x0
    s_nop 0
    buffer_load_dwordx4 v2, s[8:11], s24 offen offset:0 lds
    buffer_load_dwordx4 v3, s[8:11], s24 offen offset:1024 lds
    buffer_load_dwordx4 v2, s[8:11], s24 offen offset:2048 lds
    buffer_load_dwordx4 v3, s[8:11], s24 offen offset:3072 lds
    s_add_u32 s24, s24, 128
    s_add_u32 m0, s30, 0x1000
    s_nop 0
    buffer_load_dwordx4 v2, s[8:11], s35 offen offset:0 lds
    buffer_load_dwordx4 v3, s[8:11], s35 offen offset:1024 lds
    buffer_load_dwordx4 v2, s[8:11], s35 offen offset:2048 lds
    buffer_load_dwordx4 v3, s[8:11], s35 offen offset:3072 lds
    s_add_u32 s35, s35, 128
    s_add_u32 m0, s31, 0x4200
    s_nop 0
    buffer_load_dwordx4 v6, s[16:19], s25 offen offset:0 lds
    buffer_load_dwordx4 v7, s[16:19], s25 offen offset:1056 lds
    buffer_load_dwordx4 v8, s[16:19], s25 offen offset:2112 lds
    buffer_load_dwordx4 v9, s[16:19], s25 offen offset:3168 lds
    s_add_u32 s25, s25, 0x70000
    s_add_u32 m0, s31, 0x8400
    s_nop 0
    buffer_load_dwordx4 v6, s[12:15], s25 offen offset:0 lds
    buffer_load_dwordx4 v7, s[12:15], s25 offen offset:1056 lds
    buffer_load_dwordx4 v8, s[12:15], s25 offen offset:2112 lds
    buffer_load_dwordx4 v9, s[12:15], s25 offen offset:3168 lds
    s_mov_b32 s64, s60
    s_mov_b32 s65, s61
    s_mov_b32 s66, 0x4000000
    s_mov_b32 s67, 0x00020000
    v_and_b32 v32, 15, v1
    v_lshrrev_b32 v33, 4, v1
    v_lshrrev_b32 v34, 1, v32
    v_xor_b32 v34, v34, v33
    v_lshlrev_b32 v32, 7, v32
    v_add_u32_e64 v32, s30, v32
    v_lshl_add_u32 v10, v34, 4, v32
    v_xor_b32_e64 v34, 4, v34
    v_lshl_add_u32 v11, v34, 4, v32
    v_bfe_u32 v32, v1, 2, 3
    v_mul_u32_u24 v32, 1056, v32
    v_lshrrev_b32_e64 v33, 5, v1
    v_lshl_add_u32 v32, v33, 9, v32
    v_and_b32_e64 v33, 3, v1
    v_lshl_add_u32 v12, v33, 3, v32
    s_lshl_b32 s4, s32, 2
    s_add_u32 s32, s4, s3
    s_and_b32 s4, s32, 7
    s_lshl_b32 s4, s4, 5
    s_lshr_b32 s5, s32, 3
    s_mul_i32 s5, s5, 8448
    s_add_u32 s4, s4, s5
    v_add_u32_e64 v13, s4, v12
    v_mov_b32 v16, 0x3f803f80
    v_mov_b32 v17, 0x3f803f80
    v_mov_b32 v18, 0x3f803f80
    v_mov_b32 v19, 0x3f803f80
    s_mov_b32 s20, s58
    s_mov_b32 s21, s59
    s_mov_b32 s22, 0x100
    s_mov_b32 s23, 0x00020000
    s_lshl_b32 s72, s63, 12
    s_lshl_b32 s5, s69, 9
    s_add_u32 s72, s72, s5
    s_lshr_b32 s5, s32, 3
    s_lshl_b32 s5, s5, 10
    s_add_u32 s72, s72, s5
    s_and_b32 s5, s32, 7
    s_lshl_b32 s5, s5, 6
    s_add_u32 s72, s72, s5
    s_add_u32 s72, s72, 0x1060000
    s_mov_b32 s80, 0x00010001
    s_mov_b32 s81, 0x00010001
    s_lshl_b32 s73, s63, 5
    s_lshl_b32 s6, s62, 2
    s_add_u32 s73, s73, s6
    s_add_u32 s73, s73, s3
    s_lshl_b32 s73, s73, 2
    s_add_u32 s73, s73, 0x1020000
    s_lshl_b32 s4, s63, 7
    s_add_u32 s4, s4, 0x1020000
    s_add_u32 s5, s6, s3
    s_lshl_b32 s5, s5, 4
    s_add_u32 s5, s5, 0x1022000
    v_lshlrev_b32 v33, 2, v1
    v_and_b32 v34, 12, v33
    v_add_u32 v33, s4, v33
    v_add_u32_e64 v34, s5, v34
    v_cmp_gt_u32 vcc, 32, v1
    s_nop 1
    v_cndmask_b32 v33, v34, v33, vcc
    s_lshl_b32 s75, s63, 12
    s_add_u32 s75, s75, 0x1060000
    v_and_b32_e64 v35, 15, v1
    v_lshlrev_b32 v35, 3, v35
    s_lshl_b32 s76, s62, 11
    s_lshl_b32 s5, s3, 9
    s_add_u32 s76, s76, s5
    s_add_u32 s76, s76, 0x1000000
    s_and_b32 s34, s2, 63
    s_lshl_b32 s34, s34, 7
    s_add_u32 s34, s34, 0x1023000
WALKA_RET:
    s_mov_b64 exec, -1
    s_waitcnt vmcnt(8)
    s_barrier
    ds_read_b128 v[96:99], v10 offset:0
    ds_read_b128 v[100:103], v11 offset:0
    ds_read_b128 v[104:107], v10 offset:2048
    ds_read_b128 v[108:111], v11 offset:2048
    ds_read_b128 v[112:115], v10 offset:4096
    ds_read_b128 v[116:119], v11 offset:4096
    ds_read_b64_tr_b16 a[128:129], v12 offset:0
    ds_read_b64_tr_b16 a[130:131], v12 offset:256
    ds_read_b64_tr_b16 a[132:133], v12 offset:32
    ds_read_b64_tr_b16 a[134:135], v12 offset:288
    ds_read_b64_tr_b16 a[136:137], v12 offset:64
    ds_read_b64_tr_b16 a[138:139], v12 offset:320
    ds_read_b64_tr_b16 a[140:141], v12 offset:96
    ds_read_b64_tr_b16 a[142:143], v12 offset:352
    ds_read_b64_tr_b16 a[144:145], v12 offset:128
    ds_read_b64_tr_b16 a[146:147], v12 offset:384
    ds_read_b64_tr_b16 a[148:149], v12 offset:160
    ds_read_b64_tr_b16 a[150:151], v12 offset:416
    ds_read_b64_tr_b16 a[152:153], v12 offset:192
    ds_read_b64_tr_b16 a[154:155], v12 offset:448
    ds_read_b64_tr_b16 a[156:157], v12 offset:224
    ds_read_b64_tr_b16 a[158:159], v12 offset:480
    ds_read_b64_tr_b16 a[160:161], v12 offset:8448
    ds_read_b64_tr_b16 a[162:163], v12 offset:8704
    ds_read_b64_tr_b16 a[164:165], v12 offset:8480
    ds_read_b64_tr_b16 a[166:167], v12 offset:8736
    ds_read_b64_tr_b16 a[168:169], v12 offset:8512
    ds_read_b64_tr_b16 a[170:171], v12 offset:8768
    ds_read_b64_tr_b16 a[172:173], v12 offset:8544
    ds_read_b64_tr_b16 a[174:175], v12 offset:8800
    ds_read_b64_tr_b16 a[176:177], v12 offset:8576
    ds_read_b64_tr_b16 a[178:179], v12 offset:8832
    ds_read_b64_tr_b16 a[180:181], v12 offset:8608
    ds_read_b64_tr_b16 a[182:183], v12 offset:8864
    ds_read_b64_tr_b16 a[184:185], v12 offset:8640
    ds_read_b64_tr_b16 a[186:187], v12 offset:8896
    ds_read_b64_tr_b16 a[188:189], v12 offset:8672
    ds_read_b64_tr_b16 a[190:191], v12 offset:8928
    ds_read_b64_tr_b16 v[24:25], v13 offset:0
    ds_read_b64_tr_b16 v[26:27], v13 offset:256
    s_mov_b32 s7, 0
    s_waitcnt vmcnt(4) lgkmcnt(0)
    s_barrier
    v_mfma_f32_16x16x32_bf16 v[128:131], a[128:131], v[96:99], 0
    ds_read_b128 v[120:123], v10 offset:6144
    s_add_u32 m0, s30, 0x2400
    s_nop 0
    buffer_load_dwordx4 v2, s[8:11], s24 offen offset:0 lds
    v_mfma_f32_16x16x32_bf16 v[128:131], a[160:163], v[100:103], v[128:131]
    ds_read_b128 v[124:127], v11 offset:6144
    v_mfma_f32_16x16x32_bf16 v[132:135], a[164:167], v[100:103], 0
    buffer_load_dwordx4 v3, s[8:11], s24 offen offset:1024 lds
    v_mfma_f32_16x16x32_bf16 v[132:135], a[132:135], v[96:99], v[132:135]
    ds_read_b64_tr_b16 a[192:193], v12 offset:16896
    v_mfma_f32_16x16x32_bf16 v[136:139], a[136:139], v[96:99], 0
    ds_read_b64_tr_b16 a[194:195], v12 offset:17152
    v_mfma_f32_16x16x32_bf16 v[136:139], a[168:171], v[100:103], v[136:139]
    buffer_load_dwordx4 v2, s[8:11], s24 offen offset:2048 lds
    v_mfma_f32_16x16x32_bf16 v[140:143], a[172:175], v[100:103], 0
    ds_read_b64_tr_b16 a[196:197], v12 offset:16928
    v_mfma_f32_16x16x32_bf16 v[140:143], a[140:143], v[96:99], v[140:143]
    ds_read_b64_tr_b16 a[198:199], v12 offset:17184
    v_mfma_f32_16x16x32_bf16 v[144:147], a[144:147], v[96:99], 0
    buffer_load_dwordx4 v3, s[8:11], s24 offen offset:3072 lds
    v_mfma_f32_16x16x32_bf16 v[144:147], a[176:179], v[100:103], v[144:147]
    ds_read_b64_tr_b16 a[200:201], v12 offset:16960
    s_add_u32 s24, s24, 128
    v_mfma_f32_16x16x32_bf16 v[148:151], a[180:183], v[100:103], 0
    ds_read_b64_tr_b16 a[202:203], v12 offset:17216
    s_add_u32 m0, s30, 0x3400
    v_mfma_f32_16x16x32_bf16 v[148:151], a[148:151], v[96:99], v[148:151]
    buffer_load_dwordx4 v2, s[8:11], s35 offen offset:0 lds
    v_mfma_f32_16x16x32_bf16 v[152:155], a[152:155], v[96:99], 0
    ds_read_b64_tr_b16 a[204:205], v12 offset:16992
    v_mfma_f32_16x16x32_bf16 v[152:155], a[184:187], v[100:103], v[152:155]
    ds_read_b64_tr_b16 a[206:207], v12 offset:17248
    v_mfma_f32_16x16x32_bf16 v[156:159], a[188:191], v[100:103], 0
    buffer_load_dwordx4 v3, s[8:11], s35 offen offset:1024 lds
    v_mfma_f32_16x16x32_bf16 v[156:159], a[156:159], v[96:99], v[156:159]
    ds_read_b64_tr_b16 a[208:209], v12 offset:17024
    v_mfma_f32_16x16x32_bf16 v[160:163], a[128:131], v[104:107], 0
    buffer_load_dwordx4 v2, s[8:11], s35 offen offset:2048 lds
    v_mfma_f32_16x16x32_bf16 v[160:163], a[160:163], v[108:111], v[160:163]
    ds_read_b64_tr_b16 a[210:211], v12 offset:17280
    v_mfma_f32_16x16x32_bf16 v[164:167], a[164:167], v[108:111], 0
    ds_read_b64_tr_b16 a[212:213], v12 offset:17056
    v_mfma_f32_16x16x32_bf16 v[164:167], a[132:135], v[104:107], v[164:167]
    buffer_load_dwordx4 v3, s[8:11], s35 offen offset:3072 lds
    v_mfma_f32_16x16x32_bf16 v[20:23], v[24:27], v[16:19], 0
    ds_read_b64_tr_b16 a[214:215], v12 offset:17312
    s_add_u32 s35, s35, 128
    v_mfma_f32_16x16x32_bf16 v[168:171], a[136:139], v[104:107], 0
    ds_read_b64_tr_b16 a[216:217], v12 offset:17088
    s_add_u32 m0, s31, 0xc600
    v_mfma_f32_16x16x32_bf16 v[168:171], a[168:171], v[108:111], v[168:171]
    buffer_load_dwordx4 v6, s[16:19], s25 offen offset:0 lds
    v_mfma_f32_16x16x32_bf16 v[172:175], a[172:175], v[108:111], 0
    ds_read_b64_tr_b16 a[218:219], v12 offset:17344
    v_mfma_f32_16x16x32_bf16 v[172:175], a[140:143], v[104:107], v[172:175]
    ds_read_b64_tr_b16 a[220:221], v12 offset:17120
    v_mfma_f32_16x16x32_bf16 v[176:179], a[144:147], v[104:107], 0
    buffer_load_dwordx4 v7, s[16:19], s25 offen offset:1056 lds
    v_mfma_f32_16x16x32_bf16 v[176:179], a[176:179], v[108:111], v[176:179]
    ds_read_b64_tr_b16 a[222:223], v12 offset:17376
    v_mfma_f32_16x16x32_bf16 v[180:183], a[180:183], v[108:111], 0
    ds_read_b64_tr_b16 a[224:225], v12 offset:25344
    buffer_load_dwordx4 v8, s[16:19], s25 offen offset:2112 lds
    v_mfma_f32_16x16x32_bf16 v[180:183], a[148:151], v[104:107], v[180:183]
    ds_read_b64_tr_b16 a[226:227], v12 offset:25600
    v_mfma_f32_16x16x32_bf16 v[184:187], a[152:155], v[104:107], 0
    buffer_load_dwordx4 v9, s[16:19], s25 offen offset:3168 lds
    v_mfma_f32_16x16x32_bf16 v[184:187], a[184:187], v[108:111], v[184:187]
    ds_read_b64_tr_b16 a[228:229], v12 offset:25376
    s_and_b32 s4, s33, 7
    s_mul_i32 s5, s4, 0xe0000
    s_add_u32 s25, s28, s5
    s_lshl_b32 s4, s4, 8
    s_add_u32 s24, s27, s4
    s_add_u32 s35, s24, 0x10000
    s_add_u32 s33, s33, 1
    v_mfma_f32_16x16x32_bf16 v[188:191], a[188:191], v[108:111], 0
    ds_read_b64_tr_b16 a[230:231], v12 offset:25632
    s_add_u32 m0, s31, 0x0
    v_mfma_f32_16x16x32_bf16 v[188:191], a[156:159], v[104:107], v[188:191]
    buffer_load_dwordx4 v6, s[12:15], s25 offen offset:0 lds
    v_mfma_f32_16x16x32_bf16 v[192:195], a[128:131], v[112:115], 0
    ds_read_b64_tr_b16 a[232:233], v12 offset:25408
    v_mfma_f32_16x16x32_bf16 v[192:195], a[160:163], v[116:119], v[192:195]
    ds_read_b64_tr_b16 a[234:235], v12 offset:25664
    v_mfma_f32_16x16x32_bf16 v[196:199], a[164:167], v[116:119], 0
    buffer_load_dwordx4 v7, s[12:15], s25 offen offset:1056 lds
    v_mfma_f32_16x16x32_bf16 v[196:199], a[132:135], v[112:115], v[196:199]
    ds_read_b64_tr_b16 a[236:237], v12 offset:25440
    v_mfma_f32_16x16x32_bf16 v[200:203], a[136:139], v[112:115], 0
    ds_read_b64_tr_b16 a[238:239], v12 offset:25696
    v_mfma_f32_16x16x32_bf16 v[200:203], a[168:171], v[116:119], v[200:203]
    buffer_load_dwordx4 v8, s[12:15], s25 offen offset:2112 lds
    v_mfma_f32_16x16x32_bf16 v[204:207], a[172:175], v[116:119], 0
    ds_read_b64_tr_b16 a[240:241], v12 offset:25472
    v_mfma_f32_16x16x32_bf16 v[204:207], a[140:143], v[112:115], v[204:207]
    ds_read_b64_tr_b16 a[242:243], v12 offset:25728
    v_mfma_f32_16x16x32_bf16 v[208:211], a[144:147], v[112:115], 0
    buffer_load_dwordx4 v9, s[12:15], s25 offen offset:3168 lds
    v_mfma_f32_16x16x32_bf16 v[208:211], a[176:179], v[116:119], v[208:211]
    ds_read_b64_tr_b16 a[244:245], v12 offset:25504
    s_add_u32 m0, s30, 0x0
    v_mfma_f32_16x16x32_bf16 v[212:215], a[180:183], v[116:119], 0
    s_waitcnt lgkmcnt(15)
    buffer_load_dwordx4 v2, s[8:11], s24 offen offset:0 lds
    v_mfma_f32_16x16x32_bf16 v[212:215], a[148:151], v[112:115], v[212:215]
    ds_read_b64_tr_b16 a[246:247], v12 offset:25760
    v_mfma_f32_16x16x32_bf16 v[216:219], a[152:155], v[112:115], 0
    ds_read_b64_tr_b16 a[248:249], v12 offset:25536
    v_mfma_f32_16x16x32_bf16 v[216:219], a[184:187], v[116:119], v[216:219]
    buffer_load_dwordx4 v3, s[8:11], s24 offen offset:1024 lds
    v_mfma_f32_16x16x32_bf16 v[220:223], a[188:191], v[116:119], 0
    ds_read_b64_tr_b16 a[250:251], v12 offset:25792
    v_mfma_f32_16x16x32_bf16 v[220:223], a[156:159], v[112:115], v[220:223]
    ds_read_b64_tr_b16 a[252:253], v12 offset:25568
    v_mfma_f32_16x16x32_bf16 v[224:227], a[128:131], v[120:123], 0
    buffer_load_dwordx4 v2, s[8:11], s24 offen offset:2048 lds
    v_mfma_f32_16x16x32_bf16 v[224:227], a[160:163], v[124:127], v[224:227]
    ds_read_b64_tr_b16 a[254:255], v12 offset:25824
    v_mfma_f32_16x16x32_bf16 v[228:231], a[164:167], v[124:127], 0
    ds_read_b64_tr_b16 v[28:29], v13 offset:16896
    v_mfma_f32_16x16x32_bf16 v[228:231], a[132:135], v[120:123], v[228:231]
    buffer_load_dwordx4 v3, s[8:11], s24 offen offset:3072 lds
    v_mfma_f32_16x16x32_bf16 v[232:235], a[136:139], v[120:123], 0
    ds_read_b64_tr_b16 v[30:31], v13 offset:17152
    s_add_u32 s24, s24, 128
    v_mfma_f32_16x16x32_bf16 v[232:235], a[168:171], v[124:127], v[232:235]
    v_mfma_f32_16x16x32_bf16 v[236:239], a[172:175], v[124:127], 0
    v_mfma_f32_16x16x32_bf16 v[236:239], a[140:143], v[120:123], v[236:239]
    v_mfma_f32_16x16x32_bf16 v[240:243], a[144:147], v[120:123], 0
    v_mfma_f32_16x16x32_bf16 v[240:243], a[176:179], v[124:127], v[240:243]
    v_mfma_f32_16x16x32_bf16 v[244:247], a[180:183], v[124:127], 0
    v_mfma_f32_16x16x32_bf16 v[244:247], a[148:151], v[120:123], v[244:247]
    v_mfma_f32_16x16x32_bf16 v[248:251], a[152:155], v[120:123], 0
    v_mfma_f32_16x16x32_bf16 v[248:251], a[184:187], v[124:127], v[248:251]
    v_mfma_f32_16x16x32_bf16 v[252:255], a[188:191], v[124:127], 0
    v_mfma_f32_16x16x32_bf16 v[252:255], a[156:159], v[120:123], v[252:255]
    s_waitcnt vmcnt(20) lgkmcnt(0)
    s_barrier
    v_mfma_f32_16x16x32_bf16 a[0:3], a[192:195], v[96:99], 0
    ds_read_b64_tr_b16 a[128:129], v12 offset:33792
    v_mfma_f32_16x16x32_bf16 a[0:3], a[224:227], v[100:103], a[0:3]
    ds_read_b64_tr_b16 a[130:131], v12 offset:34048
    s_add_u32 m0, s30, 0x1000
    v_mfma_f32_16x16x32_bf16 a[4:7], a[228:231], v[100:103], 0
    buffer_load_dwordx4 v2, s[8:11], s35 offen offset:0 lds
    v_mfma_f32_16x16x32_bf16 a[4:7], a[196:199], v[96:99], a[4:7]
    ds_read_b64_tr_b16 a[132:133], v12 offset:33824
    v_mfma_f32_16x16x32_bf16 a[8:11], a[200:203], v[96:99], 0
    ds_read_b64_tr_b16 a[134:135], v12 offset:34080
    v_mfma_f32_16x16x32_bf16 a[8:11], a[232:235], v[100:103], a[8:11]
    ds_read_b64_tr_b16 a[136:137], v12 offset:33856
    v_mfma_f32_16x16x32_bf16 a[12:15], a[236:239], v[100:103], 0
    v_mfma_f32_16x16x32_bf16 a[12:15], a[204:207], v[96:99], a[12:15]
    ds_read_b64_tr_b16 a[138:139], v12 offset:34112
    v_mfma_f32_16x16x32_bf16 a[16:19], a[208:211], v[96:99], 0
    buffer_load_dwordx4 v3, s[8:11], s35 offen offset:1024 lds
    v_mfma_f32_16x16x32_bf16 a[16:19], a[240:243], v[100:103], a[16:19]
    ds_read_b64_tr_b16 a[140:141], v12 offset:33888
    v_mfma_f32_16x16x32_bf16 a[20:23], a[244:247], v[100:103], 0
    ds_read_b64_tr_b16 a[142:143], v12 offset:34144
    v_mfma_f32_16x16x32_bf16 a[20:23], a[212:215], v[96:99], a[20:23]
    ds_read_b64_tr_b16 a[144:145], v12 offset:33920
    v_mfma_f32_16x16x32_bf16 a[24:27], a[216:219], v[96:99], 0
    ds_read_b64_tr_b16 a[146:147], v12 offset:34176
    v_mfma_f32_16x16x32_bf16 a[24:27], a[248:251], v[100:103], a[24:27]
    v_mfma_f32_16x16x32_bf16 a[28:31], a[252:255], v[100:103], 0
    ds_read_b64_tr_b16 a[148:149], v12 offset:33952
    v_mfma_f32_16x16x32_bf16 a[28:31], a[220:223], v[96:99], a[28:31]
    buffer_load_dwordx4 v2, s[8:11], s35 offen offset:2048 lds
    v_mfma_f32_16x16x32_bf16 a[32:35], a[192:195], v[104:107], 0
    ds_read_b64_tr_b16 a[150:151], v12 offset:34208
    v_mfma_f32_16x16x32_bf16 a[32:35], a[224:227], v[108:111], a[32:35]
    ds_read_b64_tr_b16 a[152:153], v12 offset:33984
    v_mfma_f32_16x16x32_bf16 a[36:39], a[228:231], v[108:111], 0
    ds_read_b64_tr_b16 a[154:155], v12 offset:34240
    v_mfma_f32_16x16x32_bf16 a[36:39], a[196:199], v[104:107], a[36:39]
    ds_read_b64_tr_b16 a[156:157], v12 offset:34016
    v_mfma_f32_16x16x32_bf16 v[40:43], v[28:31], v[16:19], 0
    v_mfma_f32_16x16x32_bf16 a[40:43], a[200:203], v[104:107], 0
    buffer_load_dwordx4 v3, s[8:11], s35 offen offset:3072 lds
    v_mfma_f32_16x16x32_bf16 a[40:43], a[232:235], v[108:111], a[40:43]
    ds_read_b64_tr_b16 a[158:159], v12 offset:34272
    s_add_u32 s35, s35, 128
    v_mfma_f32_16x16x32_bf16 a[44:47], a[236:239], v[108:111], 0
    ds_read_b64_tr_b16 a[160:161], v12 offset:42240
    v_mfma_f32_16x16x32_bf16 a[44:47], a[204:207], v[104:107], a[44:47]
    ds_read_b64_tr_b16 a[162:163], v12 offset:42496
    v_mfma_f32_16x16x32_bf16 a[48:51], a[208:211], v[104:107], 0
    ds_read_b64_tr_b16 a[164:165], v12 offset:42272
    s_add_u32 m0, s31, 0x4200
    v_mfma_f32_16x16x32_bf16 a[48:51], a[240:243], v[108:111], a[48:51]
    buffer_load_dwordx4 v6, s[16:19], s25 offen offset:0 lds
    v_mfma_f32_16x16x32_bf16 a[52:55], a[244:247], v[108:111], 0
    v_mfma_f32_16x16x32_bf16 a[52:55], a[212:215], v[104:107], a[52:55]
    ds_read_b64_tr_b16 a[166:167], v12 offset:42528
    v_mfma_f32_16x16x32_bf16 a[56:59], a[216:219], v[104:107], 0
    ds_read_b64_tr_b16 a[168:169], v12 offset:42304
    v_mfma_f32_16x16x32_bf16 a[56:59], a[248:251], v[108:111], a[56:59]
    ds_read_b64_tr_b16 a[170:171], v12 offset:42560
    v_mfma_f32_16x16x32_bf16 a[60:63], a[252:255], v[108:111], 0
    ds_read_b64_tr_b16 a[172:173], v12 offset:42336
    v_mfma_f32_16x16x32_bf16 a[60:63], a[220:223], v[104:107], a[60:63]
    buffer_load_dwordx4 v7, s[16:19], s25 offen offset:1056 lds
    v_mfma_f32_16x16x32_bf16 a[64:67], a[192:195], v[112:115], 0
    ds_read_b64_tr_b16 a[174:175], v12 offset:42592
    v_mfma_f32_16x16x32_bf16 a[64:67], a[224:227], v[116:119], a[64:67]
    v_mfma_f32_16x16x32_bf16 a[68:71], a[228:231], v[116:119], 0
    ds_read_b64_tr_b16 a[176:177], v12 offset:42368
    v_mfma_f32_16x16x32_bf16 a[68:71], a[196:199], v[112:115], a[68:71]
    ds_read_b64_tr_b16 a[178:179], v12 offset:42624
    v_mfma_f32_16x16x32_bf16 a[72:75], a[200:203], v[112:115], 0
    ds_read_b64_tr_b16 a[180:181], v12 offset:42400
    v_mfma_f32_16x16x32_bf16 a[72:75], a[232:235], v[116:119], a[72:75]
    ds_read_b64_tr_b16 a[182:183], v12 offset:42656
    v_mfma_f32_16x16x32_bf16 a[76:79], a[236:239], v[116:119], 0
    buffer_load_dwordx4 v8, s[16:19], s25 offen offset:2112 lds
    v_mfma_f32_16x16x32_bf16 a[76:79], a[204:207], v[112:115], a[76:79]
    ds_read_b64_tr_b16 a[184:185], v12 offset:42432
    v_mfma_f32_16x16x32_bf16 a[80:83], a[208:211], v[112:115], 0
    v_mfma_f32_16x16x32_bf16 a[80:83], a[240:243], v[116:119], a[80:83]
    ds_read_b64_tr_b16 a[186:187], v12 offset:42688
    v_mfma_f32_16x16x32_bf16 a[84:87], a[244:247], v[116:119], 0
    ds_read_b64_tr_b16 a[188:189], v12 offset:42464
    v_mfma_f32_16x16x32_bf16 a[84:87], a[212:215], v[112:115], a[84:87]
    ds_read_b64_tr_b16 a[190:191], v12 offset:42720
    v_mfma_f32_16x16x32_bf16 a[88:91], a[216:219], v[112:115], 0
    buffer_load_dwordx4 v9, s[16:19], s25 offen offset:3168 lds
    v_mfma_f32_16x16x32_bf16 a[88:91], a[248:251], v[116:119], a[88:91]
    ds_read_b64_tr_b16 v[24:25], v13 offset:33792
    s_add_u32 s25, s25, 0x70000
    v_mfma_f32_16x16x32_bf16 a[92:95], a[252:255], v[116:119], 0
    ds_read_b64_tr_b16 v[26:27], v13 offset:34048
    v_mfma_f32_16x16x32_bf16 a[92:95], a[220:223], v[112:115], a[92:95]
    v_mfma_f32_16x16x32_bf16 a[96:99], a[192:195], v[120:123], 0
    s_waitcnt vmcnt(20)
    ds_read_b128 v[96:99], v10 offset:9216
    v_mfma_f32_16x16x32_bf16 a[96:99], a[224:227], v[124:127], a[96:99]
    ds_read_b128 v[100:103], v11 offset:9216
    v_mfma_f32_16x16x32_bf16 a[100:103], a[228:231], v[124:127], 0
    ds_read_b128 v[104:107], v10 offset:11264
    v_mfma_f32_16x16x32_bf16 a[100:103], a[196:199], v[120:123], a[100:103]
    ds_read_b128 v[108:111], v11 offset:11264
    v_mfma_f32_16x16x32_bf16 a[104:107], a[200:203], v[120:123], 0
    ds_read_b128 v[112:115], v10 offset:13312
    v_mfma_f32_16x16x32_bf16 a[104:107], a[232:235], v[124:127], a[104:107]
    ds_read_b128 v[116:119], v11 offset:13312
    v_mfma_f32_16x16x32_bf16 a[108:111], a[236:239], v[124:127], 0
    v_mfma_f32_16x16x32_bf16 a[108:111], a[204:207], v[120:123], a[108:111]
    v_mfma_f32_16x16x32_bf16 a[112:115], a[208:211], v[120:123], 0
    v_mfma_f32_16x16x32_bf16 a[112:115], a[240:243], v[124:127], a[112:115]
    v_mfma_f32_16x16x32_bf16 a[116:119], a[244:247], v[124:127], 0
    v_mfma_f32_16x16x32_bf16 a[116:119], a[212:215], v[120:123], a[116:119]
    v_mfma_f32_16x16x32_bf16 a[120:123], a[216:219], v[120:123], 0
    v_mfma_f32_16x16x32_bf16 a[120:123], a[248:251], v[124:127], a[120:123]
    v_mfma_f32_16x16x32_bf16 a[124:127], a[252:255], v[124:127], 0
    v_mfma_f32_16x16x32_bf16 a[124:127], a[220:223], v[120:123], a[124:127]
    s_branch G1_S1
.p2align 3
G1_LOOP:
    s_waitcnt vmcnt(16) lgkmcnt(0)
    s_barrier
    v_mfma_f32_16x16x32_bf16 v[128:131], a[128:131], v[96:99], v[128:131]
    ds_read_b128 v[120:123], v10 offset:6144
    v_mfma_f32_16x16x32_bf16 v[128:131], a[160:163], v[100:103], v[128:131]
    ds_read_b128 v[124:127], v11 offset:6144
    s_add_u32 m0, s31, 0x0
    v_mfma_f32_16x16x32_bf16 v[132:135], a[164:167], v[100:103], v[132:135]
    buffer_load_dwordx4 v6, s[12:15], s25 offen offset:0 lds
    v_mfma_f32_16x16x32_bf16 v[132:135], a[132:135], v[96:99], v[132:135]
    ds_read_b64_tr_b16 a[192:193], v12 offset:16896
    v_mfma_f32_16x16x32_bf16 v[136:139], a[136:139], v[96:99], v[136:139]
    ds_read_b64_tr_b16 a[194:195], v12 offset:17152
    v_mfma_f32_16x16x32_bf16 v[136:139], a[168:171], v[100:103], v[136:139]
    v_mfma_f32_16x16x32_bf16 v[140:143], a[172:175], v[100:103], v[140:143]
    ds_read_b64_tr_b16 a[196:197], v12 offset:16928
    v_mfma_f32_16x16x32_bf16 v[140:143], a[140:143], v[96:99], v[140:143]
    ds_read_b64_tr_b16 a[198:199], v12 offset:17184
    v_mfma_f32_16x16x32_bf16 v[144:147], a[144:147], v[96:99], v[144:147]
    ds_read_b64_tr_b16 a[200:201], v12 offset:16960
    v_mfma_f32_16x16x32_bf16 v[144:147], a[176:179], v[100:103], v[144:147]
    buffer_load_dwordx4 v7, s[12:15], s25 offen offset:1056 lds
    v_mfma_f32_16x16x32_bf16 v[148:151], a[180:183], v[100:103], v[148:151]
    v_mfma_f32_16x16x32_bf16 v[148:151], a[148:151], v[96:99], v[148:151]
    ds_read_b64_tr_b16 a[202:203], v12 offset:17216
    v_mfma_f32_16x16x32_bf16 v[152:155], a[152:155], v[96:99], v[152:155]
    ds_read_b64_tr_b16 a[204:205], v12 offset:16992
    v_mfma_f32_16x16x32_bf16 v[152:155], a[184:187], v[100:103], v[152:155]
    ds_read_b64_tr_b16 a[206:207], v12 offset:17248
    v_mfma_f32_16x16x32_bf16 v[156:159], a[188:191], v[100:103], v[156:159]
    ds_read_b64_tr_b16 a[208:209], v12 offset:17024
    v_mfma_f32_16x16x32_bf16 v[156:159], a[156:159], v[96:99], v[156:159]
    buffer_load_dwordx4 v8, s[12:15], s25 offen offset:2112 lds
    v_mfma_f32_16x16x32_bf16 v[160:163], a[128:131], v[104:107], v[160:163]
    v_mfma_f32_16x16x32_bf16 v[160:163], a[160:163], v[108:111], v[160:163]
    ds_read_b64_tr_b16 a[210:211], v12 offset:17280
    v_mfma_f32_16x16x32_bf16 v[164:167], a[164:167], v[108:111], v[164:167]
    ds_read_b64_tr_b16 a[212:213], v12 offset:17056
    v_mfma_f32_16x16x32_bf16 v[164:167], a[132:135], v[104:107], v[164:167]
    ds_read_b64_tr_b16 a[214:215], v12 offset:17312
    v_mfma_f32_16x16x32_bf16 v[20:23], v[24:27], v[16:19], v[20:23]
    ds_read_b64_tr_b16 a[216:217], v12 offset:17088
    v_mfma_f32_16x16x32_bf16 v[168:171], a[136:139], v[104:107], v[168:171]
    v_mfma_f32_16x16x32_bf16 v[168:171], a[168:171], v[108:111], v[168:171]
    ds_read_b64_tr_b16 a[218:219], v12 offset:17344
    v_mfma_f32_16x16x32_bf16 v[172:175], a[172:175], v[108:111], v[172:175]
    buffer_load_dwordx4 v9, s[12:15], s25 offen offset:3168 lds
    v_mfma_f32_16x16x32_bf16 v[172:175], a[140:143], v[104:107], v[172:175]
    ds_read_b64_tr_b16 a[220:221], v12 offset:17120
    v_mfma_f32_16x16x32_bf16 v[176:179], a[144:147], v[104:107], v[176:179]
    ds_read_b64_tr_b16 a[222:223], v12 offset:17376
    v_mfma_f32_16x16x32_bf16 v[176:179], a[176:179], v[108:111], v[176:179]
    v_mfma_f32_16x16x32_bf16 v[180:183], a[180:183], v[108:111], v[180:183]
    ds_read_b64_tr_b16 a[224:225], v12 offset:25344
    v_mfma_f32_16x16x32_bf16 v[180:183], a[148:151], v[104:107], v[180:183]
    ds_read_b64_tr_b16 a[226:227], v12 offset:25600
    s_add_u32 m0, s30, 0x0
    v_mfma_f32_16x16x32_bf16 v[184:187], a[152:155], v[104:107], v[184:187]
    s_waitcnt lgkmcnt(15)
    buffer_load_dwordx4 v2, s[8:11], s24 offen offset:0 lds
    v_mfma_f32_16x16x32_bf16 v[184:187], a[184:187], v[108:111], v[184:187]
    ds_read_b64_tr_b16 a[228:229], v12 offset:25376
    v_mfma_f32_16x16x32_bf16 v[188:191], a[188:191], v[108:111], v[188:191]
    ds_read_b64_tr_b16 a[230:231], v12 offset:25632
    v_mfma_f32_16x16x32_bf16 v[188:191], a[156:159], v[104:107], v[188:191]
    v_mfma_f32_16x16x32_bf16 v[192:195], a[128:131], v[112:115], v[192:195]
    ds_read_b64_tr_b16 a[232:233], v12 offset:25408
    v_mfma_f32_16x16x32_bf16 v[192:195], a[160:163], v[116:119], v[192:195]
    ds_read_b64_tr_b16 a[234:235], v12 offset:25664
    v_mfma_f32_16x16x32_bf16 v[196:199], a[164:167], v[116:119], v[196:199]
    ds_read_b64_tr_b16 a[236:237], v12 offset:25440
    v_mfma_f32_16x16x32_bf16 v[196:199], a[132:135], v[112:115], v[196:199]
    buffer_load_dwordx4 v3, s[8:11], s24 offen offset:1024 lds
    v_mfma_f32_16x16x32_bf16 v[200:203], a[136:139], v[112:115], v[200:203]
    v_mfma_f32_16x16x32_bf16 v[200:203], a[168:171], v[116:119], v[200:203]
    ds_read_b64_tr_b16 a[238:239], v12 offset:25696
    v_mfma_f32_16x16x32_bf16 v[204:207], a[172:175], v[116:119], v[204:207]
    ds_read_b64_tr_b16 a[240:241], v12 offset:25472
    v_mfma_f32_16x16x32_bf16 v[204:207], a[140:143], v[112:115], v[204:207]
    ds_read_b64_tr_b16 a[242:243], v12 offset:25728
    v_mfma_f32_16x16x32_bf16 v[208:211], a[144:147], v[112:115], v[208:211]
    ds_read_b64_tr_b16 a[244:245], v12 offset:25504
    v_mfma_f32_16x16x32_bf16 v[208:211], a[176:179], v[116:119], v[208:211]
    buffer_load_dwordx4 v2, s[8:11], s24 offen offset:2048 lds
    v_mfma_f32_16x16x32_bf16 v[212:215], a[180:183], v[116:119], v[212:215]
    v_mfma_f32_16x16x32_bf16 v[212:215], a[148:151], v[112:115], v[212:215]
    ds_read_b64_tr_b16 a[246:247], v12 offset:25760
    v_mfma_f32_16x16x32_bf16 v[216:219], a[152:155], v[112:115], v[216:219]
    ds_read_b64_tr_b16 a[248:249], v12 offset:25536
    v_mfma_f32_16x16x32_bf16 v[216:219], a[184:187], v[116:119], v[216:219]
    ds_read_b64_tr_b16 a[250:251], v12 offset:25792
    v_mfma_f32_16x16x32_bf16 v[220:223], a[188:191], v[116:119], v[220:223]
    ds_read_b64_tr_b16 a[252:253], v12 offset:25568
    v_mfma_f32_16x16x32_bf16 v[220:223], a[156:159], v[112:115], v[220:223]
    v_mfma_f32_16x16x32_bf16 v[224:227], a[128:131], v[120:123], v[224:227]
    ds_read_b64_tr_b16 a[254:255], v12 offset:25824
    v_mfma_f32_16x16x32_bf16 v[224:227], a[160:163], v[124:127], v[224:227]
    buffer_load_dwordx4 v3, s[8:11], s24 offen offset:3072 lds
    v_mfma_f32_16x16x32_bf16 v[228:231], a[164:167], v[124:127], v[228:231]
    ds_read_b64_tr_b16 v[28:29], v13 offset:16896
    s_add_u32 s24, s24, 128
    v_mfma_f32_16x16x32_bf16 v[228:231], a[132:135], v[120:123], v[228:231]
    ds_read_b64_tr_b16 v[30:31], v13 offset:17152
    v_mfma_f32_16x16x32_bf16 v[232:235], a[136:139], v[120:123], v[232:235]
    v_mfma_f32_16x16x32_bf16 v[232:235], a[168:171], v[124:127], v[232:235]
    v_mfma_f32_16x16x32_bf16 v[236:239], a[172:175], v[124:127], v[236:239]
    v_mfma_f32_16x16x32_bf16 v[236:239], a[140:143], v[120:123], v[236:239]
    v_mfma_f32_16x16x32_bf16 v[240:243], a[144:147], v[120:123], v[240:243]
    v_mfma_f32_16x16x32_bf16 v[240:243], a[176:179], v[124:127], v[240:243]
    v_mfma_f32_16x16x32_bf16 v[244:247], a[180:183], v[124:127], v[244:247]
    v_mfma_f32_16x16x32_bf16 v[244:247], a[148:151], v[120:123], v[244:247]
    v_mfma_f32_16x16x32_bf16 v[248:251], a[152:155], v[120:123], v[248:251]
    v_mfma_f32_16x16x32_bf16 v[248:251], a[184:187], v[124:127], v[248:251]
    v_mfma_f32_16x16x32_bf16 v[252:255], a[188:191], v[124:127], v[252:255]
    v_mfma_f32_16x16x32_bf16 v[252:255], a[156:159], v[120:123], v[252:255]
    s_waitcnt vmcnt(20) lgkmcnt(0)
    s_barrier
    v_mfma_f32_16x16x32_bf16 a[0:3], a[192:195], v[96:99], a[0:3]
    ds_read_b64_tr_b16 a[128:129], v12 offset:33792
    v_mfma_f32_16x16x32_bf16 a[0:3], a[224:227], v[100:103], a[0:3]
    ds_read_b64_tr_b16 a[130:131], v12 offset:34048
    s_add_u32 m0, s30, 0x1000
    v_mfma_f32_16x16x32_bf16 a[4:7], a[228:231], v[100:103], a[4:7]
    buffer_load_dwordx4 v2, s[8:11], s35 offen offset:0 lds
    v_mfma_f32_16x16x32_bf16 a[4:7], a[196:199], v[96:99], a[4:7]
    ds_read_b64_tr_b16 a[132:133], v12 offset:33824
    v_mfma_f32_16x16x32_bf16 a[8:11], a[200:203], v[96:99], a[8:11]
    ds_read_b64_tr_b16 a[134:135], v12 offset:34080
    v_mfma_f32_16x16x32_bf16 a[8:11], a[232:235], v[100:103], a[8:11]
    ds_read_b64_tr_b16 a[136:137], v12 offset:33856
    v_mfma_f32_16x16x32_bf16 a[12:15], a[236:239], v[100:103], a[12:15]
    v_mfma_f32_16x16x32_bf16 a[12:15], a[204:207], v[96:99], a[12:15]
    ds_read_b64_tr_b16 a[138:139], v12 offset:34112
    v_mfma_f32_16x16x32_bf16 a[16:19], a[208:211], v[96:99], a[16:19]
    buffer_load_dwordx4 v3, s[8:11], s35 offen offset:1024 lds
    v_mfma_f32_16x16x32_bf16 a[16:19], a[240:243], v[100:103], a[16:19]
    ds_read_b64_tr_b16 a[140:141], v12 offset:33888
    v_mfma_f32_16x16x32_bf16 a[20:23], a[244:247], v[100:103], a[20:23]
    ds_read_b64_tr_b16 a[142:143], v12 offset:34144
    v_mfma_f32_16x16x32_bf16 a[20:23], a[212:215], v[96:99], a[20:23]
    ds_read_b64_tr_b16 a[144:145], v12 offset:33920
    v_mfma_f32_16x16x32_bf16 a[24:27], a[216:219], v[96:99], a[24:27]
    ds_read_b64_tr_b16 a[146:147], v12 offset:34176
    v_mfma_f32_16x16x32_bf16 a[24:27], a[248:251], v[100:103], a[24:27]
    v_mfma_f32_16x16x32_bf16 a[28:31], a[252:255], v[100:103], a[28:31]
    ds_read_b64_tr_b16 a[148:149], v12 offset:33952
    v_mfma_f32_16x16x32_bf16 a[28:31], a[220:223], v[96:99], a[28:31]
    buffer_load_dwordx4 v2, s[8:11], s35 offen offset:2048 lds
    v_mfma_f32_16x16x32_bf16 a[32:35], a[192:195], v[104:107], a[32:35]
    ds_read_b64_tr_b16 a[150:151], v12 offset:34208
    v_mfma_f32_16x16x32_bf16 a[32:35], a[224:227], v[108:111], a[32:35]
    ds_read_b64_tr_b16 a[152:153], v12 offset:33984
    v_mfma_f32_16x16x32_bf16 a[36:39], a[228:231], v[108:111], a[36:39]
    ds_read_b64_tr_b16 a[154:155], v12 offset:34240
    v_mfma_f32_16x16x32_bf16 a[36:39], a[196:199], v[104:107], a[36:39]
    ds_read_b64_tr_b16 a[156:157], v12 offset:34016
    v_mfma_f32_16x16x32_bf16 v[40:43], v[28:31], v[16:19], v[40:43]
    v_mfma_f32_16x16x32_bf16 a[40:43], a[200:203], v[104:107], a[40:43]
    buffer_load_dwordx4 v3, s[8:11], s35 offen offset:3072 lds
    v_mfma_f32_16x16x32_bf16 a[40:43], a[232:235], v[108:111], a[40:43]
    ds_read_b64_tr_b16 a[158:159], v12 offset:34272
    s_add_u32 s35, s35, 128
    v_mfma_f32_16x16x32_bf16 a[44:47], a[236:239], v[108:111], a[44:47]
    ds_read_b64_tr_b16 a[160:161], v12 offset:42240
    v_mfma_f32_16x16x32_bf16 a[44:47], a[204:207], v[104:107], a[44:47]
    ds_read_b64_tr_b16 a[162:163], v12 offset:42496
    v_mfma_f32_16x16x32_bf16 a[48:51], a[208:211], v[104:107], a[48:51]
    ds_read_b64_tr_b16 a[164:165], v12 offset:42272
    s_add_u32 m0, s31, 0x4200
    v_mfma_f32_16x16x32_bf16 a[48:51], a[240:243], v[108:111], a[48:51]
    buffer_load_dwordx4 v6, s[16:19], s25 offen offset:0 lds
    v_mfma_f32_16x16x32_bf16 a[52:55], a[244:247], v[108:111], a[52:55]
    v_mfma_f32_16x16x32_bf16 a[52:55], a[212:215], v[104:107], a[52:55]
    ds_read_b64_tr_b16 a[166:167], v12 offset:42528
    v_mfma_f32_16x16x32_bf16 a[56:59], a[216:219], v[104:107], a[56:59]
    ds_read_b64_tr_b16 a[168:169], v12 offset:42304
    v_mfma_f32_16x16x32_bf16 a[56:59], a[248:251], v[108:111], a[56:59]
    ds_read_b64_tr_b16 a[170:171], v12 offset:42560
    v_mfma_f32_16x16x32_bf16 a[60:63], a[252:255], v[108:111], a[60:63]
    ds_read_b64_tr_b16 a[172:173], v12 offset:42336
    v_mfma_f32_16x16x32_bf16 a[60:63], a[220:223], v[104:107], a[60:63]
    buffer_load_dwordx4 v7, s[16:19], s25 offen offset:1056 lds
    v_mfma_f32_16x16x32_bf16 a[64:67], a[192:195], v[112:115], a[64:67]
    ds_read_b64_tr_b16 a[174:175], v12 offset:42592
    v_mfma_f32_16x16x32_bf16 a[64:67], a[224:227], v[116:119], a[64:67]
    v_mfma_f32_16x16x32_bf16 a[68:71], a[228:231], v[116:119], a[68:71]
    ds_read_b64_tr_b16 a[176:177], v12 offset:42368
    v_mfma_f32_16x16x32_bf16 a[68:71], a[196:199], v[112:115], a[68:71]
    ds_read_b64_tr_b16 a[178:179], v12 offset:42624
    v_mfma_f32_16x16x32_bf16 a[72:75], a[200:203], v[112:115], a[72:75]
    ds_read_b64_tr_b16 a[180:181], v12 offset:42400
    v_mfma_f32_16x16x32_bf16 a[72:75], a[232:235], v[116:119], a[72:75]
    ds_read_b64_tr_b16 a[182:183], v12 offset:42656
    v_mfma_f32_16x16x32_bf16 a[76:79], a[236:239], v[116:119], a[76:79]
    buffer_load_dwordx4 v8, s[16:19], s25 offen offset:2112 lds
    v_mfma_f32_16x16x32_bf16 a[76:79], a[204:207], v[112:115], a[76:79]
    ds_read_b64_tr_b16 a[184:185], v12 offset:42432
    v_mfma_f32_16x16x32_bf16 a[80:83], a[208:211], v[112:115], a[80:83]
    v_mfma_f32_16x16x32_bf16 a[80:83], a[240:243], v[116:119], a[80:83]
    ds_read_b64_tr_b16 a[186:187], v12 offset:42688
    v_mfma_f32_16x16x32_bf16 a[84:87], a[244:247], v[116:119], a[84:87]
    ds_read_b64_tr_b16 a[188:189], v12 offset:42464
    v_mfma_f32_16x16x32_bf16 a[84:87], a[212:215], v[112:115], a[84:87]
    ds_read_b64_tr_b16 a[190:191], v12 offset:42720
    v_mfma_f32_16x16x32_bf16 a[88:91], a[216:219], v[112:115], a[88:91]
    buffer_load_dwordx4 v9, s[16:19], s25 offen offset:3168 lds
    v_mfma_f32_16x16x32_bf16 a[88:91], a[248:251], v[116:119], a[88:91]
    ds_read_b64_tr_b16 v[24:25], v13 offset:33792
    s_add_u32 s25, s25, 0x70000
    v_mfma_f32_16x16x32_bf16 a[92:95], a[252:255], v[116:119], a[92:95]
    ds_read_b64_tr_b16 v[26:27], v13 offset:34048
    v_mfma_f32_16x16x32_bf16 a[92:95], a[220:223], v[112:115], a[92:95]
    v_mfma_f32_16x16x32_bf16 a[96:99], a[192:195], v[120:123], a[96:99]
    s_waitcnt vmcnt(20)
    ds_read_b128 v[96:99], v10 offset:9216
    v_mfma_f32_16x16x32_bf16 a[96:99], a[224:227], v[124:127], a[96:99]
    ds_read_b128 v[100:103], v11 offset:9216
    v_mfma_f32_16x16x32_bf16 a[100:103], a[228:231], v[124:127], a[100:103]
    ds_read_b128 v[104:107], v10 offset:11264
    v_mfma_f32_16x16x32_bf16 a[100:103], a[196:199], v[120:123], a[100:103]
    ds_read_b128 v[108:111], v11 offset:11264
    v_mfma_f32_16x16x32_bf16 a[104:107], a[200:203], v[120:123], a[104:107]
    ds_read_b128 v[112:115], v10 offset:13312
    v_mfma_f32_16x16x32_bf16 a[104:107], a[232:235], v[124:127], a[104:107]
    ds_read_b128 v[116:119], v11 offset:13312
    v_mfma_f32_16x16x32_bf16 a[108:111], a[236:239], v[124:127], a[108:111]
    v_mfma_f32_16x16x32_bf16 a[108:111], a[204:207], v[120:123], a[108:111]
    v_mfma_f32_16x16x32_bf16 a[112:115], a[208:211], v[120:123], a[112:115]
    v_mfma_f32_16x16x32_bf16 a[112:115], a[240:243], v[124:127], a[112:115]
    v_mfma_f32_16x16x32_bf16 a[116:119], a[244:247], v[124:127], a[116:119]
    v_mfma_f32_16x16x32_bf16 a[116:119], a[212:215], v[120:123], a[116:119]
    v_mfma_f32_16x16x32_bf16 a[120:123], a[216:219], v[120:123], a[120:123]
    v_mfma_f32_16x16x32_bf16 a[120:123], a[248:251], v[124:127], a[120:123]
    v_mfma_f32_16x16x32_bf16 a[124:127], a[252:255], v[124:127], a[124:127]
    v_mfma_f32_16x16x32_bf16 a[124:127], a[220:223], v[120:123], a[124:127]
G1_S1:
    s_waitcnt vmcnt(16) lgkmcnt(0)
    s_barrier
    v_mfma_f32_16x16x32_bf16 v[128:131], a[128:131], v[96:99], v[128:131]
    ds_read_b128 v[120:123], v10 offset:15360
    v_mfma_f32_16x16x32_bf16 v[128:131], a[160:163], v[100:103], v[128:131]
    ds_read_b128 v[124:127], v11 offset:15360
    s_add_u32 m0, s31, 0x8400
    v_mfma_f32_16x16x32_bf16 v[132:135], a[164:167], v[100:103], v[132:135]
    buffer_load_dwordx4 v6, s[12:15], s25 offen offset:0 lds
    v_mfma_f32_16x16x32_bf16 v[132:135], a[132:135], v[96:99], v[132:135]
    ds_read_b64_tr_b16 a[192:193], v12 offset:50688
    v_mfma_f32_16x16x32_bf16 v[136:139], a[136:139], v[96:99], v[136:139]
    ds_read_b64_tr_b16 a[194:195], v12 offset:50944
    v_mfma_f32_16x16x32_bf16 v[136:139], a[168:171], v[100:103], v[136:139]
    v_mfma_f32_16x16x32_bf16 v[140:143], a[172:175], v[100:103], v[140:143]
    ds_read_b64_tr_b16 a[196:197], v12 offset:50720
    v_mfma_f32_16x16x32_bf16 v[140:143], a[140:143], v[96:99], v[140:143]
    ds_read_b64_tr_b16 a[198:199], v12 offset:50976
    v_mfma_f32_16x16x32_bf16 v[144:147], a[144:147], v[96:99], v[144:147]
    ds_read_b64_tr_b16 a[200:201], v12 offset:50752
    v_mfma_f32_16x16x32_bf16 v[144:147], a[176:179], v[100:103], v[144:147]
    buffer_load_dwordx4 v7, s[12:15], s25 offen offset:1056 lds
    v_mfma_f32_16x16x32_bf16 v[148:151], a[180:183], v[100:103], v[148:151]
    v_mfma_f32_16x16x32_bf16 v[148:151], a[148:151], v[96:99], v[148:151]
    ds_read_b64_tr_b16 a[202:203], v12 offset:51008
    v_mfma_f32_16x16x32_bf16 v[152:155], a[152:155], v[96:99], v[152:155]
    ds_read_b64_tr_b16 a[204:205], v12 offset:50784
    v_mfma_f32_16x16x32_bf16 v[152:155], a[184:187], v[100:103], v[152:155]
    ds_read_b64_tr_b16 a[206:207], v12 offset:51040
    v_mfma_f32_16x16x32_bf16 v[156:159], a[188:191], v[100:103], v[156:159]
    ds_read_b64_tr_b16 a[208:209], v12 offset:50816
    v_mfma_f32_16x16x32_bf16 v[156:159], a[156:159], v[96:99], v[156:159]
    buffer_load_dwordx4 v8, s[12:15], s25 offen offset:2112 lds
    v_mfma_f32_16x16x32_bf16 v[160:163], a[128:131], v[104:107], v[160:163]
    v_mfma_f32_16x16x32_bf16 v[160:163], a[160:163], v[108:111], v[160:163]
    ds_read_b64_tr_b16 a[210:211], v12 offset:51072
    v_mfma_f32_16x16x32_bf16 v[164:167], a[164:167], v[108:111], v[164:167]
    ds_read_b64_tr_b16 a[212:213], v12 offset:50848
    v_mfma_f32_16x16x32_bf16 v[164:167], a[132:135], v[104:107], v[164:167]
    ds_read_b64_tr_b16 a[214:215], v12 offset:51104
    v_mfma_f32_16x16x32_bf16 v[20:23], v[24:27], v[16:19], v[20:23]
    ds_read_b64_tr_b16 a[216:217], v12 offset:50880
    v_mfma_f32_16x16x32_bf16 v[168:171], a[136:139], v[104:107], v[168:171]
    v_mfma_f32_16x16x32_bf16 v[168:171], a[168:171], v[108:111], v[168:171]
    ds_read_b64_tr_b16 a[218:219], v12 offset:51136
    v_mfma_f32_16x16x32_bf16 v[172:175], a[172:175], v[108:111], v[172:175]
    buffer_load_dwordx4 v9, s[12:15], s25 offen offset:3168 lds
    v_mfma_f32_16x16x32_bf16 v[172:175], a[140:143], v[104:107], v[172:175]
    ds_read_b64_tr_b16 a[220:221], v12 offset:50912
    v_mfma_f32_16x16x32_bf16 v[176:179], a[144:147], v[104:107], v[176:179]
    ds_read_b64_tr_b16 a[222:223], v12 offset:51168
    v_mfma_f32_16x16x32_bf16 v[176:179], a[176:179], v[108:111], v[176:179]
    v_mfma_f32_16x16x32_bf16 v[180:183], a[180:183], v[108:111], v[180:183]
    ds_read_b64_tr_b16 a[224:225], v12 offset:59136
    v_mfma_f32_16x16x32_bf16 v[180:183], a[148:151], v[104:107], v[180:183]
    ds_read_b64_tr_b16 a[226:227], v12 offset:59392
    s_add_u32 m0, s30, 0x2400
    v_mfma_f32_16x16x32_bf16 v[184:187], a[152:155], v[104:107], v[184:187]
    s_waitcnt lgkmcnt(15)
    buffer_load_dwordx4 v2, s[8:11], s24 offen offset:0 lds
    v_mfma_f32_16x16x32_bf16 v[184:187], a[184:187], v[108:111], v[184:187]
    ds_read_b64_tr_b16 a[228:229], v12 offset:59168
    v_mfma_f32_16x16x32_bf16 v[188:191], a[188:191], v[108:111], v[188:191]
    ds_read_b64_tr_b16 a[230:231], v12 offset:59424
    v_mfma_f32_16x16x32_bf16 v[188:191], a[156:159], v[104:107], v[188:191]
    v_mfma_f32_16x16x32_bf16 v[192:195], a[128:131], v[112:115], v[192:195]
    ds_read_b64_tr_b16 a[232:233], v12 offset:59200
    v_mfma_f32_16x16x32_bf16 v[192:195], a[160:163], v[116:119], v[192:195]
    ds_read_b64_tr_b16 a[234:235], v12 offset:59456
    v_mfma_f32_16x16x32_bf16 v[196:199], a[164:167], v[116:119], v[196:199]
    ds_read_b64_tr_b16 a[236:237], v12 offset:59232
    v_mfma_f32_16x16x32_bf16 v[196:199], a[132:135], v[112:115], v[196:199]
    buffer_load_dwordx4 v3, s[8:11], s24 offen offset:1024 lds
    v_mfma_f32_16x16x32_bf16 v[200:203], a[136:139], v[112:115], v[200:203]
    v_mfma_f32_16x16x32_bf16 v[200:203], a[168:171], v[116:119], v[200:203]
    ds_read_b64_tr_b16 a[238:239], v12 offset:59488
    v_mfma_f32_16x16x32_bf16 v[204:207], a[172:175], v[116:119], v[204:207]
    ds_read_b64_tr_b16 a[240:241], v12 offset:59264
    v_mfma_f32_16x16x32_bf16 v[204:207], a[140:143], v[112:115], v[204:207]
    ds_read_b64_tr_b16 a[242:243], v12 offset:59520
    v_mfma_f32_16x16x32_bf16 v[208:211], a[144:147], v[112:115], v[208:211]
    ds_read_b64_tr_b16 a[244:245], v12 offset:59296
    v_mfma_f32_16x16x32_bf16 v[208:211], a[176:179], v[116:119], v[208:211]
    buffer_load_dwordx4 v2, s[8:11], s24 offen offset:2048 lds
    v_mfma_f32_16x16x32_bf16 v[212:215], a[180:183], v[116:119], v[212:215]
    v_mfma_f32_16x16x32_bf16 v[212:215], a[148:151], v[112:115], v[212:215]
    ds_read_b64_tr_b16 a[246:247], v12 offset:59552
    v_mfma_f32_16x16x32_bf16 v[216:219], a[152:155], v[112:115], v[216:219]
    ds_read_b64_tr_b16 a[248:249], v12 offset:59328
    v_mfma_f32_16x16x32_bf16 v[216:219], a[184:187], v[116:119], v[216:219]
    ds_read_b64_tr_b16 a[250:251], v12 offset:59584
    v_mfma_f32_16x16x32_bf16 v[220:223], a[188:191], v[116:119], v[220:223]
    ds_read_b64_tr_b16 a[252:253], v12 offset:59360
    v_mfma_f32_16x16x32_bf16 v[220:223], a[156:159], v[112:115], v[220:223]
    v_mfma_f32_16x16x32_bf16 v[224:227], a[128:131], v[120:123], v[224:227]
    ds_read_b64_tr_b16 a[254:255], v12 offset:59616
    v_mfma_f32_16x16x32_bf16 v[224:227], a[160:163], v[124:127], v[224:227]
    buffer_load_dwordx4 v3, s[8:11], s24 offen offset:3072 lds
    v_mfma_f32_16x16x32_bf16 v[228:231], a[164:167], v[124:127], v[228:231]
    ds_read_b64_tr_b16 v[28:29], v13 offset:50688
    s_add_u32 s24, s24, 128
    v_mfma_f32_16x16x32_bf16 v[228:231], a[132:135], v[120:123], v[228:231]
    ds_read_b64_tr_b16 v[30:31], v13 offset:50944
    v_mfma_f32_16x16x32_bf16 v[232:235], a[136:139], v[120:123], v[232:235]
    v_mfma_f32_16x16x32_bf16 v[232:235], a[168:171], v[124:127], v[232:235]
    v_mfma_f32_16x16x32_bf16 v[236:239], a[172:175], v[124:127], v[236:239]
    v_mfma_f32_16x16x32_bf16 v[236:239], a[140:143], v[120:123], v[236:239]
    v_mfma_f32_16x16x32_bf16 v[240:243], a[144:147], v[120:123], v[240:243]
    v_mfma_f32_16x16x32_bf16 v[240:243], a[176:179], v[124:127], v[240:243]
    v_mfma_f32_16x16x32_bf16 v[244:247], a[180:183], v[124:127], v[244:247]
    v_mfma_f32_16x16x32_bf16 v[244:247], a[148:151], v[120:123], v[244:247]
    v_mfma_f32_16x16x32_bf16 v[248:251], a[152:155], v[120:123], v[248:251]
    v_mfma_f32_16x16x32_bf16 v[248:251], a[184:187], v[124:127], v[248:251]
    v_mfma_f32_16x16x32_bf16 v[252:255], a[188:191], v[124:127], v[252:255]
    v_mfma_f32_16x16x32_bf16 v[252:255], a[156:159], v[120:123], v[252:255]
    s_waitcnt vmcnt(20) lgkmcnt(0)
    s_barrier
    v_mfma_f32_16x16x32_bf16 a[0:3], a[192:195], v[96:99], a[0:3]
    ds_read_b64_tr_b16 a[128:129], v12 offset:0
    v_mfma_f32_16x16x32_bf16 a[0:3], a[224:227], v[100:103], a[0:3]
    ds_read_b64_tr_b16 a[130:131], v12 offset:256
    s_add_u32 m0, s30, 0x3400
    v_mfma_f32_16x16x32_bf16 a[4:7], a[228:231], v[100:103], a[4:7]
    buffer_load_dwordx4 v2, s[8:11], s35 offen offset:0 lds
    v_mfma_f32_16x16x32_bf16 a[4:7], a[196:199], v[96:99], a[4:7]
    ds_read_b64_tr_b16 a[132:133], v12 offset:32
    v_mfma_f32_16x16x32_bf16 a[8:11], a[200:203], v[96:99], a[8:11]
    ds_read_b64_tr_b16 a[134:135], v12 offset:288
    v_mfma_f32_16x16x32_bf16 a[8:11], a[232:235], v[100:103], a[8:11]
    ds_read_b64_tr_b16 a[136:137], v12 offset:64
    v_mfma_f32_16x16x32_bf16 a[12:15], a[236:239], v[100:103], a[12:15]
    v_mfma_f32_16x16x32_bf16 a[12:15], a[204:207], v[96:99], a[12:15]
    ds_read_b64_tr_b16 a[138:139], v12 offset:320
    v_mfma_f32_16x16x32_bf16 a[16:19], a[208:211], v[96:99], a[16:19]
    buffer_load_dwordx4 v3, s[8:11], s35 offen offset:1024 lds
    v_mfma_f32_16x16x32_bf16 a[16:19], a[240:243], v[100:103], a[16:19]
    ds_read_b64_tr_b16 a[140:141], v12 offset:96
    v_mfma_f32_16x16x32_bf16 a[20:23], a[244:247], v[100:103], a[20:23]
    ds_read_b64_tr_b16 a[142:143], v12 offset:352
    v_mfma_f32_16x16x32_bf16 a[20:23], a[212:215], v[96:99], a[20:23]
    ds_read_b64_tr_b16 a[144:145], v12 offset:128
    v_mfma_f32_16x16x32_bf16 a[24:27], a[216:219], v[96:99], a[24:27]
    ds_read_b64_tr_b16 a[146:147], v12 offset:384
    v_mfma_f32_16x16x32_bf16 a[24:27], a[248:251], v[100:103], a[24:27]
    v_mfma_f32_16x16x32_bf16 a[28:31], a[252:255], v[100:103], a[28:31]
    ds_read_b64_tr_b16 a[148:149], v12 offset:160
    v_mfma_f32_16x16x32_bf16 a[28:31], a[220:223], v[96:99], a[28:31]
    buffer_load_dwordx4 v2, s[8:11], s35 offen offset:2048 lds
    v_mfma_f32_16x16x32_bf16 a[32:35], a[192:195], v[104:107], a[32:35]
    ds_read_b64_tr_b16 a[150:151], v12 offset:416
    v_mfma_f32_16x16x32_bf16 a[32:35], a[224:227], v[108:111], a[32:35]
    ds_read_b64_tr_b16 a[152:153], v12 offset:192
    v_mfma_f32_16x16x32_bf16 a[36:39], a[228:231], v[108:111], a[36:39]
    ds_read_b64_tr_b16 a[154:155], v12 offset:448
    v_mfma_f32_16x16x32_bf16 a[36:39], a[196:199], v[104:107], a[36:39]
    ds_read_b64_tr_b16 a[156:157], v12 offset:224
    v_mfma_f32_16x16x32_bf16 v[40:43], v[28:31], v[16:19], v[40:43]
    v_mfma_f32_16x16x32_bf16 a[40:43], a[200:203], v[104:107], a[40:43]
    buffer_load_dwordx4 v3, s[8:11], s35 offen offset:3072 lds
    v_mfma_f32_16x16x32_bf16 a[40:43], a[232:235], v[108:111], a[40:43]
    ds_read_b64_tr_b16 a[158:159], v12 offset:480
    s_add_u32 s35, s35, 128
    v_mfma_f32_16x16x32_bf16 a[44:47], a[236:239], v[108:111], a[44:47]
    ds_read_b64_tr_b16 a[160:161], v12 offset:8448
    v_mfma_f32_16x16x32_bf16 a[44:47], a[204:207], v[104:107], a[44:47]
    ds_read_b64_tr_b16 a[162:163], v12 offset:8704
    v_mfma_f32_16x16x32_bf16 a[48:51], a[208:211], v[104:107], a[48:51]
    ds_read_b64_tr_b16 a[164:165], v12 offset:8480
    s_add_u32 m0, s31, 0xc600
    v_mfma_f32_16x16x32_bf16 a[48:51], a[240:243], v[108:111], a[48:51]
    buffer_load_dwordx4 v6, s[16:19], s25 offen offset:0 lds
    v_mfma_f32_16x16x32_bf16 a[52:55], a[244:247], v[108:111], a[52:55]
    v_mfma_f32_16x16x32_bf16 a[52:55], a[212:215], v[104:107], a[52:55]
    ds_read_b64_tr_b16 a[166:167], v12 offset:8736
    v_mfma_f32_16x16x32_bf16 a[56:59], a[216:219], v[104:107], a[56:59]
    ds_read_b64_tr_b16 a[168:169], v12 offset:8512
    v_mfma_f32_16x16x32_bf16 a[56:59], a[248:251], v[108:111], a[56:59]
    ds_read_b64_tr_b16 a[170:171], v12 offset:8768
    v_mfma_f32_16x16x32_bf16 a[60:63], a[252:255], v[108:111], a[60:63]
    ds_read_b64_tr_b16 a[172:173], v12 offset:8544
    v_mfma_f32_16x16x32_bf16 a[60:63], a[220:223], v[104:107], a[60:63]
    buffer_load_dwordx4 v7, s[16:19], s25 offen offset:1056 lds
    v_mfma_f32_16x16x32_bf16 a[64:67], a[192:195], v[112:115], a[64:67]
    ds_read_b64_tr_b16 a[174:175], v12 offset:8800
    v_mfma_f32_16x16x32_bf16 a[64:67], a[224:227], v[116:119], a[64:67]
    v_mfma_f32_16x16x32_bf16 a[68:71], a[228:231], v[116:119], a[68:71]
    ds_read_b64_tr_b16 a[176:177], v12 offset:8576
    v_mfma_f32_16x16x32_bf16 a[68:71], a[196:199], v[112:115], a[68:71]
    ds_read_b64_tr_b16 a[178:179], v12 offset:8832
    v_mfma_f32_16x16x32_bf16 a[72:75], a[200:203], v[112:115], a[72:75]
    ds_read_b64_tr_b16 a[180:181], v12 offset:8608
    v_mfma_f32_16x16x32_bf16 a[72:75], a[232:235], v[116:119], a[72:75]
    ds_read_b64_tr_b16 a[182:183], v12 offset:8864
    v_mfma_f32_16x16x32_bf16 a[76:79], a[236:239], v[116:119], a[76:79]
    buffer_load_dwordx4 v8, s[16:19], s25 offen offset:2112 lds
    v_mfma_f32_16x16x32_bf16 a[76:79], a[204:207], v[112:115], a[76:79]
    ds_read_b64_tr_b16 a[184:185], v12 offset:8640
    v_mfma_f32_16x16x32_bf16 a[80:83], a[208:211], v[112:115], a[80:83]
    v_mfma_f32_16x16x32_bf16 a[80:83], a[240:243], v[116:119], a[80:83]
    ds_read_b64_tr_b16 a[186:187], v12 offset:8896
    v_mfma_f32_16x16x32_bf16 a[84:87], a[244:247], v[116:119], a[84:87]
    ds_read_b64_tr_b16 a[188:189], v12 offset:8672
    v_mfma_f32_16x16x32_bf16 a[84:87], a[212:215], v[112:115], a[84:87]
    ds_read_b64_tr_b16 a[190:191], v12 offset:8928
    v_mfma_f32_16x16x32_bf16 a[88:91], a[216:219], v[112:115], a[88:91]
    buffer_load_dwordx4 v9, s[16:19], s25 offen offset:3168 lds
    v_mfma_f32_16x16x32_bf16 a[88:91], a[248:251], v[116:119], a[88:91]
    ds_read_b64_tr_b16 v[24:25], v13 offset:0
    s_add_u32 s25, s25, 0x70000
    v_mfma_f32_16x16x32_bf16 a[92:95], a[252:255], v[116:119], a[92:95]
    ds_read_b64_tr_b16 v[26:27], v13 offset:256
    v_mfma_f32_16x16x32_bf16 a[92:95], a[220:223], v[112:115], a[92:95]
    v_mfma_f32_16x16x32_bf16 a[96:99], a[192:195], v[120:123], a[96:99]
    s_waitcnt vmcnt(20)
    ds_read_b128 v[96:99], v10 offset:0
    v_mfma_f32_16x16x32_bf16 a[96:99], a[224:227], v[124:127], a[96:99]
    ds_read_b128 v[100:103], v11 offset:0
    v_mfma_f32_16x16x32_bf16 a[100:103], a[228:231], v[124:127], a[100:103]
    ds_read_b128 v[104:107], v10 offset:2048
    v_mfma_f32_16x16x32_bf16 a[100:103], a[196:199], v[120:123], a[100:103]
    ds_read_b128 v[108:111], v11 offset:2048
    v_mfma_f32_16x16x32_bf16 a[104:107], a[200:203], v[120:123], a[104:107]
    ds_read_b128 v[112:115], v10 offset:4096
    v_mfma_f32_16x16x32_bf16 a[104:107], a[232:235], v[124:127], a[104:107]
    ds_read_b128 v[116:119], v11 offset:4096
    v_mfma_f32_16x16x32_bf16 a[108:111], a[236:239], v[124:127], a[108:111]
    s_and_b32 s4, s33, 7
    v_mfma_f32_16x16x32_bf16 a[108:111], a[204:207], v[120:123], a[108:111]
    s_mul_i32 s5, s4, 0xe0000
    v_mfma_f32_16x16x32_bf16 a[112:115], a[208:211], v[120:123], a[112:115]
    s_add_u32 s25, s28, s5
    v_mfma_f32_16x16x32_bf16 a[112:115], a[240:243], v[124:127], a[112:115]
    v_mfma_f32_16x16x32_bf16 a[116:119], a[244:247], v[124:127], a[116:119]
    s_lshl_b32 s4, s4, 8
    v_mfma_f32_16x16x32_bf16 a[116:119], a[212:215], v[120:123], a[116:119]
    s_add_u32 s24, s27, s4
    v_mfma_f32_16x16x32_bf16 a[120:123], a[216:219], v[120:123], a[120:123]
    v_mfma_f32_16x16x32_bf16 a[120:123], a[248:251], v[124:127], a[120:123]
    s_add_u32 s35, s24, 0x10000
    v_mfma_f32_16x16x32_bf16 a[124:127], a[252:255], v[124:127], a[124:127]
    s_add_u32 s33, s33, 1
    v_mfma_f32_16x16x32_bf16 a[124:127], a[220:223], v[120:123], a[124:127]
    s_add_u32 s7, s7, 1
    s_bitcmp1_b32 0x70, s7
    s_cbranch_scc1 G1_HOOK
G1_BACK:
    s_cmp_lt_u32 s7, 7
    s_cbranch_scc1 G1_LOOP
    v_cmp_ne_u32 vcc, 0, v32
    s_nop 0
    s_cmp_eq_u64 vcc, -1
    s_cbranch_scc0 CS_SLOW
CS_OK:
    s_waitcnt vmcnt(16) lgkmcnt(0)
    s_barrier
    v_mfma_f32_16x16x32_bf16 v[128:131], a[128:131], v[96:99], v[128:131]
    ds_read_b128 v[120:123], v10 offset:6144
    buffer_load_dword v36, v4, s[64:67], s34 offen sc1
    v_mfma_f32_16x16x32_bf16 v[128:131], a[160:163], v[100:103], v[128:131]
    ds_read_b128 v[124:127], v11 offset:6144
    s_lshl_b32 s24, s2, 2
    v_mfma_f32_16x16x32_bf16 v[132:135], a[164:167], v[100:103], v[132:135]
    s_add_u32 s24, s24, s3
    s_lshl_b32 s4, s24, 12
    v_mfma_f32_16x16x32_bf16 v[132:135], a[132:135], v[96:99], v[132:135]
    ds_read_b64_tr_b16 a[192:193], v12 offset:16896
    v_mfma_f32_16x16x32_bf16 v[136:139], a[136:139], v[96:99], v[136:139]
    ds_read_b64_tr_b16 a[194:195], v12 offset:17152
    s_add_u32 s8, s44, s4
    s_addc_u32 s9, s45, 0
    v_mfma_f32_16x16x32_bf16 v[136:139], a[168:171], v[100:103], v[136:139]
    s_movk_i32 s10, 4096
    buffer_load_dwordx4 v[60:63], v14, s[64:67], s75 offen offset:0 sc1
    v_mfma_f32_16x16x32_bf16 v[140:143], a[172:175], v[100:103], v[140:143]
    ds_read_b64_tr_b16 a[196:197], v12 offset:16928
    s_mov_b32 s11, 0x00020000
    v_mfma_f32_16x16x32_bf16 v[140:143], a[140:143], v[96:99], v[140:143]
    ds_read_b64_tr_b16 a[198:199], v12 offset:17184
    v_mfma_f32_16x16x32_bf16 v[144:147], a[144:147], v[96:99], v[144:147]
    s_mov_b32 s16, s46
    s_mov_b32 s17, s47
    v_mfma_f32_16x16x32_bf16 v[144:147], a[176:179], v[100:103], v[144:147]
    ds_read_b64_tr_b16 a[200:201], v12 offset:16960
    s_mov_b32 s18, 0x800
    v_mfma_f32_16x16x32_bf16 v[148:151], a[180:183], v[100:103], v[148:151]
    buffer_load_dwordx4 v[64:67], v14, s[64:67], s75 offen offset:1024 sc1
    v_mfma_f32_16x16x32_bf16 v[148:151], a[148:151], v[96:99], v[148:151]
    ds_read_b64_tr_b16 a[202:203], v12 offset:17216
    s_mov_b32 s19, 0x00020000
    v_mfma_f32_16x16x32_bf16 v[152:155], a[152:155], v[96:99], v[152:155]
    ds_read_b64_tr_b16 a[204:205], v12 offset:16992
    s_mov_b32 s12, s54
    v_mfma_f32_16x16x32_bf16 v[152:155], a[184:187], v[100:103], v[152:155]
    s_mov_b32 s13, s55
    v_mfma_f32_16x16x32_bf16 v[156:159], a[188:191], v[100:103], v[156:159]
    ds_read_b64_tr_b16 a[206:207], v12 offset:17248
    s_mov_b32 s14, 0x700000
    v_mfma_f32_16x16x32_bf16 v[156:159], a[156:159], v[96:99], v[156:159]
    ds_read_b64_tr_b16 a[208:209], v12 offset:17024
    s_mov_b32 s15, 0x00020000
    v_mfma_f32_16x16x32_bf16 v[160:163], a[128:131], v[104:107], v[160:163]
    buffer_load_dwordx4 v[76:79], v14, s[64:67], s75 offen offset:2048 sc1
    s_mul_i32 s25, s3, 18432
    v_mfma_f32_16x16x32_bf16 v[160:163], a[160:163], v[108:111], v[160:163]
    ds_read_b64_tr_b16 a[210:211], v12 offset:17280
    v_mfma_f32_16x16x32_bf16 v[164:167], a[164:167], v[108:111], v[164:167]
    s_add_u32 s25, s25, 0x10800
    s_and_b32 s4, s2, 1
    v_mfma_f32_16x16x32_bf16 v[164:167], a[132:135], v[104:107], v[164:167]
    ds_read_b64_tr_b16 a[212:213], v12 offset:17056
    s_lshl_b32 s4, s4, 2
    v_mfma_f32_16x16x32_bf16 v[168:171], a[136:139], v[104:107], v[168:171]
    ds_read_b64_tr_b16 a[214:215], v12 offset:17312
    buffer_load_dwordx4 v[80:83], v14, s[64:67], s75 offen offset:3072 sc1
    v_mfma_f32_16x16x32_bf16 v[168:171], a[168:171], v[108:111], v[168:171]
    s_bfe_u32 s5, s2, 0x20003
    v_mfma_f32_16x16x32_bf16 v[172:175], a[172:175], v[108:111], v[172:175]
    ds_read_b64_tr_b16 a[216:217], v12 offset:17088
    s_add_u32 s26, s4, s5
    v_mfma_f32_16x16x32_bf16 v[172:175], a[140:143], v[104:107], v[172:175]
    ds_read_b64_tr_b16 a[218:219], v12 offset:17344
    s_lshr_b32 s4, s2, 5
    v_mfma_f32_16x16x32_bf16 v[176:179], a[144:147], v[104:107], v[176:179]
    s_bfe_u32 s35, s2, 0x20001
    v_mfma_f32_16x16x32_bf16 v[176:179], a[176:179], v[108:111], v[176:179]
    ds_read_b64_tr_b16 a[220:221], v12 offset:17120
    s_lshl_b32 s27, s4, 2
    v_mfma_f32_16x16x32_bf16 v[180:183], a[180:183], v[108:111], v[180:183]
    buffer_load_dwordx2 v[68:69], v35, s[64:67], s76 offen offset:0 sc1
    s_add_u32 s27, s27, s35
    v_mfma_f32_16x16x32_bf16 v[180:183], a[148:151], v[104:107], v[180:183]
    ds_read_b64_tr_b16 a[222:223], v12 offset:17376
    v_mfma_f32_16x16x32_bf16 v[184:187], a[152:155], v[104:107], v[184:187]
    ds_read_b64_tr_b16 a[224:225], v12 offset:25344
    s_lshl_b32 s4, s4, 8
    v_mfma_f32_16x16x32_bf16 v[184:187], a[184:187], v[108:111], v[184:187]
    s_lshl_b32 s5, s3, 16
    s_add_u32 s30, s4, s5
    v_mfma_f32_16x16x32_bf16 v[188:191], a[188:191], v[108:111], v[188:191]
    ds_read_b64_tr_b16 a[226:227], v12 offset:25600
    buffer_load_dwordx2 v[70:71], v35, s[64:67], s76 offen offset:128 sc1
    v_mfma_f32_16x16x32_bf16 v[188:191], a[156:159], v[104:107], v[188:191]
    ds_read_b64_tr_b16 a[228:229], v12 offset:25376
    v_mfma_f32_16x16x32_bf16 v[192:195], a[128:131], v[112:115], v[192:195]
    s_lshl_b32 s4, s3, 2
    s_lshl_b32 s28, s26, 4
    v_mfma_f32_16x16x32_bf16 v[192:195], a[160:163], v[116:119], v[192:195]
    ds_read_b64_tr_b16 a[230:231], v12 offset:25632
    s_add_u32 s28, s28, s4
    v_mfma_f32_16x16x32_bf16 v[196:199], a[164:167], v[116:119], v[196:199]
    ds_read_b64_tr_b16 a[232:233], v12 offset:25408
    v_mfma_f32_16x16x32_bf16 v[196:199], a[132:135], v[112:115], v[196:199]
    s_mul_i32 s5, s26, 1792
    s_add_u32 s4, s4, s5
    v_mfma_f32_16x16x32_bf16 v[200:203], a[136:139], v[112:115], v[200:203]
    ds_read_b64_tr_b16 a[234:235], v12 offset:25664
    buffer_load_dwordx2 v[72:73], v35, s[64:67], s76 offen offset:256 sc1
    v_mfma_f32_16x16x32_bf16 v[200:203], a[168:171], v[116:119], v[200:203]
    s_lshl_b32 s29, s4, 10
    v_mfma_f32_16x16x32_bf16 v[204:207], a[172:175], v[116:119], v[204:207]
    ds_read_b64_tr_b16 a[236:237], v12 offset:25440
    s_lshl_b32 s31, s3, 13
    v_mfma_f32_16x16x32_bf16 v[204:207], a[140:143], v[112:115], v[204:207]
    ds_read_b64_tr_b16 a[238:239], v12 offset:25696
    s_lshl_b32 s4, s27, 6
    v_mfma_f32_16x16x32_bf16 v[208:211], a[144:147], v[112:115], v[208:211]
    s_lshl_b32 s72, s28, 15
    buffer_load_dwordx2 v[74:75], v35, s[64:67], s76 offen offset:384 sc1
    v_mfma_f32_16x16x32_bf16 v[208:211], a[176:179], v[116:119], v[208:211]
    ds_read_b64_tr_b16 a[240:241], v12 offset:25472
    v_mfma_f32_16x16x32_bf16 v[212:215], a[180:183], v[116:119], v[212:215]
    ds_read_b64_tr_b16 a[242:243], v12 offset:25728
    s_add_u32 s72, s72, s4
    v_mfma_f32_16x16x32_bf16 v[212:215], a[148:151], v[112:115], v[212:215]
    s_add_u32 s77, s72, 0x10000
    v_lshrrev_b32 v16, 4, v1
    v_mfma_f32_16x16x32_bf16 v[216:219], a[152:155], v[112:115], v[216:219]
    ds_read_b64_tr_b16 a[244:245], v12 offset:25504
    v_and_b32_e64 v17, 15, v1
    v_mfma_f32_16x16x32_bf16 v[216:219], a[184:187], v[116:119], v[216:219]
    v_lshlrev_b32_e64 v18, 1, v16
    v_mfma_f32_16x16x32_bf16 v[220:223], a[188:191], v[116:119], v[220:223]
    ds_read_b64_tr_b16 a[246:247], v12 offset:25760
    v_xor_b32_e64 v17, v17, v18
    v_mfma_f32_16x16x32_bf16 v[220:223], a[156:159], v[112:115], v[220:223]
    ds_read_b64_tr_b16 a[248:249], v12 offset:25536
    v_lshlrev_b32 v17, 4, v17
    s_waitcnt lgkmcnt(9)
    v_mfma_f32_16x16x32_bf16 v[224:227], a[128:131], v[120:123], v[224:227]
    v_lshl_add_u32 v6, v16, 11, v17
    v_mfma_f32_16x16x32_bf16 v[224:227], a[160:163], v[124:127], v[224:227]
    ds_read_b64_tr_b16 a[250:251], v12 offset:25792
    v_xor_b32 v17, 0x80, v6
    v_mfma_f32_16x16x32_bf16 v[228:231], a[164:167], v[124:127], v[228:231]
    ds_read_b64_tr_b16 a[252:253], v12 offset:25568
    v_add_u32 v7, 0x1c00, v6
    v_mfma_f32_16x16x32_bf16 v[228:231], a[132:135], v[120:123], v[228:231]
    v_add_u32 v8, 0x3800, v17
    v_mfma_f32_16x16x32_bf16 v[232:235], a[136:139], v[120:123], v[232:235]
    ds_read_b64_tr_b16 a[254:255], v12 offset:25824
    v_add_u32 v9, 0x5400, v17
    v_mfma_f32_16x16x32_bf16 v[232:235], a[168:171], v[124:127], v[232:235]
    v_subrev_u32 v16, 16, v1
    v_lshlrev_b32 v16, 2, v16
    v_mfma_f32_16x16x32_bf16 v[236:239], a[172:175], v[124:127], v[236:239]
    v_min_u32_e64 v22, 0x40000000, v16
    v_mfma_f32_16x16x32_bf16 v[236:239], a[140:143], v[120:123], v[236:239]
    v_subrev_u32 v16, 15, v1
    v_lshlrev_b32 v16, 2, v16
    v_mfma_f32_16x16x32_bf16 v[240:243], a[144:147], v[120:123], v[240:243]
    v_min_u32_e64 v23, 0x40000000, v16
    v_mfma_f32_16x16x32_bf16 v[240:243], a[176:179], v[124:127], v[240:243]
    s_lshl_b32 s4, s24, 1
    buffer_load_ushort v2, v4, s[16:19], s4 offen
    v_mfma_f32_16x16x32_bf16 v[244:247], a[180:183], v[124:127], v[244:247]
    v_and_b32 v15, 15, v1
    v_lshlrev_b32_e64 v15, 12, v15
    v_mfma_f32_16x16x32_bf16 v[244:247], a[148:151], v[120:123], v[244:247]
    v_lshrrev_b32_e64 v3, 4, v1
    v_mfma_f32_16x16x32_bf16 v[248:251], a[152:155], v[120:123], v[248:251]
    v_lshl_add_u32 v3, v3, 3, v15
    s_lshl_b32 s4, s24, 10
    v_mfma_f32_16x16x32_bf16 v[248:251], a[184:187], v[124:127], v[248:251]
    s_add_u32 s4, s4, 0x280000
    v_mfma_f32_16x16x32_bf16 v[252:255], a[188:191], v[124:127], v[252:255]
    buffer_load_dwordx4 v[88:91], v14, s[12:15], s4 offen
    s_add_u32 s4, s4, 0x380000
    v_mfma_f32_16x16x32_bf16 v[252:255], a[156:159], v[120:123], v[252:255]
    buffer_load_dwordx4 v[88:91], v14, s[12:15], s4 offen
    s_waitcnt vmcnt(11)
    v_cmp_ne_u32 vcc, 0, v36
    s_nop 0
    s_cmp_eq_u64 vcc, -1
    s_cbranch_scc0 UF_SLOW
UF_OK:
    s_waitcnt lgkmcnt(0)
    s_barrier
    v_mfma_f32_16x16x32_bf16 a[0:3], a[192:195], v[96:99], a[0:3]
    ds_read_b64_tr_b16 a[128:129], v12 offset:33792
    s_lshr_b32 s75, s2, 5
    v_mfma_f32_16x16x32_bf16 a[0:3], a[224:227], v[100:103], a[0:3]
    ds_read_b64_tr_b16 a[130:131], v12 offset:34048
    v_mfma_f32_16x16x32_bf16 a[4:7], a[228:231], v[100:103], a[4:7]
    s_bfe_u32 s81, s2, 0x20003
    v_mfma_f32_16x16x32_bf16 a[4:7], a[196:199], v[96:99], a[4:7]
    ds_read_b64_tr_b16 a[132:133], v12 offset:33824
    s_lshl_b32 s81, s81, 1
    v_mfma_f32_16x16x32_bf16 a[8:11], a[200:203], v[96:99], a[8:11]
    ds_read_b64_tr_b16 a[134:135], v12 offset:34080
    v_mfma_f32_16x16x32_bf16 a[8:11], a[232:235], v[100:103], a[8:11]
    s_add_u32 s75, s75, s81
    v_mfma_f32_16x16x32_bf16 a[12:15], a[236:239], v[100:103], a[12:15]
    ds_read_b64_tr_b16 a[136:137], v12 offset:33856
    s_mov_b32 s75, 0
    v_mfma_f32_16x16x32_bf16 a[12:15], a[204:207], v[96:99], a[12:15]
    ds_read_b64_tr_b16 a[138:139], v12 offset:34112
    v_mfma_f32_16x16x32_bf16 a[16:19], a[208:211], v[96:99], a[16:19]
    s_lshl_b32 s6, s75, 3
    s_lshr_b64 s[4:5], s[48:49], s6
    s_and_b32 s16, s4, 31
    v_mfma_f32_16x16x32_bf16 a[16:19], a[240:243], v[100:103], a[16:19]
    ds_read_b64_tr_b16 a[140:141], v12 offset:33888
    s_add_u32 s75, s75, 1
    v_mfma_f32_16x16x32_bf16 a[20:23], a[244:247], v[100:103], a[20:23]
    ds_read_b64_tr_b16 a[142:143], v12 offset:34144
    v_mfma_f32_16x16x32_bf16 a[20:23], a[212:215], v[96:99], a[20:23]
    s_cmp_eq_u32 s75, 7
    s_cselect_b32 s75, 0, s75
    v_mfma_f32_16x16x32_bf16 a[24:27], a[216:219], v[96:99], a[24:27]
    ds_read_b64_tr_b16 a[144:145], v12 offset:33920
    s_lshl_b32 s6, s75, 3
    s_lshr_b64 s[4:5], s[48:49], s6
    s_and_b32 s17, s4, 31
    v_mfma_f32_16x16x32_bf16 a[24:27], a[248:251], v[100:103], a[24:27]
    ds_read_b64_tr_b16 a[146:147], v12 offset:34176
    v_mfma_f32_16x16x32_bf16 a[28:31], a[252:255], v[100:103], a[28:31]
    s_add_u32 s75, s75, 1
    v_mfma_f32_16x16x32_bf16 a[28:31], a[220:223], v[96:99], a[28:31]
    ds_read_b64_tr_b16 a[148:149], v12 offset:33952
    s_cmp_eq_u32 s75, 7
    s_cselect_b32 s75, 0, s75
    v_mfma_f32_16x16x32_bf16 a[32:35], a[192:195], v[104:107], a[32:35]
    ds_read_b64_tr_b16 a[150:151], v12 offset:34208
    v_mfma_f32_16x16x32_bf16 a[32:35], a[224:227], v[108:111], a[32:35]
    s_mov_b32 s20, s36
    v_mfma_f32_16x16x32_bf16 a[36:39], a[228:231], v[108:111], a[36:39]
    ds_read_b64_tr_b16 a[152:153], v12 offset:33984
    s_mov_b32 s21, s37
    v_mfma_f32_16x16x32_bf16 a[36:39], a[196:199], v[104:107], a[36:39]
    ds_read_b64_tr_b16 a[154:155], v12 offset:34240
    v_mfma_f32_16x16x32_bf16 a[40:43], a[200:203], v[104:107], a[40:43]
    s_mov_b32 s22, 0x400000
    v_mfma_f32_16x16x32_bf16 a[40:43], a[232:235], v[108:111], a[40:43]
    ds_read_b64_tr_b16 a[156:157], v12 offset:34016
    s_mov_b32 s23, 0x00020000
    v_mfma_f32_16x16x32_bf16 a[44:47], a[236:239], v[108:111], a[44:47]
    ds_read_b64_tr_b16 a[158:159], v12 offset:34272
    v_mfma_f32_16x16x32_bf16 a[44:47], a[204:207], v[104:107], a[44:47]
    s_mul_i32 s71, s24, 4224
    s_add_u32 s71, s71, 0x1400000
    v_mfma_f32_16x16x32_bf16 a[48:51], a[208:211], v[104:107], a[48:51]
    ds_read_b64_tr_b16 a[160:161], v12 offset:42240
    s_mul_i32 s4, s62, 112
    v_mfma_f32_16x16x32_bf16 a[48:51], a[240:243], v[108:111], a[48:51]
    s_lshl_b32 s5, s63, 2
    v_mfma_f32_16x16x32_bf16 a[52:55], a[244:247], v[108:111], a[52:55]
    ds_read_b64_tr_b16 a[162:163], v12 offset:42496
    v_mfma_f32_16x16x32_bf16 a[52:55], a[212:215], v[104:107], a[52:55]
    ds_read_b64_tr_b16 a[164:165], v12 offset:42272
    s_add_u32 s4, s4, s5
    v_mfma_f32_16x16x32_bf16 a[56:59], a[216:219], v[104:107], a[56:59]
    s_add_u32 m0, s25, 4576
    s_nop 0
    buffer_load_dwordx4 v14, s[64:67], s71 offen offset:0 sc1 lds
    v_mfma_f32_16x16x32_bf16 a[56:59], a[248:251], v[108:111], a[56:59]
    ds_read_b64_tr_b16 a[166:167], v12 offset:42528
    v_mfma_f32_16x16x32_bf16 a[60:63], a[252:255], v[108:111], a[60:63]
    ds_read_b64_tr_b16 a[168:169], v12 offset:42304
    s_lshl_b32 s4, s4, 14
    v_mfma_f32_16x16x32_bf16 a[60:63], a[220:223], v[104:107], a[60:63]
    s_lshl_b32 s5, s3, 12
    v_mfma_f32_16x16x32_bf16 a[64:67], a[192:195], v[112:115], a[64:67]
    ds_read_b64_tr_b16 a[170:171], v12 offset:42560
    v_mfma_f32_16x16x32_bf16 a[64:67], a[224:227], v[116:119], a[64:67]
    ds_read_b64_tr_b16 a[172:173], v12 offset:42336
    buffer_load_dwordx4 v14, s[64:67], s71 offen offset:1024 sc1 lds
    v_mfma_f32_16x16x32_bf16 a[68:71], a[228:231], v[116:119], a[68:71]
    s_add_u32 s32, s4, s5
    v_mfma_f32_16x16x32_bf16 a[68:71], a[196:199], v[112:115], a[68:71]
    ds_read_b64_tr_b16 a[174:175], v12 offset:42592
    v_mfma_f32_16x16x32_bf16 a[72:75], a[200:203], v[112:115], a[72:75]
    ds_read_b64_tr_b16 a[176:177], v12 offset:42368
    v_mfma_f32_16x16x32_bf16 a[72:75], a[232:235], v[116:119], a[72:75]
    v_and_b32_e64 v18, 15, v1
    v_mfma_f32_16x16x32_bf16 a[76:79], a[236:239], v[116:119], a[76:79]
    ds_read_b64_tr_b16 a[178:179], v12 offset:42624
    buffer_load_dwordx4 v14, s[64:67], s71 offen offset:2048 sc1 lds
    v_mfma_f32_16x16x32_bf16 a[76:79], a[204:207], v[112:115], a[76:79]
    ds_read_b64_tr_b16 a[180:181], v12 offset:42400
    v_mfma_f32_16x16x32_bf16 a[80:83], a[208:211], v[112:115], a[80:83]
    v_lshlrev_b32_e64 v18, 4, v18
    v_mfma_f32_16x16x32_bf16 a[80:83], a[240:243], v[116:119], a[80:83]
    ds_read_b64_tr_b16 a[182:183], v12 offset:42656
    v_bfe_u32 v19, v1, 5, 1
    v_mfma_f32_16x16x32_bf16 a[84:87], a[244:247], v[116:119], a[84:87]
    ds_read_b64_tr_b16 a[184:185], v12 offset:42432
    v_mfma_f32_16x16x32_bf16 a[84:87], a[212:215], v[112:115], a[84:87]
    buffer_load_dwordx4 v14, s[64:67], s71 offen offset:3072 sc1 lds
    v_mfma_f32_16x16x32_bf16 a[88:91], a[216:219], v[112:115], a[88:91]
    ds_read_b64_tr_b16 a[186:187], v12 offset:42688
    v_lshl_add_u32 v18, v19, 8, v18
    v_mfma_f32_16x16x32_bf16 a[88:91], a[248:251], v[116:119], a[88:91]
    ds_read_b64_tr_b16 a[188:189], v12 offset:42464
    v_mfma_f32_16x16x32_bf16 a[92:95], a[252:255], v[116:119], a[92:95]
    v_bfe_u32 v19, v1, 4, 1
    v_mfma_f32_16x16x32_bf16 a[92:95], a[220:223], v[112:115], a[92:95]
    ds_read_b64_tr_b16 a[190:191], v12 offset:42720
    v_and_b32_e64 v28, 15, v1
    v_lshlrev_b32 v28, 3, v28
    s_lshl_b32 s81, s28, 7
    s_add_u32 s81, s81, 0x1000000
    buffer_load_dwordx2 v[20:21], v28, s[64:67], s81 offen offset:0 sc1
    buffer_load_dwordx2 v[30:31], v28, s[64:67], s81 offen offset:128 sc1
    buffer_load_dwordx2 v[24:25], v28, s[64:67], s81 offen offset:256 sc1
    buffer_load_dwordx2 v[26:27], v28, s[64:67], s81 offen offset:384 sc1
    v_mfma_f32_16x16x32_bf16 a[96:99], a[192:195], v[120:123], a[96:99]
    v_lshl_add_u32 v16, v19, 9, v18
    v_mfma_f32_16x16x32_bf16 a[96:99], a[224:227], v[124:127], a[96:99]
    ds_read_b128 v[96:99], v10 offset:9216
    s_lshl_b32 s74, s62, 2
    v_mfma_f32_16x16x32_bf16 a[100:103], a[228:231], v[124:127], a[100:103]
    ds_read_b128 v[100:103], v11 offset:9216
    s_add_u32 s74, s74, s3
    v_mfma_f32_16x16x32_bf16 a[100:103], a[196:199], v[120:123], a[100:103]
    ds_read_b128 v[104:107], v10 offset:11264
    s_lshl_b32 s79, s16, 18
    s_add_u32 m0, s31, 0x0
    s_add_u32 s79, s79, s30
    buffer_load_dwordx4 v6, s[12:15], s79 offen offset:0 lds
    v_mfma_f32_16x16x32_bf16 a[104:107], a[200:203], v[120:123], a[104:107]
    ds_read_b128 v[108:111], v11 offset:11264
    s_lshl_b32 s74, s74, 7
    v_mfma_f32_16x16x32_bf16 a[104:107], a[232:235], v[124:127], a[104:107]
    ds_read_b128 v[112:115], v10 offset:13312
    s_bfe_u32 s4, s2, 0x20001
    v_mfma_f32_16x16x32_bf16 a[108:111], a[236:239], v[124:127], a[108:111]
    ds_read_b128 v[116:119], v11 offset:13312
    buffer_load_dwordx4 v7, s[12:15], s79 offen offset:1024 lds
    v_mfma_f32_16x16x32_bf16 a[108:111], a[204:207], v[120:123], a[108:111]
    s_lshl_b32 s4, s4, 3
    v_mfma_f32_16x16x32_bf16 a[112:115], a[208:211], v[120:123], a[112:115]
    s_add_u32 s74, s74, s4
    v_mfma_f32_16x16x32_bf16 a[112:115], a[240:243], v[124:127], a[112:115]
    buffer_load_dwordx4 v8, s[12:15], s79 offen offset:2048 lds
    v_mfma_f32_16x16x32_bf16 a[116:119], a[244:247], v[124:127], a[116:119]
    s_lshr_b32 s4, s2, 5
    v_mfma_f32_16x16x32_bf16 a[116:119], a[212:215], v[120:123], a[116:119]
    s_add_u32 s74, s74, s4
    v_mfma_f32_16x16x32_bf16 a[120:123], a[216:219], v[120:123], a[120:123]
    buffer_load_dwordx4 v9, s[12:15], s79 offen offset:3072 lds
    v_mfma_f32_16x16x32_bf16 a[120:123], a[248:251], v[124:127], a[120:123]
    s_lshl_b32 s74, s74, 2
    v_mfma_f32_16x16x32_bf16 a[124:127], a[252:255], v[124:127], a[124:127]
    s_add_u32 s74, s74, 0x1025000
    v_mfma_f32_16x16x32_bf16 a[124:127], a[220:223], v[120:123], a[124:127]
    s_waitcnt lgkmcnt(0)
    s_barrier
    v_mfma_f32_16x16x32_bf16 v[128:131], a[128:131], v[96:99], v[128:131]
    ds_read_b128 v[120:123], v10 offset:15360
    v_mfma_f32_16x16x32_bf16 v[128:131], a[160:163], v[100:103], v[128:131]
    ds_read_b128 v[124:127], v11 offset:15360
    v_mfma_f32_16x16x32_bf16 v[132:135], a[164:167], v[100:103], v[132:135]
    v_mfma_f32_16x16x32_bf16 v[132:135], a[132:135], v[96:99], v[132:135]
    ds_read_b64_tr_b16 a[192:193], v12 offset:50688
    v_mfma_f32_16x16x32_bf16 v[136:139], a[136:139], v[96:99], v[136:139]
    ds_read_b64_tr_b16 a[194:195], v12 offset:50944
    v_mfma_f32_16x16x32_bf16 v[136:139], a[168:171], v[100:103], v[136:139]
    v_mfma_f32_16x16x32_bf16 v[140:143], a[172:175], v[100:103], v[140:143]
    ds_read_b64_tr_b16 a[196:197], v12 offset:50720
    s_waitcnt lgkmcnt(3)
    s_add_u32 m0, s25, 9216
    s_movk_i32 s80, 192
    buffer_load_dword v22, s[8:11], 0 offen lds
    v_mfma_f32_16x16x32_bf16 v[140:143], a[140:143], v[96:99], v[140:143]
    ds_read_b64_tr_b16 a[198:199], v12 offset:50976
    s_waitcnt vmcnt(22)
    v_add_f32_e64 v60, v60, v64
    v_mfma_f32_16x16x32_bf16 v[144:147], a[144:147], v[96:99], v[144:147]
    v_add_f32_e64 v61, v61, v65
    v_mfma_f32_16x16x32_bf16 v[144:147], a[176:179], v[100:103], v[144:147]
    ds_read_b64_tr_b16 a[200:201], v12 offset:50752
    v_add_f32_e64 v62, v62, v66
    v_mfma_f32_16x16x32_bf16 v[148:151], a[180:183], v[100:103], v[148:151]
    v_add_f32_e64 v63, v63, v67
    v_mfma_f32_16x16x32_bf16 v[148:151], a[148:151], v[96:99], v[148:151]
    ds_read_b64_tr_b16 a[202:203], v12 offset:51008
    s_waitcnt vmcnt(21)
    v_add_f32 v60, v60, v76
    v_mfma_f32_16x16x32_bf16 v[152:155], a[152:155], v[96:99], v[152:155]
    ds_read_b64_tr_b16 a[204:205], v12 offset:50784
    v_mfma_f32_16x16x32_bf16 v[152:155], a[184:187], v[100:103], v[152:155]
    s_add_u32 m0, s25, 9472
    s_nop 0
    buffer_load_dwordx4 v14, s[8:11], s80 offen offset:0  lds
    v_add_f32 v61, v61, v77
    v_mfma_f32_16x16x32_bf16 v[156:159], a[188:191], v[100:103], v[156:159]
    ds_read_b64_tr_b16 a[206:207], v12 offset:51040
    v_mfma_f32_16x16x32_bf16 v[156:159], a[156:159], v[96:99], v[156:159]
    ds_read_b64_tr_b16 a[208:209], v12 offset:50816
    v_add_f32_e64 v62, v62, v78
    v_mfma_f32_16x16x32_bf16 v[160:163], a[128:131], v[104:107], v[160:163]
    v_add_f32_e64 v63, v63, v79
    v_mfma_f32_16x16x32_bf16 v[160:163], a[160:163], v[108:111], v[160:163]
    ds_read_b64_tr_b16 a[210:211], v12 offset:51072
    s_waitcnt vmcnt(21)
    v_add_f32 v60, v60, v80
    v_mfma_f32_16x16x32_bf16 v[164:167], a[164:167], v[108:111], v[164:167]
    v_add_f32_e64 v61, v61, v81
    v_mfma_f32_16x16x32_bf16 v[164:167], a[132:135], v[104:107], v[164:167]
    ds_read_b64_tr_b16 a[212:213], v12 offset:50848
    buffer_load_dwordx4 v14, s[8:11], s80 offen offset:1024  lds
    v_mfma_f32_16x16x32_bf16 v[168:171], a[136:139], v[104:107], v[168:171]
    ds_read_b64_tr_b16 a[214:215], v12 offset:51104
    v_add_f32_e64 v62, v62, v82
    v_mfma_f32_16x16x32_bf16 v[168:171], a[168:171], v[108:111], v[168:171]
    v_add_f32_e64 v63, v63, v83
    v_mfma_f32_16x16x32_bf16 v[172:175], a[172:175], v[108:111], v[172:175]
    ds_read_b64_tr_b16 a[216:217], v12 offset:50880
    v_mfma_f32_16x16x32_bf16 v[172:175], a[140:143], v[104:107], v[172:175]
    ds_read_b64_tr_b16 a[218:219], v12 offset:51136
    s_lshl_b32 s4, s3, 10
    v_mfma_f32_16x16x32_bf16 v[176:179], a[144:147], v[104:107], v[176:179]
    s_add_u32 s4, s4, 0x26000
    v_mfma_f32_16x16x32_bf16 v[176:179], a[176:179], v[108:111], v[176:179]
    ds_read_b64_tr_b16 a[220:221], v12 offset:50912
    buffer_load_dwordx4 v14, s[8:11], s80 offen offset:2048  lds
    v_mfma_f32_16x16x32_bf16 v[180:183], a[180:183], v[108:111], v[180:183]
    v_add_u32 v64, s4, v14
    v_mfma_f32_16x16x32_bf16 v[180:183], a[148:151], v[104:107], v[180:183]
    ds_read_b64_tr_b16 a[222:223], v12 offset:51168
    ds_write_b128 v64, v[60:63]
    v_mfma_f32_16x16x32_bf16 v[184:187], a[152:155], v[104:107], v[184:187]
    ds_read_b64_tr_b16 a[224:225], v12 offset:59136
    v_and_b32_e64 v35, 0x30, v1
    v_mfma_f32_16x16x32_bf16 v[184:187], a[184:187], v[108:111], v[184:187]
    v_add_u32_e64 v35, s4, v35
    v_mfma_f32_16x16x32_bf16 v[188:191], a[188:191], v[108:111], v[188:191]
    ds_read_b64_tr_b16 a[226:227], v12 offset:59392
    s_waitcnt vmcnt(22)
    v_mov_b32 v36, v68
    v_mfma_f32_16x16x32_bf16 v[188:191], a[156:159], v[104:107], v[188:191]
    ds_read_b64_tr_b16 a[228:229], v12 offset:59168
    v_mfma_f32_16x16x32_bf16 v[192:195], a[128:131], v[112:115], v[192:195]
    buffer_load_dwordx4 v14, s[8:11], s80 offen offset:3072  lds
    v_mov_b32_e64 v37, v68
    v_mfma_f32_16x16x32_bf16 v[192:195], a[160:163], v[116:119], v[192:195]
    ds_read_b64_tr_b16 a[230:231], v12 offset:59424
    v_mfma_f32_16x16x32_bf16 v[196:199], a[164:167], v[116:119], v[196:199]
    ds_read_b64_tr_b16 a[232:233], v12 offset:59200
    v_rcp_f32_e64 v38, v69
    v_mfma_f32_16x16x32_bf16 v[196:199], a[132:135], v[112:115], v[196:199]
    v_mul_f32_e64 v40, v69, v69
    v_mfma_f32_16x16x32_bf16 v[200:203], a[136:139], v[112:115], v[200:203]
    ds_read_b64_tr_b16 a[234:235], v12 offset:59456
    v_mul_f32 v38, 0xbfb8aa3b, v38
    v_mfma_f32_16x16x32_bf16 v[200:203], a[168:171], v[116:119], v[200:203]
    s_add_u32 m0, s25, 13632
    s_movk_i32 s80, 196
    buffer_load_dword v23, s[8:11], 0 offen lds
    v_mfma_f32_16x16x32_bf16 v[204:207], a[172:175], v[116:119], v[204:207]
    ds_read_b64_tr_b16 a[236:237], v12 offset:59232
    v_mov_b32 v41, v40
    v_mfma_f32_16x16x32_bf16 v[204:207], a[140:143], v[112:115], v[204:207]
    ds_read_b64_tr_b16 a[238:239], v12 offset:59488
    v_mfma_f32_16x16x32_bf16 v[208:211], a[144:147], v[112:115], v[208:211]
    v_mov_b32 v39, v38
    s_waitcnt vmcnt(23)
    v_mov_b32_e64 v42, v70
    v_mfma_f32_16x16x32_bf16 v[208:211], a[176:179], v[116:119], v[208:211]
    ds_read_b64_tr_b16 a[240:241], v12 offset:59264
    v_mfma_f32_16x16x32_bf16 v[212:215], a[180:183], v[116:119], v[212:215]
    ds_read_b64_tr_b16 a[242:243], v12 offset:59520
    v_mov_b32_e64 v43, v70
    v_mfma_f32_16x16x32_bf16 v[212:215], a[148:151], v[112:115], v[212:215]
    v_rcp_f32_e64 v44, v71
    v_mfma_f32_16x16x32_bf16 v[216:219], a[152:155], v[112:115], v[216:219]
    ds_read_b64_tr_b16 a[244:245], v12 offset:59296
    s_add_u32 m0, s25, 13888
    s_nop 0
    buffer_load_dwordx4 v14, s[8:11], s80 offen offset:0  lds
    v_mfma_f32_16x16x32_bf16 v[216:219], a[184:187], v[116:119], v[216:219]
    v_mul_f32 v46, v71, v71
    v_mfma_f32_16x16x32_bf16 v[220:223], a[188:191], v[116:119], v[220:223]
    ds_read_b64_tr_b16 a[246:247], v12 offset:59552
    v_mul_f32 v44, 0xbfb8aa3b, v44
    v_mfma_f32_16x16x32_bf16 v[220:223], a[156:159], v[112:115], v[220:223]
    ds_read_b64_tr_b16 a[248:249], v12 offset:59328
    v_mov_b32_e64 v47, v46
    v_mfma_f32_16x16x32_bf16 v[224:227], a[128:131], v[120:123], v[224:227]
    v_mov_b32_e64 v45, v44
    v_mfma_f32_16x16x32_bf16 v[224:227], a[160:163], v[124:127], v[224:227]
    ds_read_b64_tr_b16 a[250:251], v12 offset:59584
    s_waitcnt vmcnt(23)
    v_mov_b32 v48, v72
    v_mfma_f32_16x16x32_bf16 v[228:231], a[164:167], v[124:127], v[228:231]
    ds_read_b64_tr_b16 a[252:253], v12 offset:59360
    v_mfma_f32_16x16x32_bf16 v[228:231], a[132:135], v[120:123], v[228:231]
    buffer_load_dwordx4 v14, s[8:11], s80 offen offset:1024  lds
    v_mov_b32_e64 v49, v72
    v_mfma_f32_16x16x32_bf16 v[232:235], a[136:139], v[120:123], v[232:235]
    ds_read_b64_tr_b16 a[254:255], v12 offset:59616
    v_mfma_f32_16x16x32_bf16 v[232:235], a[168:171], v[124:127], v[232:235]
    v_rcp_f32_e64 v50, v73
    v_mfma_f32_16x16x32_bf16 v[236:239], a[172:175], v[124:127], v[236:239]
    v_mul_f32_e64 v52, v73, v73
    v_mul_f32 v50, 0xbfb8aa3b, v50
    v_mfma_f32_16x16x32_bf16 v[236:239], a[140:143], v[120:123], v[236:239]
    buffer_load_dwordx4 v14, s[8:11], s80 offen offset:2048  lds
    v_mfma_f32_16x16x32_bf16 v[240:243], a[144:147], v[120:123], v[240:243]
    v_mov_b32_e64 v53, v52
    v_mfma_f32_16x16x32_bf16 v[240:243], a[176:179], v[124:127], v[240:243]
    v_mov_b32 v51, v50
    s_waitcnt vmcnt(24)
    v_mov_b32_e64 v54, v74
    v_mfma_f32_16x16x32_bf16 v[244:247], a[180:183], v[124:127], v[244:247]
    v_mov_b32_e64 v55, v74
    v_mfma_f32_16x16x32_bf16 v[244:247], a[148:151], v[120:123], v[244:247]
    v_rcp_f32_e64 v56, v75
    v_mfma_f32_16x16x32_bf16 v[248:251], a[152:155], v[120:123], v[248:251]
    buffer_load_dwordx4 v14, s[8:11], s80 offen offset:3072  lds
    v_mul_f32_e64 v58, v75, v75
    v_mfma_f32_16x16x32_bf16 v[248:251], a[184:187], v[124:127], v[248:251]
    v_mul_f32 v56, 0xbfb8aa3b, v56
    v_mfma_f32_16x16x32_bf16 v[252:255], a[188:191], v[124:127], v[252:255]
    v_mov_b32_e64 v59, v58
    v_mfma_f32_16x16x32_bf16 v[252:255], a[156:159], v[120:123], v[252:255]
    v_mov_b32_e64 v57, v56
    s_waitcnt lgkmcnt(0)
    s_barrier
    v_mfma_f32_16x16x32_bf16 a[0:3], a[192:195], v[96:99], a[0:3]
    s_add_u32 m0, s31, 0x1000
    s_add_u32 s79, s79, 0x8000
    buffer_load_dwordx4 v6, s[12:15], s79 offen offset:0 lds
    v_mfma_f32_16x16x32_bf16 a[0:3], a[224:227], v[100:103], a[0:3]
    v_and_b32 v10, 15, v1
    v_lshrrev_b32 v11, 4, v1
    v_mfma_f32_16x16x32_bf16 a[4:7], a[228:231], v[100:103], a[4:7]
    v_lshl_add_u32 v12, v11, 2, v10
    v_mfma_f32_16x16x32_bf16 a[4:7], a[196:199], v[96:99], a[4:7]
    v_add_u32_e64 v12, 1, v12
    v_mfma_f32_16x16x32_bf16 a[8:11], a[200:203], v[96:99], a[8:11]
    v_and_b32_e64 v29, 1, v12
    v_mfma_f32_16x16x32_bf16 a[8:11], a[232:235], v[100:103], a[8:11]
    v_sub_u32_e64 v12, v12, v29
    v_mfma_f32_16x16x32_bf16 a[12:15], a[236:239], v[100:103], a[12:15]
    buffer_load_dwordx4 v7, s[12:15], s79 offen offset:1024 lds
    v_mfma_f32_16x16x32_bf16 a[12:15], a[204:207], v[96:99], a[12:15]
    v_lshlrev_b32_e64 v12, 2, v12
    v_mfma_f32_16x16x32_bf16 a[16:19], a[208:211], v[96:99], a[16:19]
    v_mul_u32_u24 v29, 4416, v29
    v_mfma_f32_16x16x32_bf16 a[16:19], a[240:243], v[100:103], a[16:19]
    v_add3_u32 v12, v12, v29, s25
    v_mfma_f32_16x16x32_bf16 a[20:23], a[244:247], v[100:103], a[20:23]
    v_add_u32 v12, 9216, v12
    v_mfma_f32_16x16x32_bf16 a[20:23], a[212:215], v[96:99], a[20:23]
    v_add_u32 v13, 0x800, v12
    v_mfma_f32_16x16x32_bf16 a[24:27], a[216:219], v[96:99], a[24:27]
    v_lshrrev_b32_e64 v29, 1, v10
    v_mfma_f32_16x16x32_bf16 a[24:27], a[248:251], v[100:103], a[24:27]
    buffer_load_dwordx4 v8, s[12:15], s79 offen offset:2048 lds
    v_lshlrev_b32_e64 v29, 6, v29
    v_mfma_f32_16x16x32_bf16 a[28:31], a[252:255], v[100:103], a[28:31]
    v_lshlrev_b32_e64 v18, 4, v11
    v_mfma_f32_16x16x32_bf16 a[28:31], a[220:223], v[96:99], a[28:31]
    v_sub_u32_e64 v18, v18, v29
    v_mfma_f32_16x16x32_bf16 a[32:35], a[192:195], v[104:107], a[32:35]
    v_and_b32_e64 v29, 1, v10
    v_mfma_f32_16x16x32_bf16 a[32:35], a[224:227], v[108:111], a[32:35]
    v_mul_u32_u24 v29, 4576, v29
    v_mfma_f32_16x16x32_bf16 a[36:39], a[228:231], v[108:111], a[36:39]
    v_add3_u32 v18, v18, v29, s25
    v_mfma_f32_16x16x32_bf16 a[36:39], a[196:199], v[104:107], a[36:39]
    v_mov_b32_e64 v92, 0
    v_mfma_f32_16x16x32_bf16 a[40:43], a[200:203], v[104:107], a[40:43]
    buffer_load_dwordx4 v9, s[12:15], s79 offen offset:3072 lds
    v_mfma_f32_16x16x32_bf16 a[40:43], a[232:235], v[108:111], a[40:43]
    v_mov_b32_e64 v93, 0
    v_mfma_f32_16x16x32_bf16 a[44:47], a[236:239], v[108:111], a[44:47]
    v_mov_b32_e64 v94, 0
    v_mfma_f32_16x16x32_bf16 a[44:47], a[204:207], v[104:107], a[44:47]
    v_mov_b32_e64 v95, 0
    v_mfma_f32_16x16x32_bf16 a[48:51], a[208:211], v[104:107], a[48:51]
    v_add_u32_e64 v29, s25, v14
    v_mfma_f32_16x16x32_bf16 a[48:51], a[240:243], v[108:111], a[48:51]
    s_mov_b64 exec, 0x0fffffff
    ds_write_b128 v29, v[92:95] offset:4096
    ds_write_b128 v29, v[92:95] offset:8672
    s_mov_b64 exec, -1
    v_mfma_f32_16x16x32_bf16 a[52:55], a[244:247], v[108:111], a[52:55]
    v_sub_u32 v19, 15, v10
    v_mfma_f32_16x16x32_bf16 a[52:55], a[212:215], v[104:107], a[52:55]
    s_lshl_b32 s79, s17, 18
    s_add_u32 m0, s31, 0x8000
    s_add_u32 s79, s79, s30
    buffer_load_dwordx4 v6, s[12:15], s79 offen offset:0 lds
    v_mfma_f32_16x16x32_bf16 a[56:59], a[216:219], v[104:107], a[56:59]
    v_lshlrev_b32_e64 v17, 2, v11
    v_mfma_f32_16x16x32_bf16 a[56:59], a[248:251], v[108:111], a[56:59]
    v_sub_u32_e64 v19, v19, v17
    v_mfma_f32_16x16x32_bf16 a[60:63], a[252:255], v[108:111], a[60:63]
    v_cmp_eq_u32 vcc, 0, v19
    s_waitcnt vmcnt(29)
    s_nop 0
    v_cndmask_b32 v92, 0, v2, vcc
    v_mfma_f32_16x16x32_bf16 a[60:63], a[220:223], v[104:107], a[60:63]
    v_cmp_eq_u32 vcc, 1, v19
    s_nop 1
    v_cndmask_b32 v93, 0, v2, vcc
    v_mfma_f32_16x16x32_bf16 a[64:67], a[192:195], v[112:115], a[64:67]
    v_cmp_eq_u32 vcc, 2, v19
    s_nop 1
    v_cndmask_b32 v94, 0, v2, vcc
    v_mfma_f32_16x16x32_bf16 a[64:67], a[224:227], v[116:119], a[64:67]
    v_cmp_eq_u32 vcc, 3, v19
    s_nop 1
    v_cndmask_b32 v95, 0, v2, vcc
    v_mfma_f32_16x16x32_bf16 a[68:71], a[228:231], v[116:119], a[68:71]
    buffer_load_dwordx4 v7, s[12:15], s79 offen offset:1024 lds
    s_waitcnt vmcnt(24)
    ds_read_b128 v[96:99], v29 offset:4576
    v_mfma_f32_16x16x32_bf16 a[68:71], a[196:199], v[112:115], a[68:71]
    ds_read_b32 v76, v29 offset:4592
    v_mfma_f32_16x16x32_bf16 a[72:75], a[200:203], v[112:115], a[72:75]
    ds_read_b128 v[100:103], v29 offset:5600
    ds_read_b32 v77, v29 offset:5616
    v_mfma_f32_16x16x32_bf16 a[72:75], a[232:235], v[116:119], a[72:75]
    ds_read_b128 v[104:107], v29 offset:6624
    v_mfma_f32_16x16x32_bf16 a[76:79], a[236:239], v[116:119], a[76:79]
    buffer_load_dwordx4 v8, s[12:15], s79 offen offset:2048 lds
    ds_read_b32 v78, v29 offset:6640
    v_mfma_f32_16x16x32_bf16 a[76:79], a[204:207], v[112:115], a[76:79]
    ds_read_b128 v[108:111], v29 offset:7648
    v_mfma_f32_16x16x32_bf16 a[80:83], a[208:211], v[112:115], a[80:83]
    ds_read_b32 v79, v29 offset:7664
    v_mfma_f32_16x16x32_bf16 a[80:83], a[240:243], v[116:119], a[80:83]
    v_mfma_f32_16x16x32_bf16 a[84:87], a[244:247], v[116:119], a[84:87]
    buffer_load_dwordx4 v9, s[12:15], s79 offen offset:3072 lds
    v_mfma_f32_16x16x32_bf16 a[84:87], a[212:215], v[112:115], a[84:87]
    v_mfma_f32_16x16x32_bf16 a[88:91], a[216:219], v[112:115], a[88:91]
    v_mfma_f32_16x16x32_bf16 a[88:91], a[248:251], v[116:119], a[88:91]
    v_mfma_f32_16x16x32_bf16 a[92:95], a[252:255], v[116:119], a[92:95]
    ds_read_b128 v[60:63], v35 offset:0
    s_waitcnt lgkmcnt(8)
    v_alignbit_b32 v80, v97, v96, 16
    v_mfma_f32_16x16x32_bf16 a[92:95], a[220:223], v[112:115], a[92:95]
    v_alignbit_b32 v81, v98, v97, 16
    v_mfma_f32_16x16x32_bf16 a[96:99], a[192:195], v[120:123], a[96:99]
    v_alignbit_b32 v82, v99, v98, 16
    v_mfma_f32_16x16x32_bf16 a[96:99], a[224:227], v[124:127], a[96:99]
    s_waitcnt lgkmcnt(7)
    v_alignbit_b32 v83, v76, v99, 16
    v_mfma_f32_16x16x32_bf16 a[100:103], a[228:231], v[124:127], a[100:103]
    ds_read_b128 v[64:67], v35 offset:512
    ds_write_b128 v29, v[80:83] offset:0
    v_mfma_f32_16x16x32_bf16 a[100:103], a[196:199], v[120:123], a[100:103]
    s_waitcnt lgkmcnt(8)
    v_alignbit_b32 v84, v101, v100, 16
    v_mfma_f32_16x16x32_bf16 a[104:107], a[200:203], v[120:123], a[104:107]
    v_alignbit_b32 v85, v102, v101, 16
    v_alignbit_b32 v86, v103, v102, 16
    v_mfma_f32_16x16x32_bf16 a[104:107], a[232:235], v[124:127], a[104:107]
    s_waitcnt lgkmcnt(7)
    v_alignbit_b32 v87, v77, v103, 16
    v_mfma_f32_16x16x32_bf16 a[108:111], a[236:239], v[124:127], a[108:111]
    ds_read_b128 v[68:71], v35 offset:64
    ds_write_b128 v29, v[84:87] offset:1024
    v_mfma_f32_16x16x32_bf16 a[108:111], a[204:207], v[120:123], a[108:111]
    s_waitcnt lgkmcnt(8)
    v_alignbit_b32 v80, v105, v104, 16
    v_mfma_f32_16x16x32_bf16 a[112:115], a[208:211], v[120:123], a[112:115]
    v_alignbit_b32 v81, v106, v105, 16
    v_mfma_f32_16x16x32_bf16 a[112:115], a[240:243], v[124:127], a[112:115]
    v_alignbit_b32 v82, v107, v106, 16
    v_mfma_f32_16x16x32_bf16 a[116:119], a[244:247], v[124:127], a[116:119]
    ds_read_b128 v[72:75], v35 offset:576
    s_waitcnt lgkmcnt(8)
    v_alignbit_b32 v83, v78, v107, 16
    v_mfma_f32_16x16x32_bf16 a[116:119], a[212:215], v[120:123], a[116:119]
    ds_write_b128 v29, v[80:83] offset:2048
    v_mfma_f32_16x16x32_bf16 a[120:123], a[216:219], v[120:123], a[120:123]
    s_waitcnt lgkmcnt(8)
    v_alignbit_b32 v84, v109, v108, 16
    v_alignbit_b32 v85, v110, v109, 16
    v_mfma_f32_16x16x32_bf16 a[120:123], a[248:251], v[124:127], a[120:123]
    v_alignbit_b32 v86, v111, v110, 16
    v_mfma_f32_16x16x32_bf16 a[124:127], a[252:255], v[124:127], a[124:127]
    s_waitcnt lgkmcnt(7)
    v_alignbit_b32 v87, v79, v111, 16
    v_mfma_f32_16x16x32_bf16 a[124:127], a[220:223], v[120:123], a[124:127]
    ds_write_b128 v29, v[84:87] offset:3072
.p2align 3
    s_waitcnt lgkmcnt(7)
    v_pk_fma_f32 v[128:129], v[60:61], v[36:37], v[128:129]
    v_pk_fma_f32 v[130:131], v[62:63], v[36:37], v[130:131]
    s_waitcnt lgkmcnt(4)
    v_pk_fma_f32 v[132:133], v[68:69], v[36:37], v[132:133]
    v_pk_fma_f32 v[134:135], v[70:71], v[36:37], v[134:135]
    v_pk_mul_f32 v[84:85], v[128:129], v[38:39]
    v_pk_mul_f32 v[86:87], v[130:131], v[38:39]
    v_pk_mul_f32 v[88:89], v[132:133], v[38:39]
    v_pk_mul_f32 v[90:91], v[134:135], v[38:39]
    v_accvgpr_read_b32 v76, a0
    v_accvgpr_read_b32 v77, a1
    v_accvgpr_read_b32 v78, a2
    v_accvgpr_read_b32 v79, a3
    v_accvgpr_read_b32 v80, a4
    v_accvgpr_read_b32 v81, a5
    v_accvgpr_read_b32 v82, a6
    v_accvgpr_read_b32 v83, a7
    v_exp_f32 v84, v84
    v_exp_f32 v85, v85
    v_exp_f32 v86, v86
    v_exp_f32 v87, v87
    v_exp_f32 v88, v88
    v_exp_f32 v89, v89
    v_exp_f32 v90, v90
    v_exp_f32 v91, v91
    v_pk_fma_f32 v[76:77], v[64:65], v[36:37], v[76:77]
    v_pk_fma_f32 v[78:79], v[66:67], v[36:37], v[78:79]
    s_waitcnt lgkmcnt(2)
    v_pk_fma_f32 v[80:81], v[72:73], v[36:37], v[80:81]
    v_pk_fma_f32 v[82:83], v[74:75], v[36:37], v[82:83]
    v_pk_fma_f32 v[84:85], v[84:85], v[40:41], v[40:41]
    v_pk_fma_f32 v[86:87], v[86:87], v[40:41], v[40:41]
    v_pk_fma_f32 v[88:89], v[88:89], v[40:41], v[40:41]
    v_pk_fma_f32 v[90:91], v[90:91], v[40:41], v[40:41]
    v_pk_mul_f32 v[128:129], v[128:129], v[76:77]
    v_pk_mul_f32 v[130:131], v[130:131], v[78:79]
    v_pk_mul_f32 v[132:133], v[132:133], v[80:81]
    v_pk_mul_f32 v[134:135], v[134:135], v[82:83]
    v_rcp_f32 v84, v84
    v_rcp_f32 v85, v85
    v_rcp_f32 v86, v86
    v_rcp_f32 v87, v87
    v_rcp_f32 v88, v88
    v_rcp_f32 v89, v89
    v_rcp_f32 v90, v90
    v_rcp_f32_e64 v91, v91
    v_pk_mul_f32 v[128:129], v[128:129], v[84:85]
    v_pk_mul_f32 v[130:131], v[130:131], v[86:87]
    v_pk_mul_f32 v[132:133], v[132:133], v[88:89]
    v_pk_mul_f32 v[134:135], v[134:135], v[90:91]
    v_cvt_pk_bf16_f32 v128, v128, v129
    v_cvt_pk_bf16_f32 v129, v130, v131
    v_cvt_pk_bf16_f32 v130, v132, v133
    v_cvt_pk_bf16_f32 v131, v134, v135
    v_pk_fma_f32 v[160:161], v[60:61], v[42:43], v[160:161]
    v_pk_fma_f32 v[162:163], v[62:63], v[42:43], v[162:163]
    v_pk_fma_f32 v[164:165], v[68:69], v[42:43], v[164:165]
    v_pk_fma_f32 v[166:167], v[70:71], v[42:43], v[166:167]
    v_permlane16_swap_b32 v128, v130
    v_permlane16_swap_b32 v129, v131
    buffer_store_dwordx4 v[128:131], v16, s[64:67], s32 offen offset:0 sc1
    v_pk_mul_f32 v[84:85], v[160:161], v[44:45]
    v_pk_mul_f32 v[86:87], v[162:163], v[44:45]
    v_pk_mul_f32 v[88:89], v[164:165], v[44:45]
    v_pk_mul_f32 v[90:91], v[166:167], v[44:45]
    v_accvgpr_read_b32 v76, a32
    v_accvgpr_read_b32 v77, a33
    v_accvgpr_read_b32 v78, a34
    v_accvgpr_read_b32 v79, a35
    v_accvgpr_read_b32 v80, a36
    v_accvgpr_read_b32 v81, a37
    v_accvgpr_read_b32 v82, a38
    v_accvgpr_read_b32 v83, a39
    v_exp_f32 v84, v84
    v_exp_f32 v85, v85
    v_exp_f32 v86, v86
    v_exp_f32 v87, v87
    v_exp_f32 v88, v88
    v_exp_f32 v89, v89
    v_exp_f32 v90, v90
    v_exp_f32 v91, v91
    v_pk_fma_f32 v[76:77], v[64:65], v[42:43], v[76:77]
    v_pk_fma_f32 v[78:79], v[66:67], v[42:43], v[78:79]
    v_pk_fma_f32 v[80:81], v[72:73], v[42:43], v[80:81]
    v_pk_fma_f32 v[82:83], v[74:75], v[42:43], v[82:83]
    v_pk_fma_f32 v[84:85], v[84:85], v[46:47], v[46:47]
    v_pk_fma_f32 v[86:87], v[86:87], v[46:47], v[46:47]
    v_pk_fma_f32 v[88:89], v[88:89], v[46:47], v[46:47]
    v_pk_fma_f32 v[90:91], v[90:91], v[46:47], v[46:47]
    v_pk_mul_f32 v[160:161], v[160:161], v[76:77]
    v_pk_mul_f32 v[162:163], v[162:163], v[78:79]
    v_pk_mul_f32 v[164:165], v[164:165], v[80:81]
    v_pk_mul_f32 v[166:167], v[166:167], v[82:83]
    v_rcp_f32 v84, v84
    v_rcp_f32 v85, v85
    v_rcp_f32 v86, v86
    v_rcp_f32 v87, v87
    v_rcp_f32 v88, v88
    v_rcp_f32 v89, v89
    v_rcp_f32 v90, v90
    v_rcp_f32 v91, v91
    v_pk_mul_f32 v[160:161], v[160:161], v[84:85]
    v_pk_mul_f32 v[162:163], v[162:163], v[86:87]
    v_pk_mul_f32 v[164:165], v[164:165], v[88:89]
    v_pk_mul_f32 v[166:167], v[166:167], v[90:91]
    v_cvt_pk_bf16_f32 v160, v160, v161
    v_cvt_pk_bf16_f32 v161, v162, v163
    v_cvt_pk_bf16_f32 v162, v164, v165
    v_cvt_pk_bf16_f32 v163, v166, v167
    v_pk_fma_f32 v[192:193], v[60:61], v[48:49], v[192:193]
    v_pk_fma_f32 v[194:195], v[62:63], v[48:49], v[194:195]
    v_pk_fma_f32 v[196:197], v[68:69], v[48:49], v[196:197]
    v_pk_fma_f32 v[198:199], v[70:71], v[48:49], v[198:199]
    v_permlane16_swap_b32 v160, v162
    v_permlane16_swap_b32 v161, v163
    buffer_store_dwordx4 v[160:163], v16, s[64:67], s32 offen offset:1024 sc1
    v_pk_mul_f32 v[84:85], v[192:193], v[50:51]
    v_pk_mul_f32 v[86:87], v[194:195], v[50:51]
    v_pk_mul_f32 v[88:89], v[196:197], v[50:51]
    v_pk_mul_f32 v[90:91], v[198:199], v[50:51]
    v_accvgpr_read_b32 v76, a64
    v_accvgpr_read_b32 v77, a65
    v_accvgpr_read_b32 v78, a66
    v_accvgpr_read_b32 v79, a67
    v_accvgpr_read_b32 v80, a68
    v_accvgpr_read_b32 v81, a69
    v_accvgpr_read_b32 v82, a70
    v_accvgpr_read_b32 v83, a71
    v_exp_f32 v84, v84
    v_exp_f32 v85, v85
    v_exp_f32 v86, v86
    v_exp_f32 v87, v87
    v_exp_f32 v88, v88
    v_exp_f32 v89, v89
    v_exp_f32 v90, v90
    v_exp_f32 v91, v91
    v_pk_fma_f32 v[76:77], v[64:65], v[48:49], v[76:77]
    v_pk_fma_f32 v[78:79], v[66:67], v[48:49], v[78:79]
    v_pk_fma_f32 v[80:81], v[72:73], v[48:49], v[80:81]
    v_pk_fma_f32 v[82:83], v[74:75], v[48:49], v[82:83]
    v_pk_fma_f32 v[84:85], v[84:85], v[52:53], v[52:53]
    v_pk_fma_f32 v[86:87], v[86:87], v[52:53], v[52:53]
    v_pk_fma_f32 v[88:89], v[88:89], v[52:53], v[52:53]
    v_pk_fma_f32 v[90:91], v[90:91], v[52:53], v[52:53]
    v_pk_mul_f32 v[192:193], v[192:193], v[76:77]
    v_pk_mul_f32 v[194:195], v[194:195], v[78:79]
    v_pk_mul_f32 v[196:197], v[196:197], v[80:81]
    v_pk_mul_f32 v[198:199], v[198:199], v[82:83]
    v_rcp_f32 v84, v84
    v_rcp_f32 v85, v85
    v_rcp_f32 v86, v86
    v_rcp_f32 v87, v87
    v_rcp_f32 v88, v88
    v_rcp_f32 v89, v89
    v_rcp_f32 v90, v90
    v_rcp_f32 v91, v91
    v_pk_mul_f32 v[192:193], v[192:193], v[84:85]
    v_pk_mul_f32 v[194:195], v[194:195], v[86:87]
    v_pk_mul_f32 v[196:197], v[196:197], v[88:89]
    v_pk_mul_f32 v[198:199], v[198:199], v[90:91]
    v_cvt_pk_bf16_f32 v192, v192, v193
    v_cvt_pk_bf16_f32 v193, v194, v195
    v_cvt_pk_bf16_f32 v194, v196, v197
    v_cvt_pk_bf16_f32 v195, v198, v199
    v_pk_fma_f32 v[224:225], v[60:61], v[54:55], v[224:225]
    v_pk_fma_f32 v[226:227], v[62:63], v[54:55], v[226:227]
    v_pk_fma_f32 v[228:229], v[68:69], v[54:55], v[228:229]
    v_pk_fma_f32 v[230:231], v[70:71], v[54:55], v[230:231]
    v_permlane16_swap_b32 v192, v194
    v_permlane16_swap_b32 v193, v195
    buffer_store_dwordx4 v[192:195], v16, s[64:67], s32 offen offset:2048 sc1
    v_pk_mul_f32 v[84:85], v[224:225], v[56:57]
    v_pk_mul_f32 v[86:87], v[226:227], v[56:57]
    v_pk_mul_f32 v[88:89], v[228:229], v[56:57]
    v_pk_mul_f32 v[90:91], v[230:231], v[56:57]
    v_accvgpr_read_b32 v76, a96
    v_accvgpr_read_b32 v77, a97
    v_accvgpr_read_b32 v78, a98
    v_accvgpr_read_b32 v79, a99
    v_accvgpr_read_b32 v80, a100
    v_accvgpr_read_b32 v81, a101
    v_accvgpr_read_b32 v82, a102
    v_accvgpr_read_b32 v83, a103
    v_exp_f32 v84, v84
    v_exp_f32 v85, v85
    v_exp_f32 v86, v86
    v_exp_f32 v87, v87
    v_exp_f32 v88, v88
    v_exp_f32 v89, v89
    v_exp_f32 v90, v90
    v_exp_f32 v91, v91
    v_pk_fma_f32 v[76:77], v[64:65], v[54:55], v[76:77]
    v_pk_fma_f32 v[78:79], v[66:67], v[54:55], v[78:79]
    v_pk_fma_f32 v[80:81], v[72:73], v[54:55], v[80:81]
    v_pk_fma_f32 v[82:83], v[74:75], v[54:55], v[82:83]
    ds_read_b128 v[60:63], v35 offset:128
    ds_read_b128 v[64:67], v35 offset:640
    ds_read_b128 v[68:71], v35 offset:192
    ds_read_b128 v[72:75], v35 offset:704
    v_pk_fma_f32 v[84:85], v[84:85], v[58:59], v[58:59]
    v_pk_fma_f32 v[86:87], v[86:87], v[58:59], v[58:59]
    v_pk_fma_f32 v[88:89], v[88:89], v[58:59], v[58:59]
    v_pk_fma_f32 v[90:91], v[90:91], v[58:59], v[58:59]
    v_pk_mul_f32 v[224:225], v[224:225], v[76:77]
    v_pk_mul_f32 v[226:227], v[226:227], v[78:79]
    v_pk_mul_f32 v[228:229], v[228:229], v[80:81]
    v_pk_mul_f32 v[230:231], v[230:231], v[82:83]
    v_rcp_f32 v84, v84
    v_rcp_f32 v85, v85
    v_rcp_f32 v86, v86
    v_rcp_f32 v87, v87
    v_rcp_f32 v88, v88
    v_rcp_f32 v89, v89
    v_rcp_f32 v90, v90
    v_rcp_f32 v91, v91
    v_pk_mul_f32 v[224:225], v[224:225], v[84:85]
    v_pk_mul_f32 v[226:227], v[226:227], v[86:87]
    v_pk_mul_f32 v[228:229], v[228:229], v[88:89]
    v_pk_mul_f32 v[230:231], v[230:231], v[90:91]
    v_cvt_pk_bf16_f32 v224, v224, v225
    v_cvt_pk_bf16_f32 v225, v226, v227
    v_cvt_pk_bf16_f32 v226, v228, v229
    v_cvt_pk_bf16_f32 v227, v230, v231
    s_waitcnt lgkmcnt(3)
    v_pk_fma_f32 v[136:137], v[60:61], v[36:37], v[136:137]
    v_pk_fma_f32 v[138:139], v[62:63], v[36:37], v[138:139]
    s_waitcnt lgkmcnt(1)
    v_pk_fma_f32 v[140:141], v[68:69], v[36:37], v[140:141]
    v_pk_fma_f32 v[142:143], v[70:71], v[36:37], v[142:143]
    v_permlane16_swap_b32 v224, v226
    v_permlane16_swap_b32 v225, v227
    buffer_store_dwordx4 v[224:227], v16, s[64:67], s32 offen offset:3072 sc1
    s_add_u32 s32, s32, 0x4000
    v_pk_mul_f32 v[84:85], v[136:137], v[38:39]
    v_pk_mul_f32 v[86:87], v[138:139], v[38:39]
    v_pk_mul_f32 v[88:89], v[140:141], v[38:39]
    v_pk_mul_f32 v[90:91], v[142:143], v[38:39]
    v_accvgpr_read_b32 v76, a8
    v_accvgpr_read_b32 v77, a9
    v_accvgpr_read_b32 v78, a10
    v_accvgpr_read_b32 v79, a11
    v_accvgpr_read_b32 v80, a12
    v_accvgpr_read_b32 v81, a13
    v_accvgpr_read_b32 v82, a14
    v_accvgpr_read_b32 v83, a15
    v_exp_f32 v84, v84
    v_exp_f32 v85, v85
    v_exp_f32 v86, v86
    v_exp_f32 v87, v87
    v_exp_f32 v88, v88
    v_exp_f32 v89, v89
    v_exp_f32 v90, v90
    v_exp_f32 v91, v91
    v_pk_fma_f32 v[76:77], v[64:65], v[36:37], v[76:77]
    v_pk_fma_f32 v[78:79], v[66:67], v[36:37], v[78:79]
    s_waitcnt lgkmcnt(0)
    v_pk_fma_f32 v[80:81], v[72:73], v[36:37], v[80:81]
    v_pk_fma_f32 v[82:83], v[74:75], v[36:37], v[82:83]
    v_pk_fma_f32 v[84:85], v[84:85], v[40:41], v[40:41]
    v_pk_fma_f32 v[86:87], v[86:87], v[40:41], v[40:41]
    v_pk_fma_f32 v[88:89], v[88:89], v[40:41], v[40:41]
    v_pk_fma_f32 v[90:91], v[90:91], v[40:41], v[40:41]
    v_pk_mul_f32 v[136:137], v[136:137], v[76:77]
    v_pk_mul_f32 v[138:139], v[138:139], v[78:79]
    v_pk_mul_f32 v[140:141], v[140:141], v[80:81]
    v_pk_mul_f32 v[142:143], v[142:143], v[82:83]
    v_rcp_f32 v84, v84
    v_rcp_f32 v85, v85
    v_rcp_f32 v86, v86
    v_rcp_f32 v87, v87
    v_rcp_f32 v88, v88
    v_rcp_f32 v89, v89
    v_rcp_f32 v90, v90
    v_rcp_f32_e64 v91, v91
    v_pk_mul_f32 v[136:137], v[136:137], v[84:85]
    v_pk_mul_f32 v[138:139], v[138:139], v[86:87]
    v_pk_mul_f32 v[140:141], v[140:141], v[88:89]
    v_pk_mul_f32 v[142:143], v[142:143], v[90:91]
    v_cvt_pk_bf16_f32 v136, v136, v137
    v_cvt_pk_bf16_f32 v137, v138, v139
    v_cvt_pk_bf16_f32 v138, v140, v141
    v_cvt_pk_bf16_f32 v139, v142, v143
    v_pk_fma_f32 v[168:169], v[60:61], v[42:43], v[168:169]
    v_pk_fma_f32 v[170:171], v[62:63], v[42:43], v[170:171]
    v_pk_fma_f32 v[172:173], v[68:69], v[42:43], v[172:173]
    v_pk_fma_f32 v[174:175], v[70:71], v[42:43], v[174:175]
    v_permlane16_swap_b32 v136, v138
    v_permlane16_swap_b32 v137, v139
    buffer_store_dwordx4 v[136:139], v16, s[64:67], s32 offen offset:0 sc1
    v_pk_mul_f32 v[84:85], v[168:169], v[44:45]
    v_pk_mul_f32 v[86:87], v[170:171], v[44:45]
    v_pk_mul_f32 v[88:89], v[172:173], v[44:45]
    v_pk_mul_f32 v[90:91], v[174:175], v[44:45]
    v_accvgpr_read_b32 v76, a40
    v_accvgpr_read_b32 v77, a41
    v_accvgpr_read_b32 v78, a42
    v_accvgpr_read_b32 v79, a43
    v_accvgpr_read_b32 v80, a44
    v_accvgpr_read_b32 v81, a45
    v_accvgpr_read_b32 v82, a46
    v_accvgpr_read_b32 v83, a47
    v_exp_f32 v84, v84
    v_exp_f32 v85, v85
    v_exp_f32 v86, v86
    v_exp_f32 v87, v87
    v_exp_f32 v88, v88
    v_exp_f32 v89, v89
    v_exp_f32 v90, v90
    v_exp_f32 v91, v91
    v_pk_fma_f32 v[76:77], v[64:65], v[42:43], v[76:77]
    v_pk_fma_f32 v[78:79], v[66:67], v[42:43], v[78:79]
    v_pk_fma_f32 v[80:81], v[72:73], v[42:43], v[80:81]
    v_pk_fma_f32 v[82:83], v[74:75], v[42:43], v[82:83]
    v_pk_fma_f32 v[84:85], v[84:85], v[46:47], v[46:47]
    v_pk_fma_f32 v[86:87], v[86:87], v[46:47], v[46:47]
    v_pk_fma_f32 v[88:89], v[88:89], v[46:47], v[46:47]
    v_pk_fma_f32 v[90:91], v[90:91], v[46:47], v[46:47]
    v_pk_mul_f32 v[168:169], v[168:169], v[76:77]
    v_pk_mul_f32 v[170:171], v[170:171], v[78:79]
    v_pk_mul_f32 v[172:173], v[172:173], v[80:81]
    v_pk_mul_f32 v[174:175], v[174:175], v[82:83]
    v_rcp_f32 v84, v84
    v_rcp_f32 v85, v85
    v_rcp_f32 v86, v86
    v_rcp_f32 v87, v87
    v_rcp_f32 v88, v88
    v_rcp_f32 v89, v89
    v_rcp_f32 v90, v90
    v_rcp_f32 v91, v91
    v_pk_mul_f32 v[168:169], v[168:169], v[84:85]
    v_pk_mul_f32 v[170:171], v[170:171], v[86:87]
    v_pk_mul_f32 v[172:173], v[172:173], v[88:89]
    v_pk_mul_f32 v[174:175], v[174:175], v[90:91]
    v_cvt_pk_bf16_f32 v168, v168, v169
    v_cvt_pk_bf16_f32 v169, v170, v171
    v_cvt_pk_bf16_f32 v170, v172, v173
    v_cvt_pk_bf16_f32 v171, v174, v175
    v_pk_fma_f32 v[200:201], v[60:61], v[48:49], v[200:201]
    v_pk_fma_f32 v[202:203], v[62:63], v[48:49], v[202:203]
    v_pk_fma_f32 v[204:205], v[68:69], v[48:49], v[204:205]
    v_pk_fma_f32 v[206:207], v[70:71], v[48:49], v[206:207]
    v_permlane16_swap_b32 v168, v170
    v_permlane16_swap_b32 v169, v171
    buffer_store_dwordx4 v[168:171], v16, s[64:67], s32 offen offset:1024 sc1
    v_pk_mul_f32 v[84:85], v[200:201], v[50:51]
    v_pk_mul_f32 v[86:87], v[202:203], v[50:51]
    v_pk_mul_f32 v[88:89], v[204:205], v[50:51]
    v_pk_mul_f32 v[90:91], v[206:207], v[50:51]
    v_accvgpr_read_b32 v76, a72
    v_accvgpr_read_b32 v77, a73
    v_accvgpr_read_b32 v78, a74
    v_accvgpr_read_b32 v79, a75
    v_accvgpr_read_b32 v80, a76
    v_accvgpr_read_b32 v81, a77
    v_accvgpr_read_b32 v82, a78
    v_accvgpr_read_b32 v83, a79
    v_exp_f32 v84, v84
    v_exp_f32 v85, v85
    v_exp_f32 v86, v86
    v_exp_f32 v87, v87
    v_exp_f32 v88, v88
    v_exp_f32 v89, v89
    v_exp_f32 v90, v90
    v_exp_f32 v91, v91
    v_pk_fma_f32 v[76:77], v[64:65], v[48:49], v[76:77]
    v_pk_fma_f32 v[78:79], v[66:67], v[48:49], v[78:79]
    v_pk_fma_f32 v[80:81], v[72:73], v[48:49], v[80:81]
    v_pk_fma_f32 v[82:83], v[74:75], v[48:49], v[82:83]
    v_pk_fma_f32 v[84:85], v[84:85], v[52:53], v[52:53]
    v_pk_fma_f32 v[86:87], v[86:87], v[52:53], v[52:53]
    v_pk_fma_f32 v[88:89], v[88:89], v[52:53], v[52:53]
    v_pk_fma_f32 v[90:91], v[90:91], v[52:53], v[52:53]
    v_pk_mul_f32 v[200:201], v[200:201], v[76:77]
    v_pk_mul_f32 v[202:203], v[202:203], v[78:79]
    v_pk_mul_f32 v[204:205], v[204:205], v[80:81]
    v_pk_mul_f32 v[206:207], v[206:207], v[82:83]
    v_rcp_f32 v84, v84
    v_rcp_f32 v85, v85
    v_rcp_f32 v86, v86
    v_rcp_f32 v87, v87
    v_rcp_f32 v88, v88
    v_rcp_f32 v89, v89
    v_rcp_f32 v90, v90
    v_rcp_f32 v91, v91
    v_pk_mul_f32 v[200:201], v[200:201], v[84:85]
    v_pk_mul_f32 v[202:203], v[202:203], v[86:87]
    v_pk_mul_f32 v[204:205], v[204:205], v[88:89]
    v_pk_mul_f32 v[206:207], v[206:207], v[90:91]
    v_cvt_pk_bf16_f32 v200, v200, v201
    v_cvt_pk_bf16_f32 v201, v202, v203
    v_cvt_pk_bf16_f32 v202, v204, v205
    v_cvt_pk_bf16_f32 v203, v206, v207
    v_pk_fma_f32 v[232:233], v[60:61], v[54:55], v[232:233]
    v_pk_fma_f32 v[234:235], v[62:63], v[54:55], v[234:235]
    v_pk_fma_f32 v[236:237], v[68:69], v[54:55], v[236:237]
    v_pk_fma_f32 v[238:239], v[70:71], v[54:55], v[238:239]
    v_permlane16_swap_b32 v200, v202
    v_permlane16_swap_b32 v201, v203
    buffer_store_dwordx4 v[200:203], v16, s[64:67], s32 offen offset:2048 sc1
    v_pk_mul_f32 v[84:85], v[232:233], v[56:57]
    v_pk_mul_f32 v[86:87], v[234:235], v[56:57]
    v_pk_mul_f32 v[88:89], v[236:237], v[56:57]
    v_pk_mul_f32 v[90:91], v[238:239], v[56:57]
    v_accvgpr_read_b32 v76, a104
    v_accvgpr_read_b32 v77, a105
    v_accvgpr_read_b32 v78, a106
    v_accvgpr_read_b32 v79, a107
    v_accvgpr_read_b32 v80, a108
    v_accvgpr_read_b32 v81, a109
    v_accvgpr_read_b32 v82, a110
    v_accvgpr_read_b32 v83, a111
    v_exp_f32 v84, v84
    v_exp_f32 v85, v85
    v_exp_f32 v86, v86
    v_exp_f32 v87, v87
    v_exp_f32 v88, v88
    v_exp_f32 v89, v89
    v_exp_f32 v90, v90
    v_exp_f32 v91, v91
    v_pk_fma_f32 v[76:77], v[64:65], v[54:55], v[76:77]
    v_pk_fma_f32 v[78:79], v[66:67], v[54:55], v[78:79]
    v_pk_fma_f32 v[80:81], v[72:73], v[54:55], v[80:81]
    v_pk_fma_f32 v[82:83], v[74:75], v[54:55], v[82:83]
    ds_read_b128 v[60:63], v35 offset:256
    ds_read_b128 v[64:67], v35 offset:768
    ds_read_b128 v[68:71], v35 offset:320
    ds_read_b128 v[72:75], v35 offset:832
    v_pk_fma_f32 v[84:85], v[84:85], v[58:59], v[58:59]
    v_pk_fma_f32 v[86:87], v[86:87], v[58:59], v[58:59]
    v_pk_fma_f32 v[88:89], v[88:89], v[58:59], v[58:59]
    v_pk_fma_f32 v[90:91], v[90:91], v[58:59], v[58:59]
    v_pk_mul_f32 v[232:233], v[232:233], v[76:77]
    v_pk_mul_f32 v[234:235], v[234:235], v[78:79]
    v_pk_mul_f32 v[236:237], v[236:237], v[80:81]
    v_pk_mul_f32 v[238:239], v[238:239], v[82:83]
    v_rcp_f32 v84, v84
    v_rcp_f32 v85, v85
    v_rcp_f32 v86, v86
    v_rcp_f32 v87, v87
    v_rcp_f32 v88, v88
    v_rcp_f32 v89, v89
    v_rcp_f32 v90, v90
    v_rcp_f32 v91, v91
    v_pk_mul_f32 v[232:233], v[232:233], v[84:85]
    v_pk_mul_f32 v[234:235], v[234:235], v[86:87]
    v_pk_mul_f32 v[236:237], v[236:237], v[88:89]
    v_pk_mul_f32 v[238:239], v[238:239], v[90:91]
    v_cvt_pk_bf16_f32 v232, v232, v233
    v_cvt_pk_bf16_f32 v233, v234, v235
    v_cvt_pk_bf16_f32 v234, v236, v237
    v_cvt_pk_bf16_f32 v235, v238, v239
    s_waitcnt lgkmcnt(3)
    v_pk_fma_f32 v[144:145], v[60:61], v[36:37], v[144:145]
    v_pk_fma_f32 v[146:147], v[62:63], v[36:37], v[146:147]
    s_waitcnt lgkmcnt(1)
    v_pk_fma_f32 v[148:149], v[68:69], v[36:37], v[148:149]
    v_pk_fma_f32 v[150:151], v[70:71], v[36:37], v[150:151]
    v_permlane16_swap_b32 v232, v234
    v_permlane16_swap_b32 v233, v235
    buffer_store_dwordx4 v[232:235], v16, s[64:67], s32 offen offset:3072 sc1
    s_add_u32 s32, s32, 0x4000
    v_pk_mul_f32 v[84:85], v[144:145], v[38:39]
    v_pk_mul_f32 v[86:87], v[146:147], v[38:39]
    v_pk_mul_f32 v[88:89], v[148:149], v[38:39]
    v_pk_mul_f32 v[90:91], v[150:151], v[38:39]
    v_accvgpr_read_b32 v76, a16
    v_accvgpr_read_b32 v77, a17
    v_accvgpr_read_b32 v78, a18
    v_accvgpr_read_b32 v79, a19
    v_accvgpr_read_b32 v80, a20
    v_accvgpr_read_b32 v81, a21
    v_accvgpr_read_b32 v82, a22
    v_accvgpr_read_b32 v83, a23
    v_exp_f32 v84, v84
    v_exp_f32 v85, v85
    v_exp_f32 v86, v86
    v_exp_f32 v87, v87
    v_exp_f32 v88, v88
    v_exp_f32 v89, v89
    v_exp_f32 v90, v90
    v_exp_f32 v91, v91
    v_pk_fma_f32 v[76:77], v[64:65], v[36:37], v[76:77]
    v_pk_fma_f32 v[78:79], v[66:67], v[36:37], v[78:79]
    s_waitcnt lgkmcnt(0)
    v_pk_fma_f32 v[80:81], v[72:73], v[36:37], v[80:81]
    v_pk_fma_f32 v[82:83], v[74:75], v[36:37], v[82:83]
    v_pk_fma_f32 v[84:85], v[84:85], v[40:41], v[40:41]
    v_pk_fma_f32 v[86:87], v[86:87], v[40:41], v[40:41]
    v_pk_fma_f32 v[88:89], v[88:89], v[40:41], v[40:41]
    v_pk_fma_f32 v[90:91], v[90:91], v[40:41], v[40:41]
    v_pk_mul_f32 v[144:145], v[144:145], v[76:77]
    v_pk_mul_f32 v[146:147], v[146:147], v[78:79]
    v_pk_mul_f32 v[148:149], v[148:149], v[80:81]
    v_pk_mul_f32 v[150:151], v[150:151], v[82:83]
    v_rcp_f32 v84, v84
    v_rcp_f32 v85, v85
    v_rcp_f32 v86, v86
    v_rcp_f32 v87, v87
    v_rcp_f32 v88, v88
    v_rcp_f32 v89, v89
    v_rcp_f32 v90, v90
    v_rcp_f32_e64 v91, v91
    v_pk_mul_f32 v[144:145], v[144:145], v[84:85]
    v_pk_mul_f32 v[146:147], v[146:147], v[86:87]
    v_pk_mul_f32 v[148:149], v[148:149], v[88:89]
    v_pk_mul_f32 v[150:151], v[150:151], v[90:91]
    v_cvt_pk_bf16_f32 v144, v144, v145
    v_cvt_pk_bf16_f32 v145, v146, v147
    v_cvt_pk_bf16_f32 v146, v148, v149
    v_cvt_pk_bf16_f32 v147, v150, v151
    v_pk_fma_f32 v[176:177], v[60:61], v[42:43], v[176:177]
    v_pk_fma_f32 v[178:179], v[62:63], v[42:43], v[178:179]
    v_pk_fma_f32 v[180:181], v[68:69], v[42:43], v[180:181]
    v_pk_fma_f32 v[182:183], v[70:71], v[42:43], v[182:183]
    v_permlane16_swap_b32 v144, v146
    v_permlane16_swap_b32 v145, v147
    buffer_store_dwordx4 v[144:147], v16, s[64:67], s32 offen offset:0 sc1
    v_pk_mul_f32 v[84:85], v[176:177], v[44:45]
    v_pk_mul_f32 v[86:87], v[178:179], v[44:45]
    v_pk_mul_f32 v[88:89], v[180:181], v[44:45]
    v_pk_mul_f32 v[90:91], v[182:183], v[44:45]
    v_accvgpr_read_b32 v76, a48
    v_accvgpr_read_b32 v77, a49
    v_accvgpr_read_b32 v78, a50
    v_accvgpr_read_b32 v79, a51
    v_accvgpr_read_b32 v80, a52
    v_accvgpr_read_b32 v81, a53
    v_accvgpr_read_b32 v82, a54
    v_accvgpr_read_b32 v83, a55
    v_exp_f32 v84, v84
    v_exp_f32 v85, v85
    v_exp_f32 v86, v86
    v_exp_f32 v87, v87
    v_exp_f32 v88, v88
    v_exp_f32 v89, v89
    v_exp_f32 v90, v90
    v_exp_f32 v91, v91
    v_pk_fma_f32 v[76:77], v[64:65], v[42:43], v[76:77]
    v_pk_fma_f32 v[78:79], v[66:67], v[42:43], v[78:79]
    v_pk_fma_f32 v[80:81], v[72:73], v[42:43], v[80:81]
    v_pk_fma_f32 v[82:83], v[74:75], v[42:43], v[82:83]
    v_pk_fma_f32 v[84:85], v[84:85], v[46:47], v[46:47]
    v_pk_fma_f32 v[86:87], v[86:87], v[46:47], v[46:47]
    v_pk_fma_f32 v[88:89], v[88:89], v[46:47], v[46:47]
    v_pk_fma_f32 v[90:91], v[90:91], v[46:47], v[46:47]
    v_pk_mul_f32 v[176:177], v[176:177], v[76:77]
    v_pk_mul_f32 v[178:179], v[178:179], v[78:79]
    v_pk_mul_f32 v[180:181], v[180:181], v[80:81]
    v_pk_mul_f32 v[182:183], v[182:183], v[82:83]
    v_rcp_f32 v84, v84
    v_rcp_f32 v85, v85
    v_rcp_f32 v86, v86
    v_rcp_f32 v87, v87
    v_rcp_f32 v88, v88
    v_rcp_f32 v89, v89
    v_rcp_f32 v90, v90
    v_rcp_f32 v91, v91
    v_pk_mul_f32 v[176:177], v[176:177], v[84:85]
    v_pk_mul_f32 v[178:179], v[178:179], v[86:87]
    v_pk_mul_f32 v[180:181], v[180:181], v[88:89]
    v_pk_mul_f32 v[182:183], v[182:183], v[90:91]
    v_cvt_pk_bf16_f32 v176, v176, v177
    v_cvt_pk_bf16_f32 v177, v178, v179
    v_cvt_pk_bf16_f32 v178, v180, v181
    v_cvt_pk_bf16_f32 v179, v182, v183
    v_pk_fma_f32 v[208:209], v[60:61], v[48:49], v[208:209]
    v_pk_fma_f32 v[210:211], v[62:63], v[48:49], v[210:211]
    v_pk_fma_f32 v[212:213], v[68:69], v[48:49], v[212:213]
    v_pk_fma_f32 v[214:215], v[70:71], v[48:49], v[214:215]
    v_permlane16_swap_b32 v176, v178
    v_permlane16_swap_b32 v177, v179
    buffer_store_dwordx4 v[176:179], v16, s[64:67], s32 offen offset:1024 sc1
    v_pk_mul_f32 v[84:85], v[208:209], v[50:51]
    v_pk_mul_f32 v[86:87], v[210:211], v[50:51]
    v_pk_mul_f32 v[88:89], v[212:213], v[50:51]
    v_pk_mul_f32 v[90:91], v[214:215], v[50:51]
    v_accvgpr_read_b32 v76, a80
    v_accvgpr_read_b32 v77, a81
    v_accvgpr_read_b32 v78, a82
    v_accvgpr_read_b32 v79, a83
    v_accvgpr_read_b32 v80, a84
    v_accvgpr_read_b32 v81, a85
    v_accvgpr_read_b32 v82, a86
    v_accvgpr_read_b32 v83, a87
    v_exp_f32 v84, v84
    v_exp_f32 v85, v85
    v_exp_f32 v86, v86
    v_exp_f32 v87, v87
    v_exp_f32 v88, v88
    v_exp_f32 v89, v89
    v_exp_f32 v90, v90
    v_exp_f32 v91, v91
    v_pk_fma_f32 v[76:77], v[64:65], v[48:49], v[76:77]
    v_pk_fma_f32 v[78:79], v[66:67], v[48:49], v[78:79]
    v_pk_fma_f32 v[80:81], v[72:73], v[48:49], v[80:81]
    v_pk_fma_f32 v[82:83], v[74:75], v[48:49], v[82:83]
    v_pk_fma_f32 v[84:85], v[84:85], v[52:53], v[52:53]
    v_pk_fma_f32 v[86:87], v[86:87], v[52:53], v[52:53]
    v_pk_fma_f32 v[88:89], v[88:89], v[52:53], v[52:53]
    v_pk_fma_f32 v[90:91], v[90:91], v[52:53], v[52:53]
    v_pk_mul_f32 v[208:209], v[208:209], v[76:77]
    v_pk_mul_f32 v[210:211], v[210:211], v[78:79]
    v_pk_mul_f32 v[212:213], v[212:213], v[80:81]
    v_pk_mul_f32 v[214:215], v[214:215], v[82:83]
    v_rcp_f32 v84, v84
    v_rcp_f32 v85, v85
    v_rcp_f32 v86, v86
    v_rcp_f32 v87, v87
    v_rcp_f32 v88, v88
    v_rcp_f32 v89, v89
    v_rcp_f32 v90, v90
    v_rcp_f32 v91, v91
    v_pk_mul_f32 v[208:209], v[208:209], v[84:85]
    v_pk_mul_f32 v[210:211], v[210:211], v[86:87]
    v_pk_mul_f32 v[212:213], v[212:213], v[88:89]
    v_pk_mul_f32 v[214:215], v[214:215], v[90:91]
    v_cvt_pk_bf16_f32 v208, v208, v209
    v_cvt_pk_bf16_f32 v209, v210, v211
    v_cvt_pk_bf16_f32 v210, v212, v213
    v_cvt_pk_bf16_f32 v211, v214, v215
    v_pk_fma_f32 v[240:241], v[60:61], v[54:55], v[240:241]
    v_pk_fma_f32 v[242:243], v[62:63], v[54:55], v[242:243]
    v_pk_fma_f32 v[244:245], v[68:69], v[54:55], v[244:245]
    v_pk_fma_f32 v[246:247], v[70:71], v[54:55], v[246:247]
    v_permlane16_swap_b32 v208, v210
    v_permlane16_swap_b32 v209, v211
    buffer_store_dwordx4 v[208:211], v16, s[64:67], s32 offen offset:2048 sc1
    v_pk_mul_f32 v[84:85], v[240:241], v[56:57]
    v_pk_mul_f32 v[86:87], v[242:243], v[56:57]
    v_pk_mul_f32 v[88:89], v[244:245], v[56:57]
    v_pk_mul_f32 v[90:91], v[246:247], v[56:57]
    v_accvgpr_read_b32 v76, a112
    v_accvgpr_read_b32 v77, a113
    v_accvgpr_read_b32 v78, a114
    v_accvgpr_read_b32 v79, a115
    v_accvgpr_read_b32 v80, a116
    v_accvgpr_read_b32 v81, a117
    v_accvgpr_read_b32 v82, a118
    v_accvgpr_read_b32 v83, a119
    v_exp_f32 v84, v84
    v_exp_f32 v85, v85
    v_exp_f32 v86, v86
    v_exp_f32 v87, v87
    v_exp_f32 v88, v88
    v_exp_f32 v89, v89
    v_exp_f32 v90, v90
    v_exp_f32 v91, v91
    v_pk_fma_f32 v[76:77], v[64:65], v[54:55], v[76:77]
    v_pk_fma_f32 v[78:79], v[66:67], v[54:55], v[78:79]
    v_pk_fma_f32 v[80:81], v[72:73], v[54:55], v[80:81]
    v_pk_fma_f32 v[82:83], v[74:75], v[54:55], v[82:83]
    ds_read_b128 v[60:63], v35 offset:384
    ds_read_b128 v[64:67], v35 offset:896
    ds_read_b128 v[68:71], v35 offset:448
    ds_read_b128 v[72:75], v35 offset:960
    v_pk_fma_f32 v[84:85], v[84:85], v[58:59], v[58:59]
    v_pk_fma_f32 v[86:87], v[86:87], v[58:59], v[58:59]
    v_pk_fma_f32 v[88:89], v[88:89], v[58:59], v[58:59]
    v_pk_fma_f32 v[90:91], v[90:91], v[58:59], v[58:59]
    v_pk_mul_f32 v[240:241], v[240:241], v[76:77]
    v_pk_mul_f32 v[242:243], v[242:243], v[78:79]
    v_pk_mul_f32 v[244:245], v[244:245], v[80:81]
    v_pk_mul_f32 v[246:247], v[246:247], v[82:83]
    v_rcp_f32 v84, v84
    v_rcp_f32 v85, v85
    v_rcp_f32 v86, v86
    v_rcp_f32 v87, v87
    v_rcp_f32 v88, v88
    v_rcp_f32 v89, v89
    v_rcp_f32 v90, v90
    v_rcp_f32 v91, v91
    v_pk_mul_f32 v[240:241], v[240:241], v[84:85]
    v_pk_mul_f32 v[242:243], v[242:243], v[86:87]
    v_pk_mul_f32 v[244:245], v[244:245], v[88:89]
    v_pk_mul_f32 v[246:247], v[246:247], v[90:91]
    v_cvt_pk_bf16_f32 v240, v240, v241
    v_cvt_pk_bf16_f32 v241, v242, v243
    v_cvt_pk_bf16_f32 v242, v244, v245
    v_cvt_pk_bf16_f32 v243, v246, v247
    s_waitcnt lgkmcnt(3)
    v_pk_fma_f32 v[152:153], v[60:61], v[36:37], v[152:153]
    v_pk_fma_f32 v[154:155], v[62:63], v[36:37], v[154:155]
    s_waitcnt lgkmcnt(1)
    v_pk_fma_f32 v[156:157], v[68:69], v[36:37], v[156:157]
    v_pk_fma_f32 v[158:159], v[70:71], v[36:37], v[158:159]
    v_permlane16_swap_b32 v240, v242
    v_permlane16_swap_b32 v241, v243
    buffer_store_dwordx4 v[240:243], v16, s[64:67], s32 offen offset:3072 sc1
    s_add_u32 s32, s32, 0x4000
    v_pk_mul_f32 v[84:85], v[152:153], v[38:39]
    v_pk_mul_f32 v[86:87], v[154:155], v[38:39]
    v_pk_mul_f32 v[88:89], v[156:157], v[38:39]
    v_pk_mul_f32 v[90:91], v[158:159], v[38:39]
    v_accvgpr_read_b32 v76, a24
    s_waitcnt vmcnt(20)
    ds_read2_b64 a[128:131], v12 offset0:0 offset1:1
    v_accvgpr_read_b32 v77, a25
    v_accvgpr_read_b32 v78, a26
    v_accvgpr_read_b32 v79, a27
    v_accvgpr_read_b32 v80, a28
    v_accvgpr_read_b32 v81, a29
    v_accvgpr_read_b32 v82, a30
    v_accvgpr_read_b32 v83, a31
    v_exp_f32 v84, v84
    v_exp_f32 v85, v85
    v_exp_f32 v86, v86
    v_exp_f32 v87, v87
    v_exp_f32 v88, v88
    ds_read_b128 a[160:163], v18 offset:4032
    v_exp_f32 v89, v89
    v_exp_f32 v90, v90
    v_exp_f32_e64 v91, v91
    v_pk_fma_f32 v[76:77], v[64:65], v[36:37], v[76:77]
    v_pk_fma_f32 v[78:79], v[66:67], v[36:37], v[78:79]
    s_waitcnt lgkmcnt(2)
    v_pk_fma_f32 v[80:81], v[72:73], v[36:37], v[80:81]
    v_pk_fma_f32 v[82:83], v[74:75], v[36:37], v[82:83]
    v_pk_fma_f32 v[84:85], v[84:85], v[40:41], v[40:41]
    v_pk_fma_f32 v[86:87], v[86:87], v[40:41], v[40:41]
    v_pk_fma_f32 v[88:89], v[88:89], v[40:41], v[40:41]
    v_pk_fma_f32 v[90:91], v[90:91], v[40:41], v[40:41]
    v_pk_mul_f32 v[152:153], v[152:153], v[76:77]
    ds_read2_b64 a[132:135], v12 offset0:64 offset1:65
    v_pk_mul_f32 v[154:155], v[154:155], v[78:79]
    v_pk_mul_f32 v[156:157], v[156:157], v[80:81]
    v_pk_mul_f32 v[158:159], v[158:159], v[82:83]
    v_rcp_f32 v84, v84
    v_rcp_f32 v85, v85
    v_rcp_f32 v86, v86
    v_rcp_f32 v87, v87
    v_rcp_f32 v88, v88
    v_rcp_f32 v89, v89
    v_rcp_f32 v90, v90
    v_rcp_f32_e64 v91, v91
    v_pk_mul_f32 v[152:153], v[152:153], v[84:85]
    ds_read_b128 a[164:167], v18 offset:3520
    v_pk_mul_f32 v[154:155], v[154:155], v[86:87]
    v_pk_mul_f32 v[156:157], v[156:157], v[88:89]
    v_pk_mul_f32 v[158:159], v[158:159], v[90:91]
    v_cvt_pk_bf16_f32 v152, v152, v153
    v_cvt_pk_bf16_f32 v153, v154, v155
    v_cvt_pk_bf16_f32 v154, v156, v157
    v_cvt_pk_bf16_f32 v155, v158, v159
    v_pk_fma_f32 v[184:185], v[60:61], v[42:43], v[184:185]
    v_pk_fma_f32 v[186:187], v[62:63], v[42:43], v[186:187]
    v_pk_fma_f32 v[188:189], v[68:69], v[42:43], v[188:189]
    v_pk_fma_f32 v[190:191], v[70:71], v[42:43], v[190:191]
    v_permlane16_swap_b32 v152, v154
    ds_read2_b64 a[136:139], v12 offset0:128 offset1:129
    v_permlane16_swap_b32 v153, v155
    buffer_store_dwordx4 v[152:155], v16, s[64:67], s32 offen offset:0 sc1
    v_pk_mul_f32 v[84:85], v[184:185], v[44:45]
    v_pk_mul_f32 v[86:87], v[186:187], v[44:45]
    v_pk_mul_f32 v[88:89], v[188:189], v[44:45]
    v_pk_mul_f32 v[90:91], v[190:191], v[44:45]
    v_accvgpr_read_b32 v76, a56
    v_accvgpr_read_b32 v77, a57
    v_accvgpr_read_b32 v78, a58
    v_accvgpr_read_b32 v79, a59
    v_accvgpr_read_b32 v80, a60
    v_accvgpr_read_b32 v81, a61
    ds_read_b128 a[168:171], v18 offset:3008
    v_accvgpr_read_b32 v82, a62
    v_accvgpr_read_b32 v83, a63
    v_exp_f32 v84, v84
    v_exp_f32 v85, v85
    v_exp_f32 v86, v86
    v_exp_f32 v87, v87
    v_exp_f32 v88, v88
    v_exp_f32 v89, v89
    v_exp_f32 v90, v90
    v_exp_f32 v91, v91
    v_pk_fma_f32 v[76:77], v[64:65], v[42:43], v[76:77]
    v_pk_fma_f32 v[78:79], v[66:67], v[42:43], v[78:79]
    ds_read2_b64 a[140:143], v12 offset0:192 offset1:193
    v_pk_fma_f32 v[80:81], v[72:73], v[42:43], v[80:81]
    v_pk_fma_f32 v[82:83], v[74:75], v[42:43], v[82:83]
    v_pk_fma_f32 v[84:85], v[84:85], v[46:47], v[46:47]
    v_pk_fma_f32 v[86:87], v[86:87], v[46:47], v[46:47]
    v_pk_fma_f32 v[88:89], v[88:89], v[46:47], v[46:47]
    v_pk_fma_f32 v[90:91], v[90:91], v[46:47], v[46:47]
    v_pk_mul_f32 v[184:185], v[184:185], v[76:77]
    v_pk_mul_f32 v[186:187], v[186:187], v[78:79]
    v_pk_mul_f32 v[188:189], v[188:189], v[80:81]
    v_pk_mul_f32 v[190:191], v[190:191], v[82:83]
    v_rcp_f32 v84, v84
    v_rcp_f32 v85, v85
    ds_read_b128 a[172:175], v18 offset:2496
    v_rcp_f32 v86, v86
    v_rcp_f32 v87, v87
    v_rcp_f32 v88, v88
    v_rcp_f32 v89, v89
    v_rcp_f32 v90, v90
    v_rcp_f32 v91, v91
    v_pk_mul_f32 v[184:185], v[184:185], v[84:85]
    v_pk_mul_f32 v[186:187], v[186:187], v[86:87]
    v_pk_mul_f32 v[188:189], v[188:189], v[88:89]
    v_pk_mul_f32 v[190:191], v[190:191], v[90:91]
    v_cvt_pk_bf16_f32 v184, v184, v185
    v_cvt_pk_bf16_f32 v185, v186, v187
    ds_read2_b64 a[144:147], v13 offset0:0 offset1:1
    v_cvt_pk_bf16_f32 v186, v188, v189
    v_cvt_pk_bf16_f32 v187, v190, v191
    v_pk_fma_f32 v[216:217], v[60:61], v[48:49], v[216:217]
    v_pk_fma_f32 v[218:219], v[62:63], v[48:49], v[218:219]
    v_pk_fma_f32 v[220:221], v[68:69], v[48:49], v[220:221]
    v_pk_fma_f32 v[222:223], v[70:71], v[48:49], v[222:223]
    v_permlane16_swap_b32 v184, v186
    v_permlane16_swap_b32 v185, v187
    buffer_store_dwordx4 v[184:187], v16, s[64:67], s32 offen offset:1024 sc1
    v_pk_mul_f32 v[84:85], v[216:217], v[50:51]
    v_pk_mul_f32 v[86:87], v[218:219], v[50:51]
    v_pk_mul_f32 v[88:89], v[220:221], v[50:51]
    ds_read_b128 a[176:179], v18 offset:1984
    v_pk_mul_f32 v[90:91], v[222:223], v[50:51]
    v_accvgpr_read_b32 v76, a88
    v_accvgpr_read_b32 v77, a89
    v_accvgpr_read_b32 v78, a90
    v_accvgpr_read_b32 v79, a91
    v_accvgpr_read_b32 v80, a92
    v_accvgpr_read_b32 v81, a93
    v_accvgpr_read_b32 v82, a94
    v_accvgpr_read_b32 v83, a95
    v_exp_f32 v84, v84
    v_exp_f32 v85, v85
    v_exp_f32_e64 v86, v86
    ds_read2_b64 a[148:151], v13 offset0:64 offset1:65
    v_exp_f32 v87, v87
    v_exp_f32 v88, v88
    v_exp_f32 v89, v89
    v_exp_f32 v90, v90
    v_exp_f32_e64 v91, v91
    v_pk_fma_f32 v[76:77], v[64:65], v[48:49], v[76:77]
    v_pk_fma_f32 v[78:79], v[66:67], v[48:49], v[78:79]
    v_pk_fma_f32 v[80:81], v[72:73], v[48:49], v[80:81]
    v_pk_fma_f32 v[82:83], v[74:75], v[48:49], v[82:83]
    v_pk_fma_f32 v[84:85], v[84:85], v[52:53], v[52:53]
    v_pk_fma_f32 v[86:87], v[86:87], v[52:53], v[52:53]
    v_pk_fma_f32 v[88:89], v[88:89], v[52:53], v[52:53]
    ds_read_b128 a[180:183], v18 offset:1472
    v_pk_fma_f32 v[90:91], v[90:91], v[52:53], v[52:53]
    v_pk_mul_f32 v[216:217], v[216:217], v[76:77]
    v_pk_mul_f32 v[218:219], v[218:219], v[78:79]
    v_pk_mul_f32 v[220:221], v[220:221], v[80:81]
    v_pk_mul_f32 v[222:223], v[222:223], v[82:83]
    v_rcp_f32 v84, v84
    v_rcp_f32 v85, v85
    v_rcp_f32 v86, v86
    v_rcp_f32 v87, v87
    v_rcp_f32 v88, v88
    v_rcp_f32 v89, v89
    v_rcp_f32_e64 v90, v90
    ds_read2_b64 a[152:155], v13 offset0:128 offset1:129
    v_rcp_f32_e64 v91, v91
    v_pk_mul_f32 v[216:217], v[216:217], v[84:85]
    v_pk_mul_f32 v[218:219], v[218:219], v[86:87]
    v_pk_mul_f32 v[220:221], v[220:221], v[88:89]
    v_pk_mul_f32 v[222:223], v[222:223], v[90:91]
    v_cvt_pk_bf16_f32 v216, v216, v217
    v_cvt_pk_bf16_f32 v217, v218, v219
    v_cvt_pk_bf16_f32 v218, v220, v221
    v_cvt_pk_bf16_f32 v219, v222, v223
    v_pk_fma_f32 v[248:249], v[60:61], v[54:55], v[248:249]
    v_pk_fma_f32 v[250:251], v[62:63], v[54:55], v[250:251]
    v_pk_fma_f32 v[252:253], v[68:69], v[54:55], v[252:253]
    ds_read_b128 a[184:187], v18 offset:960
    v_pk_fma_f32 v[254:255], v[70:71], v[54:55], v[254:255]
    v_permlane16_swap_b32 v216, v218
    v_permlane16_swap_b32 v217, v219
    buffer_store_dwordx4 v[216:219], v16, s[64:67], s32 offen offset:2048 sc1
    v_pk_mul_f32 v[84:85], v[248:249], v[56:57]
    v_pk_mul_f32 v[86:87], v[250:251], v[56:57]
    v_pk_mul_f32 v[88:89], v[252:253], v[56:57]
    v_pk_mul_f32 v[90:91], v[254:255], v[56:57]
    v_accvgpr_read_b32 v76, a120
    v_accvgpr_read_b32 v77, a121
    v_accvgpr_read_b32 v78, a122
    v_accvgpr_read_b32 v79, a123
    ds_read2_b64 a[156:159], v13 offset0:192 offset1:193
    v_accvgpr_read_b32 v80, a124
    v_accvgpr_read_b32 v81, a125
    v_accvgpr_read_b32 v82, a126
    v_accvgpr_read_b32 v83, a127
    v_exp_f32 v84, v84
    v_exp_f32 v85, v85
    v_exp_f32 v86, v86
    v_exp_f32 v87, v87
    v_exp_f32 v88, v88
    v_exp_f32 v89, v89
    v_exp_f32 v90, v90
    v_exp_f32 v91, v91
    ds_read_b128 a[188:191], v18 offset:448
    v_pk_fma_f32 v[76:77], v[64:65], v[54:55], v[76:77]
    v_pk_fma_f32 v[78:79], v[66:67], v[54:55], v[78:79]
    v_pk_fma_f32 v[80:81], v[72:73], v[54:55], v[80:81]
    v_pk_fma_f32 v[82:83], v[74:75], v[54:55], v[82:83]
    v_pk_fma_f32 v[84:85], v[84:85], v[58:59], v[58:59]
    v_pk_fma_f32 v[86:87], v[86:87], v[58:59], v[58:59]
    v_pk_fma_f32 v[88:89], v[88:89], v[58:59], v[58:59]
    v_pk_fma_f32 v[90:91], v[90:91], v[58:59], v[58:59]
    v_pk_mul_f32 v[248:249], v[248:249], v[76:77]
    v_pk_mul_f32 v[250:251], v[250:251], v[78:79]
    v_pk_mul_f32 v[252:253], v[252:253], v[80:81]
    v_pk_mul_f32 v[254:255], v[254:255], v[82:83]
    v_rcp_f32 v84, v84
    v_rcp_f32 v85, v85
    v_rcp_f32 v86, v86
    v_rcp_f32 v87, v87
    v_rcp_f32 v88, v88
    v_rcp_f32 v89, v89
    v_rcp_f32 v90, v90
    v_rcp_f32 v91, v91
    v_pk_mul_f32 v[248:249], v[248:249], v[84:85]
    v_pk_mul_f32 v[250:251], v[250:251], v[86:87]
    v_pk_mul_f32 v[252:253], v[252:253], v[88:89]
    v_pk_mul_f32 v[254:255], v[254:255], v[90:91]
    v_cvt_pk_bf16_f32 v248, v248, v249
    v_cvt_pk_bf16_f32 v249, v250, v251
    v_cvt_pk_bf16_f32 v250, v252, v253
    v_cvt_pk_bf16_f32 v251, v254, v255
    s_nop 0
    v_permlane16_swap_b32 v248, v250
    v_permlane16_swap_b32 v249, v251
    buffer_store_dwordx4 v[248:251], v16, s[64:67], s32 offen offset:3072 sc1
    s_mov_b32 s73, 1
GAP:
    s_waitcnt lgkmcnt(8)
    v_mfma_f32_16x16x32_bf16 v[160:163], v[92:95], a[160:163], 0
    v_mfma_f32_16x16x32_bf16 v[164:167], v[92:95], a[164:167], 0
    v_mfma_f32_16x16x32_bf16 v[168:171], v[92:95], a[168:171], 0
    v_mfma_f32_16x16x32_bf16 v[172:175], v[92:95], a[172:175], 0
    s_waitcnt lgkmcnt(6)
    v_mfma_f32_16x16x32_bf16 v[176:179], v[92:95], a[176:179], 0
    s_waitcnt lgkmcnt(4)
    v_mfma_f32_16x16x32_bf16 v[180:183], v[92:95], a[180:183], 0
    s_waitcnt lgkmcnt(2)
    v_mfma_f32_16x16x32_bf16 v[184:187], v[92:95], a[184:187], 0
    s_waitcnt lgkmcnt(0)
    v_mfma_f32_16x16x32_bf16 v[188:191], v[92:95], a[188:191], 0
    v_mfma_f32_16x16x32_bf16 v[160:163], a[128:131], a[160:163], v[160:163]
    ds_read2_b64 a[192:195], v12 offset0:8 offset1:9
    buffer_load_dwordx2 v[44:45], v3, s[20:23], s72 offen offset:0
    v_mfma_f32_16x16x32_bf16 v[164:167], a[128:131], a[164:167], v[164:167]
    ds_read_b128 a[224:227], v18 offset:4096
    v_bfe_u32 v28, v1, 2, 2
    v_mfma_f32_16x16x32_bf16 v[164:167], a[132:135], a[160:163], v[164:167]
    v_lshl_add_u32 v29, v11, 3, v28
    v_mfma_f32_16x16x32_bf16 v[168:171], a[128:131], a[168:171], v[168:171]
    ds_read2_b64 a[196:199], v12 offset0:72 offset1:73
    v_lshlrev_b32 v29, 8, v29
    v_mfma_f32_16x16x32_bf16 v[168:171], a[132:135], a[164:167], v[168:171]
    v_and_b32_e64 v63, 3, v1
    v_mfma_f32_16x16x32_bf16 v[168:171], a[136:139], a[160:163], v[168:171]
    ds_read_b128 a[228:231], v18 offset:3584
    v_lshl_add_u32 v29, v63, 3, v29
    v_mfma_f32_16x16x32_bf16 v[172:175], a[128:131], a[172:175], v[172:175]
    v_bfe_u32 v28, v1, 2, 3
    s_lshl_b32 s5, s35, 1
    v_mfma_f32_16x16x32_bf16 v[172:175], a[132:135], a[168:171], v[172:175]
    ds_read2_b64 a[200:203], v12 offset0:136 offset1:137
    v_mfma_f32_16x16x32_bf16 v[172:175], a[136:139], a[164:167], v[172:175]
    ds_read_b128 a[232:235], v18 offset:3072
    v_xor_b32 v28, s5, v28
    v_mfma_f32_16x16x32_bf16 v[172:175], a[140:143], a[160:163], v[172:175]
    v_xor_b32_e64 v62, 0, v28
    v_mfma_f32_16x16x32_bf16 v[176:179], a[128:131], a[176:179], v[176:179]
    ds_read2_b64 a[204:207], v12 offset0:200 offset1:201
    buffer_load_dwordx2 v[46:47], v3, s[20:23], s72 offen offset:32
    v_mfma_f32_16x16x32_bf16 v[176:179], a[132:135], a[172:175], v[176:179]
    v_lshl_add_u32 v36, v62, 5, v29
    v_xor_b32_e64 v62, 1, v28
    v_mfma_f32_16x16x32_bf16 v[176:179], a[136:139], a[168:171], v[176:179]
    ds_read_b128 a[236:239], v18 offset:2560
    v_mfma_f32_16x16x32_bf16 v[176:179], a[140:143], a[164:167], v[176:179]
    v_lshl_add_u32 v37, v62, 5, v29
    v_xor_b32_e64 v62, 2, v28
    v_mfma_f32_16x16x32_bf16 v[176:179], a[144:147], a[160:163], v[176:179]
    ds_read2_b64 a[208:211], v13 offset0:8 offset1:9
    v_mfma_f32_16x16x32_bf16 v[180:183], a[128:131], a[180:183], v[180:183]
    ds_read_b128 a[240:243], v18 offset:2048
    v_lshl_add_u32 v38, v62, 5, v29
    v_mfma_f32_16x16x32_bf16 v[180:183], a[132:135], a[176:179], v[180:183]
    v_xor_b32_e64 v62, 3, v28
    v_lshl_add_u32 v39, v62, 5, v29
    v_mfma_f32_16x16x32_bf16 v[180:183], a[136:139], a[172:175], v[180:183]
    ds_read2_b64 a[212:215], v13 offset0:72 offset1:73
    v_mfma_f32_16x16x32_bf16 v[180:183], a[140:143], a[168:171], v[180:183]
    v_xor_b32_e64 v62, 4, v28
    v_lshl_add_u32 v40, v62, 5, v29
    v_mfma_f32_16x16x32_bf16 v[180:183], a[144:147], a[164:167], v[180:183]
    ds_read_b128 a[244:247], v18 offset:1536
    v_mfma_f32_16x16x32_bf16 v[180:183], a[148:151], a[160:163], v[180:183]
    buffer_load_dwordx2 v[48:49], v3, s[20:23], s72 offen offset:2048
    v_xor_b32_e64 v62, 5, v28
    v_mfma_f32_16x16x32_bf16 v[184:187], a[128:131], a[184:187], v[184:187]
    ds_read2_b64 a[216:219], v13 offset0:136 offset1:137
    v_lshl_add_u32 v41, v62, 5, v29
    v_mfma_f32_16x16x32_bf16 v[184:187], a[132:135], a[180:183], v[184:187]
    ds_read_b128 a[248:251], v18 offset:1024
    v_mfma_f32_16x16x32_bf16 v[184:187], a[136:139], a[176:179], v[184:187]
    v_xor_b32_e64 v62, 6, v28
    v_lshl_add_u32 v42, v62, 5, v29
    v_mfma_f32_16x16x32_bf16 v[184:187], a[140:143], a[172:175], v[184:187]
    ds_read2_b64 a[220:223], v13 offset0:200 offset1:201
    v_mfma_f32_16x16x32_bf16 v[184:187], a[144:147], a[168:171], v[184:187]
    v_xor_b32_e64 v62, 7, v28
    v_lshl_add_u32 v43, v62, 5, v29
    v_mfma_f32_16x16x32_bf16 v[184:187], a[148:151], a[164:167], v[184:187]
    ds_read_b128 a[252:255], v18 offset:512
    s_lshl_b32 s34, s26, 2
    v_mfma_f32_16x16x32_bf16 v[184:187], a[152:155], a[160:163], v[184:187]
    s_add_u32 s34, s34, s3
    v_mfma_f32_16x16x32_bf16 v[188:191], a[128:131], a[188:191], v[188:191]
    s_lshl_b32 s34, s34, 2
    v_mfma_f32_16x16x32_bf16 v[188:191], a[132:135], a[184:187], v[188:191]
    buffer_load_dwordx2 v[50:51], v3, s[20:23], s72 offen offset:2080
    s_lshr_b32 s5, s2, 6
    v_mfma_f32_16x16x32_bf16 v[188:191], a[136:139], a[180:183], v[188:191]
    s_add_u32 s34, s34, s5
    v_mfma_f32_16x16x32_bf16 v[188:191], a[140:143], a[176:179], v[188:191]
    s_lshl_b32 s34, s34, 7
    s_add_u32 s34, s34, 0x1025000
    v_mfma_f32_16x16x32_bf16 v[188:191], a[144:147], a[172:175], v[188:191]
    v_min_u32_e64 v33, 6, v1
    v_mfma_f32_16x16x32_bf16 v[188:191], a[148:151], a[168:171], v[188:191]
    s_bfe_u32 s5, s2, 0x20001
    s_lshl_b32 s5, s5, 5
    v_mfma_f32_16x16x32_bf16 v[188:191], a[152:155], a[164:167], v[188:191]
    s_add_u32 s34, s34, s5
    v_mfma_f32_16x16x32_bf16 v[188:191], a[156:159], a[160:163], v[188:191]
    v_lshlrev_b32 v33, 2, v33
    s_waitcnt vmcnt(4)
    s_cmp_eq_u32 s73, 0
    s_cbranch_scc1 NOHPUB
    v_lshlrev_b32 v17, 7, v1
    s_mov_b64 exec, 15
    buffer_store_dword v5, v17, s[64:67], s74 offen sc1
    s_mov_b64 exec, -1
NOHPUB:
    s_waitcnt lgkmcnt(8)
    v_mfma_f32_16x16x32_bf16 v[160:163], a[192:195], a[224:227], v[160:163]
    ds_read2_b64 a[128:131], v12 offset0:16 offset1:17
    buffer_load_dwordx2 v[52:53], v3, s[20:23], s77 offen offset:0
    v_mfma_f32_16x16x32_bf16 v[164:167], a[192:195], a[228:231], v[164:167]
    ds_read_b128 a[160:163], v18 offset:4160
    v_mfma_f32_16x16x32_bf16 v[164:167], a[196:199], a[224:227], v[164:167]
    v_mfma_f32_16x16x32_bf16 v[168:171], a[192:195], a[232:235], v[168:171]
    ds_read2_b64 a[132:135], v12 offset0:80 offset1:81
    v_mfma_f32_16x16x32_bf16 v[168:171], a[196:199], a[228:231], v[168:171]
    v_mfma_f32_16x16x32_bf16 v[168:171], a[200:203], a[224:227], v[168:171]
    ds_read_b128 a[164:167], v18 offset:3648
    v_mfma_f32_16x16x32_bf16 v[172:175], a[192:195], a[236:239], v[172:175]
    v_mfma_f32_16x16x32_bf16 v[172:175], a[196:199], a[232:235], v[172:175]
    ds_read2_b64 a[136:139], v12 offset0:144 offset1:145
    v_mfma_f32_16x16x32_bf16 v[172:175], a[200:203], a[228:231], v[172:175]
    ds_read_b128 a[168:171], v18 offset:3136
    v_mfma_f32_16x16x32_bf16 v[172:175], a[204:207], a[224:227], v[172:175]
    s_waitcnt lgkmcnt(6)
    v_mfma_f32_16x16x32_bf16 v[176:179], a[192:195], a[240:243], v[176:179]
    ds_read2_b64 a[140:143], v12 offset0:208 offset1:209
    buffer_load_dwordx2 v[54:55], v3, s[20:23], s77 offen offset:32
    v_mfma_f32_16x16x32_bf16 v[176:179], a[196:199], a[236:239], v[176:179]
    v_mfma_f32_16x16x32_bf16 v[176:179], a[200:203], a[232:235], v[176:179]
    ds_read_b128 a[172:175], v18 offset:2624
    v_mfma_f32_16x16x32_bf16 v[176:179], a[204:207], a[228:231], v[176:179]
    v_mfma_f32_16x16x32_bf16 v[176:179], a[208:211], a[224:227], v[176:179]
    ds_read2_b64 a[144:147], v13 offset0:16 offset1:17
    v_mfma_f32_16x16x32_bf16 v[180:183], a[192:195], a[244:247], v[180:183]
    ds_read_b128 a[176:179], v18 offset:2112
    v_mfma_f32_16x16x32_bf16 v[180:183], a[196:199], a[240:243], v[180:183]
    v_mfma_f32_16x16x32_bf16 v[180:183], a[200:203], a[236:239], v[180:183]
    ds_read2_b64 a[148:151], v13 offset0:80 offset1:81
    v_mfma_f32_16x16x32_bf16 v[180:183], a[204:207], a[232:235], v[180:183]
    v_mfma_f32_16x16x32_bf16 v[180:183], a[208:211], a[228:231], v[180:183]
    ds_read_b128 a[180:183], v18 offset:1600
    v_mfma_f32_16x16x32_bf16 v[180:183], a[212:215], a[224:227], v[180:183]
    buffer_load_dwordx2 v[56:57], v3, s[20:23], s77 offen offset:2048
    v_mfma_f32_16x16x32_bf16 v[184:187], a[192:195], a[248:251], v[184:187]
    ds_read2_b64 a[152:155], v13 offset0:144 offset1:145
    v_mfma_f32_16x16x32_bf16 v[184:187], a[196:199], a[244:247], v[184:187]
    ds_read_b128 a[184:187], v18 offset:1088
    v_mfma_f32_16x16x32_bf16 v[184:187], a[200:203], a[240:243], v[184:187]
    v_mfma_f32_16x16x32_bf16 v[184:187], a[204:207], a[236:239], v[184:187]
    ds_read2_b64 a[156:159], v13 offset0:208 offset1:209
    v_mfma_f32_16x16x32_bf16 v[184:187], a[208:211], a[232:235], v[184:187]
    v_mfma_f32_16x16x32_bf16 v[184:187], a[212:215], a[228:231], v[184:187]
    ds_read_b128 a[188:191], v18 offset:576
    v_mfma_f32_16x16x32_bf16 v[184:187], a[216:219], a[224:227], v[184:187]
    v_mfma_f32_16x16x32_bf16 v[188:191], a[192:195], a[252:255], v[188:191]
    v_mfma_f32_16x16x32_bf16 v[188:191], a[196:199], a[248:251], v[188:191]
    buffer_load_dwordx2 v[58:59], v3, s[20:23], s77 offen offset:2080
    v_mfma_f32_16x16x32_bf16 v[188:191], a[200:203], a[244:247], v[188:191]
    v_mfma_f32_16x16x32_bf16 v[188:191], a[204:207], a[240:243], v[188:191]
    v_mfma_f32_16x16x32_bf16 v[188:191], a[208:211], a[236:239], v[188:191]
    v_mfma_f32_16x16x32_bf16 v[188:191], a[212:215], a[232:235], v[188:191]
    v_mfma_f32_16x16x32_bf16 v[188:191], a[216:219], a[228:231], v[188:191]
    v_mfma_f32_16x16x32_bf16 v[188:191], a[220:223], a[224:227], v[188:191]
    s_waitcnt lgkmcnt(8)
    v_mfma_f32_16x16x32_bf16 v[160:163], a[128:131], a[160:163], v[160:163]
    ds_read2_b64 a[192:195], v12 offset0:24 offset1:25
    s_add_u32 m0, s31, 0x9000
    s_add_u32 s79, s79, 0x8000
    buffer_load_dwordx4 v6, s[12:15], s79 offen offset:0 lds
    v_mfma_f32_16x16x32_bf16 v[164:167], a[128:131], a[164:167], v[164:167]
    ds_read_b128 a[224:227], v18 offset:4224
    v_mfma_f32_16x16x32_bf16 v[164:167], a[132:135], a[160:163], v[164:167]
    v_mfma_f32_16x16x32_bf16 v[168:171], a[128:131], a[168:171], v[168:171]
    ds_read2_b64 a[196:199], v12 offset0:88 offset1:89
    v_mfma_f32_16x16x32_bf16 v[168:171], a[132:135], a[164:167], v[168:171]
    v_mfma_f32_16x16x32_bf16 v[168:171], a[136:139], a[160:163], v[168:171]
    ds_read_b128 a[228:231], v18 offset:3712
    v_mfma_f32_16x16x32_bf16 v[172:175], a[128:131], a[172:175], v[172:175]
    v_mfma_f32_16x16x32_bf16 v[172:175], a[132:135], a[168:171], v[172:175]
    ds_read2_b64 a[200:203], v12 offset0:152 offset1:153
    v_mfma_f32_16x16x32_bf16 v[172:175], a[136:139], a[164:167], v[172:175]
    ds_read_b128 a[232:235], v18 offset:3200
    v_mfma_f32_16x16x32_bf16 v[172:175], a[140:143], a[160:163], v[172:175]
    s_waitcnt lgkmcnt(6)
    v_mfma_f32_16x16x32_bf16 v[176:179], a[128:131], a[176:179], v[176:179]
    ds_read2_b64 a[204:207], v12 offset0:216 offset1:217
    buffer_load_dwordx4 v7, s[12:15], s79 offen offset:1024 lds
    v_mfma_f32_16x16x32_bf16 v[176:179], a[132:135], a[172:175], v[176:179]
    v_mfma_f32_16x16x32_bf16 v[176:179], a[136:139], a[168:171], v[176:179]
    ds_read_b128 a[236:239], v18 offset:2688
    v_mfma_f32_16x16x32_bf16 v[176:179], a[140:143], a[164:167], v[176:179]
    v_mfma_f32_16x16x32_bf16 v[176:179], a[144:147], a[160:163], v[176:179]
    ds_read2_b64 a[208:211], v13 offset0:24 offset1:25
    v_mfma_f32_16x16x32_bf16 v[180:183], a[128:131], a[180:183], v[180:183]
    ds_read_b128 a[240:243], v18 offset:2176
    v_mfma_f32_16x16x32_bf16 v[180:183], a[132:135], a[176:179], v[180:183]
    v_mfma_f32_16x16x32_bf16 v[180:183], a[136:139], a[172:175], v[180:183]
    ds_read2_b64 a[212:215], v13 offset0:88 offset1:89
    v_mfma_f32_16x16x32_bf16 v[180:183], a[140:143], a[168:171], v[180:183]
    v_mfma_f32_16x16x32_bf16 v[180:183], a[144:147], a[164:167], v[180:183]
    ds_read_b128 a[244:247], v18 offset:1664
    v_mfma_f32_16x16x32_bf16 v[180:183], a[148:151], a[160:163], v[180:183]
    buffer_load_dwordx4 v8, s[12:15], s79 offen offset:2048 lds
    v_mfma_f32_16x16x32_bf16 v[184:187], a[128:131], a[184:187], v[184:187]
    ds_read2_b64 a[216:219], v13 offset0:152 offset1:153
    v_mfma_f32_16x16x32_bf16 v[184:187], a[132:135], a[180:183], v[184:187]
    ds_read_b128 a[248:251], v18 offset:1152
    v_mfma_f32_16x16x32_bf16 v[184:187], a[136:139], a[176:179], v[184:187]
    v_mfma_f32_16x16x32_bf16 v[184:187], a[140:143], a[172:175], v[184:187]
    ds_read2_b64 a[220:223], v13 offset0:216 offset1:217
    v_mfma_f32_16x16x32_bf16 v[184:187], a[144:147], a[168:171], v[184:187]
    v_mfma_f32_16x16x32_bf16 v[184:187], a[148:151], a[164:167], v[184:187]
    ds_read_b128 a[252:255], v18 offset:640
    v_mfma_f32_16x16x32_bf16 v[184:187], a[152:155], a[160:163], v[184:187]
    v_mfma_f32_16x16x32_bf16 v[188:191], a[128:131], a[188:191], v[188:191]
    v_mfma_f32_16x16x32_bf16 v[188:191], a[132:135], a[184:187], v[188:191]
    buffer_load_dwordx4 v9, s[12:15], s79 offen offset:3072 lds
    v_mfma_f32_16x16x32_bf16 v[188:191], a[136:139], a[180:183], v[188:191]
    v_mfma_f32_16x16x32_bf16 v[188:191], a[140:143], a[176:179], v[188:191]
    v_mfma_f32_16x16x32_bf16 v[188:191], a[144:147], a[172:175], v[188:191]
    v_mfma_f32_16x16x32_bf16 v[188:191], a[148:151], a[168:171], v[188:191]
    v_mfma_f32_16x16x32_bf16 v[188:191], a[152:155], a[164:167], v[188:191]
    v_mfma_f32_16x16x32_bf16 v[188:191], a[156:159], a[160:163], v[188:191]
    s_waitcnt lgkmcnt(8)
    v_mfma_f32_16x16x32_bf16 v[160:163], a[192:195], a[224:227], v[160:163]
    ds_read2_b64 a[128:131], v12 offset0:32 offset1:33
    s_waitcnt vmcnt(11)
    v_lshlrev_b32 v128, 16, v44
    v_mfma_f32_16x16x32_bf16 v[164:167], a[192:195], a[228:231], v[164:167]
    ds_read_b128 a[160:163], v18 offset:4288
    v_and_b32 v129, 0xffff0000, v44
    v_mfma_f32_16x16x32_bf16 v[164:167], a[196:199], a[224:227], v[164:167]
    v_lshlrev_b32_e64 v130, 16, v45
    v_and_b32 v131, 0xffff0000, v45
    v_mfma_f32_16x16x32_bf16 v[168:171], a[192:195], a[232:235], v[168:171]
    ds_read2_b64 a[132:135], v12 offset0:96 offset1:97
    s_waitcnt vmcnt(10)
    v_lshlrev_b32 v132, 16, v46
    v_mfma_f32_16x16x32_bf16 v[168:171], a[196:199], a[228:231], v[168:171]
    v_and_b32 v133, 0xffff0000, v46
    v_lshlrev_b32_e64 v134, 16, v47
    v_mfma_f32_16x16x32_bf16 v[168:171], a[200:203], a[224:227], v[168:171]
    ds_read_b128 a[164:167], v18 offset:3776
    v_and_b32 v135, 0xffff0000, v47
    v_mfma_f32_16x16x32_bf16 v[172:175], a[192:195], a[236:239], v[172:175]
    s_waitcnt vmcnt(9)
    v_lshlrev_b32 v136, 16, v48
    v_and_b32 v137, 0xffff0000, v48
    v_mfma_f32_16x16x32_bf16 v[172:175], a[196:199], a[232:235], v[172:175]
    ds_read2_b64 a[136:139], v12 offset0:160 offset1:161
    v_lshlrev_b32_e64 v138, 16, v49
    v_mfma_f32_16x16x32_bf16 v[172:175], a[200:203], a[228:231], v[172:175]
    ds_read_b128 a[168:171], v18 offset:3264
    v_and_b32 v139, 0xffff0000, v49
    v_mfma_f32_16x16x32_bf16 v[172:175], a[204:207], a[224:227], v[172:175]
    s_waitcnt vmcnt(8)
    v_lshlrev_b32 v140, 16, v50
    s_waitcnt lgkmcnt(6)
    v_mfma_f32_16x16x32_bf16 v[176:179], a[192:195], a[240:243], v[176:179]
    ds_read2_b64 a[140:143], v12 offset0:224 offset1:225
    v_and_b32 v141, 0xffff0000, v50
    v_mfma_f32_16x16x32_bf16 v[176:179], a[196:199], a[236:239], v[176:179]
    v_lshlrev_b32 v142, 16, v51
    v_and_b32 v143, 0xffff0000, v51
    v_mfma_f32_16x16x32_bf16 v[176:179], a[200:203], a[232:235], v[176:179]
    ds_read_b128 a[172:175], v18 offset:2752
    s_waitcnt vmcnt(7)
    v_lshlrev_b32 v144, 16, v52
    v_mfma_f32_16x16x32_bf16 v[176:179], a[204:207], a[228:231], v[176:179]
    v_and_b32 v145, 0xffff0000, v52
    v_lshlrev_b32_e64 v146, 16, v53
    v_mfma_f32_16x16x32_bf16 v[176:179], a[208:211], a[224:227], v[176:179]
    ds_read2_b64 a[144:147], v13 offset0:32 offset1:33
    v_and_b32 v147, 0xffff0000, v53
    v_mfma_f32_16x16x32_bf16 v[180:183], a[192:195], a[244:247], v[180:183]
    ds_read_b128 a[176:179], v18 offset:2240
    s_waitcnt vmcnt(6)
    v_lshlrev_b32 v148, 16, v54
    v_mfma_f32_16x16x32_bf16 v[180:183], a[196:199], a[240:243], v[180:183]
    v_and_b32 v149, 0xffff0000, v54
    v_lshlrev_b32_e64 v150, 16, v55
    v_mfma_f32_16x16x32_bf16 v[180:183], a[200:203], a[236:239], v[180:183]
    ds_read2_b64 a[148:151], v13 offset0:96 offset1:97
    v_and_b32 v151, 0xffff0000, v55
    v_mfma_f32_16x16x32_bf16 v[180:183], a[204:207], a[232:235], v[180:183]
    s_waitcnt vmcnt(5)
    v_lshlrev_b32 v152, 16, v56
    v_and_b32 v153, 0xffff0000, v56
    v_mfma_f32_16x16x32_bf16 v[180:183], a[208:211], a[228:231], v[180:183]
    ds_read_b128 a[180:183], v18 offset:1728
    v_mfma_f32_16x16x32_bf16 v[180:183], a[212:215], a[224:227], v[180:183]
    v_lshlrev_b32_e64 v154, 16, v57
    v_and_b32 v155, 0xffff0000, v57
    v_mfma_f32_16x16x32_bf16 v[184:187], a[192:195], a[248:251], v[184:187]
    ds_read2_b64 a[152:155], v13 offset0:160 offset1:161
    s_waitcnt vmcnt(4)
    v_lshlrev_b32 v156, 16, v58
    v_mfma_f32_16x16x32_bf16 v[184:187], a[196:199], a[244:247], v[184:187]
    ds_read_b128 a[184:187], v18 offset:1216
    v_and_b32 v157, 0xffff0000, v58
    v_mfma_f32_16x16x32_bf16 v[184:187], a[200:203], a[240:243], v[184:187]
    v_lshlrev_b32_e64 v158, 16, v59
    v_and_b32 v159, 0xffff0000, v59
    v_mfma_f32_16x16x32_bf16 v[184:187], a[204:207], a[236:239], v[184:187]
    ds_read2_b64 a[156:159], v13 offset0:224 offset1:225
    v_rcp_f32_e64 v21, v21
    v_mfma_f32_16x16x32_bf16 v[184:187], a[208:211], a[232:235], v[184:187]
    v_rcp_f32 v31, v31
    v_rcp_f32 v25, v25
    v_mfma_f32_16x16x32_bf16 v[184:187], a[212:215], a[228:231], v[184:187]
    ds_read_b128 a[188:191], v18 offset:704
    v_rcp_f32_e64 v27, v27
    v_mfma_f32_16x16x32_bf16 v[184:187], a[216:219], a[224:227], v[184:187]
    v_add_f32 v60, v128, v20
    v_add_f32 v61, v129, v20
    v_mfma_f32_16x16x32_bf16 v[188:191], a[192:195], a[252:255], v[188:191]
    v_cvt_pk_bf16_f32 v60, v60, v61
    v_mfma_f32_16x16x32_bf16 v[188:191], a[196:199], a[248:251], v[188:191]
    v_and_b32 v61, 0xffff0000, v60
    v_lshlrev_b32_e64 v60, 16, v60
    v_mfma_f32_16x16x32_bf16 v[188:191], a[200:203], a[244:247], v[188:191]
    v_mul_f32 v60, v60, v21
    v_mul_f32 v61, v61, v21
    v_mfma_f32_16x16x32_bf16 v[188:191], a[204:207], a[240:243], v[188:191]
    v_cvt_pk_bf16_f32 v44, v60, v61
    v_add_f32_e64 v62, v130, v20
    v_mfma_f32_16x16x32_bf16 v[188:191], a[208:211], a[236:239], v[188:191]
    v_add_f32_e64 v63, v131, v20
    v_cvt_pk_bf16_f32 v62, v62, v63
    v_mfma_f32_16x16x32_bf16 v[188:191], a[212:215], a[232:235], v[188:191]
    v_and_b32 v63, 0xffff0000, v62
    v_lshlrev_b32_e64 v62, 16, v62
    v_mfma_f32_16x16x32_bf16 v[188:191], a[216:219], a[228:231], v[188:191]
    v_mul_f32 v62, v62, v21
    v_mul_f32 v63, v63, v21
    v_mfma_f32_16x16x32_bf16 v[188:191], a[220:223], a[224:227], v[188:191]
    v_cvt_pk_bf16_f32 v45, v62, v63
    buffer_load_dword v32, v33, s[64:67], s34 offen sc1
    s_waitcnt lgkmcnt(8)
    v_mfma_f32_16x16x32_bf16 v[160:163], a[128:131], a[160:163], v[160:163]
    ds_read2_b64 a[192:195], v12 offset0:40 offset1:41
    v_add_f32 v60, v132, v20
    v_mfma_f32_16x16x32_bf16 v[164:167], a[128:131], a[164:167], v[164:167]
    ds_read_b128 a[224:227], v18 offset:4352
    v_add_f32_e64 v61, v133, v20
    v_mfma_f32_16x16x32_bf16 v[164:167], a[132:135], a[160:163], v[164:167]
    v_cvt_pk_bf16_f32 v60, v60, v61
    v_and_b32 v61, 0xffff0000, v60
    v_mfma_f32_16x16x32_bf16 v[168:171], a[128:131], a[168:171], v[168:171]
    ds_read2_b64 a[196:199], v12 offset0:104 offset1:105
    v_lshlrev_b32_e64 v60, 16, v60
    v_mfma_f32_16x16x32_bf16 v[168:171], a[132:135], a[164:167], v[168:171]
    v_mul_f32_e64 v60, v60, v21
    v_mfma_f32_16x16x32_bf16 v[168:171], a[136:139], a[160:163], v[168:171]
    ds_read_b128 a[228:231], v18 offset:3840
    v_mul_f32_e64 v61, v61, v21
    v_mfma_f32_16x16x32_bf16 v[172:175], a[128:131], a[172:175], v[172:175]
    v_cvt_pk_bf16_f32 v46, v60, v61
    v_add_f32_e64 v62, v134, v20
    v_mfma_f32_16x16x32_bf16 v[172:175], a[132:135], a[168:171], v[172:175]
    ds_read2_b64 a[200:203], v12 offset0:168 offset1:169
    v_add_f32_e64 v63, v135, v20
    v_mfma_f32_16x16x32_bf16 v[172:175], a[136:139], a[164:167], v[172:175]
    ds_read_b128 a[232:235], v18 offset:3328
    v_cvt_pk_bf16_f32 v62, v62, v63
    v_mfma_f32_16x16x32_bf16 v[172:175], a[140:143], a[160:163], v[172:175]
    v_and_b32 v63, 0xffff0000, v62
    s_waitcnt lgkmcnt(6)
    v_mfma_f32_16x16x32_bf16 v[176:179], a[128:131], a[176:179], v[176:179]
    ds_read2_b64 a[204:207], v12 offset0:232 offset1:233
    v_lshlrev_b32 v62, 16, v62
    v_mfma_f32_16x16x32_bf16 v[176:179], a[132:135], a[172:175], v[176:179]
    v_mul_f32 v62, v62, v21
    v_mul_f32 v63, v63, v21
    v_mfma_f32_16x16x32_bf16 v[176:179], a[136:139], a[168:171], v[176:179]
    ds_read_b128 a[236:239], v18 offset:2816
    v_cvt_pk_bf16_f32 v47, v62, v63
    v_mfma_f32_16x16x32_bf16 v[176:179], a[140:143], a[164:167], v[176:179]
    v_add_f32 v60, v136, v30
    v_add_f32 v61, v137, v30
    v_mfma_f32_16x16x32_bf16 v[176:179], a[144:147], a[160:163], v[176:179]
    ds_read2_b64 a[208:211], v13 offset0:40 offset1:41
    v_mfma_f32_16x16x32_bf16 v[180:183], a[128:131], a[180:183], v[180:183]
    ds_read_b128 a[240:243], v18 offset:2304
    v_cvt_pk_bf16_f32 v60, v60, v61
    v_mfma_f32_16x16x32_bf16 v[180:183], a[132:135], a[176:179], v[180:183]
    v_and_b32 v61, 0xffff0000, v60
    v_lshlrev_b32_e64 v60, 16, v60
    v_mfma_f32_16x16x32_bf16 v[180:183], a[136:139], a[172:175], v[180:183]
    ds_read2_b64 a[212:215], v13 offset0:104 offset1:105
    v_mul_f32_e64 v60, v60, v31
    v_mfma_f32_16x16x32_bf16 v[180:183], a[140:143], a[168:171], v[180:183]
    v_mul_f32_e64 v61, v61, v31
    v_cvt_pk_bf16_f32 v48, v60, v61
    v_mfma_f32_16x16x32_bf16 v[180:183], a[144:147], a[164:167], v[180:183]
    ds_read_b128 a[244:247], v18 offset:1792
    v_mfma_f32_16x16x32_bf16 v[180:183], a[148:151], a[160:163], v[180:183]
    v_add_f32 v62, v138, v30
    v_add_f32 v63, v139, v30
    v_mfma_f32_16x16x32_bf16 v[184:187], a[128:131], a[184:187], v[184:187]
    ds_read2_b64 a[216:219], v13 offset0:168 offset1:169
    v_cvt_pk_bf16_f32 v62, v62, v63
    v_mfma_f32_16x16x32_bf16 v[184:187], a[132:135], a[180:183], v[184:187]
    ds_read_b128 a[248:251], v18 offset:1280
    v_and_b32 v63, 0xffff0000, v62
    v_mfma_f32_16x16x32_bf16 v[184:187], a[136:139], a[176:179], v[184:187]
    v_lshlrev_b32 v62, 16, v62
    v_mul_f32 v62, v62, v31
    v_mfma_f32_16x16x32_bf16 v[184:187], a[140:143], a[172:175], v[184:187]
    ds_read2_b64 a[220:223], v13 offset0:232 offset1:233
    v_mfma_f32_16x16x32_bf16 v[184:187], a[144:147], a[168:171], v[184:187]
    v_mul_f32_e64 v63, v63, v31
    v_cvt_pk_bf16_f32 v49, v62, v63
    v_mfma_f32_16x16x32_bf16 v[184:187], a[148:151], a[164:167], v[184:187]
    ds_read_b128 a[252:255], v18 offset:768
    v_add_f32_e64 v60, v140, v30
    v_mfma_f32_16x16x32_bf16 v[184:187], a[152:155], a[160:163], v[184:187]
    v_add_f32_e64 v61, v141, v30
    v_cvt_pk_bf16_f32 v60, v60, v61
    v_mfma_f32_16x16x32_bf16 v[188:191], a[128:131], a[188:191], v[188:191]
    v_and_b32 v61, 0xffff0000, v60
    v_mfma_f32_16x16x32_bf16 v[188:191], a[132:135], a[184:187], v[188:191]
    v_lshlrev_b32 v60, 16, v60
    v_mul_f32 v60, v60, v31
    v_mfma_f32_16x16x32_bf16 v[188:191], a[136:139], a[180:183], v[188:191]
    v_mul_f32_e64 v61, v61, v31
    v_cvt_pk_bf16_f32 v50, v60, v61
    v_mfma_f32_16x16x32_bf16 v[188:191], a[140:143], a[176:179], v[188:191]
    v_add_f32 v62, v142, v30
    v_add_f32 v63, v143, v30
    v_mfma_f32_16x16x32_bf16 v[188:191], a[144:147], a[172:175], v[188:191]
    v_cvt_pk_bf16_f32 v62, v62, v63
    v_mfma_f32_16x16x32_bf16 v[188:191], a[148:151], a[168:171], v[188:191]
    v_and_b32 v63, 0xffff0000, v62
    v_lshlrev_b32_e64 v62, 16, v62
    v_mfma_f32_16x16x32_bf16 v[188:191], a[152:155], a[164:167], v[188:191]
    v_mul_f32 v62, v62, v31
    v_mul_f32 v63, v63, v31
    v_mfma_f32_16x16x32_bf16 v[188:191], a[156:159], a[160:163], v[188:191]
    v_cvt_pk_bf16_f32 v51, v62, v63
WALKB_RET:
    s_mov_b64 exec, -1
    s_waitcnt vmcnt(0)
    v_cmp_ne_u32 vcc, 0, v32
    s_nop 0
    s_cmp_eq_u64 vcc, -1
    s_cbranch_scc0 HF_LATE
HF_OK:
    s_waitcnt lgkmcnt(8)
    v_mfma_f32_16x16x32_bf16 v[160:163], a[192:195], a[224:227], v[160:163]
    ds_read2_b64 a[128:131], v12 offset0:48 offset1:49
    v_add_f32 v60, v144, v24
    v_mfma_f32_16x16x32_bf16 v[164:167], a[192:195], a[228:231], v[164:167]
    s_lshl_b32 s78, s16, 16
    s_add_u32 s78, s78, s29
    buffer_load_dwordx4 a[0:3], v14, s[64:67], s78 offen offset:0 sc1
    v_mfma_f32_16x16x32_bf16 v[164:167], a[196:199], a[224:227], v[164:167]
    v_add_f32_e64 v61, v145, v24
    v_cvt_pk_bf16_f32 v60, v60, v61
    v_mfma_f32_16x16x32_bf16 v[168:171], a[192:195], a[232:235], v[168:171]
    ds_read_b128 a[160:163], v18 offset:4416
    v_and_b32 v61, 0xffff0000, v60
    v_mfma_f32_16x16x32_bf16 v[168:171], a[196:199], a[228:231], v[168:171]
    ds_read2_b64 a[132:135], v12 offset0:112 offset1:113
    v_lshlrev_b32_e64 v60, 16, v60
    v_mfma_f32_16x16x32_bf16 v[168:171], a[200:203], a[224:227], v[168:171]
    v_mul_f32_e64 v60, v60, v25
    v_mfma_f32_16x16x32_bf16 v[172:175], a[192:195], a[236:239], v[172:175]
    ds_read_b128 a[164:167], v18 offset:3904
    v_mul_f32_e64 v61, v61, v25
    v_mfma_f32_16x16x32_bf16 v[172:175], a[196:199], a[232:235], v[172:175]
    buffer_load_dwordx4 a[4:7], v14, s[64:67], s78 offen offset:1024 sc1
    v_cvt_pk_bf16_f32 v52, v60, v61
    v_mfma_f32_16x16x32_bf16 v[172:175], a[200:203], a[228:231], v[172:175]
    v_add_f32_e64 v62, v146, v24
    v_mfma_f32_16x16x32_bf16 v[172:175], a[204:207], a[224:227], v[172:175]
    ds_read2_b64 a[136:139], v12 offset0:176 offset1:177
    v_add_f32 v63, v147, v24
    s_waitcnt lgkmcnt(11)
    v_mfma_f32_16x16x32_bf16 v[176:179], a[192:195], a[240:243], v[176:179]
    v_cvt_pk_bf16_f32 v62, v62, v63
    v_and_b32 v63, 0xffff0000, v62
    v_mfma_f32_16x16x32_bf16 v[176:179], a[196:199], a[236:239], v[176:179]
    ds_read_b128 a[168:171], v18 offset:3392
    v_lshlrev_b32_e64 v62, 16, v62
    v_mfma_f32_16x16x32_bf16 v[176:179], a[200:203], a[232:235], v[176:179]
    ds_read2_b64 a[140:143], v12 offset0:240 offset1:241
    v_mul_f32_e64 v62, v62, v25
    v_mfma_f32_16x16x32_bf16 v[176:179], a[204:207], a[228:231], v[176:179]
    v_mul_f32_e64 v63, v63, v25
    v_mfma_f32_16x16x32_bf16 v[176:179], a[208:211], a[224:227], v[176:179]
    buffer_load_dwordx4 a[8:11], v14, s[64:67], s78 offen offset:2048 sc1
    v_cvt_pk_bf16_f32 v53, v62, v63
    s_waitcnt lgkmcnt(11)
    v_mfma_f32_16x16x32_bf16 v[180:183], a[192:195], a[244:247], v[180:183]
    ds_read_b128 a[172:175], v18 offset:2880
    v_add_f32 v60, v148, v24
    v_mfma_f32_16x16x32_bf16 v[180:183], a[196:199], a[240:243], v[180:183]
    v_add_f32_e64 v61, v149, v24
    v_mfma_f32_16x16x32_bf16 v[180:183], a[200:203], a[236:239], v[180:183]
    ds_read2_b64 a[144:147], v13 offset0:48 offset1:49
    v_cvt_pk_bf16_f32 v60, v60, v61
    v_mfma_f32_16x16x32_bf16 v[180:183], a[204:207], a[232:235], v[180:183]
    ds_read_b128 a[176:179], v18 offset:2368
    v_and_b32 v61, 0xffff0000, v60
    v_mfma_f32_16x16x32_bf16 v[180:183], a[208:211], a[228:231], v[180:183]
    v_lshlrev_b32 v60, 16, v60
    v_mul_f32 v60, v60, v25
    v_mfma_f32_16x16x32_bf16 v[180:183], a[212:215], a[224:227], v[180:183]
    buffer_load_dwordx4 a[12:15], v14, s[64:67], s78 offen offset:3072 sc1
    s_add_u32 s78, s78, 16384
    s_waitcnt lgkmcnt(6)
    v_mfma_f32_16x16x32_bf16 v[184:187], a[192:195], a[248:251], v[184:187]
    v_mul_f32 v61, v61, v25
    v_mfma_f32_16x16x32_bf16 v[184:187], a[196:199], a[244:247], v[184:187]
    ds_read2_b64 a[148:151], v13 offset0:112 offset1:113
    v_cvt_pk_bf16_f32 v54, v60, v61
    v_mfma_f32_16x16x32_bf16 v[184:187], a[200:203], a[240:243], v[184:187]
    ds_read_b128 a[180:183], v18 offset:1856
    v_add_f32_e64 v62, v150, v24
    v_mfma_f32_16x16x32_bf16 v[184:187], a[204:207], a[236:239], v[184:187]
    v_add_f32_e64 v63, v151, v24
    v_cvt_pk_bf16_f32 v62, v62, v63
    v_mfma_f32_16x16x32_bf16 v[184:187], a[208:211], a[232:235], v[184:187]
    ds_read2_b64 a[152:155], v13 offset0:176 offset1:177
    v_mfma_f32_16x16x32_bf16 v[184:187], a[212:215], a[228:231], v[184:187]
    buffer_load_dwordx4 a[16:19], v14, s[64:67], s78 offen offset:0 sc1
    v_and_b32 v63, 0xffff0000, v62
    v_mfma_f32_16x16x32_bf16 v[184:187], a[216:219], a[224:227], v[184:187]
    v_lshlrev_b32 v62, 16, v62
    v_mul_f32 v62, v62, v25
    v_mfma_f32_16x16x32_bf16 v[188:191], a[192:195], a[252:255], v[188:191]
    ds_read_b128 a[184:187], v18 offset:1344
    v_mul_f32_e64 v63, v63, v25
    v_mfma_f32_16x16x32_bf16 v[188:191], a[196:199], a[248:251], v[188:191]
    ds_read2_b64 a[156:159], v13 offset0:240 offset1:241
    v_cvt_pk_bf16_f32 v55, v62, v63
    v_mfma_f32_16x16x32_bf16 v[188:191], a[200:203], a[244:247], v[188:191]
    v_add_f32_e64 v60, v152, v26
    v_mfma_f32_16x16x32_bf16 v[188:191], a[204:207], a[240:243], v[188:191]
    ds_read_b128 a[188:191], v18 offset:832
    v_add_f32_e64 v61, v153, v26
    v_mfma_f32_16x16x32_bf16 v[188:191], a[208:211], a[236:239], v[188:191]
    v_cvt_pk_bf16_f32 v60, v60, v61
    v_and_b32 v61, 0xffff0000, v60
    v_mfma_f32_16x16x32_bf16 v[188:191], a[212:215], a[232:235], v[188:191]
    v_lshlrev_b32_e64 v60, 16, v60
    v_mfma_f32_16x16x32_bf16 v[188:191], a[216:219], a[228:231], v[188:191]
    v_mul_f32 v60, v60, v27
    v_mul_f32 v61, v61, v27
    v_mfma_f32_16x16x32_bf16 v[188:191], a[220:223], a[224:227], v[188:191]
    v_cvt_pk_bf16_f32 v56, v60, v61
    v_mfma_f32_16x16x32_bf16 v[160:163], a[128:131], a[160:163], v[160:163]
    ds_read2_b64 a[192:195], v12 offset0:56 offset1:57
    v_add_f32_e64 v62, v154, v26
    v_mfma_f32_16x16x32_bf16 v[164:167], a[128:131], a[164:167], v[164:167]
    buffer_load_dwordx4 a[20:23], v14, s[64:67], s78 offen offset:1024 sc1
    v_add_f32_e64 v63, v155, v26
    v_mfma_f32_16x16x32_bf16 v[164:167], a[132:135], a[160:163], v[164:167]
    v_cvt_pk_bf16_f32 v62, v62, v63
    v_and_b32 v63, 0xffff0000, v62
    s_waitcnt lgkmcnt(11)
    v_mfma_f32_16x16x32_bf16 v[168:171], a[128:131], a[168:171], v[168:171]
    ds_read_b128 a[224:227], v18 offset:4480
    v_lshlrev_b32 v62, 16, v62
    v_mfma_f32_16x16x32_bf16 v[168:171], a[132:135], a[164:167], v[168:171]
    ds_read2_b64 a[196:199], v12 offset0:120 offset1:121
    v_mul_f32_e64 v62, v62, v27
    v_mfma_f32_16x16x32_bf16 v[168:171], a[136:139], a[160:163], v[168:171]
    v_mul_f32_e64 v63, v63, v27
    v_cvt_pk_bf16_f32 v57, v62, v63
    s_waitcnt lgkmcnt(11)
    v_mfma_f32_16x16x32_bf16 v[172:175], a[128:131], a[172:175], v[172:175]
    ds_read_b128 a[228:231], v18 offset:3968
    v_add_f32 v60, v156, v26
    v_mfma_f32_16x16x32_bf16 v[172:175], a[132:135], a[168:171], v[172:175]
    buffer_load_dwordx4 a[24:27], v14, s[64:67], s78 offen offset:2048 sc1
    v_add_f32_e64 v61, v157, v26
    v_mfma_f32_16x16x32_bf16 v[172:175], a[136:139], a[164:167], v[172:175]
    v_cvt_pk_bf16_f32 v60, v60, v61
    v_and_b32 v61, 0xffff0000, v60
    v_mfma_f32_16x16x32_bf16 v[172:175], a[140:143], a[160:163], v[172:175]
    ds_read2_b64 a[200:203], v12 offset0:184 offset1:185
    v_lshlrev_b32 v60, 16, v60
    s_waitcnt lgkmcnt(11)
    v_mfma_f32_16x16x32_bf16 v[176:179], a[128:131], a[176:179], v[176:179]
    v_mul_f32 v60, v60, v27
    v_mul_f32 v61, v61, v27
    v_mfma_f32_16x16x32_bf16 v[176:179], a[132:135], a[172:175], v[176:179]
    ds_read_b128 a[232:235], v18 offset:3456
    v_cvt_pk_bf16_f32 v58, v60, v61
    v_mfma_f32_16x16x32_bf16 v[176:179], a[136:139], a[168:171], v[176:179]
    ds_read2_b64 a[204:207], v12 offset0:248 offset1:249
    v_add_f32_e64 v62, v158, v26
    v_mfma_f32_16x16x32_bf16 v[176:179], a[140:143], a[164:167], v[176:179]
    v_add_f32_e64 v63, v159, v26
    v_cvt_pk_bf16_f32 v62, v62, v63
    v_mfma_f32_16x16x32_bf16 v[176:179], a[144:147], a[160:163], v[176:179]
    buffer_load_dwordx4 a[28:31], v14, s[64:67], s78 offen offset:3072 sc1
    s_add_u32 s78, s78, 16384
    s_waitcnt lgkmcnt(11)
    v_mfma_f32_16x16x32_bf16 v[180:183], a[128:131], a[180:183], v[180:183]
    ds_read_b128 a[236:239], v18 offset:2944
    v_and_b32 v63, 0xffff0000, v62
    v_mfma_f32_16x16x32_bf16 v[180:183], a[132:135], a[176:179], v[180:183]
    v_lshlrev_b32 v62, 16, v62
    v_mul_f32_e64 v62, v62, v27
    v_mfma_f32_16x16x32_bf16 v[180:183], a[136:139], a[172:175], v[180:183]
    ds_read2_b64 a[208:211], v13 offset0:56 offset1:57
    v_mul_f32_e64 v63, v63, v27
    v_mfma_f32_16x16x32_bf16 v[180:183], a[140:143], a[168:171], v[180:183]
    ds_read_b128 a[240:243], v18 offset:2432
    v_cvt_pk_bf16_f32 v59, v62, v63
    v_mfma_f32_16x16x32_bf16 v[180:183], a[144:147], a[164:167], v[180:183]
    v_lshrrev_b32 v35, 3, v1
    v_lshlrev_b32 v35, 12, v35
    v_mfma_f32_16x16x32_bf16 v[180:183], a[148:151], a[160:163], v[180:183]
    buffer_load_dwordx4 a[32:35], v14, s[64:67], s78 offen offset:0 sc1
    v_and_b32 v30, 7, v1
    s_waitcnt lgkmcnt(6)
    v_mfma_f32_16x16x32_bf16 v[184:187], a[128:131], a[184:187], v[184:187]
    v_lshl_add_u32 v35, v30, 4, v35
    s_lshl_b32 s32, s27, 17
    v_mfma_f32_16x16x32_bf16 v[184:187], a[132:135], a[180:183], v[184:187]
    ds_read2_b64 a[212:215], v13 offset0:120 offset1:121
    s_lshl_b32 s4, s28, 5
    v_mfma_f32_16x16x32_bf16 v[184:187], a[136:139], a[176:179], v[184:187]
    ds_read_b128 a[244:247], v18 offset:1920
    s_add_u32 s32, s32, s4
    v_mfma_f32_16x16x32_bf16 v[184:187], a[140:143], a[172:175], v[184:187]
    s_add_u32 s32, s32, 0x1c00000
    v_lshrrev_b32 v34, 2, v1
    v_mfma_f32_16x16x32_bf16 v[184:187], a[144:147], a[168:171], v[184:187]
    ds_read2_b64 a[216:219], v13 offset0:184 offset1:185
    v_lshlrev_b32_e64 v34, 7, v34
    v_mfma_f32_16x16x32_bf16 v[184:187], a[148:151], a[164:167], v[184:187]
    buffer_load_dwordx4 a[36:39], v14, s[64:67], s78 offen offset:1024 sc1
    v_and_b32_e64 v30, 3, v1
    v_mfma_f32_16x16x32_bf16 v[184:187], a[152:155], a[160:163], v[184:187]
    v_lshl_add_u32 v34, v30, 3, v34
    s_lshl_b32 s33, s3, 12
    v_mfma_f32_16x16x32_bf16 v[188:191], a[128:131], a[188:191], v[188:191]
    ds_read_b128 a[248:251], v18 offset:1408
    s_add_u32 s33, s33, 0x22800
    v_mfma_f32_16x16x32_bf16 v[188:191], a[132:135], a[184:187], v[188:191]
    ds_read2_b64 a[220:223], v13 offset0:248 offset1:249
    v_add_u32 v34, s33, v34
    v_mfma_f32_16x16x32_bf16 v[188:191], a[136:139], a[180:183], v[188:191]
    v_and_b32 v30, 1, v11
    v_lshrrev_b32 v31, 1, v11
    v_mfma_f32_16x16x32_bf16 v[188:191], a[140:143], a[176:179], v[188:191]
    ds_read_b128 a[252:255], v18 offset:896
    v_lshl_add_u32 v30, v30, 1, v31
    v_mfma_f32_16x16x32_bf16 v[188:191], a[144:147], a[172:175], v[188:191]
    v_lshl_add_u32 v15, v30, 4, v15
    s_mov_b32 s8, s56
    v_mfma_f32_16x16x32_bf16 v[188:191], a[148:151], a[168:171], v[188:191]
    s_mov_b32 s9, s57
    s_mov_b32 s10, 0x400000
    v_mfma_f32_16x16x32_bf16 v[188:191], a[152:155], a[164:167], v[188:191]
    s_mov_b32 s11, 0x00020000
    v_lshlrev_b32_e64 v29, 5, v10
    v_mfma_f32_16x16x32_bf16 v[188:191], a[156:159], a[160:163], v[188:191]
    v_lshl_add_u32 v29, v11, 3, v29
    s_lshl_b32 s71, s24, 12
    s_add_u32 s71, s71, 0x1c00000
    s_waitcnt lgkmcnt(0)
    s_barrier
    v_mfma_f32_16x16x32_bf16 v[160:163], a[192:195], a[224:227], v[160:163]
    ds_read_b64_tr_b16 v[64:65], v36 offset:0
    v_mfma_f32_16x16x32_bf16 v[164:167], a[192:195], a[228:231], v[164:167]
    buffer_load_dwordx4 a[40:43], v14, s[64:67], s78 offen offset:2048 sc1
    v_mfma_f32_16x16x32_bf16 v[164:167], a[196:199], a[224:227], v[164:167]
    v_mfma_f32_16x16x32_bf16 v[168:171], a[192:195], a[232:235], v[168:171]
    ds_read_b64_tr_b16 v[66:67], v36 offset:1024
    v_mfma_f32_16x16x32_bf16 v[168:171], a[196:199], a[228:231], v[168:171]
    ds_read_b64_tr_b16 v[68:69], v36 offset:8192
    v_mfma_f32_16x16x32_bf16 v[168:171], a[200:203], a[224:227], v[168:171]
    v_mfma_f32_16x16x32_bf16 v[172:175], a[192:195], a[236:239], v[172:175]
    buffer_load_dwordx4 a[44:47], v14, s[64:67], s78 offen offset:3072 sc1
    s_add_u32 s78, s78, 16384
    v_mfma_f32_16x16x32_bf16 v[172:175], a[196:199], a[232:235], v[172:175]
    ds_read_b64_tr_b16 v[70:71], v36 offset:9216
    v_mfma_f32_16x16x32_bf16 v[172:175], a[200:203], a[228:231], v[172:175]
    v_mfma_f32_16x16x32_bf16 v[172:175], a[204:207], a[224:227], v[172:175]
    ds_read_b64_tr_b16 v[72:73], v37 offset:0
    v_mfma_f32_16x16x32_bf16 v[176:179], a[192:195], a[240:243], v[176:179]
    ds_read_b64_tr_b16 v[74:75], v37 offset:1024
    v_mfma_f32_16x16x32_bf16 v[176:179], a[196:199], a[236:239], v[176:179]
    v_mfma_f32_16x16x32_bf16 v[176:179], a[200:203], a[232:235], v[176:179]
    buffer_load_dwordx4 a[48:51], v14, s[64:67], s78 offen offset:0 sc1
    v_mfma_f32_16x16x32_bf16 v[176:179], a[204:207], a[228:231], v[176:179]
    ds_read_b64_tr_b16 v[76:77], v37 offset:8192
    v_mfma_f32_16x16x32_bf16 v[176:179], a[208:211], a[224:227], v[176:179]
    v_mfma_f32_16x16x32_bf16 v[180:183], a[192:195], a[244:247], v[180:183]
    ds_read_b64_tr_b16 v[78:79], v37 offset:9216
    v_mfma_f32_16x16x32_bf16 v[180:183], a[196:199], a[240:243], v[180:183]
    ds_read_b64_tr_b16 v[80:81], v36 offset:16384
    v_mfma_f32_16x16x32_bf16 v[180:183], a[200:203], a[236:239], v[180:183]
    v_mfma_f32_16x16x32_bf16 v[180:183], a[204:207], a[232:235], v[180:183]
    buffer_load_dwordx4 a[52:55], v14, s[64:67], s78 offen offset:1024 sc1
    v_mfma_f32_16x16x32_bf16 v[180:183], a[208:211], a[228:231], v[180:183]
    ds_read_b64_tr_b16 v[82:83], v36 offset:17408
    v_mfma_f32_16x16x32_bf16 v[180:183], a[212:215], a[224:227], v[180:183]
    v_mfma_f32_16x16x32_bf16 v[184:187], a[192:195], a[248:251], v[184:187]
    ds_read_b64_tr_b16 v[84:85], v36 offset:24576
    v_mfma_f32_16x16x32_bf16 v[184:187], a[196:199], a[244:247], v[184:187]
    buffer_load_dwordx4 a[56:59], v14, s[64:67], s78 offen offset:2048 sc1
    v_mfma_f32_16x16x32_bf16 v[184:187], a[200:203], a[240:243], v[184:187]
    v_mfma_f32_16x16x32_bf16 v[184:187], a[204:207], a[236:239], v[184:187]
    ds_read_b64_tr_b16 v[86:87], v36 offset:25600
    v_mfma_f32_16x16x32_bf16 v[184:187], a[208:211], a[232:235], v[184:187]
    ds_read_b64_tr_b16 v[88:89], v37 offset:16384
    v_mfma_f32_16x16x32_bf16 v[184:187], a[212:215], a[228:231], v[184:187]
    v_mfma_f32_16x16x32_bf16 v[184:187], a[216:219], a[224:227], v[184:187]
    ds_read_b64_tr_b16 v[90:91], v37 offset:17408
    v_mfma_f32_16x16x32_bf16 v[188:191], a[192:195], a[252:255], v[188:191]
    buffer_load_dwordx4 a[60:63], v14, s[64:67], s78 offen offset:3072 sc1
    v_mfma_f32_16x16x32_bf16 v[188:191], a[196:199], a[248:251], v[188:191]
    v_mfma_f32_16x16x32_bf16 v[188:191], a[200:203], a[244:247], v[188:191]
    ds_read_b64_tr_b16 v[92:93], v37 offset:24576
    v_mfma_f32_16x16x32_bf16 v[188:191], a[204:207], a[240:243], v[188:191]
    ds_read_b64_tr_b16 v[94:95], v37 offset:25600
    v_mfma_f32_16x16x32_bf16 v[188:191], a[208:211], a[236:239], v[188:191]
    v_mfma_f32_16x16x32_bf16 v[188:191], a[212:215], a[232:235], v[188:191]
    v_mfma_f32_16x16x32_bf16 v[188:191], a[216:219], a[228:231], v[188:191]
    v_mfma_f32_16x16x32_bf16 v[188:191], a[220:223], a[224:227], v[188:191]
    v_cvt_pk_bf16_f32 v96, v160, v161
    v_cvt_pk_bf16_f32 v97, v162, v163
    buffer_store_dwordx2 v[96:97], v29, s[64:67], s71 offen offset:0 sc1
    v_cvt_pk_bf16_f32 v98, v164, v165
    v_cvt_pk_bf16_f32 v99, v166, v167
    buffer_store_dwordx2 v[98:99], v29, s[64:67], s71 offen offset:512 sc1
    v_cvt_pk_bf16_f32 v100, v168, v169
    v_cvt_pk_bf16_f32 v101, v170, v171
    buffer_store_dwordx2 v[100:101], v29, s[64:67], s71 offen offset:1024 sc1
    v_cvt_pk_bf16_f32 v102, v172, v173
    v_cvt_pk_bf16_f32 v103, v174, v175
    buffer_store_dwordx2 v[102:103], v29, s[64:67], s71 offen offset:1536 sc1
    v_cvt_pk_bf16_f32 v104, v176, v177
    v_cvt_pk_bf16_f32 v105, v178, v179
    buffer_store_dwordx2 v[104:105], v29, s[64:67], s71 offen offset:2048 sc1
    v_cvt_pk_bf16_f32 v106, v180, v181
    v_cvt_pk_bf16_f32 v107, v182, v183
    buffer_store_dwordx2 v[106:107], v29, s[64:67], s71 offen offset:2560 sc1
    v_cvt_pk_bf16_f32 v108, v184, v185
    v_cvt_pk_bf16_f32 v109, v186, v187
    buffer_store_dwordx2 v[108:109], v29, s[64:67], s71 offen offset:3072 sc1
    v_cvt_pk_bf16_f32 v110, v188, v189
    v_cvt_pk_bf16_f32 v111, v190, v191
    buffer_store_dwordx2 v[110:111], v29, s[64:67], s71 offen offset:3584 sc1
G2_GO:
    s_lshl_b32 s74, s24, 2
    s_add_u32 s74, s74, 0x1021000
    v_and_b32_e64 v33, 31, v1
    v_lshlrev_b32 v33, 2, v33
    s_lshl_b32 s34, s27, 7
    s_add_u32 s34, s34, 0x1021000
    s_waitcnt vmcnt(15) lgkmcnt(8)
    v_mfma_f32_16x16x32_bf16 v[128:131], v[64:67], a[0:3], v[128:131]
    ds_read_b64_tr_b16 v[96:97], v38 offset:0
    s_lshl_b32 s78, s17, 16
    s_add_u32 s78, s78, s29
    s_waitcnt vmcnt(11)
    v_mfma_f32_16x16x32_bf16 v[128:131], v[68:71], a[16:19], v[128:131]
    buffer_load_dwordx4 a[64:67], v14, s[64:67], s78 offen offset:0 sc1
    v_mfma_f32_16x16x32_bf16 v[136:139], v[64:67], a[4:7], v[136:139]
    ds_read_b64_tr_b16 v[98:99], v38 offset:1024
    s_waitcnt vmcnt(11)
    v_mfma_f32_16x16x32_bf16 v[136:139], v[68:71], a[20:23], v[136:139]
    buffer_load_dwordx4 a[68:71], v14, s[64:67], s78 offen offset:1024 sc1
    v_mfma_f32_16x16x32_bf16 v[144:147], v[64:67], a[8:11], v[144:147]
    ds_read_b64_tr_b16 v[100:101], v38 offset:8192
    s_waitcnt vmcnt(11)
    v_mfma_f32_16x16x32_bf16 v[144:147], v[68:71], a[24:27], v[144:147]
    ds_read_b64_tr_b16 v[102:103], v38 offset:9216
    v_mfma_f32_16x16x32_bf16 v[152:155], v[64:67], a[12:15], v[152:155]
    buffer_load_dwordx4 a[72:75], v14, s[64:67], s78 offen offset:2048 sc1
    s_waitcnt vmcnt(11)
    v_mfma_f32_16x16x32_bf16 v[152:155], v[68:71], a[28:31], v[152:155]
    ds_read_b64_tr_b16 v[104:105], v39 offset:0
    v_mfma_f32_16x16x32_bf16 v[132:135], v[72:75], a[0:3], v[132:135]
    buffer_load_dwordx4 a[76:79], v14, s[64:67], s78 offen offset:3072 sc1
    s_add_u32 s78, s78, 16384
    v_mfma_f32_16x16x32_bf16 v[132:135], v[76:79], a[16:19], v[132:135]
    ds_read_b64_tr_b16 v[106:107], v39 offset:1024
    v_mfma_f32_16x16x32_bf16 v[140:143], v[72:75], a[4:7], v[140:143]
    ds_read_b64_tr_b16 v[108:109], v39 offset:8192
    v_mfma_f32_16x16x32_bf16 v[140:143], v[76:79], a[20:23], v[140:143]
    buffer_load_dwordx4 a[80:83], v14, s[64:67], s78 offen offset:0 sc1
    v_mfma_f32_16x16x32_bf16 v[148:151], v[72:75], a[8:11], v[148:151]
    ds_read_b64_tr_b16 v[110:111], v39 offset:9216
    v_mfma_f32_16x16x32_bf16 v[148:151], v[76:79], a[24:27], v[148:151]
    ds_read_b64_tr_b16 v[112:113], v38 offset:16384
    v_mfma_f32_16x16x32_bf16 v[156:159], v[72:75], a[12:15], v[156:159]
    buffer_load_dwordx4 a[84:87], v14, s[64:67], s78 offen offset:1024 sc1
    v_mfma_f32_16x16x32_bf16 v[156:159], v[76:79], a[28:31], v[156:159]
    ds_read_b64_tr_b16 v[114:115], v38 offset:17408
    s_waitcnt vmcnt(13) lgkmcnt(9)
    v_mfma_f32_16x16x32_bf16 v[128:131], v[80:83], a[32:35], v[128:131]
    buffer_load_dwordx4 a[88:91], v14, s[64:67], s78 offen offset:2048 sc1
    s_waitcnt vmcnt(10)
    v_mfma_f32_16x16x32_bf16 v[128:131], v[84:87], a[48:51], v[128:131]
    ds_read_b64_tr_b16 v[116:117], v38 offset:24576
    v_mfma_f32_16x16x32_bf16 v[136:139], v[80:83], a[36:39], v[136:139]
    ds_read_b64_tr_b16 v[118:119], v38 offset:25600
    s_waitcnt vmcnt(9)
    v_mfma_f32_16x16x32_bf16 v[136:139], v[84:87], a[52:55], v[136:139]
    buffer_load_dwordx4 a[92:95], v14, s[64:67], s78 offen offset:3072 sc1
    s_add_u32 s78, s78, 16384
    v_mfma_f32_16x16x32_bf16 v[144:147], v[80:83], a[40:43], v[144:147]
    ds_read_b64_tr_b16 v[120:121], v39 offset:16384
    s_waitcnt vmcnt(9)
    v_mfma_f32_16x16x32_bf16 v[144:147], v[84:87], a[56:59], v[144:147]
    buffer_load_dwordx4 a[96:99], v14, s[64:67], s78 offen offset:0 sc1
    v_mfma_f32_16x16x32_bf16 v[152:155], v[80:83], a[44:47], v[152:155]
    ds_read_b64_tr_b16 v[122:123], v39 offset:17408
    s_waitcnt vmcnt(9)
    v_mfma_f32_16x16x32_bf16 v[152:155], v[84:87], a[60:63], v[152:155]
    ds_read_b64_tr_b16 v[124:125], v39 offset:24576
    v_mfma_f32_16x16x32_bf16 v[132:135], v[88:91], a[32:35], v[132:135]
    buffer_load_dwordx4 a[100:103], v14, s[64:67], s78 offen offset:1024 sc1
    v_mfma_f32_16x16x32_bf16 v[132:135], v[92:95], a[48:51], v[132:135]
    ds_read_b64_tr_b16 v[126:127], v39 offset:25600
    v_mfma_f32_16x16x32_bf16 v[140:143], v[88:91], a[36:39], v[140:143]
    v_mfma_f32_16x16x32_bf16 v[140:143], v[92:95], a[52:55], v[140:143]
    v_mfma_f32_16x16x32_bf16 v[148:151], v[88:91], a[40:43], v[148:151]
    v_mfma_f32_16x16x32_bf16 v[148:151], v[92:95], a[56:59], v[148:151]
    v_mfma_f32_16x16x32_bf16 v[156:159], v[88:91], a[44:47], v[156:159]
    v_mfma_f32_16x16x32_bf16 v[156:159], v[92:95], a[60:63], v[156:159]
    s_waitcnt lgkmcnt(8)
    v_mfma_f32_16x16x32_bf16 v[160:163], v[96:99], a[0:3], 0
    ds_read_b64_tr_b16 v[64:65], v40 offset:0
    v_mfma_f32_16x16x32_bf16 v[160:163], v[100:103], a[16:19], v[160:163]
    buffer_load_dwordx4 a[104:107], v14, s[64:67], s78 offen offset:2048 sc1
    v_mfma_f32_16x16x32_bf16 v[168:171], v[96:99], a[4:7], 0
    ds_read_b64_tr_b16 v[66:67], v40 offset:1024
    v_mfma_f32_16x16x32_bf16 v[168:171], v[100:103], a[20:23], v[168:171]
    buffer_load_dwordx4 a[108:111], v14, s[64:67], s78 offen offset:3072 sc1
    s_add_u32 s78, s78, 16384
    v_mfma_f32_16x16x32_bf16 v[176:179], v[96:99], a[8:11], 0
    ds_read_b64_tr_b16 v[68:69], v40 offset:8192
    v_mfma_f32_16x16x32_bf16 v[176:179], v[100:103], a[24:27], v[176:179]
    ds_read_b64_tr_b16 v[70:71], v40 offset:9216
    v_mfma_f32_16x16x32_bf16 v[184:187], v[96:99], a[12:15], 0
    buffer_load_dwordx4 a[112:115], v14, s[64:67], s78 offen offset:0 sc1
    v_mfma_f32_16x16x32_bf16 v[184:187], v[100:103], a[28:31], v[184:187]
    ds_read_b64_tr_b16 v[72:73], v41 offset:0
    v_mfma_f32_16x16x32_bf16 v[164:167], v[104:107], a[0:3], 0
    buffer_load_dwordx4 a[116:119], v14, s[64:67], s78 offen offset:1024 sc1
    v_mfma_f32_16x16x32_bf16 v[164:167], v[108:111], a[16:19], v[164:167]
    ds_read_b64_tr_b16 v[74:75], v41 offset:1024
    v_mfma_f32_16x16x32_bf16 v[172:175], v[104:107], a[4:7], 0
    ds_read_b64_tr_b16 v[76:77], v41 offset:8192
    v_mfma_f32_16x16x32_bf16 v[172:175], v[108:111], a[20:23], v[172:175]
    buffer_load_dwordx4 a[120:123], v14, s[64:67], s78 offen offset:2048 sc1
    v_mfma_f32_16x16x32_bf16 v[180:183], v[104:107], a[8:11], 0
    ds_read_b64_tr_b16 v[78:79], v41 offset:9216
    v_mfma_f32_16x16x32_bf16 v[180:183], v[108:111], a[24:27], v[180:183]
    ds_read_b64_tr_b16 v[80:81], v40 offset:16384
    v_mfma_f32_16x16x32_bf16 v[188:191], v[104:107], a[12:15], 0
    buffer_load_dwordx4 a[124:127], v14, s[64:67], s78 offen offset:3072 sc1
    v_mfma_f32_16x16x32_bf16 v[188:191], v[108:111], a[28:31], v[188:191]
    ds_read_b64_tr_b16 v[82:83], v40 offset:17408
    s_lshl_b32 s6, s75, 3
    s_lshr_b64 s[4:5], s[48:49], s6
    s_and_b32 s16, s4, 31
    s_lshl_b32 s79, s16, 18
    s_add_u32 m0, s31, 0x10000
    s_add_u32 s79, s79, s30
    s_waitcnt lgkmcnt(9)
    v_mfma_f32_16x16x32_bf16 v[160:163], v[112:115], a[32:35], v[160:163]
    buffer_load_dwordx4 v6, s[12:15], s79 offen offset:0 lds
    v_mfma_f32_16x16x32_bf16 v[160:163], v[116:119], a[48:51], v[160:163]
    ds_read_b64_tr_b16 v[84:85], v40 offset:24576
    v_mfma_f32_16x16x32_bf16 v[168:171], v[112:115], a[36:39], v[168:171]
    ds_read_b64_tr_b16 v[86:87], v40 offset:25600
    v_mfma_f32_16x16x32_bf16 v[168:171], v[116:119], a[52:55], v[168:171]
    buffer_load_dwordx4 v7, s[12:15], s79 offen offset:1024 lds
    s_add_u32 s75, s75, 1
    v_mfma_f32_16x16x32_bf16 v[176:179], v[112:115], a[40:43], v[176:179]
    ds_read_b64_tr_b16 v[88:89], v41 offset:16384
    v_mfma_f32_16x16x32_bf16 v[176:179], v[116:119], a[56:59], v[176:179]
    buffer_load_dwordx4 v8, s[12:15], s79 offen offset:2048 lds
    s_cmp_eq_u32 s75, 7
    s_cselect_b32 s75, 0, s75
    v_mfma_f32_16x16x32_bf16 v[184:187], v[112:115], a[44:47], v[184:187]
    ds_read_b64_tr_b16 v[90:91], v41 offset:17408
    v_mfma_f32_16x16x32_bf16 v[184:187], v[116:119], a[60:63], v[184:187]
    ds_read_b64_tr_b16 v[92:93], v41 offset:24576
    v_mfma_f32_16x16x32_bf16 v[164:167], v[120:123], a[32:35], v[164:167]
    buffer_load_dwordx4 v9, s[12:15], s79 offen offset:3072 lds
    v_mfma_f32_16x16x32_bf16 v[164:167], v[124:127], a[48:51], v[164:167]
    ds_read_b64_tr_b16 v[94:95], v41 offset:25600
    v_mfma_f32_16x16x32_bf16 v[172:175], v[120:123], a[36:39], v[172:175]
    v_mfma_f32_16x16x32_bf16 v[172:175], v[124:127], a[52:55], v[172:175]
    v_mfma_f32_16x16x32_bf16 v[180:183], v[120:123], a[40:43], v[180:183]
    v_mfma_f32_16x16x32_bf16 v[180:183], v[124:127], a[56:59], v[180:183]
    v_mfma_f32_16x16x32_bf16 v[188:191], v[120:123], a[44:47], v[188:191]
    v_mfma_f32_16x16x32_bf16 v[188:191], v[124:127], a[60:63], v[188:191]
    s_waitcnt lgkmcnt(8)
    v_mfma_f32_16x16x32_bf16 v[192:195], v[64:67], a[0:3], 0
    ds_read_b64_tr_b16 v[96:97], v42 offset:0
    s_add_u32 m0, s31, 0x11000
    s_add_u32 s79, s79, 0x8000
    v_mfma_f32_16x16x32_bf16 v[192:195], v[68:71], a[16:19], v[192:195]
    buffer_load_dwordx4 v6, s[12:15], s79 offen offset:0 lds
    v_mfma_f32_16x16x32_bf16 v[200:203], v[64:67], a[4:7], 0
    ds_read_b64_tr_b16 v[98:99], v42 offset:1024
    v_mfma_f32_16x16x32_bf16 v[200:203], v[68:71], a[20:23], v[200:203]
    buffer_load_dwordx4 v7, s[12:15], s79 offen offset:1024 lds
    v_mfma_f32_16x16x32_bf16 v[208:211], v[64:67], a[8:11], 0
    ds_read_b64_tr_b16 v[100:101], v42 offset:8192
    v_mfma_f32_16x16x32_bf16 v[208:211], v[68:71], a[24:27], v[208:211]
    ds_read_b64_tr_b16 v[102:103], v42 offset:9216
    v_mfma_f32_16x16x32_bf16 v[216:219], v[64:67], a[12:15], 0
    buffer_load_dwordx4 v8, s[12:15], s79 offen offset:2048 lds
    v_mfma_f32_16x16x32_bf16 v[216:219], v[68:71], a[28:31], v[216:219]
    ds_read_b64_tr_b16 v[104:105], v43 offset:0
    v_mfma_f32_16x16x32_bf16 v[196:199], v[72:75], a[0:3], 0
    buffer_load_dwordx4 v9, s[12:15], s79 offen offset:3072 lds
    v_mfma_f32_16x16x32_bf16 v[196:199], v[76:79], a[16:19], v[196:199]
    ds_read_b64_tr_b16 v[106:107], v43 offset:1024
    v_mfma_f32_16x16x32_bf16 v[204:207], v[72:75], a[4:7], 0
    ds_read_b64_tr_b16 v[108:109], v43 offset:8192
    s_lshl_b32 s78, s16, 16
    s_add_u32 s78, s78, s29
    v_mfma_f32_16x16x32_bf16 v[204:207], v[76:79], a[20:23], v[204:207]
    buffer_load_dwordx4 a[128:131], v14, s[64:67], s78 offen offset:0 sc1
    v_mfma_f32_16x16x32_bf16 v[212:215], v[72:75], a[8:11], 0
    ds_read_b64_tr_b16 v[110:111], v43 offset:9216
    v_mfma_f32_16x16x32_bf16 v[212:215], v[76:79], a[24:27], v[212:215]
    ds_read_b64_tr_b16 v[112:113], v42 offset:16384
    v_mfma_f32_16x16x32_bf16 v[220:223], v[72:75], a[12:15], 0
    buffer_load_dwordx4 a[132:135], v14, s[64:67], s78 offen offset:1024 sc1
    v_mfma_f32_16x16x32_bf16 v[220:223], v[76:79], a[28:31], v[220:223]
    ds_read_b64_tr_b16 v[114:115], v42 offset:17408
    s_waitcnt lgkmcnt(9)
    v_mfma_f32_16x16x32_bf16 v[192:195], v[80:83], a[32:35], v[192:195]
    buffer_load_dwordx4 a[136:139], v14, s[64:67], s78 offen offset:2048 sc1
    v_mfma_f32_16x16x32_bf16 v[192:195], v[84:87], a[48:51], v[192:195]
    ds_read_b64_tr_b16 v[116:117], v42 offset:24576
    v_mfma_f32_16x16x32_bf16 v[200:203], v[80:83], a[36:39], v[200:203]
    ds_read_b64_tr_b16 v[118:119], v42 offset:25600
    v_mfma_f32_16x16x32_bf16 v[200:203], v[84:87], a[52:55], v[200:203]
    buffer_load_dwordx4 a[140:143], v14, s[64:67], s78 offen offset:3072 sc1
    s_add_u32 s78, s78, 16384
    v_mfma_f32_16x16x32_bf16 v[208:211], v[80:83], a[40:43], v[208:211]
    ds_read_b64_tr_b16 v[120:121], v43 offset:16384
    v_mfma_f32_16x16x32_bf16 v[208:211], v[84:87], a[56:59], v[208:211]
    buffer_load_dwordx4 a[144:147], v14, s[64:67], s78 offen offset:0 sc1
    v_mfma_f32_16x16x32_bf16 v[216:219], v[80:83], a[44:47], v[216:219]
    ds_read_b64_tr_b16 v[122:123], v43 offset:17408
    v_mfma_f32_16x16x32_bf16 v[216:219], v[84:87], a[60:63], v[216:219]
    ds_read_b64_tr_b16 v[124:125], v43 offset:24576
    v_mfma_f32_16x16x32_bf16 v[196:199], v[88:91], a[32:35], v[196:199]
    buffer_load_dwordx4 a[148:151], v14, s[64:67], s78 offen offset:1024 sc1
    v_mfma_f32_16x16x32_bf16 v[196:199], v[92:95], a[48:51], v[196:199]
    ds_read_b64_tr_b16 v[126:127], v43 offset:25600
    v_mfma_f32_16x16x32_bf16 v[204:207], v[88:91], a[36:39], v[204:207]
    v_mfma_f32_16x16x32_bf16 v[204:207], v[92:95], a[52:55], v[204:207]
    v_mfma_f32_16x16x32_bf16 v[212:215], v[88:91], a[40:43], v[212:215]
    v_mfma_f32_16x16x32_bf16 v[212:215], v[92:95], a[56:59], v[212:215]
    v_mfma_f32_16x16x32_bf16 v[220:223], v[88:91], a[44:47], v[220:223]
    v_mfma_f32_16x16x32_bf16 v[220:223], v[92:95], a[60:63], v[220:223]
    s_waitcnt lgkmcnt(0)
    s_barrier
    v_mfma_f32_16x16x32_bf16 v[224:227], v[96:99], a[0:3], 0
    ds_read_b64_tr_b16 v[64:65], v36 offset:32768
    v_mfma_f32_16x16x32_bf16 v[224:227], v[100:103], a[16:19], v[224:227]
    buffer_load_dwordx4 a[152:155], v14, s[64:67], s78 offen offset:2048 sc1
    v_mfma_f32_16x16x32_bf16 v[232:235], v[96:99], a[4:7], 0
    ds_read_b64_tr_b16 v[66:67], v36 offset:33792
    v_mfma_f32_16x16x32_bf16 v[232:235], v[100:103], a[20:23], v[232:235]
    buffer_load_dwordx4 a[156:159], v14, s[64:67], s78 offen offset:3072 sc1
    s_add_u32 s78, s78, 16384
    v_mfma_f32_16x16x32_bf16 v[240:243], v[96:99], a[8:11], 0
    ds_read_b64_tr_b16 v[68:69], v36 offset:40960
    v_mfma_f32_16x16x32_bf16 v[240:243], v[100:103], a[24:27], v[240:243]
    ds_read_b64_tr_b16 v[70:71], v36 offset:41984
    v_mfma_f32_16x16x32_bf16 v[248:251], v[96:99], a[12:15], 0
    buffer_load_dwordx4 a[160:163], v14, s[64:67], s78 offen offset:0 sc1
    v_mfma_f32_16x16x32_bf16 v[248:251], v[100:103], a[28:31], v[248:251]
    ds_read_b64_tr_b16 v[72:73], v37 offset:32768
    v_mfma_f32_16x16x32_bf16 v[228:231], v[104:107], a[0:3], 0
    buffer_load_dwordx4 a[164:167], v14, s[64:67], s78 offen offset:1024 sc1
    v_mfma_f32_16x16x32_bf16 v[228:231], v[108:111], a[16:19], v[228:231]
    ds_read_b64_tr_b16 v[74:75], v37 offset:33792
    v_mfma_f32_16x16x32_bf16 v[236:239], v[104:107], a[4:7], 0
    ds_read_b64_tr_b16 v[76:77], v37 offset:40960
    v_mfma_f32_16x16x32_bf16 v[236:239], v[108:111], a[20:23], v[236:239]
    buffer_load_dwordx4 a[168:171], v14, s[64:67], s78 offen offset:2048 sc1
    v_mfma_f32_16x16x32_bf16 v[244:247], v[104:107], a[8:11], 0
    ds_read_b64_tr_b16 v[78:79], v37 offset:41984
    v_mfma_f32_16x16x32_bf16 v[244:247], v[108:111], a[24:27], v[244:247]
    ds_read_b64_tr_b16 v[80:81], v36 offset:49152
    v_mfma_f32_16x16x32_bf16 v[252:255], v[104:107], a[12:15], 0
    buffer_load_dwordx4 a[172:175], v14, s[64:67], s78 offen offset:3072 sc1
    s_add_u32 s78, s78, 16384
    v_mfma_f32_16x16x32_bf16 v[252:255], v[108:111], a[28:31], v[252:255]
    ds_read_b64_tr_b16 v[82:83], v36 offset:50176
    v_mfma_f32_16x16x32_bf16 v[224:227], v[112:115], a[32:35], v[224:227]
    buffer_load_dwordx4 a[176:179], v14, s[64:67], s78 offen offset:0 sc1
    v_mfma_f32_16x16x32_bf16 v[224:227], v[116:119], a[48:51], v[224:227]
    ds_read_b64_tr_b16 v[84:85], v36 offset:57344
    v_mfma_f32_16x16x32_bf16 v[232:235], v[112:115], a[36:39], v[232:235]
    ds_read_b64_tr_b16 v[86:87], v36 offset:58368
    v_mfma_f32_16x16x32_bf16 v[232:235], v[116:119], a[52:55], v[232:235]
    buffer_load_dwordx4 a[180:183], v14, s[64:67], s78 offen offset:1024 sc1
    v_mfma_f32_16x16x32_bf16 v[240:243], v[112:115], a[40:43], v[240:243]
    ds_read_b64_tr_b16 v[88:89], v37 offset:49152
    v_mfma_f32_16x16x32_bf16 v[240:243], v[116:119], a[56:59], v[240:243]
    buffer_load_dwordx4 a[184:187], v14, s[64:67], s78 offen offset:2048 sc1
    v_mfma_f32_16x16x32_bf16 v[248:251], v[112:115], a[44:47], v[248:251]
    ds_read_b64_tr_b16 v[90:91], v37 offset:50176
    v_mfma_f32_16x16x32_bf16 v[248:251], v[116:119], a[60:63], v[248:251]
    ds_read_b64_tr_b16 v[92:93], v37 offset:57344
    v_mfma_f32_16x16x32_bf16 v[228:231], v[120:123], a[32:35], v[228:231]
    buffer_load_dwordx4 a[188:191], v14, s[64:67], s78 offen offset:3072 sc1
    v_mfma_f32_16x16x32_bf16 v[228:231], v[124:127], a[48:51], v[228:231]
    ds_read_b64_tr_b16 v[94:95], v37 offset:58368
    v_mfma_f32_16x16x32_bf16 v[236:239], v[120:123], a[36:39], v[236:239]
    v_mfma_f32_16x16x32_bf16 v[236:239], v[124:127], a[52:55], v[236:239]
    v_mfma_f32_16x16x32_bf16 v[244:247], v[120:123], a[40:43], v[244:247]
    v_mfma_f32_16x16x32_bf16 v[244:247], v[124:127], a[56:59], v[244:247]
    v_mfma_f32_16x16x32_bf16 v[252:255], v[120:123], a[44:47], v[252:255]
    v_mfma_f32_16x16x32_bf16 v[252:255], v[124:127], a[60:63], v[252:255]
    s_waitcnt vmcnt(39) lgkmcnt(8)
    v_mfma_f32_16x16x32_bf16 v[128:131], v[64:67], a[64:67], v[128:131]
    ds_read_b64_tr_b16 v[96:97], v38 offset:32768
    s_lshl_b32 s6, s75, 3
    s_lshr_b64 s[4:5], s[48:49], s6
    s_and_b32 s16, s4, 31
    s_lshl_b32 s79, s16, 18
    s_add_u32 m0, s31, 0x0
    s_add_u32 s79, s79, s30
    s_waitcnt vmcnt(35)
    v_mfma_f32_16x16x32_bf16 v[128:131], v[68:71], a[80:83], v[128:131]
    buffer_load_dwordx4 v6, s[12:15], s79 offen offset:0 lds
    v_mfma_f32_16x16x32_bf16 v[136:139], v[64:67], a[68:71], v[136:139]
    ds_read_b64_tr_b16 v[98:99], v38 offset:33792
    s_waitcnt vmcnt(35)
    v_mfma_f32_16x16x32_bf16 v[136:139], v[68:71], a[84:87], v[136:139]
    ds_read_b64_tr_b16 v[100:101], v38 offset:40960
    v_mfma_f32_16x16x32_bf16 v[144:147], v[64:67], a[72:75], v[144:147]
    buffer_load_dwordx4 v7, s[12:15], s79 offen offset:1024 lds
    s_add_u32 s75, s75, 1
    s_waitcnt vmcnt(35)
    v_mfma_f32_16x16x32_bf16 v[144:147], v[68:71], a[88:91], v[144:147]
    v_mfma_f32_16x16x32_bf16 v[152:155], v[64:67], a[76:79], v[152:155]
    ds_read_b64_tr_b16 v[102:103], v38 offset:41984
    s_waitcnt vmcnt(34)
    v_mfma_f32_16x16x32_bf16 v[152:155], v[68:71], a[92:95], v[152:155]
    ds_read_b64_tr_b16 v[104:105], v39 offset:32768
    v_mfma_f32_16x16x32_bf16 v[132:135], v[72:75], a[64:67], v[132:135]
    ds_read_b64_tr_b16 v[106:107], v39 offset:33792
    v_mfma_f32_16x16x32_bf16 v[132:135], v[76:79], a[80:83], v[132:135]
    buffer_load_dwordx4 v8, s[12:15], s79 offen offset:2048 lds
    s_cmp_eq_u32 s75, 7
    s_cselect_b32 s75, 0, s75
    v_mfma_f32_16x16x32_bf16 v[140:143], v[72:75], a[68:71], v[140:143]
    v_mfma_f32_16x16x32_bf16 v[140:143], v[76:79], a[84:87], v[140:143]
    ds_read_b64_tr_b16 v[108:109], v39 offset:40960
    v_mfma_f32_16x16x32_bf16 v[148:151], v[72:75], a[72:75], v[148:151]
    ds_read_b64_tr_b16 v[110:111], v39 offset:41984
    v_mfma_f32_16x16x32_bf16 v[148:151], v[76:79], a[88:91], v[148:151]
    ds_read_b64_tr_b16 v[112:113], v38 offset:49152
    v_mfma_f32_16x16x32_bf16 v[156:159], v[72:75], a[76:79], v[156:159]
    buffer_load_dwordx4 v9, s[12:15], s79 offen offset:3072 lds
    v_mfma_f32_16x16x32_bf16 v[156:159], v[76:79], a[92:95], v[156:159]
    ds_read_b64_tr_b16 v[114:115], v38 offset:50176
    s_waitcnt vmcnt(35) lgkmcnt(9)
    v_mfma_f32_16x16x32_bf16 v[128:131], v[80:83], a[96:99], v[128:131]
    s_waitcnt vmcnt(31)
    v_mfma_f32_16x16x32_bf16 v[128:131], v[84:87], a[112:115], v[128:131]
    ds_read_b64_tr_b16 v[116:117], v38 offset:57344
    s_add_u32 m0, s31, 0x1000
    s_add_u32 s79, s79, 0x8000
    v_mfma_f32_16x16x32_bf16 v[136:139], v[80:83], a[100:103], v[136:139]
    buffer_load_dwordx4 v6, s[12:15], s79 offen offset:0 lds
    s_waitcnt vmcnt(31)
    v_mfma_f32_16x16x32_bf16 v[136:139], v[84:87], a[116:119], v[136:139]
    ds_read_b64_tr_b16 v[118:119], v38 offset:58368
    v_mfma_f32_16x16x32_bf16 v[144:147], v[80:83], a[104:107], v[144:147]
    ds_read_b64_tr_b16 v[120:121], v39 offset:49152
    s_waitcnt vmcnt(30)
    v_mfma_f32_16x16x32_bf16 v[144:147], v[84:87], a[120:123], v[144:147]
    v_mfma_f32_16x16x32_bf16 v[152:155], v[80:83], a[108:111], v[152:155]
    ds_read_b64_tr_b16 v[122:123], v39 offset:50176
    s_waitcnt vmcnt(29)
    v_mfma_f32_16x16x32_bf16 v[152:155], v[84:87], a[124:127], v[152:155]
    buffer_load_dwordx4 v7, s[12:15], s79 offen offset:1024 lds
    v_mfma_f32_16x16x32_bf16 v[132:135], v[88:91], a[96:99], v[132:135]
    ds_read_b64_tr_b16 v[124:125], v39 offset:57344
    v_mfma_f32_16x16x32_bf16 v[132:135], v[92:95], a[112:115], v[132:135]
    ds_read_b64_tr_b16 v[126:127], v39 offset:58368
    v_mfma_f32_16x16x32_bf16 v[140:143], v[88:91], a[100:103], v[140:143]
    v_mfma_f32_16x16x32_bf16 v[140:143], v[92:95], a[116:119], v[140:143]
    v_mfma_f32_16x16x32_bf16 v[148:151], v[88:91], a[104:107], v[148:151]
    v_mfma_f32_16x16x32_bf16 v[148:151], v[92:95], a[120:123], v[148:151]
    v_mfma_f32_16x16x32_bf16 v[156:159], v[88:91], a[108:111], v[156:159]
    v_mfma_f32_16x16x32_bf16 v[156:159], v[92:95], a[124:127], v[156:159]
    s_waitcnt lgkmcnt(8)
    v_mfma_f32_16x16x32_bf16 v[160:163], v[96:99], a[64:67], v[160:163]
    ds_read_b64_tr_b16 v[64:65], v40 offset:32768
    v_mfma_f32_16x16x32_bf16 v[160:163], v[100:103], a[80:83], v[160:163]
    buffer_load_dwordx4 v8, s[12:15], s79 offen offset:2048 lds
    v_mfma_f32_16x16x32_bf16 v[168:171], v[96:99], a[68:71], v[168:171]
    ds_read_b64_tr_b16 v[66:67], v40 offset:33792
    v_mfma_f32_16x16x32_bf16 v[168:171], v[100:103], a[84:87], v[168:171]
    ds_read_b64_tr_b16 v[68:69], v40 offset:40960
    v_mfma_f32_16x16x32_bf16 v[176:179], v[96:99], a[72:75], v[176:179]
    buffer_load_dwordx4 v9, s[12:15], s79 offen offset:3072 lds
    v_mfma_f32_16x16x32_bf16 v[176:179], v[100:103], a[88:91], v[176:179]
    v_mfma_f32_16x16x32_bf16 v[184:187], v[96:99], a[76:79], v[184:187]
    ds_read_b64_tr_b16 v[70:71], v40 offset:41984
    v_mfma_f32_16x16x32_bf16 v[184:187], v[100:103], a[92:95], v[184:187]
    ds_read_b64_tr_b16 v[72:73], v41 offset:32768
    v_mfma_f32_16x16x32_bf16 v[164:167], v[104:107], a[64:67], v[164:167]
    ds_read_b64_tr_b16 v[74:75], v41 offset:33792
    s_lshl_b32 s78, s16, 16
    s_add_u32 s78, s78, s29
    v_mfma_f32_16x16x32_bf16 v[164:167], v[108:111], a[80:83], v[164:167]
    buffer_load_dwordx4 a[0:3], v14, s[64:67], s78 offen offset:0 sc1
    v_mfma_f32_16x16x32_bf16 v[172:175], v[104:107], a[68:71], v[172:175]
    v_mfma_f32_16x16x32_bf16 v[172:175], v[108:111], a[84:87], v[172:175]
    ds_read_b64_tr_b16 v[76:77], v41 offset:40960
    v_mfma_f32_16x16x32_bf16 v[180:183], v[104:107], a[72:75], v[180:183]
    ds_read_b64_tr_b16 v[78:79], v41 offset:41984
    v_mfma_f32_16x16x32_bf16 v[180:183], v[108:111], a[88:91], v[180:183]
    ds_read_b64_tr_b16 v[80:81], v40 offset:49152
    v_mfma_f32_16x16x32_bf16 v[188:191], v[104:107], a[76:79], v[188:191]
    buffer_load_dwordx4 a[4:7], v14, s[64:67], s78 offen offset:1024 sc1
    v_mfma_f32_16x16x32_bf16 v[188:191], v[108:111], a[92:95], v[188:191]
    ds_read_b64_tr_b16 v[82:83], v40 offset:50176
    s_waitcnt lgkmcnt(9)
    v_mfma_f32_16x16x32_bf16 v[160:163], v[112:115], a[96:99], v[160:163]
    v_mfma_f32_16x16x32_bf16 v[160:163], v[116:119], a[112:115], v[160:163]
    ds_read_b64_tr_b16 v[84:85], v40 offset:57344
    v_mfma_f32_16x16x32_bf16 v[168:171], v[112:115], a[100:103], v[168:171]
    buffer_load_dwordx4 a[8:11], v14, s[64:67], s78 offen offset:2048 sc1
    v_mfma_f32_16x16x32_bf16 v[168:171], v[116:119], a[116:119], v[168:171]
    ds_read_b64_tr_b16 v[86:87], v40 offset:58368
    v_mfma_f32_16x16x32_bf16 v[176:179], v[112:115], a[104:107], v[176:179]
    ds_read_b64_tr_b16 v[88:89], v41 offset:49152
    v_mfma_f32_16x16x32_bf16 v[176:179], v[116:119], a[120:123], v[176:179]
    v_mfma_f32_16x16x32_bf16 v[184:187], v[112:115], a[108:111], v[184:187]
    ds_read_b64_tr_b16 v[90:91], v41 offset:50176
    v_mfma_f32_16x16x32_bf16 v[184:187], v[116:119], a[124:127], v[184:187]
    buffer_load_dwordx4 a[12:15], v14, s[64:67], s78 offen offset:3072 sc1
    s_add_u32 s78, s78, 16384
    v_mfma_f32_16x16x32_bf16 v[164:167], v[120:123], a[96:99], v[164:167]
    ds_read_b64_tr_b16 v[92:93], v41 offset:57344
    v_mfma_f32_16x16x32_bf16 v[164:167], v[124:127], a[112:115], v[164:167]
    ds_read_b64_tr_b16 v[94:95], v41 offset:58368
    v_mfma_f32_16x16x32_bf16 v[172:175], v[120:123], a[100:103], v[172:175]
    v_mfma_f32_16x16x32_bf16 v[172:175], v[124:127], a[116:119], v[172:175]
    v_mfma_f32_16x16x32_bf16 v[180:183], v[120:123], a[104:107], v[180:183]
    v_mfma_f32_16x16x32_bf16 v[180:183], v[124:127], a[120:123], v[180:183]
    v_mfma_f32_16x16x32_bf16 v[188:191], v[120:123], a[108:111], v[188:191]
    v_mfma_f32_16x16x32_bf16 v[188:191], v[124:127], a[124:127], v[188:191]
    s_waitcnt lgkmcnt(8)
    v_mfma_f32_16x16x32_bf16 v[192:195], v[64:67], a[64:67], v[192:195]
    ds_read_b64_tr_b16 v[96:97], v42 offset:32768
    v_mfma_f32_16x16x32_bf16 v[192:195], v[68:71], a[80:83], v[192:195]
    buffer_load_dwordx4 a[16:19], v14, s[64:67], s78 offen offset:0 sc1
    v_mfma_f32_16x16x32_bf16 v[200:203], v[64:67], a[68:71], v[200:203]
    ds_read_b64_tr_b16 v[98:99], v42 offset:33792
    v_mfma_f32_16x16x32_bf16 v[200:203], v[68:71], a[84:87], v[200:203]
    ds_read_b64_tr_b16 v[100:101], v42 offset:40960
    v_mfma_f32_16x16x32_bf16 v[208:211], v[64:67], a[72:75], v[208:211]
    buffer_load_dwordx4 a[20:23], v14, s[64:67], s78 offen offset:1024 sc1
    v_mfma_f32_16x16x32_bf16 v[208:211], v[68:71], a[88:91], v[208:211]
    v_mfma_f32_16x16x32_bf16 v[216:219], v[64:67], a[76:79], v[216:219]
    ds_read_b64_tr_b16 v[102:103], v42 offset:41984
    v_mfma_f32_16x16x32_bf16 v[216:219], v[68:71], a[92:95], v[216:219]
    ds_read_b64_tr_b16 v[104:105], v43 offset:32768
    v_mfma_f32_16x16x32_bf16 v[196:199], v[72:75], a[64:67], v[196:199]
    ds_read_b64_tr_b16 v[106:107], v43 offset:33792
    v_mfma_f32_16x16x32_bf16 v[196:199], v[76:79], a[80:83], v[196:199]
    buffer_load_dwordx4 a[24:27], v14, s[64:67], s78 offen offset:2048 sc1
    v_mfma_f32_16x16x32_bf16 v[204:207], v[72:75], a[68:71], v[204:207]
    v_mfma_f32_16x16x32_bf16 v[204:207], v[76:79], a[84:87], v[204:207]
    ds_read_b64_tr_b16 v[108:109], v43 offset:40960
    v_mfma_f32_16x16x32_bf16 v[212:215], v[72:75], a[72:75], v[212:215]
    ds_read_b64_tr_b16 v[110:111], v43 offset:41984
    v_mfma_f32_16x16x32_bf16 v[212:215], v[76:79], a[88:91], v[212:215]
    ds_read_b64_tr_b16 v[112:113], v42 offset:49152
    v_mfma_f32_16x16x32_bf16 v[220:223], v[72:75], a[76:79], v[220:223]
    buffer_load_dwordx4 a[28:31], v14, s[64:67], s78 offen offset:3072 sc1
    s_add_u32 s78, s78, 16384
    v_mfma_f32_16x16x32_bf16 v[220:223], v[76:79], a[92:95], v[220:223]
    ds_read_b64_tr_b16 v[114:115], v42 offset:50176
    s_waitcnt lgkmcnt(9)
    v_mfma_f32_16x16x32_bf16 v[192:195], v[80:83], a[96:99], v[192:195]
    v_mfma_f32_16x16x32_bf16 v[192:195], v[84:87], a[112:115], v[192:195]
    ds_read_b64_tr_b16 v[116:117], v42 offset:57344
    v_mfma_f32_16x16x32_bf16 v[200:203], v[80:83], a[100:103], v[200:203]
    buffer_load_dwordx4 a[32:35], v14, s[64:67], s78 offen offset:0 sc1
    v_mfma_f32_16x16x32_bf16 v[200:203], v[84:87], a[116:119], v[200:203]
    ds_read_b64_tr_b16 v[118:119], v42 offset:58368
    v_mfma_f32_16x16x32_bf16 v[208:211], v[80:83], a[104:107], v[208:211]
    ds_read_b64_tr_b16 v[120:121], v43 offset:49152
    v_mfma_f32_16x16x32_bf16 v[208:211], v[84:87], a[120:123], v[208:211]
    v_mfma_f32_16x16x32_bf16 v[216:219], v[80:83], a[108:111], v[216:219]
    ds_read_b64_tr_b16 v[122:123], v43 offset:50176
    v_mfma_f32_16x16x32_bf16 v[216:219], v[84:87], a[124:127], v[216:219]
    buffer_load_dwordx4 a[36:39], v14, s[64:67], s78 offen offset:1024 sc1
    v_mfma_f32_16x16x32_bf16 v[196:199], v[88:91], a[96:99], v[196:199]
    ds_read_b64_tr_b16 v[124:125], v43 offset:57344
    v_mfma_f32_16x16x32_bf16 v[196:199], v[92:95], a[112:115], v[196:199]
    ds_read_b64_tr_b16 v[126:127], v43 offset:58368
    v_mfma_f32_16x16x32_bf16 v[204:207], v[88:91], a[100:103], v[204:207]
    v_mfma_f32_16x16x32_bf16 v[204:207], v[92:95], a[116:119], v[204:207]
    v_mfma_f32_16x16x32_bf16 v[212:215], v[88:91], a[104:107], v[212:215]
    v_mfma_f32_16x16x32_bf16 v[212:215], v[92:95], a[120:123], v[212:215]
    v_mfma_f32_16x16x32_bf16 v[220:223], v[88:91], a[108:111], v[220:223]
    v_mfma_f32_16x16x32_bf16 v[220:223], v[92:95], a[124:127], v[220:223]
    s_waitcnt vmcnt(34) lgkmcnt(0)
    s_barrier
    v_add_u32 v36, 0x10000, v36
    v_add_u32 v37, 0x10000, v37
    v_mfma_f32_16x16x32_bf16 v[224:227], v[96:99], a[64:67], v[224:227]
    ds_read_b64_tr_b16 v[64:65], v36 offset:0
    v_mfma_f32_16x16x32_bf16 v[224:227], v[100:103], a[80:83], v[224:227]
    buffer_load_dwordx4 a[40:43], v14, s[64:67], s78 offen offset:2048 sc1
    v_mfma_f32_16x16x32_bf16 v[232:235], v[96:99], a[68:71], v[232:235]
    ds_read_b64_tr_b16 v[66:67], v36 offset:1024
    v_mfma_f32_16x16x32_bf16 v[232:235], v[100:103], a[84:87], v[232:235]
    ds_read_b64_tr_b16 v[68:69], v36 offset:8192
    v_mfma_f32_16x16x32_bf16 v[240:243], v[96:99], a[72:75], v[240:243]
    buffer_load_dwordx4 a[44:47], v14, s[64:67], s78 offen offset:3072 sc1
    s_add_u32 s78, s78, 16384
    v_mfma_f32_16x16x32_bf16 v[240:243], v[100:103], a[88:91], v[240:243]
    v_mfma_f32_16x16x32_bf16 v[248:251], v[96:99], a[76:79], v[248:251]
    ds_read_b64_tr_b16 v[70:71], v36 offset:9216
    v_mfma_f32_16x16x32_bf16 v[248:251], v[100:103], a[92:95], v[248:251]
    ds_read_b64_tr_b16 v[72:73], v37 offset:0
    v_mfma_f32_16x16x32_bf16 v[228:231], v[104:107], a[64:67], v[228:231]
    ds_read_b64_tr_b16 v[74:75], v37 offset:1024
    v_mfma_f32_16x16x32_bf16 v[228:231], v[108:111], a[80:83], v[228:231]
    buffer_load_dwordx4 a[48:51], v14, s[64:67], s78 offen offset:0 sc1
    v_mfma_f32_16x16x32_bf16 v[236:239], v[104:107], a[68:71], v[236:239]
    v_mfma_f32_16x16x32_bf16 v[236:239], v[108:111], a[84:87], v[236:239]
    ds_read_b64_tr_b16 v[76:77], v37 offset:8192
    v_mfma_f32_16x16x32_bf16 v[244:247], v[104:107], a[72:75], v[244:247]
    ds_read_b64_tr_b16 v[78:79], v37 offset:9216
    v_mfma_f32_16x16x32_bf16 v[244:247], v[108:111], a[88:91], v[244:247]
    ds_read_b64_tr_b16 v[80:81], v36 offset:16384
    v_mfma_f32_16x16x32_bf16 v[252:255], v[104:107], a[76:79], v[252:255]
    buffer_load_dwordx4 a[52:55], v14, s[64:67], s78 offen offset:1024 sc1
    v_mfma_f32_16x16x32_bf16 v[252:255], v[108:111], a[92:95], v[252:255]
    ds_read_b64_tr_b16 v[82:83], v36 offset:17408
    v_mfma_f32_16x16x32_bf16 v[224:227], v[112:115], a[96:99], v[224:227]
    v_mfma_f32_16x16x32_bf16 v[224:227], v[116:119], a[112:115], v[224:227]
    ds_read_b64_tr_b16 v[84:85], v36 offset:24576
    v_mfma_f32_16x16x32_bf16 v[232:235], v[112:115], a[100:103], v[232:235]
    buffer_load_dwordx4 a[56:59], v14, s[64:67], s78 offen offset:2048 sc1
    v_mfma_f32_16x16x32_bf16 v[232:235], v[116:119], a[116:119], v[232:235]
    ds_read_b64_tr_b16 v[86:87], v36 offset:25600
    v_mfma_f32_16x16x32_bf16 v[240:243], v[112:115], a[104:107], v[240:243]
    ds_read_b64_tr_b16 v[88:89], v37 offset:16384
    v_mfma_f32_16x16x32_bf16 v[240:243], v[116:119], a[120:123], v[240:243]
    v_mfma_f32_16x16x32_bf16 v[248:251], v[112:115], a[108:111], v[248:251]
    ds_read_b64_tr_b16 v[90:91], v37 offset:17408
    v_mfma_f32_16x16x32_bf16 v[248:251], v[116:119], a[124:127], v[248:251]
    buffer_load_dwordx4 a[60:63], v14, s[64:67], s78 offen offset:3072 sc1
    v_mfma_f32_16x16x32_bf16 v[228:231], v[120:123], a[96:99], v[228:231]
    ds_read_b64_tr_b16 v[92:93], v37 offset:24576
    v_mfma_f32_16x16x32_bf16 v[228:231], v[124:127], a[112:115], v[228:231]
    ds_read_b64_tr_b16 v[94:95], v37 offset:25600
    v_mfma_f32_16x16x32_bf16 v[236:239], v[120:123], a[100:103], v[236:239]
    v_mfma_f32_16x16x32_bf16 v[236:239], v[124:127], a[116:119], v[236:239]
    v_mfma_f32_16x16x32_bf16 v[244:247], v[120:123], a[104:107], v[244:247]
    v_mfma_f32_16x16x32_bf16 v[244:247], v[124:127], a[120:123], v[244:247]
    v_mfma_f32_16x16x32_bf16 v[252:255], v[120:123], a[108:111], v[252:255]
    v_mfma_f32_16x16x32_bf16 v[252:255], v[124:127], a[124:127], v[252:255]
    s_mov_b64 exec, 1
    buffer_store_dword v5, v4, s[64:67], s74 offen sc1
    s_mov_b64 exec, -1
    v_add_u32 v38, 0x10000, v38
    v_add_u32 v39, 0x10000, v39
    s_waitcnt vmcnt(40) lgkmcnt(8)
    v_mfma_f32_16x16x32_bf16 v[128:131], v[64:67], a[128:131], v[128:131]
    ds_read_b64_tr_b16 v[96:97], v38 offset:0
    s_lshl_b32 s6, s75, 3
    s_lshr_b64 s[4:5], s[48:49], s6
    s_and_b32 s16, s4, 31
    s_lshl_b32 s79, s16, 18
    s_add_u32 m0, s31, 0x8000
    s_add_u32 s79, s79, s30
    s_waitcnt vmcnt(36)
    v_mfma_f32_16x16x32_bf16 v[128:131], v[68:71], a[144:147], v[128:131]
    buffer_load_dwordx4 v6, s[12:15], s79 offen offset:0 lds
    v_mfma_f32_16x16x32_bf16 v[136:139], v[64:67], a[132:135], v[136:139]
    ds_read_b64_tr_b16 v[98:99], v38 offset:1024
    s_waitcnt vmcnt(36)
    v_mfma_f32_16x16x32_bf16 v[136:139], v[68:71], a[148:151], v[136:139]
    ds_read_b64_tr_b16 v[100:101], v38 offset:8192
    v_mfma_f32_16x16x32_bf16 v[144:147], v[64:67], a[136:139], v[144:147]
    buffer_load_dwordx4 v7, s[12:15], s79 offen offset:1024 lds
    s_add_u32 s75, s75, 1
    s_waitcnt vmcnt(36)
    v_mfma_f32_16x16x32_bf16 v[144:147], v[68:71], a[152:155], v[144:147]
    v_mfma_f32_16x16x32_bf16 v[152:155], v[64:67], a[140:143], v[152:155]
    ds_read_b64_tr_b16 v[102:103], v38 offset:9216
    s_waitcnt vmcnt(35)
    v_mfma_f32_16x16x32_bf16 v[152:155], v[68:71], a[156:159], v[152:155]
    ds_read_b64_tr_b16 v[104:105], v39 offset:0
    v_mfma_f32_16x16x32_bf16 v[132:135], v[72:75], a[128:131], v[132:135]
    ds_read_b64_tr_b16 v[106:107], v39 offset:1024
    v_mfma_f32_16x16x32_bf16 v[132:135], v[76:79], a[144:147], v[132:135]
    buffer_load_dwordx4 v8, s[12:15], s79 offen offset:2048 lds
    s_cmp_eq_u32 s75, 7
    s_cselect_b32 s75, 0, s75
    v_mfma_f32_16x16x32_bf16 v[140:143], v[72:75], a[132:135], v[140:143]
    v_mfma_f32_16x16x32_bf16 v[140:143], v[76:79], a[148:151], v[140:143]
    ds_read_b64_tr_b16 v[108:109], v39 offset:8192
    v_mfma_f32_16x16x32_bf16 v[148:151], v[72:75], a[136:139], v[148:151]
    ds_read_b64_tr_b16 v[110:111], v39 offset:9216
    v_mfma_f32_16x16x32_bf16 v[148:151], v[76:79], a[152:155], v[148:151]
    ds_read_b64_tr_b16 v[112:113], v38 offset:16384
    v_mfma_f32_16x16x32_bf16 v[156:159], v[72:75], a[140:143], v[156:159]
    buffer_load_dwordx4 v9, s[12:15], s79 offen offset:3072 lds
    v_mfma_f32_16x16x32_bf16 v[156:159], v[76:79], a[156:159], v[156:159]
    ds_read_b64_tr_b16 v[114:115], v38 offset:17408
    s_waitcnt vmcnt(36) lgkmcnt(9)
    v_mfma_f32_16x16x32_bf16 v[128:131], v[80:83], a[160:163], v[128:131]
    s_waitcnt vmcnt(32)
    v_mfma_f32_16x16x32_bf16 v[128:131], v[84:87], a[176:179], v[128:131]
    ds_read_b64_tr_b16 v[116:117], v38 offset:24576
    s_add_u32 m0, s31, 0x9000
    s_add_u32 s79, s79, 0x8000
    v_mfma_f32_16x16x32_bf16 v[136:139], v[80:83], a[164:167], v[136:139]
    buffer_load_dwordx4 v6, s[12:15], s79 offen offset:0 lds
    s_waitcnt vmcnt(32)
    v_mfma_f32_16x16x32_bf16 v[136:139], v[84:87], a[180:183], v[136:139]
    ds_read_b64_tr_b16 v[118:119], v38 offset:25600
    v_mfma_f32_16x16x32_bf16 v[144:147], v[80:83], a[168:171], v[144:147]
    ds_read_b64_tr_b16 v[120:121], v39 offset:16384
    s_waitcnt vmcnt(31)
    v_mfma_f32_16x16x32_bf16 v[144:147], v[84:87], a[184:187], v[144:147]
    v_mfma_f32_16x16x32_bf16 v[152:155], v[80:83], a[172:175], v[152:155]
    ds_read_b64_tr_b16 v[122:123], v39 offset:17408
    s_waitcnt vmcnt(30)
    v_mfma_f32_16x16x32_bf16 v[152:155], v[84:87], a[188:191], v[152:155]
    buffer_load_dwordx4 v7, s[12:15], s79 offen offset:1024 lds
    v_mfma_f32_16x16x32_bf16 v[132:135], v[88:91], a[160:163], v[132:135]
    ds_read_b64_tr_b16 v[124:125], v39 offset:24576
    v_mfma_f32_16x16x32_bf16 v[132:135], v[92:95], a[176:179], v[132:135]
    ds_read_b64_tr_b16 v[126:127], v39 offset:25600
    v_mfma_f32_16x16x32_bf16 v[140:143], v[88:91], a[164:167], v[140:143]
    v_mfma_f32_16x16x32_bf16 v[140:143], v[92:95], a[180:183], v[140:143]
    v_mfma_f32_16x16x32_bf16 v[148:151], v[88:91], a[168:171], v[148:151]
    v_mfma_f32_16x16x32_bf16 v[148:151], v[92:95], a[184:187], v[148:151]
    v_mfma_f32_16x16x32_bf16 v[156:159], v[88:91], a[172:175], v[156:159]
    v_mfma_f32_16x16x32_bf16 v[156:159], v[92:95], a[188:191], v[156:159]
    v_add_u32 v40, 0x10000, v40
    v_add_u32 v41, 0x10000, v41
    s_waitcnt lgkmcnt(8)
    v_mfma_f32_16x16x32_bf16 v[160:163], v[96:99], a[128:131], v[160:163]
    ds_read_b64_tr_b16 v[64:65], v40 offset:0
    v_mfma_f32_16x16x32_bf16 v[160:163], v[100:103], a[144:147], v[160:163]
    buffer_load_dwordx4 v8, s[12:15], s79 offen offset:2048 lds
    v_mfma_f32_16x16x32_bf16 v[168:171], v[96:99], a[132:135], v[168:171]
    ds_read_b64_tr_b16 v[66:67], v40 offset:1024
    v_mfma_f32_16x16x32_bf16 v[168:171], v[100:103], a[148:151], v[168:171]
    ds_read_b64_tr_b16 v[68:69], v40 offset:8192
    v_mfma_f32_16x16x32_bf16 v[176:179], v[96:99], a[136:139], v[176:179]
    buffer_load_dwordx4 v9, s[12:15], s79 offen offset:3072 lds
    v_mfma_f32_16x16x32_bf16 v[176:179], v[100:103], a[152:155], v[176:179]
    v_mfma_f32_16x16x32_bf16 v[184:187], v[96:99], a[140:143], v[184:187]
    ds_read_b64_tr_b16 v[70:71], v40 offset:9216
    v_mfma_f32_16x16x32_bf16 v[184:187], v[100:103], a[156:159], v[184:187]
    ds_read_b64_tr_b16 v[72:73], v41 offset:0
    v_mfma_f32_16x16x32_bf16 v[164:167], v[104:107], a[128:131], v[164:167]
    ds_read_b64_tr_b16 v[74:75], v41 offset:1024
    s_lshl_b32 s78, s16, 16
    s_add_u32 s78, s78, s29
    v_mfma_f32_16x16x32_bf16 v[164:167], v[108:111], a[144:147], v[164:167]
    buffer_load_dwordx4 a[64:67], v14, s[64:67], s78 offen offset:0 sc1
    v_mfma_f32_16x16x32_bf16 v[172:175], v[104:107], a[132:135], v[172:175]
    v_mfma_f32_16x16x32_bf16 v[172:175], v[108:111], a[148:151], v[172:175]
    ds_read_b64_tr_b16 v[76:77], v41 offset:8192
    v_mfma_f32_16x16x32_bf16 v[180:183], v[104:107], a[136:139], v[180:183]
    ds_read_b64_tr_b16 v[78:79], v41 offset:9216
    v_mfma_f32_16x16x32_bf16 v[180:183], v[108:111], a[152:155], v[180:183]
    ds_read_b64_tr_b16 v[80:81], v40 offset:16384
    v_mfma_f32_16x16x32_bf16 v[188:191], v[104:107], a[140:143], v[188:191]
    buffer_load_dwordx4 a[68:71], v14, s[64:67], s78 offen offset:1024 sc1
    v_mfma_f32_16x16x32_bf16 v[188:191], v[108:111], a[156:159], v[188:191]
    ds_read_b64_tr_b16 v[82:83], v40 offset:17408
    s_waitcnt lgkmcnt(9)
    v_mfma_f32_16x16x32_bf16 v[160:163], v[112:115], a[160:163], v[160:163]
    v_mfma_f32_16x16x32_bf16 v[160:163], v[116:119], a[176:179], v[160:163]
    ds_read_b64_tr_b16 v[84:85], v40 offset:24576
    v_mfma_f32_16x16x32_bf16 v[168:171], v[112:115], a[164:167], v[168:171]
    buffer_load_dwordx4 a[72:75], v14, s[64:67], s78 offen offset:2048 sc1
    v_mfma_f32_16x16x32_bf16 v[168:171], v[116:119], a[180:183], v[168:171]
    ds_read_b64_tr_b16 v[86:87], v40 offset:25600
    v_mfma_f32_16x16x32_bf16 v[176:179], v[112:115], a[168:171], v[176:179]
    ds_read_b64_tr_b16 v[88:89], v41 offset:16384
    v_mfma_f32_16x16x32_bf16 v[176:179], v[116:119], a[184:187], v[176:179]
    v_mfma_f32_16x16x32_bf16 v[184:187], v[112:115], a[172:175], v[184:187]
    ds_read_b64_tr_b16 v[90:91], v41 offset:17408
    v_mfma_f32_16x16x32_bf16 v[184:187], v[116:119], a[188:191], v[184:187]
    buffer_load_dwordx4 a[76:79], v14, s[64:67], s78 offen offset:3072 sc1
    s_add_u32 s78, s78, 16384
    v_mfma_f32_16x16x32_bf16 v[164:167], v[120:123], a[160:163], v[164:167]
    ds_read_b64_tr_b16 v[92:93], v41 offset:24576
    v_mfma_f32_16x16x32_bf16 v[164:167], v[124:127], a[176:179], v[164:167]
    ds_read_b64_tr_b16 v[94:95], v41 offset:25600
    v_mfma_f32_16x16x32_bf16 v[172:175], v[120:123], a[164:167], v[172:175]
    v_mfma_f32_16x16x32_bf16 v[172:175], v[124:127], a[180:183], v[172:175]
    v_mfma_f32_16x16x32_bf16 v[180:183], v[120:123], a[168:171], v[180:183]
    v_mfma_f32_16x16x32_bf16 v[180:183], v[124:127], a[184:187], v[180:183]
    v_mfma_f32_16x16x32_bf16 v[188:191], v[120:123], a[172:175], v[188:191]
    v_mfma_f32_16x16x32_bf16 v[188:191], v[124:127], a[188:191], v[188:191]
    v_add_u32 v42, 0x10000, v42
    v_add_u32 v43, 0x10000, v43
    s_waitcnt lgkmcnt(8)
    v_mfma_f32_16x16x32_bf16 v[192:195], v[64:67], a[128:131], v[192:195]
    ds_read_b64_tr_b16 v[96:97], v42 offset:0
    v_mfma_f32_16x16x32_bf16 v[192:195], v[68:71], a[144:147], v[192:195]
    buffer_load_dwordx4 a[80:83], v14, s[64:67], s78 offen offset:0 sc1
    v_mfma_f32_16x16x32_bf16 v[200:203], v[64:67], a[132:135], v[200:203]
    ds_read_b64_tr_b16 v[98:99], v42 offset:1024
    v_mfma_f32_16x16x32_bf16 v[200:203], v[68:71], a[148:151], v[200:203]
    ds_read_b64_tr_b16 v[100:101], v42 offset:8192
    v_mfma_f32_16x16x32_bf16 v[208:211], v[64:67], a[136:139], v[208:211]
    buffer_load_dwordx4 a[84:87], v14, s[64:67], s78 offen offset:1024 sc1
    v_mfma_f32_16x16x32_bf16 v[208:211], v[68:71], a[152:155], v[208:211]
    v_mfma_f32_16x16x32_bf16 v[216:219], v[64:67], a[140:143], v[216:219]
    ds_read_b64_tr_b16 v[102:103], v42 offset:9216
    v_mfma_f32_16x16x32_bf16 v[216:219], v[68:71], a[156:159], v[216:219]
    ds_read_b64_tr_b16 v[104:105], v43 offset:0
    v_mfma_f32_16x16x32_bf16 v[196:199], v[72:75], a[128:131], v[196:199]
    ds_read_b64_tr_b16 v[106:107], v43 offset:1024
    v_mfma_f32_16x16x32_bf16 v[196:199], v[76:79], a[144:147], v[196:199]
    buffer_load_dwordx4 a[88:91], v14, s[64:67], s78 offen offset:2048 sc1
    v_mfma_f32_16x16x32_bf16 v[204:207], v[72:75], a[132:135], v[204:207]
    v_mfma_f32_16x16x32_bf16 v[204:207], v[76:79], a[148:151], v[204:207]
    ds_read_b64_tr_b16 v[108:109], v43 offset:8192
    v_mfma_f32_16x16x32_bf16 v[212:215], v[72:75], a[136:139], v[212:215]
    ds_read_b64_tr_b16 v[110:111], v43 offset:9216
    v_mfma_f32_16x16x32_bf16 v[212:215], v[76:79], a[152:155], v[212:215]
    ds_read_b64_tr_b16 v[112:113], v42 offset:16384
    v_mfma_f32_16x16x32_bf16 v[220:223], v[72:75], a[140:143], v[220:223]
    buffer_load_dwordx4 a[92:95], v14, s[64:67], s78 offen offset:3072 sc1
    s_add_u32 s78, s78, 16384
    v_mfma_f32_16x16x32_bf16 v[220:223], v[76:79], a[156:159], v[220:223]
    ds_read_b64_tr_b16 v[114:115], v42 offset:17408
    s_waitcnt lgkmcnt(9)
    v_mfma_f32_16x16x32_bf16 v[192:195], v[80:83], a[160:163], v[192:195]
    v_mfma_f32_16x16x32_bf16 v[192:195], v[84:87], a[176:179], v[192:195]
    ds_read_b64_tr_b16 v[116:117], v42 offset:24576
    v_mfma_f32_16x16x32_bf16 v[200:203], v[80:83], a[164:167], v[200:203]
    buffer_load_dwordx4 a[96:99], v14, s[64:67], s78 offen offset:0 sc1
    v_mfma_f32_16x16x32_bf16 v[200:203], v[84:87], a[180:183], v[200:203]
    ds_read_b64_tr_b16 v[118:119], v42 offset:25600
    v_mfma_f32_16x16x32_bf16 v[208:211], v[80:83], a[168:171], v[208:211]
    ds_read_b64_tr_b16 v[120:121], v43 offset:16384
    v_mfma_f32_16x16x32_bf16 v[208:211], v[84:87], a[184:187], v[208:211]
    v_mfma_f32_16x16x32_bf16 v[216:219], v[80:83], a[172:175], v[216:219]
    ds_read_b64_tr_b16 v[122:123], v43 offset:17408
    v_mfma_f32_16x16x32_bf16 v[216:219], v[84:87], a[188:191], v[216:219]
    buffer_load_dwordx4 a[100:103], v14, s[64:67], s78 offen offset:1024 sc1
    v_mfma_f32_16x16x32_bf16 v[196:199], v[88:91], a[160:163], v[196:199]
    ds_read_b64_tr_b16 v[124:125], v43 offset:24576
    v_mfma_f32_16x16x32_bf16 v[196:199], v[92:95], a[176:179], v[196:199]
    ds_read_b64_tr_b16 v[126:127], v43 offset:25600
    v_mfma_f32_16x16x32_bf16 v[204:207], v[88:91], a[164:167], v[204:207]
    v_mfma_f32_16x16x32_bf16 v[204:207], v[92:95], a[180:183], v[204:207]
    v_mfma_f32_16x16x32_bf16 v[212:215], v[88:91], a[168:171], v[212:215]
    v_mfma_f32_16x16x32_bf16 v[212:215], v[92:95], a[184:187], v[212:215]
    v_mfma_f32_16x16x32_bf16 v[220:223], v[88:91], a[172:175], v[220:223]
    v_mfma_f32_16x16x32_bf16 v[220:223], v[92:95], a[188:191], v[220:223]
    s_waitcnt vmcnt(35) lgkmcnt(0)
    s_barrier
    v_subrev_u32 v36, 0x10000, v36
    v_subrev_u32 v37, 0x10000, v37
    v_mfma_f32_16x16x32_bf16 v[224:227], v[96:99], a[128:131], v[224:227]
    ds_read_b64_tr_b16 v[64:65], v36 offset:0
    v_mfma_f32_16x16x32_bf16 v[224:227], v[100:103], a[144:147], v[224:227]
    buffer_load_dwordx4 a[104:107], v14, s[64:67], s78 offen offset:2048 sc1
    v_mfma_f32_16x16x32_bf16 v[232:235], v[96:99], a[132:135], v[232:235]
    ds_read_b64_tr_b16 v[66:67], v36 offset:1024
    v_mfma_f32_16x16x32_bf16 v[232:235], v[100:103], a[148:151], v[232:235]
    ds_read_b64_tr_b16 v[68:69], v36 offset:8192
    v_mfma_f32_16x16x32_bf16 v[240:243], v[96:99], a[136:139], v[240:243]
    buffer_load_dwordx4 a[108:111], v14, s[64:67], s78 offen offset:3072 sc1
    s_add_u32 s78, s78, 16384
    v_mfma_f32_16x16x32_bf16 v[240:243], v[100:103], a[152:155], v[240:243]
    v_mfma_f32_16x16x32_bf16 v[248:251], v[96:99], a[140:143], v[248:251]
    ds_read_b64_tr_b16 v[70:71], v36 offset:9216
    v_mfma_f32_16x16x32_bf16 v[248:251], v[100:103], a[156:159], v[248:251]
    ds_read_b64_tr_b16 v[72:73], v37 offset:0
    v_mfma_f32_16x16x32_bf16 v[228:231], v[104:107], a[128:131], v[228:231]
    ds_read_b64_tr_b16 v[74:75], v37 offset:1024
    v_mfma_f32_16x16x32_bf16 v[228:231], v[108:111], a[144:147], v[228:231]
    buffer_load_dwordx4 a[112:115], v14, s[64:67], s78 offen offset:0 sc1
    v_mfma_f32_16x16x32_bf16 v[236:239], v[104:107], a[132:135], v[236:239]
    v_mfma_f32_16x16x32_bf16 v[236:239], v[108:111], a[148:151], v[236:239]
    ds_read_b64_tr_b16 v[76:77], v37 offset:8192
    v_mfma_f32_16x16x32_bf16 v[244:247], v[104:107], a[136:139], v[244:247]
    ds_read_b64_tr_b16 v[78:79], v37 offset:9216
    v_mfma_f32_16x16x32_bf16 v[244:247], v[108:111], a[152:155], v[244:247]
    ds_read_b64_tr_b16 v[80:81], v36 offset:16384
    v_mfma_f32_16x16x32_bf16 v[252:255], v[104:107], a[140:143], v[252:255]
    buffer_load_dwordx4 a[116:119], v14, s[64:67], s78 offen offset:1024 sc1
    v_mfma_f32_16x16x32_bf16 v[252:255], v[108:111], a[156:159], v[252:255]
    ds_read_b64_tr_b16 v[82:83], v36 offset:17408
    v_mfma_f32_16x16x32_bf16 v[224:227], v[112:115], a[160:163], v[224:227]
    v_mfma_f32_16x16x32_bf16 v[224:227], v[116:119], a[176:179], v[224:227]
    ds_read_b64_tr_b16 v[84:85], v36 offset:24576
    v_mfma_f32_16x16x32_bf16 v[232:235], v[112:115], a[164:167], v[232:235]
    buffer_load_dwordx4 a[120:123], v14, s[64:67], s78 offen offset:2048 sc1
    v_mfma_f32_16x16x32_bf16 v[232:235], v[116:119], a[180:183], v[232:235]
    ds_read_b64_tr_b16 v[86:87], v36 offset:25600
    v_mfma_f32_16x16x32_bf16 v[240:243], v[112:115], a[168:171], v[240:243]
    ds_read_b64_tr_b16 v[88:89], v37 offset:16384
    v_mfma_f32_16x16x32_bf16 v[240:243], v[116:119], a[184:187], v[240:243]
    v_mfma_f32_16x16x32_bf16 v[248:251], v[112:115], a[172:175], v[248:251]
    ds_read_b64_tr_b16 v[90:91], v37 offset:17408
    v_mfma_f32_16x16x32_bf16 v[248:251], v[116:119], a[188:191], v[248:251]
    buffer_load_dwordx4 a[124:127], v14, s[64:67], s78 offen offset:3072 sc1
    v_mfma_f32_16x16x32_bf16 v[228:231], v[120:123], a[160:163], v[228:231]
    ds_read_b64_tr_b16 v[92:93], v37 offset:24576
    v_mfma_f32_16x16x32_bf16 v[228:231], v[124:127], a[176:179], v[228:231]
    ds_read_b64_tr_b16 v[94:95], v37 offset:25600
    v_mfma_f32_16x16x32_bf16 v[236:239], v[120:123], a[164:167], v[236:239]
    v_mfma_f32_16x16x32_bf16 v[236:239], v[124:127], a[180:183], v[236:239]
    v_mfma_f32_16x16x32_bf16 v[244:247], v[120:123], a[168:171], v[244:247]
    v_mfma_f32_16x16x32_bf16 v[244:247], v[124:127], a[184:187], v[244:247]
    v_mfma_f32_16x16x32_bf16 v[252:255], v[120:123], a[172:175], v[252:255]
    v_mfma_f32_16x16x32_bf16 v[252:255], v[124:127], a[188:191], v[252:255]
    v_subrev_u32 v38, 0x10000, v38
    v_subrev_u32 v39, 0x10000, v39
    s_waitcnt vmcnt(40) lgkmcnt(8)
    v_mfma_f32_16x16x32_bf16 v[128:131], v[64:67], a[0:3], v[128:131]
    ds_read_b64_tr_b16 v[96:97], v38 offset:0
    s_lshl_b32 s6, s75, 3
    s_lshr_b64 s[4:5], s[48:49], s6
    s_and_b32 s16, s4, 31
    s_lshl_b32 s79, s16, 18
    s_add_u32 m0, s31, 0x10000
    s_add_u32 s79, s79, s30
    s_waitcnt vmcnt(36)
    v_mfma_f32_16x16x32_bf16 v[128:131], v[68:71], a[16:19], v[128:131]
    buffer_load_dwordx4 v6, s[12:15], s79 offen offset:0 lds
    v_mfma_f32_16x16x32_bf16 v[136:139], v[64:67], a[4:7], v[136:139]
    ds_read_b64_tr_b16 v[98:99], v38 offset:1024
    s_waitcnt vmcnt(36)
    v_mfma_f32_16x16x32_bf16 v[136:139], v[68:71], a[20:23], v[136:139]
    ds_read_b64_tr_b16 v[100:101], v38 offset:8192
    v_mfma_f32_16x16x32_bf16 v[144:147], v[64:67], a[8:11], v[144:147]
    buffer_load_dwordx4 v7, s[12:15], s79 offen offset:1024 lds
    s_add_u32 s75, s75, 1
    s_waitcnt vmcnt(36)
    v_mfma_f32_16x16x32_bf16 v[144:147], v[68:71], a[24:27], v[144:147]
    v_mfma_f32_16x16x32_bf16 v[152:155], v[64:67], a[12:15], v[152:155]
    ds_read_b64_tr_b16 v[102:103], v38 offset:9216
    s_waitcnt vmcnt(35)
    v_mfma_f32_16x16x32_bf16 v[152:155], v[68:71], a[28:31], v[152:155]
    ds_read_b64_tr_b16 v[104:105], v39 offset:0
    v_mfma_f32_16x16x32_bf16 v[132:135], v[72:75], a[0:3], v[132:135]
    ds_read_b64_tr_b16 v[106:107], v39 offset:1024
    v_mfma_f32_16x16x32_bf16 v[132:135], v[76:79], a[16:19], v[132:135]
    buffer_load_dwordx4 v8, s[12:15], s79 offen offset:2048 lds
    s_cmp_eq_u32 s75, 7
    s_cselect_b32 s75, 0, s75
    v_mfma_f32_16x16x32_bf16 v[140:143], v[72:75], a[4:7], v[140:143]
    v_mfma_f32_16x16x32_bf16 v[140:143], v[76:79], a[20:23], v[140:143]
    ds_read_b64_tr_b16 v[108:109], v39 offset:8192
    v_mfma_f32_16x16x32_bf16 v[148:151], v[72:75], a[8:11], v[148:151]
    ds_read_b64_tr_b16 v[110:111], v39 offset:9216
    v_mfma_f32_16x16x32_bf16 v[148:151], v[76:79], a[24:27], v[148:151]
    ds_read_b64_tr_b16 v[112:113], v38 offset:16384
    v_mfma_f32_16x16x32_bf16 v[156:159], v[72:75], a[12:15], v[156:159]
    buffer_load_dwordx4 v9, s[12:15], s79 offen offset:3072 lds
    v_mfma_f32_16x16x32_bf16 v[156:159], v[76:79], a[28:31], v[156:159]
    ds_read_b64_tr_b16 v[114:115], v38 offset:17408
    s_waitcnt vmcnt(36) lgkmcnt(9)
    v_mfma_f32_16x16x32_bf16 v[128:131], v[80:83], a[32:35], v[128:131]
    s_waitcnt vmcnt(32)
    v_mfma_f32_16x16x32_bf16 v[128:131], v[84:87], a[48:51], v[128:131]
    ds_read_b64_tr_b16 v[116:117], v38 offset:24576
    s_add_u32 m0, s31, 0x11000
    s_add_u32 s79, s79, 0x8000
    v_mfma_f32_16x16x32_bf16 v[136:139], v[80:83], a[36:39], v[136:139]
    buffer_load_dwordx4 v6, s[12:15], s79 offen offset:0 lds
    s_waitcnt vmcnt(32)
    v_mfma_f32_16x16x32_bf16 v[136:139], v[84:87], a[52:55], v[136:139]
    ds_read_b64_tr_b16 v[118:119], v38 offset:25600
    v_mfma_f32_16x16x32_bf16 v[144:147], v[80:83], a[40:43], v[144:147]
    ds_read_b64_tr_b16 v[120:121], v39 offset:16384
    s_waitcnt vmcnt(31)
    v_mfma_f32_16x16x32_bf16 v[144:147], v[84:87], a[56:59], v[144:147]
    v_mfma_f32_16x16x32_bf16 v[152:155], v[80:83], a[44:47], v[152:155]
    ds_read_b64_tr_b16 v[122:123], v39 offset:17408
    s_waitcnt vmcnt(30)
    v_mfma_f32_16x16x32_bf16 v[152:155], v[84:87], a[60:63], v[152:155]
    buffer_load_dwordx4 v7, s[12:15], s79 offen offset:1024 lds
    v_mfma_f32_16x16x32_bf16 v[132:135], v[88:91], a[32:35], v[132:135]
    ds_read_b64_tr_b16 v[124:125], v39 offset:24576
    v_mfma_f32_16x16x32_bf16 v[132:135], v[92:95], a[48:51], v[132:135]
    ds_read_b64_tr_b16 v[126:127], v39 offset:25600
    v_mfma_f32_16x16x32_bf16 v[140:143], v[88:91], a[36:39], v[140:143]
    v_mfma_f32_16x16x32_bf16 v[140:143], v[92:95], a[52:55], v[140:143]
    v_mfma_f32_16x16x32_bf16 v[148:151], v[88:91], a[40:43], v[148:151]
    v_mfma_f32_16x16x32_bf16 v[148:151], v[92:95], a[56:59], v[148:151]
    v_mfma_f32_16x16x32_bf16 v[156:159], v[88:91], a[44:47], v[156:159]
    v_mfma_f32_16x16x32_bf16 v[156:159], v[92:95], a[60:63], v[156:159]
    v_subrev_u32 v40, 0x10000, v40
    v_subrev_u32 v41, 0x10000, v41
    s_waitcnt lgkmcnt(8)
    v_mfma_f32_16x16x32_bf16 v[160:163], v[96:99], a[0:3], v[160:163]
    ds_read_b64_tr_b16 v[64:65], v40 offset:0
    v_mfma_f32_16x16x32_bf16 v[160:163], v[100:103], a[16:19], v[160:163]
    buffer_load_dwordx4 v8, s[12:15], s79 offen offset:2048 lds
    v_mfma_f32_16x16x32_bf16 v[168:171], v[96:99], a[4:7], v[168:171]
    ds_read_b64_tr_b16 v[66:67], v40 offset:1024
    v_mfma_f32_16x16x32_bf16 v[168:171], v[100:103], a[20:23], v[168:171]
    ds_read_b64_tr_b16 v[68:69], v40 offset:8192
    v_mfma_f32_16x16x32_bf16 v[176:179], v[96:99], a[8:11], v[176:179]
    buffer_load_dwordx4 v9, s[12:15], s79 offen offset:3072 lds
    v_mfma_f32_16x16x32_bf16 v[176:179], v[100:103], a[24:27], v[176:179]
    v_mfma_f32_16x16x32_bf16 v[184:187], v[96:99], a[12:15], v[184:187]
    ds_read_b64_tr_b16 v[70:71], v40 offset:9216
    v_mfma_f32_16x16x32_bf16 v[184:187], v[100:103], a[28:31], v[184:187]
    ds_read_b64_tr_b16 v[72:73], v41 offset:0
    v_mfma_f32_16x16x32_bf16 v[164:167], v[104:107], a[0:3], v[164:167]
    ds_read_b64_tr_b16 v[74:75], v41 offset:1024
    s_lshl_b32 s78, s16, 16
    s_add_u32 s78, s78, s29
    v_mfma_f32_16x16x32_bf16 v[164:167], v[108:111], a[16:19], v[164:167]
    buffer_load_dwordx4 a[128:131], v14, s[64:67], s78 offen offset:0 sc1
    v_mfma_f32_16x16x32_bf16 v[172:175], v[104:107], a[4:7], v[172:175]
    v_mfma_f32_16x16x32_bf16 v[172:175], v[108:111], a[20:23], v[172:175]
    ds_read_b64_tr_b16 v[76:77], v41 offset:8192
    v_mfma_f32_16x16x32_bf16 v[180:183], v[104:107], a[8:11], v[180:183]
    ds_read_b64_tr_b16 v[78:79], v41 offset:9216
    v_mfma_f32_16x16x32_bf16 v[180:183], v[108:111], a[24:27], v[180:183]
    ds_read_b64_tr_b16 v[80:81], v40 offset:16384
    v_mfma_f32_16x16x32_bf16 v[188:191], v[104:107], a[12:15], v[188:191]
    buffer_load_dwordx4 a[132:135], v14, s[64:67], s78 offen offset:1024 sc1
    v_mfma_f32_16x16x32_bf16 v[188:191], v[108:111], a[28:31], v[188:191]
    ds_read_b64_tr_b16 v[82:83], v40 offset:17408
    s_waitcnt lgkmcnt(9)
    v_mfma_f32_16x16x32_bf16 v[160:163], v[112:115], a[32:35], v[160:163]
    v_mfma_f32_16x16x32_bf16 v[160:163], v[116:119], a[48:51], v[160:163]
    ds_read_b64_tr_b16 v[84:85], v40 offset:24576
    v_mfma_f32_16x16x32_bf16 v[168:171], v[112:115], a[36:39], v[168:171]
    buffer_load_dwordx4 a[136:139], v14, s[64:67], s78 offen offset:2048 sc1
    v_mfma_f32_16x16x32_bf16 v[168:171], v[116:119], a[52:55], v[168:171]
    ds_read_b64_tr_b16 v[86:87], v40 offset:25600
    v_mfma_f32_16x16x32_bf16 v[176:179], v[112:115], a[40:43], v[176:179]
    ds_read_b64_tr_b16 v[88:89], v41 offset:16384
    v_mfma_f32_16x16x32_bf16 v[176:179], v[116:119], a[56:59], v[176:179]
    v_mfma_f32_16x16x32_bf16 v[184:187], v[112:115], a[44:47], v[184:187]
    ds_read_b64_tr_b16 v[90:91], v41 offset:17408
    v_mfma_f32_16x16x32_bf16 v[184:187], v[116:119], a[60:63], v[184:187]
    buffer_load_dwordx4 a[140:143], v14, s[64:67], s78 offen offset:3072 sc1
    s_add_u32 s78, s78, 16384
    v_mfma_f32_16x16x32_bf16 v[164:167], v[120:123], a[32:35], v[164:167]
    ds_read_b64_tr_b16 v[92:93], v41 offset:24576
    v_mfma_f32_16x16x32_bf16 v[164:167], v[124:127], a[48:51], v[164:167]
    ds_read_b64_tr_b16 v[94:95], v41 offset:25600
    v_mfma_f32_16x16x32_bf16 v[172:175], v[120:123], a[36:39], v[172:175]
    v_mfma_f32_16x16x32_bf16 v[172:175], v[124:127], a[52:55], v[172:175]
    v_mfma_f32_16x16x32_bf16 v[180:183], v[120:123], a[40:43], v[180:183]
    v_mfma_f32_16x16x32_bf16 v[180:183], v[124:127], a[56:59], v[180:183]
    v_mfma_f32_16x16x32_bf16 v[188:191], v[120:123], a[44:47], v[188:191]
    v_mfma_f32_16x16x32_bf16 v[188:191], v[124:127], a[60:63], v[188:191]
    v_subrev_u32 v42, 0x10000, v42
    v_subrev_u32 v43, 0x10000, v43
    s_waitcnt lgkmcnt(8)
    v_mfma_f32_16x16x32_bf16 v[192:195], v[64:67], a[0:3], v[192:195]
    ds_read_b64_tr_b16 v[96:97], v42 offset:0
    v_mfma_f32_16x16x32_bf16 v[192:195], v[68:71], a[16:19], v[192:195]
    buffer_load_dwordx4 a[144:147], v14, s[64:67], s78 offen offset:0 sc1
    v_mfma_f32_16x16x32_bf16 v[200:203], v[64:67], a[4:7], v[200:203]
    ds_read_b64_tr_b16 v[98:99], v42 offset:1024
    v_mfma_f32_16x16x32_bf16 v[200:203], v[68:71], a[20:23], v[200:203]
    ds_read_b64_tr_b16 v[100:101], v42 offset:8192
    v_mfma_f32_16x16x32_bf16 v[208:211], v[64:67], a[8:11], v[208:211]
    buffer_load_dwordx4 a[148:151], v14, s[64:67], s78 offen offset:1024 sc1
    v_mfma_f32_16x16x32_bf16 v[208:211], v[68:71], a[24:27], v[208:211]
    v_mfma_f32_16x16x32_bf16 v[216:219], v[64:67], a[12:15], v[216:219]
    ds_read_b64_tr_b16 v[102:103], v42 offset:9216
    v_mfma_f32_16x16x32_bf16 v[216:219], v[68:71], a[28:31], v[216:219]
    ds_read_b64_tr_b16 v[104:105], v43 offset:0
    v_mfma_f32_16x16x32_bf16 v[196:199], v[72:75], a[0:3], v[196:199]
    ds_read_b64_tr_b16 v[106:107], v43 offset:1024
    v_mfma_f32_16x16x32_bf16 v[196:199], v[76:79], a[16:19], v[196:199]
    buffer_load_dwordx4 a[152:155], v14, s[64:67], s78 offen offset:2048 sc1
    v_mfma_f32_16x16x32_bf16 v[204:207], v[72:75], a[4:7], v[204:207]
    v_mfma_f32_16x16x32_bf16 v[204:207], v[76:79], a[20:23], v[204:207]
    ds_read_b64_tr_b16 v[108:109], v43 offset:8192
    v_mfma_f32_16x16x32_bf16 v[212:215], v[72:75], a[8:11], v[212:215]
    ds_read_b64_tr_b16 v[110:111], v43 offset:9216
    v_mfma_f32_16x16x32_bf16 v[212:215], v[76:79], a[24:27], v[212:215]
    ds_read_b64_tr_b16 v[112:113], v42 offset:16384
    v_mfma_f32_16x16x32_bf16 v[220:223], v[72:75], a[12:15], v[220:223]
    buffer_load_dwordx4 a[156:159], v14, s[64:67], s78 offen offset:3072 sc1
    s_add_u32 s78, s78, 16384
    v_mfma_f32_16x16x32_bf16 v[220:223], v[76:79], a[28:31], v[220:223]
    ds_read_b64_tr_b16 v[114:115], v42 offset:17408
    s_waitcnt lgkmcnt(9)
    v_mfma_f32_16x16x32_bf16 v[192:195], v[80:83], a[32:35], v[192:195]
    v_mfma_f32_16x16x32_bf16 v[192:195], v[84:87], a[48:51], v[192:195]
    ds_read_b64_tr_b16 v[116:117], v42 offset:24576
    v_mfma_f32_16x16x32_bf16 v[200:203], v[80:83], a[36:39], v[200:203]
    buffer_load_dwordx4 a[160:163], v14, s[64:67], s78 offen offset:0 sc1
    v_mfma_f32_16x16x32_bf16 v[200:203], v[84:87], a[52:55], v[200:203]
    ds_read_b64_tr_b16 v[118:119], v42 offset:25600
    v_mfma_f32_16x16x32_bf16 v[208:211], v[80:83], a[40:43], v[208:211]
    ds_read_b64_tr_b16 v[120:121], v43 offset:16384
    v_mfma_f32_16x16x32_bf16 v[208:211], v[84:87], a[56:59], v[208:211]
    v_mfma_f32_16x16x32_bf16 v[216:219], v[80:83], a[44:47], v[216:219]
    ds_read_b64_tr_b16 v[122:123], v43 offset:17408
    v_mfma_f32_16x16x32_bf16 v[216:219], v[84:87], a[60:63], v[216:219]
    buffer_load_dwordx4 a[164:167], v14, s[64:67], s78 offen offset:1024 sc1
    v_mfma_f32_16x16x32_bf16 v[196:199], v[88:91], a[32:35], v[196:199]
    ds_read_b64_tr_b16 v[124:125], v43 offset:24576
    v_mfma_f32_16x16x32_bf16 v[196:199], v[92:95], a[48:51], v[196:199]
    ds_read_b64_tr_b16 v[126:127], v43 offset:25600
    v_mfma_f32_16x16x32_bf16 v[204:207], v[88:91], a[36:39], v[204:207]
    v_mfma_f32_16x16x32_bf16 v[204:207], v[92:95], a[52:55], v[204:207]
    v_mfma_f32_16x16x32_bf16 v[212:215], v[88:91], a[40:43], v[212:215]
    v_mfma_f32_16x16x32_bf16 v[212:215], v[92:95], a[56:59], v[212:215]
    v_mfma_f32_16x16x32_bf16 v[220:223], v[88:91], a[44:47], v[220:223]
    v_mfma_f32_16x16x32_bf16 v[220:223], v[92:95], a[60:63], v[220:223]
    s_waitcnt vmcnt(34) lgkmcnt(0)
    s_barrier
    v_mfma_f32_16x16x32_bf16 v[224:227], v[96:99], a[0:3], v[224:227]
    ds_read_b64_tr_b16 v[64:65], v38 offset:32768
    v_mfma_f32_16x16x32_bf16 v[224:227], v[100:103], a[16:19], v[224:227]
    buffer_load_dwordx4 a[168:171], v14, s[64:67], s78 offen offset:2048 sc1
    v_mfma_f32_16x16x32_bf16 v[232:235], v[96:99], a[4:7], v[232:235]
    ds_read_b64_tr_b16 v[66:67], v38 offset:33792
    v_mfma_f32_16x16x32_bf16 v[232:235], v[100:103], a[20:23], v[232:235]
    ds_read_b64_tr_b16 v[68:69], v38 offset:40960
    v_mfma_f32_16x16x32_bf16 v[240:243], v[96:99], a[8:11], v[240:243]
    buffer_load_dwordx4 a[172:175], v14, s[64:67], s78 offen offset:3072 sc1
    s_add_u32 s78, s78, 16384
    v_mfma_f32_16x16x32_bf16 v[240:243], v[100:103], a[24:27], v[240:243]
    v_mfma_f32_16x16x32_bf16 v[248:251], v[96:99], a[12:15], v[248:251]
    ds_read_b64_tr_b16 v[70:71], v38 offset:41984
    v_mfma_f32_16x16x32_bf16 v[248:251], v[100:103], a[28:31], v[248:251]
    ds_read_b64_tr_b16 v[72:73], v39 offset:32768
    v_mfma_f32_16x16x32_bf16 v[228:231], v[104:107], a[0:3], v[228:231]
    ds_read_b64_tr_b16 v[74:75], v39 offset:33792
    v_mfma_f32_16x16x32_bf16 v[228:231], v[108:111], a[16:19], v[228:231]
    buffer_load_dwordx4 a[176:179], v14, s[64:67], s78 offen offset:0 sc1
    v_mfma_f32_16x16x32_bf16 v[236:239], v[104:107], a[4:7], v[236:239]
    v_mfma_f32_16x16x32_bf16 v[236:239], v[108:111], a[20:23], v[236:239]
    ds_read_b64_tr_b16 v[76:77], v39 offset:40960
    v_mfma_f32_16x16x32_bf16 v[244:247], v[104:107], a[8:11], v[244:247]
    ds_read_b64_tr_b16 v[78:79], v39 offset:41984
    v_mfma_f32_16x16x32_bf16 v[244:247], v[108:111], a[24:27], v[244:247]
    ds_read_b64_tr_b16 v[80:81], v38 offset:49152
    v_mfma_f32_16x16x32_bf16 v[252:255], v[104:107], a[12:15], v[252:255]
    buffer_load_dwordx4 a[180:183], v14, s[64:67], s78 offen offset:1024 sc1
    v_mfma_f32_16x16x32_bf16 v[252:255], v[108:111], a[28:31], v[252:255]
    ds_read_b64_tr_b16 v[82:83], v38 offset:50176
    v_mfma_f32_16x16x32_bf16 v[224:227], v[112:115], a[32:35], v[224:227]
    v_mfma_f32_16x16x32_bf16 v[224:227], v[116:119], a[48:51], v[224:227]
    ds_read_b64_tr_b16 v[84:85], v38 offset:57344
    v_mfma_f32_16x16x32_bf16 v[232:235], v[112:115], a[36:39], v[232:235]
    buffer_load_dwordx4 a[184:187], v14, s[64:67], s78 offen offset:2048 sc1
    v_mfma_f32_16x16x32_bf16 v[232:235], v[116:119], a[52:55], v[232:235]
    ds_read_b64_tr_b16 v[86:87], v38 offset:58368
    v_mfma_f32_16x16x32_bf16 v[240:243], v[112:115], a[40:43], v[240:243]
    ds_read_b64_tr_b16 v[88:89], v39 offset:49152
    v_mfma_f32_16x16x32_bf16 v[240:243], v[116:119], a[56:59], v[240:243]
    v_mfma_f32_16x16x32_bf16 v[248:251], v[112:115], a[44:47], v[248:251]
    ds_read_b64_tr_b16 v[90:91], v39 offset:50176
    v_mfma_f32_16x16x32_bf16 v[248:251], v[116:119], a[60:63], v[248:251]
    buffer_load_dwordx4 a[188:191], v14, s[64:67], s78 offen offset:3072 sc1
    v_mfma_f32_16x16x32_bf16 v[228:231], v[120:123], a[32:35], v[228:231]
    ds_read_b64_tr_b16 v[92:93], v39 offset:57344
    v_mfma_f32_16x16x32_bf16 v[228:231], v[124:127], a[48:51], v[228:231]
    ds_read_b64_tr_b16 v[94:95], v39 offset:58368
    v_mfma_f32_16x16x32_bf16 v[236:239], v[120:123], a[36:39], v[236:239]
    v_mfma_f32_16x16x32_bf16 v[236:239], v[124:127], a[52:55], v[236:239]
    v_mfma_f32_16x16x32_bf16 v[244:247], v[120:123], a[40:43], v[244:247]
    v_mfma_f32_16x16x32_bf16 v[244:247], v[124:127], a[56:59], v[244:247]
    v_mfma_f32_16x16x32_bf16 v[252:255], v[120:123], a[44:47], v[252:255]
    v_mfma_f32_16x16x32_bf16 v[252:255], v[124:127], a[60:63], v[252:255]
    buffer_load_dword v32, v33, s[64:67], s34 offen sc1
    s_waitcnt vmcnt(40) lgkmcnt(8)
    v_mfma_f32_16x16x32_bf16 v[160:163], v[64:67], a[64:67], v[160:163]
    ds_read_b64_tr_b16 v[96:97], v40 offset:32768
    s_lshl_b32 s6, s75, 3
    s_lshr_b64 s[4:5], s[48:49], s6
    s_and_b32 s16, s4, 31
    s_lshl_b32 s79, s16, 18
    s_add_u32 m0, s31, 0x0
    s_add_u32 s79, s79, s30
    s_waitcnt vmcnt(36)
    v_mfma_f32_16x16x32_bf16 v[160:163], v[68:71], a[80:83], v[160:163]
    buffer_load_dwordx4 v6, s[12:15], s79 offen offset:0 lds
    v_mfma_f32_16x16x32_bf16 v[168:171], v[64:67], a[68:71], v[168:171]
    ds_read_b64_tr_b16 v[98:99], v40 offset:33792
    s_waitcnt vmcnt(36)
    v_mfma_f32_16x16x32_bf16 v[168:171], v[68:71], a[84:87], v[168:171]
    ds_read_b64_tr_b16 v[100:101], v40 offset:40960
    v_mfma_f32_16x16x32_bf16 v[176:179], v[64:67], a[72:75], v[176:179]
    buffer_load_dwordx4 v7, s[12:15], s79 offen offset:1024 lds
    s_add_u32 s75, s75, 1
    s_waitcnt vmcnt(36)
    v_mfma_f32_16x16x32_bf16 v[176:179], v[68:71], a[88:91], v[176:179]
    ds_read_b64_tr_b16 v[102:103], v40 offset:41984
    v_mfma_f32_16x16x32_bf16 v[184:187], v[64:67], a[76:79], v[184:187]
    ds_read_b64_tr_b16 v[104:105], v41 offset:32768
    s_waitcnt vmcnt(35)
    v_mfma_f32_16x16x32_bf16 v[184:187], v[68:71], a[92:95], v[184:187]
    buffer_load_dwordx4 v8, s[12:15], s79 offen offset:2048 lds
    s_cmp_eq_u32 s75, 7
    s_cselect_b32 s75, 0, s75
    v_mfma_f32_16x16x32_bf16 v[164:167], v[72:75], a[64:67], v[164:167]
    v_mfma_f32_16x16x32_bf16 v[164:167], v[76:79], a[80:83], v[164:167]
    ds_read_b64_tr_b16 v[106:107], v41 offset:33792
    v_mfma_f32_16x16x32_bf16 v[172:175], v[72:75], a[68:71], v[172:175]
    ds_read_b64_tr_b16 v[108:109], v41 offset:40960
    v_mfma_f32_16x16x32_bf16 v[172:175], v[76:79], a[84:87], v[172:175]
    buffer_load_dwordx4 v9, s[12:15], s79 offen offset:3072 lds
    v_mfma_f32_16x16x32_bf16 v[180:183], v[72:75], a[72:75], v[180:183]
    ds_read_b64_tr_b16 v[110:111], v41 offset:41984
    v_mfma_f32_16x16x32_bf16 v[180:183], v[76:79], a[88:91], v[180:183]
    ds_read_b64_tr_b16 v[112:113], v40 offset:49152
    s_add_u32 m0, s31, 0x1000
    s_add_u32 s79, s79, 0x8000
    v_mfma_f32_16x16x32_bf16 v[188:191], v[72:75], a[76:79], v[188:191]
    buffer_load_dwordx4 v6, s[12:15], s79 offen offset:0 lds
    v_mfma_f32_16x16x32_bf16 v[188:191], v[76:79], a[92:95], v[188:191]
    ds_read_b64_tr_b16 v[114:115], v40 offset:50176
    s_waitcnt vmcnt(37) lgkmcnt(9)
    v_mfma_f32_16x16x32_bf16 v[160:163], v[80:83], a[96:99], v[160:163]
    ds_read_b64_tr_b16 v[116:117], v40 offset:57344
    s_waitcnt vmcnt(33)
    v_mfma_f32_16x16x32_bf16 v[160:163], v[84:87], a[112:115], v[160:163]
    v_mfma_f32_16x16x32_bf16 v[168:171], v[80:83], a[100:103], v[168:171]
    buffer_load_dwordx4 v7, s[12:15], s79 offen offset:1024 lds
    s_waitcnt vmcnt(33)
    v_mfma_f32_16x16x32_bf16 v[168:171], v[84:87], a[116:119], v[168:171]
    ds_read_b64_tr_b16 v[118:119], v40 offset:58368
    v_mfma_f32_16x16x32_bf16 v[176:179], v[80:83], a[104:107], v[176:179]
    ds_read_b64_tr_b16 v[120:121], v41 offset:49152
    s_waitcnt vmcnt(32)
    v_mfma_f32_16x16x32_bf16 v[176:179], v[84:87], a[120:123], v[176:179]
    buffer_load_dwordx4 v8, s[12:15], s79 offen offset:2048 lds
    v_mfma_f32_16x16x32_bf16 v[184:187], v[80:83], a[108:111], v[184:187]
    ds_read_b64_tr_b16 v[122:123], v41 offset:50176
    s_waitcnt vmcnt(32)
    v_mfma_f32_16x16x32_bf16 v[184:187], v[84:87], a[124:127], v[184:187]
    ds_read_b64_tr_b16 v[124:125], v41 offset:57344
    v_mfma_f32_16x16x32_bf16 v[164:167], v[88:91], a[96:99], v[164:167]
    buffer_load_dwordx4 v9, s[12:15], s79 offen offset:3072 lds
    v_mfma_f32_16x16x32_bf16 v[164:167], v[92:95], a[112:115], v[164:167]
    ds_read_b64_tr_b16 v[126:127], v41 offset:58368
    v_mfma_f32_16x16x32_bf16 v[172:175], v[88:91], a[100:103], v[172:175]
    v_mfma_f32_16x16x32_bf16 v[172:175], v[92:95], a[116:119], v[172:175]
    v_mfma_f32_16x16x32_bf16 v[180:183], v[88:91], a[104:107], v[180:183]
    v_mfma_f32_16x16x32_bf16 v[180:183], v[92:95], a[120:123], v[180:183]
    v_mfma_f32_16x16x32_bf16 v[188:191], v[88:91], a[108:111], v[188:191]
    v_mfma_f32_16x16x32_bf16 v[188:191], v[92:95], a[124:127], v[188:191]
    s_waitcnt lgkmcnt(8)
    v_mfma_f32_16x16x32_bf16 v[192:195], v[96:99], a[64:67], v[192:195]
    ds_read_b64_tr_b16 v[64:65], v42 offset:32768
    s_lshl_b32 s78, s16, 16
    s_add_u32 s78, s78, s29
    v_mfma_f32_16x16x32_bf16 v[192:195], v[100:103], a[80:83], v[192:195]
    buffer_load_dwordx4 a[0:3], v14, s[64:67], s78 offen offset:0 sc1
    v_mfma_f32_16x16x32_bf16 v[200:203], v[96:99], a[68:71], v[200:203]
    ds_read_b64_tr_b16 v[66:67], v42 offset:33792
    v_mfma_f32_16x16x32_bf16 v[200:203], v[100:103], a[84:87], v[200:203]
    ds_read_b64_tr_b16 v[68:69], v42 offset:40960
    v_mfma_f32_16x16x32_bf16 v[208:211], v[96:99], a[72:75], v[208:211]
    buffer_load_dwordx4 a[4:7], v14, s[64:67], s78 offen offset:1024 sc1
    v_mfma_f32_16x16x32_bf16 v[208:211], v[100:103], a[88:91], v[208:211]
    ds_read_b64_tr_b16 v[70:71], v42 offset:41984
    v_mfma_f32_16x16x32_bf16 v[216:219], v[96:99], a[76:79], v[216:219]
    ds_read_b64_tr_b16 v[72:73], v43 offset:32768
    v_mfma_f32_16x16x32_bf16 v[216:219], v[100:103], a[92:95], v[216:219]
    buffer_load_dwordx4 a[8:11], v14, s[64:67], s78 offen offset:2048 sc1
    v_mfma_f32_16x16x32_bf16 v[196:199], v[104:107], a[64:67], v[196:199]
    v_mfma_f32_16x16x32_bf16 v[196:199], v[108:111], a[80:83], v[196:199]
    ds_read_b64_tr_b16 v[74:75], v43 offset:33792
    v_mfma_f32_16x16x32_bf16 v[204:207], v[104:107], a[68:71], v[204:207]
    ds_read_b64_tr_b16 v[76:77], v43 offset:40960
    v_mfma_f32_16x16x32_bf16 v[204:207], v[108:111], a[84:87], v[204:207]
    buffer_load_dwordx4 a[12:15], v14, s[64:67], s78 offen offset:3072 sc1
    s_add_u32 s78, s78, 16384
    v_mfma_f32_16x16x32_bf16 v[212:215], v[104:107], a[72:75], v[212:215]
    ds_read_b64_tr_b16 v[78:79], v43 offset:41984
    v_mfma_f32_16x16x32_bf16 v[212:215], v[108:111], a[88:91], v[212:215]
    ds_read_b64_tr_b16 v[80:81], v42 offset:49152
    v_mfma_f32_16x16x32_bf16 v[220:223], v[104:107], a[76:79], v[220:223]
    buffer_load_dwordx4 a[16:19], v14, s[64:67], s78 offen offset:0 sc1
    v_mfma_f32_16x16x32_bf16 v[220:223], v[108:111], a[92:95], v[220:223]
    ds_read_b64_tr_b16 v[82:83], v42 offset:50176
    s_waitcnt lgkmcnt(9)
    v_mfma_f32_16x16x32_bf16 v[192:195], v[112:115], a[96:99], v[192:195]
    ds_read_b64_tr_b16 v[84:85], v42 offset:57344
    v_mfma_f32_16x16x32_bf16 v[192:195], v[116:119], a[112:115], v[192:195]
    v_mfma_f32_16x16x32_bf16 v[200:203], v[112:115], a[100:103], v[200:203]
    buffer_load_dwordx4 a[20:23], v14, s[64:67], s78 offen offset:1024 sc1
    v_mfma_f32_16x16x32_bf16 v[200:203], v[116:119], a[116:119], v[200:203]
    ds_read_b64_tr_b16 v[86:87], v42 offset:58368
    v_mfma_f32_16x16x32_bf16 v[208:211], v[112:115], a[104:107], v[208:211]
    ds_read_b64_tr_b16 v[88:89], v43 offset:49152
    v_mfma_f32_16x16x32_bf16 v[208:211], v[116:119], a[120:123], v[208:211]
    buffer_load_dwordx4 a[24:27], v14, s[64:67], s78 offen offset:2048 sc1
    v_mfma_f32_16x16x32_bf16 v[216:219], v[112:115], a[108:111], v[216:219]
    ds_read_b64_tr_b16 v[90:91], v43 offset:50176
    v_mfma_f32_16x16x32_bf16 v[216:219], v[116:119], a[124:127], v[216:219]
    ds_read_b64_tr_b16 v[92:93], v43 offset:57344
    v_mfma_f32_16x16x32_bf16 v[196:199], v[120:123], a[96:99], v[196:199]
    buffer_load_dwordx4 a[28:31], v14, s[64:67], s78 offen offset:3072 sc1
    s_add_u32 s78, s78, 16384
    v_mfma_f32_16x16x32_bf16 v[196:199], v[124:127], a[112:115], v[196:199]
    ds_read_b64_tr_b16 v[94:95], v43 offset:58368
    v_mfma_f32_16x16x32_bf16 v[204:207], v[120:123], a[100:103], v[204:207]
    v_mfma_f32_16x16x32_bf16 v[204:207], v[124:127], a[116:119], v[204:207]
    v_mfma_f32_16x16x32_bf16 v[212:215], v[120:123], a[104:107], v[212:215]
    v_mfma_f32_16x16x32_bf16 v[212:215], v[124:127], a[120:123], v[212:215]
    v_mfma_f32_16x16x32_bf16 v[220:223], v[120:123], a[108:111], v[220:223]
    v_mfma_f32_16x16x32_bf16 v[220:223], v[124:127], a[124:127], v[220:223]
    s_waitcnt vmcnt(33)
    s_barrier
    v_add_u32 v38, 0x10000, v38
    v_add_u32 v39, 0x10000, v39
    s_waitcnt lgkmcnt(8)
    v_mfma_f32_16x16x32_bf16 v[224:227], v[64:67], a[64:67], v[224:227]
    ds_read_b64_tr_b16 v[96:97], v38 offset:0
    v_mfma_f32_16x16x32_bf16 v[224:227], v[68:71], a[80:83], v[224:227]
    buffer_load_dwordx4 a[32:35], v14, s[64:67], s78 offen offset:0 sc1
    v_mfma_f32_16x16x32_bf16 v[232:235], v[64:67], a[68:71], v[232:235]
    ds_read_b64_tr_b16 v[98:99], v38 offset:1024
    v_mfma_f32_16x16x32_bf16 v[232:235], v[68:71], a[84:87], v[232:235]
    ds_read_b64_tr_b16 v[100:101], v38 offset:8192
    v_mfma_f32_16x16x32_bf16 v[240:243], v[64:67], a[72:75], v[240:243]
    buffer_load_dwordx4 a[36:39], v14, s[64:67], s78 offen offset:1024 sc1
    v_mfma_f32_16x16x32_bf16 v[240:243], v[68:71], a[88:91], v[240:243]
    ds_read_b64_tr_b16 v[102:103], v38 offset:9216
    v_mfma_f32_16x16x32_bf16 v[248:251], v[64:67], a[76:79], v[248:251]
    ds_read_b64_tr_b16 v[104:105], v39 offset:0
    v_mfma_f32_16x16x32_bf16 v[248:251], v[68:71], a[92:95], v[248:251]
    buffer_load_dwordx4 a[40:43], v14, s[64:67], s78 offen offset:2048 sc1
    v_mfma_f32_16x16x32_bf16 v[228:231], v[72:75], a[64:67], v[228:231]
    v_mfma_f32_16x16x32_bf16 v[228:231], v[76:79], a[80:83], v[228:231]
    ds_read_b64_tr_b16 v[106:107], v39 offset:1024
    v_mfma_f32_16x16x32_bf16 v[236:239], v[72:75], a[68:71], v[236:239]
    ds_read_b64_tr_b16 v[108:109], v39 offset:8192
    v_mfma_f32_16x16x32_bf16 v[236:239], v[76:79], a[84:87], v[236:239]
    buffer_load_dwordx4 a[44:47], v14, s[64:67], s78 offen offset:3072 sc1
    s_add_u32 s78, s78, 16384
    v_mfma_f32_16x16x32_bf16 v[244:247], v[72:75], a[72:75], v[244:247]
    ds_read_b64_tr_b16 v[110:111], v39 offset:9216
    v_mfma_f32_16x16x32_bf16 v[244:247], v[76:79], a[88:91], v[244:247]
    ds_read_b64_tr_b16 v[112:113], v38 offset:16384
    v_mfma_f32_16x16x32_bf16 v[252:255], v[72:75], a[76:79], v[252:255]
    buffer_load_dwordx4 a[48:51], v14, s[64:67], s78 offen offset:0 sc1
    v_mfma_f32_16x16x32_bf16 v[252:255], v[76:79], a[92:95], v[252:255]
    ds_read_b64_tr_b16 v[114:115], v38 offset:17408
    s_waitcnt lgkmcnt(9)
    v_mfma_f32_16x16x32_bf16 v[224:227], v[80:83], a[96:99], v[224:227]
    ds_read_b64_tr_b16 v[116:117], v38 offset:24576
    v_mfma_f32_16x16x32_bf16 v[224:227], v[84:87], a[112:115], v[224:227]
    v_mfma_f32_16x16x32_bf16 v[232:235], v[80:83], a[100:103], v[232:235]
    buffer_load_dwordx4 a[52:55], v14, s[64:67], s78 offen offset:1024 sc1
    v_mfma_f32_16x16x32_bf16 v[232:235], v[84:87], a[116:119], v[232:235]
    ds_read_b64_tr_b16 v[118:119], v38 offset:25600
    v_mfma_f32_16x16x32_bf16 v[240:243], v[80:83], a[104:107], v[240:243]
    ds_read_b64_tr_b16 v[120:121], v39 offset:16384
    v_mfma_f32_16x16x32_bf16 v[240:243], v[84:87], a[120:123], v[240:243]
    buffer_load_dwordx4 a[56:59], v14, s[64:67], s78 offen offset:2048 sc1
    v_mfma_f32_16x16x32_bf16 v[248:251], v[80:83], a[108:111], v[248:251]
    ds_read_b64_tr_b16 v[122:123], v39 offset:17408
    v_mfma_f32_16x16x32_bf16 v[248:251], v[84:87], a[124:127], v[248:251]
    ds_read_b64_tr_b16 v[124:125], v39 offset:24576
    v_mfma_f32_16x16x32_bf16 v[228:231], v[88:91], a[96:99], v[228:231]
    buffer_load_dwordx4 a[60:63], v14, s[64:67], s78 offen offset:3072 sc1
    v_mfma_f32_16x16x32_bf16 v[228:231], v[92:95], a[112:115], v[228:231]
    ds_read_b64_tr_b16 v[126:127], v39 offset:25600
    v_mfma_f32_16x16x32_bf16 v[236:239], v[88:91], a[100:103], v[236:239]
    v_mfma_f32_16x16x32_bf16 v[236:239], v[92:95], a[116:119], v[236:239]
    v_mfma_f32_16x16x32_bf16 v[244:247], v[88:91], a[104:107], v[244:247]
    v_mfma_f32_16x16x32_bf16 v[244:247], v[92:95], a[120:123], v[244:247]
    v_mfma_f32_16x16x32_bf16 v[252:255], v[88:91], a[108:111], v[252:255]
    v_mfma_f32_16x16x32_bf16 v[252:255], v[92:95], a[124:127], v[252:255]
    v_add_u32 v40, 0x10000, v40
    v_add_u32 v41, 0x10000, v41
    s_waitcnt vmcnt(40) lgkmcnt(8)
    v_mfma_f32_16x16x32_bf16 v[160:163], v[96:99], a[128:131], v[160:163]
    ds_read_b64_tr_b16 v[64:65], v40 offset:0
    s_waitcnt vmcnt(36)
    v_mfma_f32_16x16x32_bf16 v[160:163], v[100:103], a[144:147], v[160:163]
    ds_read_b64_tr_b16 v[66:67], v40 offset:1024
    v_mfma_f32_16x16x32_bf16 v[168:171], v[96:99], a[132:135], v[168:171]
    s_waitcnt vmcnt(35)
    v_mfma_f32_16x16x32_bf16 v[168:171], v[100:103], a[148:151], v[168:171]
    ds_read_b64_tr_b16 v[68:69], v40 offset:8192
    v_mfma_f32_16x16x32_bf16 v[176:179], v[96:99], a[136:139], v[176:179]
    s_waitcnt vmcnt(34)
    v_mfma_f32_16x16x32_bf16 v[176:179], v[100:103], a[152:155], v[176:179]
    ds_read_b64_tr_b16 v[70:71], v40 offset:9216
    v_mfma_f32_16x16x32_bf16 v[184:187], v[96:99], a[140:143], v[184:187]
    ds_read_b64_tr_b16 v[72:73], v41 offset:0
    s_waitcnt vmcnt(33)
    v_mfma_f32_16x16x32_bf16 v[184:187], v[100:103], a[156:159], v[184:187]
    v_mfma_f32_16x16x32_bf16 v[164:167], v[104:107], a[128:131], v[164:167]
    ds_read_b64_tr_b16 v[74:75], v41 offset:1024
    v_mfma_f32_16x16x32_bf16 v[164:167], v[108:111], a[144:147], v[164:167]
    v_mfma_f32_16x16x32_bf16 v[172:175], v[104:107], a[132:135], v[172:175]
    ds_read_b64_tr_b16 v[76:77], v41 offset:8192
    v_mfma_f32_16x16x32_bf16 v[172:175], v[108:111], a[148:151], v[172:175]
    ds_read_b64_tr_b16 v[78:79], v41 offset:9216
    v_mfma_f32_16x16x32_bf16 v[180:183], v[104:107], a[136:139], v[180:183]
    v_mfma_f32_16x16x32_bf16 v[180:183], v[108:111], a[152:155], v[180:183]
    ds_read_b64_tr_b16 v[80:81], v40 offset:16384
    v_mfma_f32_16x16x32_bf16 v[188:191], v[104:107], a[140:143], v[188:191]
    v_mfma_f32_16x16x32_bf16 v[188:191], v[108:111], a[156:159], v[188:191]
    ds_read_b64_tr_b16 v[82:83], v40 offset:17408
    s_waitcnt vmcnt(32) lgkmcnt(9)
    v_mfma_f32_16x16x32_bf16 v[160:163], v[112:115], a[160:163], v[160:163]
    ds_read_b64_tr_b16 v[84:85], v40 offset:24576
    s_waitcnt vmcnt(28)
    v_mfma_f32_16x16x32_bf16 v[160:163], v[116:119], a[176:179], v[160:163]
    v_mfma_f32_16x16x32_bf16 v[168:171], v[112:115], a[164:167], v[168:171]
    ds_read_b64_tr_b16 v[86:87], v40 offset:25600
    s_waitcnt vmcnt(27)
    v_mfma_f32_16x16x32_bf16 v[168:171], v[116:119], a[180:183], v[168:171]
    v_mfma_f32_16x16x32_bf16 v[176:179], v[112:115], a[168:171], v[176:179]
    ds_read_b64_tr_b16 v[88:89], v41 offset:16384
    s_waitcnt vmcnt(26)
    v_mfma_f32_16x16x32_bf16 v[176:179], v[116:119], a[184:187], v[176:179]
    ds_read_b64_tr_b16 v[90:91], v41 offset:17408
    v_mfma_f32_16x16x32_bf16 v[184:187], v[112:115], a[172:175], v[184:187]
    s_waitcnt vmcnt(25)
    v_mfma_f32_16x16x32_bf16 v[184:187], v[116:119], a[188:191], v[184:187]
    ds_read_b64_tr_b16 v[92:93], v41 offset:24576
    v_mfma_f32_16x16x32_bf16 v[164:167], v[120:123], a[160:163], v[164:167]
    v_mfma_f32_16x16x32_bf16 v[164:167], v[124:127], a[176:179], v[164:167]
    ds_read_b64_tr_b16 v[94:95], v41 offset:25600
    v_mfma_f32_16x16x32_bf16 v[172:175], v[120:123], a[164:167], v[172:175]
    v_mfma_f32_16x16x32_bf16 v[172:175], v[124:127], a[180:183], v[172:175]
    v_mfma_f32_16x16x32_bf16 v[180:183], v[120:123], a[168:171], v[180:183]
    v_mfma_f32_16x16x32_bf16 v[180:183], v[124:127], a[184:187], v[180:183]
    v_mfma_f32_16x16x32_bf16 v[188:191], v[120:123], a[172:175], v[188:191]
    v_mfma_f32_16x16x32_bf16 v[188:191], v[124:127], a[188:191], v[188:191]
    s_waitcnt vmcnt(24)
    v_cmp_ne_u32 vcc, 0, v32
    s_nop 0
    s_cmp_eq_u64 vcc, -1
    s_cbranch_scc0 YF_SLOW
YF_OK:
    v_add_u32 v42, 0x10000, v42
    v_add_u32 v43, 0x10000, v43
    s_waitcnt lgkmcnt(8)
    v_mfma_f32_16x16x32_bf16 v[192:195], v[64:67], a[128:131], v[192:195]
    ds_read_b64_tr_b16 v[96:97], v42 offset:0
    s_add_u32 m0, s33, 0x0
    s_add_u32 s5, s32, 0x0
    v_mfma_f32_16x16x32_bf16 v[192:195], v[68:71], a[144:147], v[192:195]
    buffer_load_dwordx4 v35, s[64:67], s5 offen sc1 lds
    s_lshl_b32 s4, s2, 2
    v_mfma_f32_16x16x32_bf16 v[200:203], v[64:67], a[132:135], v[200:203]
    ds_read_b64_tr_b16 v[98:99], v42 offset:1024
    v_mfma_f32_16x16x32_bf16 v[200:203], v[68:71], a[148:151], v[200:203]
    s_add_u32 s4, s4, s3
    v_mfma_f32_16x16x32_bf16 v[208:211], v[64:67], a[136:139], v[208:211]
    ds_read_b64_tr_b16 v[100:101], v42 offset:8192
    v_mfma_f32_16x16x32_bf16 v[208:211], v[68:71], a[152:155], v[208:211]
    ds_read_b64_tr_b16 v[102:103], v42 offset:9216
    v_mfma_f32_16x16x32_bf16 v[216:219], v[64:67], a[140:143], v[216:219]
    ds_read_b64_tr_b16 v[104:105], v43 offset:0
    s_add_u32 m0, s33, 0x400
    s_add_u32 s5, s32, 0x8000
    v_mfma_f32_16x16x32_bf16 v[216:219], v[68:71], a[156:159], v[216:219]
    s_lshl_b32 s74, s4, 7
    v_mfma_f32_16x16x32_bf16 v[196:199], v[72:75], a[128:131], v[196:199]
    buffer_load_dwordx4 v35, s[64:67], s5 offen sc1 lds
    v_mfma_f32_16x16x32_bf16 v[196:199], v[76:79], a[144:147], v[196:199]
    ds_read_b64_tr_b16 v[106:107], v43 offset:1024
    v_mfma_f32_16x16x32_bf16 v[204:207], v[72:75], a[132:135], v[204:207]
    ds_read_b64_tr_b16 v[108:109], v43 offset:8192
    s_add_u32 s74, s74, 0x1040000
    v_mfma_f32_16x16x32_bf16 v[204:207], v[76:79], a[148:151], v[204:207]
    v_mfma_f32_16x16x32_bf16 v[212:215], v[72:75], a[136:139], v[212:215]
    ds_read_b64_tr_b16 v[110:111], v43 offset:9216
    s_lshl_b32 s75, s4, 14
    v_mfma_f32_16x16x32_bf16 v[212:215], v[76:79], a[152:155], v[212:215]
    ds_read_b64_tr_b16 v[112:113], v42 offset:16384
    s_add_u32 m0, s33, 0x800
    s_add_u32 s5, s32, 0x10000
    v_mfma_f32_16x16x32_bf16 v[220:223], v[72:75], a[140:143], v[220:223]
    buffer_load_dwordx4 v35, s[64:67], s5 offen sc1 lds
    v_mfma_f32_16x16x32_bf16 v[220:223], v[76:79], a[156:159], v[220:223]
    s_add_u32 s75, s75, 0x2000000
    s_waitcnt lgkmcnt(9)
    v_mfma_f32_16x16x32_bf16 v[192:195], v[80:83], a[160:163], v[192:195]
    ds_read_b64_tr_b16 v[114:115], v42 offset:17408
    v_mfma_f32_16x16x32_bf16 v[192:195], v[84:87], a[176:179], v[192:195]
    ds_read_b64_tr_b16 v[116:117], v42 offset:24576
    v_mfma_f32_16x16x32_bf16 v[200:203], v[80:83], a[164:167], v[200:203]
    ds_read_b64_tr_b16 v[118:119], v42 offset:25600
    v_mfma_f32_16x16x32_bf16 v[200:203], v[84:87], a[180:183], v[200:203]
    v_min_u32 v33, 2, v1
    v_mfma_f32_16x16x32_bf16 v[208:211], v[80:83], a[168:171], v[208:211]
    ds_read_b64_tr_b16 v[120:121], v43 offset:16384
    s_add_u32 m0, s33, 0xc00
    s_add_u32 s5, s32, 0x18000
    v_mfma_f32_16x16x32_bf16 v[208:211], v[84:87], a[184:187], v[208:211]
    buffer_load_dwordx4 v35, s[64:67], s5 offen sc1 lds
    v_mfma_f32_16x16x32_bf16 v[216:219], v[80:83], a[172:175], v[216:219]
    ds_read_b64_tr_b16 v[122:123], v43 offset:17408
    v_add_u32_e64 v33, 1, v33
    v_mfma_f32_16x16x32_bf16 v[216:219], v[84:87], a[188:191], v[216:219]
    v_mfma_f32_16x16x32_bf16 v[196:199], v[88:91], a[160:163], v[196:199]
    ds_read_b64_tr_b16 v[124:125], v43 offset:24576
    v_lshlrev_b32_e64 v33, 10, v33
    v_mfma_f32_16x16x32_bf16 v[196:199], v[92:95], a[176:179], v[196:199]
    ds_read_b64_tr_b16 v[126:127], v43 offset:25600
    v_mfma_f32_16x16x32_bf16 v[204:207], v[88:91], a[164:167], v[204:207]
    v_mfma_f32_16x16x32_bf16 v[204:207], v[92:95], a[180:183], v[204:207]
    v_xor_b32_e64 v33, s74, v33
    v_mfma_f32_16x16x32_bf16 v[212:215], v[88:91], a[168:171], v[212:215]
    v_mov_b32 v60, 0x3f80
    v_mfma_f32_16x16x32_bf16 v[212:215], v[92:95], a[184:187], v[212:215]
    v_mfma_f32_16x16x32_bf16 v[220:223], v[88:91], a[172:175], v[220:223]
    v_mov_b32_e64 v61, 0x3f800000
    v_mfma_f32_16x16x32_bf16 v[220:223], v[92:95], a[188:191], v[220:223]
    s_waitcnt vmcnt(20)
    s_barrier
    v_subrev_u32 v38, 0x10000, v38
    v_subrev_u32 v39, 0x10000, v39
    s_waitcnt lgkmcnt(8)
    v_mfma_f32_16x16x32_bf16 v[224:227], v[96:99], a[128:131], v[224:227]
    ds_read_b64_tr_b16 v[64:65], v38 offset:0
    v_mfma_f32_16x16x32_bf16 v[224:227], v[100:103], a[144:147], v[224:227]
    ds_read_b64_tr_b16 v[66:67], v38 offset:1024
    v_mfma_f32_16x16x32_bf16 v[232:235], v[96:99], a[132:135], v[232:235]
    v_mfma_f32_16x16x32_bf16 v[232:235], v[100:103], a[148:151], v[232:235]
    ds_read_b64_tr_b16 v[68:69], v38 offset:8192
    v_mfma_f32_16x16x32_bf16 v[240:243], v[96:99], a[136:139], v[240:243]
    v_mfma_f32_16x16x32_bf16 v[240:243], v[100:103], a[152:155], v[240:243]
    ds_read_b64_tr_b16 v[70:71], v38 offset:9216
    v_mfma_f32_16x16x32_bf16 v[248:251], v[96:99], a[140:143], v[248:251]
    ds_read_b64_tr_b16 v[72:73], v39 offset:0
    v_mfma_f32_16x16x32_bf16 v[248:251], v[100:103], a[156:159], v[248:251]
    v_mfma_f32_16x16x32_bf16 v[228:231], v[104:107], a[128:131], v[228:231]
    ds_read_b64_tr_b16 v[74:75], v39 offset:1024
    v_mfma_f32_16x16x32_bf16 v[228:231], v[108:111], a[144:147], v[228:231]
    v_mfma_f32_16x16x32_bf16 v[236:239], v[104:107], a[132:135], v[236:239]
    ds_read_b64_tr_b16 v[76:77], v39 offset:8192
    v_mfma_f32_16x16x32_bf16 v[236:239], v[108:111], a[148:151], v[236:239]
    ds_read_b64_tr_b16 v[78:79], v39 offset:9216
    v_mfma_f32_16x16x32_bf16 v[244:247], v[104:107], a[136:139], v[244:247]
    v_mfma_f32_16x16x32_bf16 v[244:247], v[108:111], a[152:155], v[244:247]
    ds_read_b64_tr_b16 v[80:81], v38 offset:16384
    v_mfma_f32_16x16x32_bf16 v[252:255], v[104:107], a[140:143], v[252:255]
    v_mfma_f32_16x16x32_bf16 v[252:255], v[108:111], a[156:159], v[252:255]
    ds_read_b64_tr_b16 v[82:83], v38 offset:17408
    s_waitcnt lgkmcnt(9)
    v_mfma_f32_16x16x32_bf16 v[224:227], v[112:115], a[160:163], v[224:227]
    ds_read_b64_tr_b16 v[84:85], v38 offset:24576
    v_mfma_f32_16x16x32_bf16 v[224:227], v[116:119], a[176:179], v[224:227]
    v_mfma_f32_16x16x32_bf16 v[232:235], v[112:115], a[164:167], v[232:235]
    ds_read_b64_tr_b16 v[86:87], v38 offset:25600
    v_mfma_f32_16x16x32_bf16 v[232:235], v[116:119], a[180:183], v[232:235]
    v_mfma_f32_16x16x32_bf16 v[240:243], v[112:115], a[168:171], v[240:243]
    ds_read_b64_tr_b16 v[88:89], v39 offset:16384
    v_mfma_f32_16x16x32_bf16 v[240:243], v[116:119], a[184:187], v[240:243]
    ds_read_b64_tr_b16 v[90:91], v39 offset:17408
    v_mfma_f32_16x16x32_bf16 v[248:251], v[112:115], a[172:175], v[248:251]
    v_mfma_f32_16x16x32_bf16 v[248:251], v[116:119], a[188:191], v[248:251]
    ds_read_b64_tr_b16 v[92:93], v39 offset:24576
    v_mfma_f32_16x16x32_bf16 v[228:231], v[120:123], a[160:163], v[228:231]
    v_mfma_f32_16x16x32_bf16 v[228:231], v[124:127], a[176:179], v[228:231]
    ds_read_b64_tr_b16 v[94:95], v39 offset:25600
    v_mfma_f32_16x16x32_bf16 v[236:239], v[120:123], a[164:167], v[236:239]
    v_mfma_f32_16x16x32_bf16 v[236:239], v[124:127], a[180:183], v[236:239]
    v_mfma_f32_16x16x32_bf16 v[244:247], v[120:123], a[168:171], v[244:247]
    v_mfma_f32_16x16x32_bf16 v[244:247], v[124:127], a[184:187], v[244:247]
    v_mfma_f32_16x16x32_bf16 v[252:255], v[120:123], a[172:175], v[252:255]
    v_mfma_f32_16x16x32_bf16 v[252:255], v[124:127], a[188:191], v[252:255]
    v_subrev_u32 v40, 0x10000, v40
    v_subrev_u32 v41, 0x10000, v41
    s_waitcnt vmcnt(19) lgkmcnt(8)
    v_mfma_f32_16x16x32_bf16 v[160:163], v[64:67], a[0:3], v[160:163]
    ds_read_b64_tr_b16 v[96:97], v40 offset:0
    s_waitcnt vmcnt(15)
    v_mfma_f32_16x16x32_bf16 v[160:163], v[68:71], a[16:19], v[160:163]
    ds_read_b64_tr_b16 v[98:99], v40 offset:1024
    v_mfma_f32_16x16x32_bf16 v[168:171], v[64:67], a[4:7], v[168:171]
    s_waitcnt vmcnt(14)
    v_mfma_f32_16x16x32_bf16 v[168:171], v[68:71], a[20:23], v[168:171]
    ds_read_b64_tr_b16 v[100:101], v40 offset:8192
    v_mfma_f32_16x16x32_bf16 v[176:179], v[64:67], a[8:11], v[176:179]
    s_waitcnt vmcnt(13)
    v_mfma_f32_16x16x32_bf16 v[176:179], v[68:71], a[24:27], v[176:179]
    ds_read_b64_tr_b16 v[102:103], v40 offset:9216
    v_mfma_f32_16x16x32_bf16 v[184:187], v[64:67], a[12:15], v[184:187]
    ds_read_b64_tr_b16 v[104:105], v41 offset:0
    s_waitcnt vmcnt(12)
    v_mfma_f32_16x16x32_bf16 v[184:187], v[68:71], a[28:31], v[184:187]
    v_mfma_f32_16x16x32_bf16 v[164:167], v[72:75], a[0:3], v[164:167]
    ds_read_b64_tr_b16 v[106:107], v41 offset:1024
    v_mfma_f32_16x16x32_bf16 v[164:167], v[76:79], a[16:19], v[164:167]
    v_mfma_f32_16x16x32_bf16 v[172:175], v[72:75], a[4:7], v[172:175]
    ds_read_b64_tr_b16 v[108:109], v41 offset:8192
    v_mfma_f32_16x16x32_bf16 v[172:175], v[76:79], a[20:23], v[172:175]
    ds_read_b64_tr_b16 v[110:111], v41 offset:9216
    v_mfma_f32_16x16x32_bf16 v[180:183], v[72:75], a[8:11], v[180:183]
    v_mfma_f32_16x16x32_bf16 v[180:183], v[76:79], a[24:27], v[180:183]
    ds_read_b64_tr_b16 v[112:113], v40 offset:16384
    v_mfma_f32_16x16x32_bf16 v[188:191], v[72:75], a[12:15], v[188:191]
    v_mfma_f32_16x16x32_bf16 v[188:191], v[76:79], a[28:31], v[188:191]
    ds_read_b64_tr_b16 v[114:115], v40 offset:17408
    s_waitcnt vmcnt(11) lgkmcnt(9)
    v_mfma_f32_16x16x32_bf16 v[160:163], v[80:83], a[32:35], v[160:163]
    ds_read_b64_tr_b16 v[116:117], v40 offset:24576
    s_waitcnt vmcnt(7)
    v_mfma_f32_16x16x32_bf16 v[160:163], v[84:87], a[48:51], v[160:163]
    v_mfma_f32_16x16x32_bf16 v[168:171], v[80:83], a[36:39], v[168:171]
    ds_read_b64_tr_b16 v[118:119], v40 offset:25600
    s_waitcnt vmcnt(6)
    v_mfma_f32_16x16x32_bf16 v[168:171], v[84:87], a[52:55], v[168:171]
    v_mfma_f32_16x16x32_bf16 v[176:179], v[80:83], a[40:43], v[176:179]
    ds_read_b64_tr_b16 v[120:121], v41 offset:16384
    s_waitcnt vmcnt(5)
    v_mfma_f32_16x16x32_bf16 v[176:179], v[84:87], a[56:59], v[176:179]
    ds_read_b64_tr_b16 v[122:123], v41 offset:17408
    v_mfma_f32_16x16x32_bf16 v[184:187], v[80:83], a[44:47], v[184:187]
    s_waitcnt vmcnt(4)
    v_mfma_f32_16x16x32_bf16 v[184:187], v[84:87], a[60:63], v[184:187]
    ds_read_b64_tr_b16 v[124:125], v41 offset:24576
    v_mfma_f32_16x16x32_bf16 v[164:167], v[88:91], a[32:35], v[164:167]
    v_mfma_f32_16x16x32_bf16 v[164:167], v[92:95], a[48:51], v[164:167]
    ds_read_b64_tr_b16 v[126:127], v41 offset:25600
    v_mfma_f32_16x16x32_bf16 v[172:175], v[88:91], a[36:39], v[172:175]
    v_mfma_f32_16x16x32_bf16 v[172:175], v[92:95], a[52:55], v[172:175]
    v_mfma_f32_16x16x32_bf16 v[180:183], v[88:91], a[40:43], v[180:183]
    v_mfma_f32_16x16x32_bf16 v[180:183], v[92:95], a[56:59], v[180:183]
    v_mfma_f32_16x16x32_bf16 v[188:191], v[88:91], a[44:47], v[188:191]
    v_mfma_f32_16x16x32_bf16 v[188:191], v[92:95], a[60:63], v[188:191]
    v_subrev_u32 v42, 0x10000, v42
    v_subrev_u32 v43, 0x10000, v43
    s_waitcnt lgkmcnt(8)
    v_mfma_f32_16x16x32_bf16 v[192:195], v[96:99], a[0:3], v[192:195]
    ds_read_b64_tr_b16 v[64:65], v42 offset:0
    v_mfma_f32_16x16x32_bf16 v[192:195], v[100:103], a[16:19], v[192:195]
    ds_read_b64_tr_b16 v[66:67], v42 offset:1024
    v_mfma_f32_16x16x32_bf16 v[200:203], v[96:99], a[4:7], v[200:203]
    v_mfma_f32_16x16x32_bf16 v[200:203], v[100:103], a[20:23], v[200:203]
    ds_read_b64_tr_b16 v[68:69], v42 offset:8192
    v_cvt_pk_bf16_f32 v160, v160, v161
    v_mfma_f32_16x16x32_bf16 v[208:211], v[96:99], a[8:11], v[208:211]
    v_cvt_pk_bf16_f32 v161, v162, v163
    v_mfma_f32_16x16x32_bf16 v[208:211], v[100:103], a[24:27], v[208:211]
    ds_read_b64_tr_b16 v[70:71], v42 offset:9216
    v_mfma_f32_16x16x32_bf16 v[216:219], v[96:99], a[12:15], v[216:219]
    ds_read_b64_tr_b16 v[72:73], v43 offset:0
    v_cvt_pk_bf16_f32 v162, v164, v165
    v_mfma_f32_16x16x32_bf16 v[216:219], v[100:103], a[28:31], v[216:219]
    v_cvt_pk_bf16_f32 v163, v166, v167
    v_mfma_f32_16x16x32_bf16 v[196:199], v[104:107], a[0:3], v[196:199]
    ds_read_b64_tr_b16 v[74:75], v43 offset:1024
    v_cvt_pk_bf16_f32 v164, v168, v169
    v_mfma_f32_16x16x32_bf16 v[196:199], v[108:111], a[16:19], v[196:199]
    v_cvt_pk_bf16_f32 v165, v170, v171
    v_mfma_f32_16x16x32_bf16 v[204:207], v[104:107], a[4:7], v[204:207]
    ds_read_b64_tr_b16 v[76:77], v43 offset:8192
    v_cvt_pk_bf16_f32 v166, v172, v173
    v_mfma_f32_16x16x32_bf16 v[204:207], v[108:111], a[20:23], v[204:207]
    ds_read_b64_tr_b16 v[78:79], v43 offset:9216
    v_mfma_f32_16x16x32_bf16 v[212:215], v[104:107], a[8:11], v[212:215]
    v_cvt_pk_bf16_f32 v167, v174, v175
    v_mfma_f32_16x16x32_bf16 v[212:215], v[108:111], a[24:27], v[212:215]
    ds_read_b64_tr_b16 v[80:81], v42 offset:16384
    v_cvt_pk_bf16_f32 v168, v176, v177
    v_mfma_f32_16x16x32_bf16 v[220:223], v[104:107], a[12:15], v[220:223]
    v_cvt_pk_bf16_f32 v169, v178, v179
    v_mfma_f32_16x16x32_bf16 v[220:223], v[108:111], a[28:31], v[220:223]
    ds_read_b64_tr_b16 v[82:83], v42 offset:17408
    v_cvt_pk_bf16_f32 v170, v180, v181
    s_waitcnt lgkmcnt(9)
    v_mfma_f32_16x16x32_bf16 v[192:195], v[112:115], a[32:35], v[192:195]
    ds_read_b64_tr_b16 v[84:85], v42 offset:24576
    v_mfma_f32_16x16x32_bf16 v[192:195], v[116:119], a[48:51], v[192:195]
    v_cvt_pk_bf16_f32 v171, v182, v183
    v_cvt_pk_bf16_f32 v172, v184, v185
    v_mfma_f32_16x16x32_bf16 v[200:203], v[112:115], a[36:39], v[200:203]
    ds_read_b64_tr_b16 v[86:87], v42 offset:25600
    v_mfma_f32_16x16x32_bf16 v[200:203], v[116:119], a[52:55], v[200:203]
    v_cvt_pk_bf16_f32 v173, v186, v187
    v_mfma_f32_16x16x32_bf16 v[208:211], v[112:115], a[40:43], v[208:211]
    ds_read_b64_tr_b16 v[88:89], v43 offset:16384
    v_cvt_pk_bf16_f32 v174, v188, v189
    v_mfma_f32_16x16x32_bf16 v[208:211], v[116:119], a[56:59], v[208:211]
    ds_read_b64_tr_b16 v[90:91], v43 offset:17408
    v_cvt_pk_bf16_f32 v175, v190, v191
    v_mfma_f32_16x16x32_bf16 v[216:219], v[112:115], a[44:47], v[216:219]
    v_mfma_f32_16x16x32_bf16 v[216:219], v[116:119], a[60:63], v[216:219]
    ds_read_b64_tr_b16 v[92:93], v43 offset:24576
    v_mfma_f32_16x16x32_bf16 v[196:199], v[120:123], a[32:35], v[196:199]
    s_add_u32 s5, s75, 0x1000
    buffer_store_dwordx4 v[160:163], v14, s[64:67], s5 offen offset:0 sc1
    v_mfma_f32_16x16x32_bf16 v[196:199], v[124:127], a[48:51], v[196:199]
    ds_read_b64_tr_b16 v[94:95], v43 offset:25600
    v_mfma_f32_16x16x32_bf16 v[204:207], v[120:123], a[36:39], v[204:207]
    buffer_store_dwordx4 v[164:167], v14, s[64:67], s5 offen offset:1024 sc1
    v_mfma_f32_16x16x32_bf16 v[204:207], v[124:127], a[52:55], v[204:207]
    buffer_store_dwordx4 v[168:171], v14, s[64:67], s5 offen offset:2048 sc1
    buffer_store_dwordx4 v[172:175], v14, s[64:67], s5 offen offset:3072 sc1
    v_mfma_f32_16x16x32_bf16 v[212:215], v[120:123], a[40:43], v[212:215]
    v_mfma_f32_16x16x32_bf16 v[212:215], v[124:127], a[56:59], v[212:215]
    v_mfma_f32_16x16x32_bf16 v[220:223], v[120:123], a[44:47], v[220:223]
    v_mfma_f32_16x16x32_bf16 v[220:223], v[124:127], a[60:63], v[220:223]
    s_waitcnt lgkmcnt(8)
    v_mfma_f32_16x16x32_bf16 v[224:227], v[64:67], a[0:3], v[224:227]
    ds_read_b64_tr_b16 v[96:97], v36 offset:0
    v_mfma_f32_16x16x32_bf16 v[224:227], v[68:71], a[16:19], v[224:227]
    ds_read_b64_tr_b16 v[98:99], v36 offset:1024
    v_mfma_f32_16x16x32_bf16 v[232:235], v[64:67], a[4:7], v[232:235]
    v_mfma_f32_16x16x32_bf16 v[232:235], v[68:71], a[20:23], v[232:235]
    ds_read_b64_tr_b16 v[100:101], v36 offset:8192
    v_cvt_pk_bf16_f32 v192, v192, v193
    v_mfma_f32_16x16x32_bf16 v[240:243], v[64:67], a[8:11], v[240:243]
    v_cvt_pk_bf16_f32 v193, v194, v195
    v_mfma_f32_16x16x32_bf16 v[240:243], v[68:71], a[24:27], v[240:243]
    ds_read_b64_tr_b16 v[102:103], v36 offset:9216
    v_mfma_f32_16x16x32_bf16 v[248:251], v[64:67], a[12:15], v[248:251]
    ds_read_b64_tr_b16 v[104:105], v37 offset:0
    v_cvt_pk_bf16_f32 v194, v196, v197
    v_mfma_f32_16x16x32_bf16 v[248:251], v[68:71], a[28:31], v[248:251]
    v_cvt_pk_bf16_f32 v195, v198, v199
    v_mfma_f32_16x16x32_bf16 v[228:231], v[72:75], a[0:3], v[228:231]
    ds_read_b64_tr_b16 v[106:107], v37 offset:1024
    v_cvt_pk_bf16_f32 v196, v200, v201
    v_mfma_f32_16x16x32_bf16 v[228:231], v[76:79], a[16:19], v[228:231]
    v_cvt_pk_bf16_f32 v197, v202, v203
    v_mfma_f32_16x16x32_bf16 v[236:239], v[72:75], a[4:7], v[236:239]
    ds_read_b64_tr_b16 v[108:109], v37 offset:8192
    v_cvt_pk_bf16_f32 v198, v204, v205
    v_mfma_f32_16x16x32_bf16 v[236:239], v[76:79], a[20:23], v[236:239]
    ds_read_b64_tr_b16 v[110:111], v37 offset:9216
    v_mfma_f32_16x16x32_bf16 v[244:247], v[72:75], a[8:11], v[244:247]
    v_cvt_pk_bf16_f32 v199, v206, v207
    v_mfma_f32_16x16x32_bf16 v[244:247], v[76:79], a[24:27], v[244:247]
    ds_read_b64_tr_b16 v[112:113], v36 offset:16384
    v_cvt_pk_bf16_f32 v200, v208, v209
    v_mfma_f32_16x16x32_bf16 v[252:255], v[72:75], a[12:15], v[252:255]
    v_cvt_pk_bf16_f32 v201, v210, v211
    v_mfma_f32_16x16x32_bf16 v[252:255], v[76:79], a[28:31], v[252:255]
    ds_read_b64_tr_b16 v[114:115], v36 offset:17408
    v_cvt_pk_bf16_f32 v202, v212, v213
    s_waitcnt lgkmcnt(9)
    v_mfma_f32_16x16x32_bf16 v[224:227], v[80:83], a[32:35], v[224:227]
    ds_read_b64_tr_b16 v[116:117], v36 offset:24576
    v_mfma_f32_16x16x32_bf16 v[224:227], v[84:87], a[48:51], v[224:227]
    v_cvt_pk_bf16_f32 v203, v214, v215
    v_cvt_pk_bf16_f32 v204, v216, v217
    v_mfma_f32_16x16x32_bf16 v[232:235], v[80:83], a[36:39], v[232:235]
    ds_read_b64_tr_b16 v[118:119], v36 offset:25600
    v_mfma_f32_16x16x32_bf16 v[232:235], v[84:87], a[52:55], v[232:235]
    v_cvt_pk_bf16_f32 v205, v218, v219
    v_mfma_f32_16x16x32_bf16 v[240:243], v[80:83], a[40:43], v[240:243]
    ds_read_b64_tr_b16 v[120:121], v37 offset:16384
    v_cvt_pk_bf16_f32 v206, v220, v221
    v_mfma_f32_16x16x32_bf16 v[240:243], v[84:87], a[56:59], v[240:243]
    ds_read_b64_tr_b16 v[122:123], v37 offset:17408
    v_cvt_pk_bf16_f32 v207, v222, v223
    v_mfma_f32_16x16x32_bf16 v[248:251], v[80:83], a[44:47], v[248:251]
    v_mfma_f32_16x16x32_bf16 v[248:251], v[84:87], a[60:63], v[248:251]
    ds_read_b64_tr_b16 v[124:125], v37 offset:24576
    v_mfma_f32_16x16x32_bf16 v[228:231], v[88:91], a[32:35], v[228:231]
    s_add_u32 s5, s75, 0x2000
    buffer_store_dwordx4 v[192:195], v14, s[64:67], s5 offen offset:0 sc1
    v_mfma_f32_16x16x32_bf16 v[228:231], v[92:95], a[48:51], v[228:231]
    ds_read_b64_tr_b16 v[126:127], v37 offset:25600
    v_mfma_f32_16x16x32_bf16 v[236:239], v[88:91], a[36:39], v[236:239]
    buffer_store_dwordx4 v[196:199], v14, s[64:67], s5 offen offset:1024 sc1
    v_mfma_f32_16x16x32_bf16 v[236:239], v[92:95], a[52:55], v[236:239]
    buffer_store_dwordx4 v[200:203], v14, s[64:67], s5 offen offset:2048 sc1
    buffer_store_dwordx4 v[204:207], v14, s[64:67], s5 offen offset:3072 sc1
    v_mfma_f32_16x16x32_bf16 v[244:247], v[88:91], a[40:43], v[244:247]
    v_mfma_f32_16x16x32_bf16 v[244:247], v[92:95], a[56:59], v[244:247]
    v_mfma_f32_16x16x32_bf16 v[252:255], v[88:91], a[44:47], v[252:255]
    v_mfma_f32_16x16x32_bf16 v[252:255], v[92:95], a[60:63], v[252:255]
    s_waitcnt lgkmcnt(8)
    v_mfma_f32_16x16x32_bf16 v[128:131], v[96:99], a[0:3], v[128:131]
    ds_read_b64_tr_b16 v[64:65], v36 offset:32768
    v_mfma_f32_16x16x32_bf16 v[128:131], v[100:103], a[16:19], v[128:131]
    ds_read_b64_tr_b16 v[66:67], v36 offset:33792
    v_mfma_f32_16x16x32_bf16 v[136:139], v[96:99], a[4:7], v[136:139]
    v_mfma_f32_16x16x32_bf16 v[136:139], v[100:103], a[20:23], v[136:139]
    ds_read_b64_tr_b16 v[68:69], v36 offset:40960
    v_cvt_pk_bf16_f32 v224, v224, v225
    v_mfma_f32_16x16x32_bf16 v[144:147], v[96:99], a[8:11], v[144:147]
    v_cvt_pk_bf16_f32 v225, v226, v227
    v_mfma_f32_16x16x32_bf16 v[144:147], v[100:103], a[24:27], v[144:147]
    ds_read_b64_tr_b16 v[70:71], v36 offset:41984
    v_mfma_f32_16x16x32_bf16 v[152:155], v[96:99], a[12:15], v[152:155]
    ds_read_b64_tr_b16 v[72:73], v37 offset:32768
    v_cvt_pk_bf16_f32 v226, v228, v229
    v_mfma_f32_16x16x32_bf16 v[152:155], v[100:103], a[28:31], v[152:155]
    v_cvt_pk_bf16_f32 v227, v230, v231
    v_mfma_f32_16x16x32_bf16 v[132:135], v[104:107], a[0:3], v[132:135]
    ds_read_b64_tr_b16 v[74:75], v37 offset:33792
    v_cvt_pk_bf16_f32 v228, v232, v233
    v_mfma_f32_16x16x32_bf16 v[132:135], v[108:111], a[16:19], v[132:135]
    v_cvt_pk_bf16_f32 v229, v234, v235
    v_mfma_f32_16x16x32_bf16 v[140:143], v[104:107], a[4:7], v[140:143]
    ds_read_b64_tr_b16 v[76:77], v37 offset:40960
    v_cvt_pk_bf16_f32 v230, v236, v237
    v_mfma_f32_16x16x32_bf16 v[140:143], v[108:111], a[20:23], v[140:143]
    ds_read_b64_tr_b16 v[78:79], v37 offset:41984
    v_mfma_f32_16x16x32_bf16 v[148:151], v[104:107], a[8:11], v[148:151]
    v_cvt_pk_bf16_f32 v231, v238, v239
    v_mfma_f32_16x16x32_bf16 v[148:151], v[108:111], a[24:27], v[148:151]
    ds_read_b64_tr_b16 v[80:81], v36 offset:49152
    v_cvt_pk_bf16_f32 v232, v240, v241
    v_mfma_f32_16x16x32_bf16 v[156:159], v[104:107], a[12:15], v[156:159]
    v_cvt_pk_bf16_f32 v233, v242, v243
    v_mfma_f32_16x16x32_bf16 v[156:159], v[108:111], a[28:31], v[156:159]
    ds_read_b64_tr_b16 v[82:83], v36 offset:50176
    v_cvt_pk_bf16_f32 v234, v244, v245
    s_waitcnt lgkmcnt(9)
    v_mfma_f32_16x16x32_bf16 v[128:131], v[112:115], a[32:35], v[128:131]
    ds_read_b64_tr_b16 v[84:85], v36 offset:57344
    v_mfma_f32_16x16x32_bf16 v[128:131], v[116:119], a[48:51], v[128:131]
    v_cvt_pk_bf16_f32 v235, v246, v247
    v_cvt_pk_bf16_f32 v236, v248, v249
    v_mfma_f32_16x16x32_bf16 v[136:139], v[112:115], a[36:39], v[136:139]
    ds_read_b64_tr_b16 v[86:87], v36 offset:58368
    v_mfma_f32_16x16x32_bf16 v[136:139], v[116:119], a[52:55], v[136:139]
    v_cvt_pk_bf16_f32 v237, v250, v251
    v_mfma_f32_16x16x32_bf16 v[144:147], v[112:115], a[40:43], v[144:147]
    ds_read_b64_tr_b16 v[88:89], v37 offset:49152
    v_cvt_pk_bf16_f32 v238, v252, v253
    v_mfma_f32_16x16x32_bf16 v[144:147], v[116:119], a[56:59], v[144:147]
    ds_read_b64_tr_b16 v[90:91], v37 offset:50176
    v_cvt_pk_bf16_f32 v239, v254, v255
    v_mfma_f32_16x16x32_bf16 v[152:155], v[112:115], a[44:47], v[152:155]
    v_mfma_f32_16x16x32_bf16 v[152:155], v[116:119], a[60:63], v[152:155]
    ds_read_b64_tr_b16 v[92:93], v37 offset:57344
    v_mfma_f32_16x16x32_bf16 v[132:135], v[120:123], a[32:35], v[132:135]
    s_add_u32 s5, s75, 0x3000
    buffer_store_dwordx4 v[224:227], v14, s[64:67], s5 offen offset:0 sc1
    v_mfma_f32_16x16x32_bf16 v[132:135], v[124:127], a[48:51], v[132:135]
    ds_read_b64_tr_b16 v[94:95], v37 offset:58368
    v_mfma_f32_16x16x32_bf16 v[140:143], v[120:123], a[36:39], v[140:143]
    buffer_store_dwordx4 v[228:231], v14, s[64:67], s5 offen offset:1024 sc1
    v_mfma_f32_16x16x32_bf16 v[140:143], v[124:127], a[52:55], v[140:143]
    buffer_store_dwordx4 v[232:235], v14, s[64:67], s5 offen offset:2048 sc1
    buffer_store_dwordx4 v[236:239], v14, s[64:67], s5 offen offset:3072 sc1
    v_mfma_f32_16x16x32_bf16 v[148:151], v[120:123], a[40:43], v[148:151]
    v_mfma_f32_16x16x32_bf16 v[148:151], v[124:127], a[56:59], v[148:151]
    v_mfma_f32_16x16x32_bf16 v[156:159], v[120:123], a[44:47], v[156:159]
    v_mfma_f32_16x16x32_bf16 v[156:159], v[124:127], a[60:63], v[156:159]
    v_add_u32 v36, 0x10000, v36
    v_add_u32 v37, 0x10000, v37
    s_waitcnt lgkmcnt(8)
    v_mfma_f32_16x16x32_bf16 v[128:131], v[64:67], a[64:67], v[128:131]
    ds_read_b64_tr_b16 v[96:97], v36 offset:0
    v_mfma_f32_16x16x32_bf16 v[128:131], v[68:71], a[80:83], v[128:131]
    ds_read_b64_tr_b16 v[98:99], v36 offset:1024
    v_mfma_f32_16x16x32_bf16 v[136:139], v[64:67], a[68:71], v[136:139]
    v_mfma_f32_16x16x32_bf16 v[136:139], v[68:71], a[84:87], v[136:139]
    ds_read_b64_tr_b16 v[100:101], v36 offset:8192
    v_mfma_f32_16x16x32_bf16 v[144:147], v[64:67], a[72:75], v[144:147]
    v_mfma_f32_16x16x32_bf16 v[144:147], v[68:71], a[88:91], v[144:147]
    ds_read_b64_tr_b16 v[102:103], v36 offset:9216
    v_mfma_f32_16x16x32_bf16 v[152:155], v[64:67], a[76:79], v[152:155]
    ds_read_b64_tr_b16 v[104:105], v37 offset:0
    v_mfma_f32_16x16x32_bf16 v[152:155], v[68:71], a[92:95], v[152:155]
    v_mfma_f32_16x16x32_bf16 v[132:135], v[72:75], a[64:67], v[132:135]
    ds_read_b64_tr_b16 v[106:107], v37 offset:1024
    v_mfma_f32_16x16x32_bf16 v[132:135], v[76:79], a[80:83], v[132:135]
    v_mfma_f32_16x16x32_bf16 v[140:143], v[72:75], a[68:71], v[140:143]
    ds_read_b64_tr_b16 v[108:109], v37 offset:8192
    v_mfma_f32_16x16x32_bf16 v[140:143], v[76:79], a[84:87], v[140:143]
    ds_read_b64_tr_b16 v[110:111], v37 offset:9216
    v_mfma_f32_16x16x32_bf16 v[148:151], v[72:75], a[72:75], v[148:151]
    v_mfma_f32_16x16x32_bf16 v[148:151], v[76:79], a[88:91], v[148:151]
    ds_read_b64_tr_b16 v[112:113], v36 offset:16384
    v_mfma_f32_16x16x32_bf16 v[156:159], v[72:75], a[76:79], v[156:159]
    v_mfma_f32_16x16x32_bf16 v[156:159], v[76:79], a[92:95], v[156:159]
    ds_read_b64_tr_b16 v[114:115], v36 offset:17408
    s_waitcnt lgkmcnt(9)
    v_mfma_f32_16x16x32_bf16 v[128:131], v[80:83], a[96:99], v[128:131]
    ds_read_b64_tr_b16 v[116:117], v36 offset:24576
    v_mfma_f32_16x16x32_bf16 v[128:131], v[84:87], a[112:115], v[128:131]
    v_mfma_f32_16x16x32_bf16 v[136:139], v[80:83], a[100:103], v[136:139]
    ds_read_b64_tr_b16 v[118:119], v36 offset:25600
    v_mfma_f32_16x16x32_bf16 v[136:139], v[84:87], a[116:119], v[136:139]
    v_mfma_f32_16x16x32_bf16 v[144:147], v[80:83], a[104:107], v[144:147]
    ds_read_b64_tr_b16 v[120:121], v37 offset:16384
    v_mfma_f32_16x16x32_bf16 v[144:147], v[84:87], a[120:123], v[144:147]
    ds_read_b64_tr_b16 v[122:123], v37 offset:17408
    v_mfma_f32_16x16x32_bf16 v[152:155], v[80:83], a[108:111], v[152:155]
    v_mfma_f32_16x16x32_bf16 v[152:155], v[84:87], a[124:127], v[152:155]
    ds_read_b64_tr_b16 v[124:125], v37 offset:24576
    v_mfma_f32_16x16x32_bf16 v[132:135], v[88:91], a[96:99], v[132:135]
    v_mfma_f32_16x16x32_bf16 v[132:135], v[92:95], a[112:115], v[132:135]
    ds_read_b64_tr_b16 v[126:127], v37 offset:25600
    v_mfma_f32_16x16x32_bf16 v[140:143], v[88:91], a[100:103], v[140:143]
    v_mfma_f32_16x16x32_bf16 v[140:143], v[92:95], a[116:119], v[140:143]
    v_mfma_f32_16x16x32_bf16 v[148:151], v[88:91], a[104:107], v[148:151]
    v_mfma_f32_16x16x32_bf16 v[148:151], v[92:95], a[120:123], v[148:151]
    v_mfma_f32_16x16x32_bf16 v[156:159], v[88:91], a[108:111], v[156:159]
    v_mfma_f32_16x16x32_bf16 v[156:159], v[92:95], a[124:127], v[156:159]
    s_waitcnt lgkmcnt(8)
    v_mfma_f32_16x16x32_bf16 v[128:131], v[96:99], a[128:131], v[128:131]
    v_mfma_f32_16x16x32_bf16 v[128:131], v[100:103], a[144:147], v[128:131]
    v_mfma_f32_16x16x32_bf16 v[136:139], v[96:99], a[132:135], v[136:139]
    v_mfma_f32_16x16x32_bf16 v[136:139], v[100:103], a[148:151], v[136:139]
    v_mfma_f32_16x16x32_bf16 v[144:147], v[96:99], a[136:139], v[144:147]
    v_mfma_f32_16x16x32_bf16 v[144:147], v[100:103], a[152:155], v[144:147]
    v_mfma_f32_16x16x32_bf16 v[152:155], v[96:99], a[140:143], v[152:155]
    v_mfma_f32_16x16x32_bf16 v[152:155], v[100:103], a[156:159], v[152:155]
    v_mfma_f32_16x16x32_bf16 v[132:135], v[104:107], a[128:131], v[132:135]
    v_mfma_f32_16x16x32_bf16 v[132:135], v[108:111], a[144:147], v[132:135]
    v_mfma_f32_16x16x32_bf16 v[140:143], v[104:107], a[132:135], v[140:143]
    v_mfma_f32_16x16x32_bf16 v[140:143], v[108:111], a[148:151], v[140:143]
    v_mfma_f32_16x16x32_bf16 v[148:151], v[104:107], a[136:139], v[148:151]
    v_mfma_f32_16x16x32_bf16 v[148:151], v[108:111], a[152:155], v[148:151]
    v_mfma_f32_16x16x32_bf16 v[156:159], v[104:107], a[140:143], v[156:159]
    v_mfma_f32_16x16x32_bf16 v[156:159], v[108:111], a[156:159], v[156:159]
    s_waitcnt lgkmcnt(6)
    v_mfma_f32_16x16x32_bf16 v[128:131], v[112:115], a[160:163], v[128:131]
    s_waitcnt lgkmcnt(4)
    v_mfma_f32_16x16x32_bf16 v[128:131], v[116:119], a[176:179], v[128:131]
    v_mfma_f32_16x16x32_bf16 v[136:139], v[112:115], a[164:167], v[136:139]
    v_mfma_f32_16x16x32_bf16 v[136:139], v[116:119], a[180:183], v[136:139]
    v_mfma_f32_16x16x32_bf16 v[144:147], v[112:115], a[168:171], v[144:147]
    v_mfma_f32_16x16x32_bf16 v[144:147], v[116:119], a[184:187], v[144:147]
    v_mfma_f32_16x16x32_bf16 v[152:155], v[112:115], a[172:175], v[152:155]
    v_mfma_f32_16x16x32_bf16 v[152:155], v[116:119], a[188:191], v[152:155]
    s_waitcnt lgkmcnt(2)
    v_mfma_f32_16x16x32_bf16 v[132:135], v[120:123], a[160:163], v[132:135]
    s_waitcnt lgkmcnt(0)
    v_mfma_f32_16x16x32_bf16 v[132:135], v[124:127], a[176:179], v[132:135]
    v_mfma_f32_16x16x32_bf16 v[140:143], v[120:123], a[164:167], v[140:143]
    v_mfma_f32_16x16x32_bf16 v[140:143], v[124:127], a[180:183], v[140:143]
    v_mfma_f32_16x16x32_bf16 v[148:151], v[120:123], a[168:171], v[148:151]
    v_mfma_f32_16x16x32_bf16 v[148:151], v[124:127], a[184:187], v[148:151]
    v_mfma_f32_16x16x32_bf16 v[156:159], v[120:123], a[172:175], v[156:159]
    v_mfma_f32_16x16x32_bf16 v[156:159], v[124:127], a[188:191], v[156:159]
    s_waitcnt vmcnt(12)
    ds_read_b64_tr_b16 v[64:65], v34 offset:0
    ds_read_b64_tr_b16 v[66:67], v34 offset:2048
    ds_read_b64_tr_b16 v[68:69], v34 offset:32
    ds_read_b64_tr_b16 v[70:71], v34 offset:2080
    ds_read_b64_tr_b16 v[72:73], v34 offset:64
    ds_read_b64_tr_b16 v[74:75], v34 offset:2112
    ds_read_b64_tr_b16 v[76:77], v34 offset:96
    ds_read_b64_tr_b16 v[78:79], v34 offset:2144
    s_waitcnt vmcnt(0)
    s_mov_b64 exec, 1
    buffer_store_dword v5, v4, s[64:67], s74 offen sc1
    s_mov_b64 exec, -1
    buffer_load_dword v32, v33, s[64:67], 0 offen sc1
    s_waitcnt lgkmcnt(7)
    v_lshlrev_b32_e64 v80, 16, v64
    v_and_b32 v81, 0xffff0000, v64
    v_lshlrev_b32_e64 v82, 16, v44
    v_and_b32 v83, 0xffff0000, v44
    v_pk_fma_f32 v[128:129], v[80:81], v[82:83], v[128:129]
    v_lshlrev_b32_e64 v84, 16, v65
    v_and_b32 v85, 0xffff0000, v65
    v_lshlrev_b32_e64 v86, 16, v45
    v_and_b32 v87, 0xffff0000, v45
    v_pk_fma_f32 v[130:131], v[84:85], v[86:87], v[130:131]
    s_waitcnt lgkmcnt(6)
    v_lshlrev_b32 v88, 16, v66
    v_and_b32 v89, 0xffff0000, v66
    v_lshlrev_b32_e64 v90, 16, v46
    v_and_b32 v91, 0xffff0000, v46
    v_pk_fma_f32 v[132:133], v[88:89], v[90:91], v[132:133]
    v_lshlrev_b32_e64 v92, 16, v67
    v_and_b32 v93, 0xffff0000, v67
    v_lshlrev_b32_e64 v94, 16, v47
    v_and_b32 v95, 0xffff0000, v47
    v_pk_fma_f32 v[134:135], v[92:93], v[94:95], v[134:135]
    s_waitcnt lgkmcnt(5)
    v_lshlrev_b32 v80, 16, v68
    v_and_b32 v81, 0xffff0000, v68
    v_lshlrev_b32_e64 v82, 16, v48
    v_and_b32 v83, 0xffff0000, v48
    v_pk_fma_f32 v[136:137], v[80:81], v[82:83], v[136:137]
    v_lshlrev_b32_e64 v84, 16, v69
    v_and_b32 v85, 0xffff0000, v69
    v_lshlrev_b32_e64 v86, 16, v49
    v_and_b32 v87, 0xffff0000, v49
    v_pk_fma_f32 v[138:139], v[84:85], v[86:87], v[138:139]
    s_waitcnt lgkmcnt(4)
    v_lshlrev_b32 v88, 16, v70
    v_and_b32 v89, 0xffff0000, v70
    v_lshlrev_b32_e64 v90, 16, v50
    v_and_b32 v91, 0xffff0000, v50
    v_pk_fma_f32 v[140:141], v[88:89], v[90:91], v[140:141]
    v_lshlrev_b32_e64 v92, 16, v71
    v_and_b32 v93, 0xffff0000, v71
    v_lshlrev_b32_e64 v94, 16, v51
    v_and_b32 v95, 0xffff0000, v51
    v_pk_fma_f32 v[142:143], v[92:93], v[94:95], v[142:143]
    s_waitcnt lgkmcnt(3)
    v_lshlrev_b32 v80, 16, v72
    v_and_b32 v81, 0xffff0000, v72
    v_lshlrev_b32_e64 v82, 16, v52
    v_and_b32 v83, 0xffff0000, v52
    v_pk_fma_f32 v[144:145], v[80:81], v[82:83], v[144:145]
    v_lshlrev_b32_e64 v84, 16, v73
    v_and_b32 v85, 0xffff0000, v73
    v_lshlrev_b32_e64 v86, 16, v53
    v_and_b32 v87, 0xffff0000, v53
    v_pk_fma_f32 v[146:147], v[84:85], v[86:87], v[146:147]
    s_waitcnt lgkmcnt(2)
    v_lshlrev_b32 v88, 16, v74
    v_and_b32 v89, 0xffff0000, v74
    v_lshlrev_b32_e64 v90, 16, v54
    v_and_b32 v91, 0xffff0000, v54
    v_pk_fma_f32 v[148:149], v[88:89], v[90:91], v[148:149]
    v_lshlrev_b32_e64 v92, 16, v75
    v_and_b32 v93, 0xffff0000, v75
    v_lshlrev_b32_e64 v94, 16, v55
    v_and_b32 v95, 0xffff0000, v55
    v_pk_fma_f32 v[150:151], v[92:93], v[94:95], v[150:151]
    s_waitcnt lgkmcnt(1)
    v_lshlrev_b32 v80, 16, v76
    v_and_b32 v81, 0xffff0000, v76
    v_lshlrev_b32_e64 v82, 16, v56
    v_and_b32 v83, 0xffff0000, v56
    v_pk_fma_f32 v[152:153], v[80:81], v[82:83], v[152:153]
    v_lshlrev_b32_e64 v84, 16, v77
    v_and_b32 v85, 0xffff0000, v77
    v_lshlrev_b32_e64 v86, 16, v57
    v_and_b32 v87, 0xffff0000, v57
    v_pk_fma_f32 v[154:155], v[84:85], v[86:87], v[154:155]
    s_waitcnt lgkmcnt(0)
    v_lshlrev_b32 v88, 16, v78
    v_and_b32 v89, 0xffff0000, v78
    v_lshlrev_b32_e64 v90, 16, v58
    v_and_b32 v91, 0xffff0000, v58
    v_pk_fma_f32 v[156:157], v[88:89], v[90:91], v[156:157]
    v_lshlrev_b32_e64 v92, 16, v79
    v_and_b32 v93, 0xffff0000, v79
    v_lshlrev_b32_e64 v94, 16, v59
    v_and_b32 v95, 0xffff0000, v59
    v_pk_fma_f32 v[158:159], v[92:93], v[94:95], v[158:159]
    s_waitcnt vmcnt(0)
    v_cmp_ne_u32 vcc, 0, v32
    s_nop 0
    s_cmp_eq_u64 vcc, -1
    s_cbranch_scc0 XF_SLOW
XF_OK:
    s_xor_b32 s4, s75, 0x20000
    s_add_u32 s4, s4, 0x1000
    buffer_load_dwordx4 v[176:179], v14, s[64:67], s4 offen offset:0 sc1
    s_xor_b32 s5, s75, 0x40000
    s_add_u32 s5, s5, 0x2000
    buffer_load_dwordx4 v[208:211], v14, s[64:67], s5 offen offset:0 sc1
    s_xor_b32 s6, s75, 0x60000
    s_add_u32 s6, s6, 0x3000
    buffer_load_dwordx4 v[240:243], v14, s[64:67], s6 offen offset:0 sc1
    buffer_load_dwordx4 v[180:183], v14, s[64:67], s4 offen offset:1024 sc1
    buffer_load_dwordx4 v[212:215], v14, s[64:67], s5 offen offset:1024 sc1
    buffer_load_dwordx4 v[244:247], v14, s[64:67], s6 offen offset:1024 sc1
    buffer_load_dwordx4 v[184:187], v14, s[64:67], s4 offen offset:2048 sc1
    buffer_load_dwordx4 v[216:219], v14, s[64:67], s5 offen offset:2048 sc1
    buffer_load_dwordx4 v[248:251], v14, s[64:67], s6 offen offset:2048 sc1
    buffer_load_dwordx4 v[188:191], v14, s[64:67], s4 offen offset:3072 sc1
    buffer_load_dwordx4 v[220:223], v14, s[64:67], s5 offen offset:3072 sc1
    buffer_load_dwordx4 v[252:255], v14, s[64:67], s6 offen offset:3072 sc1
    s_waitcnt vmcnt(11)
    v_dot2_f32_bf16 v128, v176, v60, v128
    v_dot2_f32_bf16 v129, v176, v61, v129
    v_dot2_f32_bf16 v130, v177, v60, v130
    v_dot2_f32_bf16 v131, v177, v61, v131
    v_dot2_f32_bf16 v132, v178, v60, v132
    v_dot2_f32_bf16 v133, v178, v61, v133
    v_dot2_f32_bf16 v134, v179, v60, v134
    v_dot2_f32_bf16 v135, v179, v61, v135
    s_waitcnt vmcnt(10)
    v_dot2_f32_bf16 v128, v208, v60, v128
    v_dot2_f32_bf16 v129, v208, v61, v129
    v_dot2_f32_bf16 v130, v209, v60, v130
    v_dot2_f32_bf16 v131, v209, v61, v131
    v_dot2_f32_bf16 v132, v210, v60, v132
    v_dot2_f32_bf16 v133, v210, v61, v133
    v_dot2_f32_bf16 v134, v211, v60, v134
    v_dot2_f32_bf16 v135, v211, v61, v135
    s_waitcnt vmcnt(9)
    v_dot2_f32_bf16 v128, v240, v60, v128
    v_dot2_f32_bf16 v129, v240, v61, v129
    v_dot2_f32_bf16 v130, v241, v60, v130
    v_dot2_f32_bf16 v131, v241, v61, v131
    v_dot2_f32_bf16 v132, v242, v60, v132
    v_dot2_f32_bf16 v133, v242, v61, v133
    v_dot2_f32_bf16 v134, v243, v60, v134
    v_dot2_f32_bf16 v135, v243, v61, v135
    s_nop 2
    v_cvt_pk_bf16_f32 v64, v128, v129
    v_cvt_pk_bf16_f32 v65, v130, v131
    v_cvt_pk_bf16_f32 v66, v132, v133
    v_cvt_pk_bf16_f32 v67, v134, v135
    s_nop 0
    v_permlane16_swap_b32 v64, v66
    v_permlane16_swap_b32 v65, v67
    buffer_store_dwordx4 v[64:67], v15, s[8:11], s72 offen offset:0
    s_waitcnt vmcnt(9)
    v_dot2_f32_bf16 v136, v180, v60, v136
    v_dot2_f32_bf16 v137, v180, v61, v137
    v_dot2_f32_bf16 v138, v181, v60, v138
    v_dot2_f32_bf16 v139, v181, v61, v139
    v_dot2_f32_bf16 v140, v182, v60, v140
    v_dot2_f32_bf16 v141, v182, v61, v141
    v_dot2_f32_bf16 v142, v183, v60, v142
    v_dot2_f32_bf16 v143, v183, v61, v143
    s_waitcnt vmcnt(8)
    v_dot2_f32_bf16 v136, v212, v60, v136
    v_dot2_f32_bf16 v137, v212, v61, v137
    v_dot2_f32_bf16 v138, v213, v60, v138
    v_dot2_f32_bf16 v139, v213, v61, v139
    v_dot2_f32_bf16 v140, v214, v60, v140
    v_dot2_f32_bf16 v141, v214, v61, v141
    v_dot2_f32_bf16 v142, v215, v60, v142
    v_dot2_f32_bf16 v143, v215, v61, v143
    s_waitcnt vmcnt(7)
    v_dot2_f32_bf16 v136, v244, v60, v136
    v_dot2_f32_bf16 v137, v244, v61, v137
    v_dot2_f32_bf16 v138, v245, v60, v138
    v_dot2_f32_bf16 v139, v245, v61, v139
    v_dot2_f32_bf16 v140, v246, v60, v140
    v_dot2_f32_bf16 v141, v246, v61, v141
    v_dot2_f32_bf16 v142, v247, v60, v142
    v_dot2_f32_bf16 v143, v247, v61, v143
    s_nop 2
    v_cvt_pk_bf16_f32 v68, v136, v137
    v_cvt_pk_bf16_f32 v69, v138, v139
    v_cvt_pk_bf16_f32 v70, v140, v141
    v_cvt_pk_bf16_f32 v71, v142, v143
    s_nop 0
    v_permlane16_swap_b32 v68, v70
    v_permlane16_swap_b32 v69, v71
    buffer_store_dwordx4 v[68:71], v15, s[8:11], s72 offen offset:2048
    s_waitcnt vmcnt(7)
    v_dot2_f32_bf16 v144, v184, v60, v144
    v_dot2_f32_bf16 v145, v184, v61, v145
    v_dot2_f32_bf16 v146, v185, v60, v146
    v_dot2_f32_bf16 v147, v185, v61, v147
    v_dot2_f32_bf16 v148, v186, v60, v148
    v_dot2_f32_bf16 v149, v186, v61, v149
    v_dot2_f32_bf16 v150, v187, v60, v150
    v_dot2_f32_bf16 v151, v187, v61, v151
    s_waitcnt vmcnt(6)
    v_dot2_f32_bf16 v144, v216, v60, v144
    v_dot2_f32_bf16 v145, v216, v61, v145
    v_dot2_f32_bf16 v146, v217, v60, v146
    v_dot2_f32_bf16 v147, v217, v61, v147
    v_dot2_f32_bf16 v148, v218, v60, v148
    v_dot2_f32_bf16 v149, v218, v61, v149
    v_dot2_f32_bf16 v150, v219, v60, v150
    v_dot2_f32_bf16 v151, v219, v61, v151
    s_waitcnt vmcnt(5)
    v_dot2_f32_bf16 v144, v248, v60, v144
    v_dot2_f32_bf16 v145, v248, v61, v145
    v_dot2_f32_bf16 v146, v249, v60, v146
    v_dot2_f32_bf16 v147, v249, v61, v147
    v_dot2_f32_bf16 v148, v250, v60, v148
    v_dot2_f32_bf16 v149, v250, v61, v149
    v_dot2_f32_bf16 v150, v251, v60, v150
    v_dot2_f32_bf16 v151, v251, v61, v151
    s_nop 2
    v_cvt_pk_bf16_f32 v72, v144, v145
    v_cvt_pk_bf16_f32 v73, v146, v147
    v_cvt_pk_bf16_f32 v74, v148, v149
    v_cvt_pk_bf16_f32 v75, v150, v151
    s_nop 0
    v_permlane16_swap_b32 v72, v74
    v_permlane16_swap_b32 v73, v75
    buffer_store_dwordx4 v[72:75], v15, s[8:11], s77 offen offset:0
    s_waitcnt vmcnt(5)
    v_dot2_f32_bf16 v152, v188, v60, v152
    v_dot2_f32_bf16 v153, v188, v61, v153
    v_dot2_f32_bf16 v154, v189, v60, v154
    v_dot2_f32_bf16 v155, v189, v61, v155
    v_dot2_f32_bf16 v156, v190, v60, v156
    v_dot2_f32_bf16 v157, v190, v61, v157
    v_dot2_f32_bf16 v158, v191, v60, v158
    v_dot2_f32_bf16 v159, v191, v61, v159
    s_waitcnt vmcnt(4)
    v_dot2_f32_bf16 v152, v220, v60, v152
    v_dot2_f32_bf16 v153, v220, v61, v153
    v_dot2_f32_bf16 v154, v221, v60, v154
    v_dot2_f32_bf16 v155, v221, v61, v155
    v_dot2_f32_bf16 v156, v222, v60, v156
    v_dot2_f32_bf16 v157, v222, v61, v157
    v_dot2_f32_bf16 v158, v223, v60, v158
    v_dot2_f32_bf16 v159, v223, v61, v159
    s_waitcnt vmcnt(3)
    v_dot2_f32_bf16 v152, v252, v60, v152
    v_dot2_f32_bf16 v153, v252, v61, v153
    v_dot2_f32_bf16 v154, v253, v60, v154
    v_dot2_f32_bf16 v155, v253, v61, v155
    v_dot2_f32_bf16 v156, v254, v60, v156
    v_dot2_f32_bf16 v157, v254, v61, v157
    v_dot2_f32_bf16 v158, v255, v60, v158
    v_dot2_f32_bf16 v159, v255, v61, v159
    s_nop 2
    v_cvt_pk_bf16_f32 v76, v152, v153
    v_cvt_pk_bf16_f32 v77, v154, v155
    v_cvt_pk_bf16_f32 v78, v156, v157
    v_cvt_pk_bf16_f32 v79, v158, v159
    s_nop 0
    v_permlane16_swap_b32 v76, v78
    v_permlane16_swap_b32 v77, v79
    buffer_store_dwordx4 v[76:79], v15, s[8:11], s77 offen offset:2048
M_END:
    s_endpgm
G1_HOOK:
    s_cmp_eq_u32 s7, 4
    s_cbranch_scc1 G1_HOOK4
    s_cmp_eq_u32 s7, 6
    s_cbranch_scc1 G1_HOOK6
    v_cmp_ne_u32 vcc, 0, v32
    s_nop 0
    s_cmp_eq_u64 vcc, -1
    s_cbranch_scc0 RDY_SLOW
RDY_OK:
    s_mov_b64 exec, 1
    buffer_store_dword v5, v4, s[64:67], s73 offen sc1
    s_mov_b64 exec, -1
    s_branch G1_BACK
G1_HOOK4:
    buffer_load_dword v32, v4, s[20:23], 0 offen sc1
    s_mov_b64 exec, s[80:81]
    buffer_store_dwordx4 v[20:23], v1, s[64:67], s72 offen offset:0 sc1
    buffer_store_dwordx4 v[40:43], v1, s[64:67], s72 offen offset:512 sc1
    s_mov_b64 exec, -1
    s_branch G1_BACK
G1_HOOK6:
    buffer_load_dword v32, v33, s[64:67], 0 offen sc1
    s_branch G1_BACK
HF_LATE:
    s_waitcnt lgkmcnt(8)
    v_mfma_f32_16x16x32_bf16 v[160:163], a[192:195], a[224:227], v[160:163]
    ds_read2_b64 a[128:131], v12 offset0:48 offset1:49
    v_add_f32_e64 v60, v144, v24
    v_mfma_f32_16x16x32_bf16 v[164:167], a[192:195], a[228:231], v[164:167]
    v_add_f32_e64 v61, v145, v24
    v_cvt_pk_bf16_f32 v60, v60, v61
    v_mfma_f32_16x16x32_bf16 v[164:167], a[196:199], a[224:227], v[164:167]
    ds_read_b128 a[160:163], v18 offset:4416
    v_mfma_f32_16x16x32_bf16 v[168:171], a[192:195], a[232:235], v[168:171]
    v_and_b32 v61, 0xffff0000, v60
    v_lshlrev_b32_e64 v60, 16, v60
    v_mfma_f32_16x16x32_bf16 v[168:171], a[196:199], a[228:231], v[168:171]
    ds_read2_b64 a[132:135], v12 offset0:112 offset1:113
    v_mfma_f32_16x16x32_bf16 v[168:171], a[200:203], a[224:227], v[168:171]
    v_mul_f32 v60, v60, v25
    v_mul_f32 v61, v61, v25
    v_mfma_f32_16x16x32_bf16 v[172:175], a[192:195], a[236:239], v[172:175]
    ds_read_b128 a[164:167], v18 offset:3904
    v_cvt_pk_bf16_f32 v52, v60, v61
    v_mfma_f32_16x16x32_bf16 v[172:175], a[196:199], a[232:235], v[172:175]
    v_add_f32_e64 v62, v146, v24
    v_mfma_f32_16x16x32_bf16 v[172:175], a[200:203], a[228:231], v[172:175]
    ds_read2_b64 a[136:139], v12 offset0:176 offset1:177
    v_add_f32_e64 v63, v147, v24
    v_mfma_f32_16x16x32_bf16 v[172:175], a[204:207], a[224:227], v[172:175]
    v_cvt_pk_bf16_f32 v62, v62, v63
    s_waitcnt lgkmcnt(11)
    v_mfma_f32_16x16x32_bf16 v[176:179], a[192:195], a[240:243], v[176:179]
    ds_read_b128 a[168:171], v18 offset:3392
    v_and_b32 v63, 0xffff0000, v62
    v_mfma_f32_16x16x32_bf16 v[176:179], a[196:199], a[236:239], v[176:179]
    v_lshlrev_b32 v62, 16, v62
    v_mfma_f32_16x16x32_bf16 v[176:179], a[200:203], a[232:235], v[176:179]
    ds_read2_b64 a[140:143], v12 offset0:240 offset1:241
    v_mul_f32_e64 v62, v62, v25
    v_mfma_f32_16x16x32_bf16 v[176:179], a[204:207], a[228:231], v[176:179]
    v_mul_f32_e64 v63, v63, v25
    v_mfma_f32_16x16x32_bf16 v[176:179], a[208:211], a[224:227], v[176:179]
    ds_read_b128 a[172:175], v18 offset:2880
    v_cvt_pk_bf16_f32 v53, v62, v63
    s_waitcnt lgkmcnt(6)
    v_mfma_f32_16x16x32_bf16 v[180:183], a[192:195], a[244:247], v[180:183]
    v_add_f32 v60, v148, v24
    v_add_f32_e64 v61, v149, v24
    v_mfma_f32_16x16x32_bf16 v[180:183], a[196:199], a[240:243], v[180:183]
    ds_read2_b64 a[144:147], v13 offset0:48 offset1:49
    v_mfma_f32_16x16x32_bf16 v[180:183], a[200:203], a[236:239], v[180:183]
    v_cvt_pk_bf16_f32 v60, v60, v61
    v_and_b32 v61, 0xffff0000, v60
    v_mfma_f32_16x16x32_bf16 v[180:183], a[204:207], a[232:235], v[180:183]
    ds_read_b128 a[176:179], v18 offset:2368
    v_mfma_f32_16x16x32_bf16 v[180:183], a[208:211], a[228:231], v[180:183]
    v_lshlrev_b32 v60, 16, v60
    v_mul_f32 v60, v60, v25
    v_mfma_f32_16x16x32_bf16 v[180:183], a[212:215], a[224:227], v[180:183]
    ds_read2_b64 a[148:151], v13 offset0:112 offset1:113
    v_mul_f32_e64 v61, v61, v25
    v_mfma_f32_16x16x32_bf16 v[184:187], a[192:195], a[248:251], v[184:187]
    v_cvt_pk_bf16_f32 v54, v60, v61
    v_mfma_f32_16x16x32_bf16 v[184:187], a[196:199], a[244:247], v[184:187]
    ds_read_b128 a[180:183], v18 offset:1856
    v_add_f32_e64 v62, v150, v24
    v_mfma_f32_16x16x32_bf16 v[184:187], a[200:203], a[240:243], v[184:187]
    v_add_f32_e64 v63, v151, v24
    v_mfma_f32_16x16x32_bf16 v[184:187], a[204:207], a[236:239], v[184:187]
    ds_read2_b64 a[152:155], v13 offset0:176 offset1:177
    v_cvt_pk_bf16_f32 v62, v62, v63
    v_mfma_f32_16x16x32_bf16 v[184:187], a[208:211], a[232:235], v[184:187]
    v_and_b32 v63, 0xffff0000, v62
    v_mfma_f32_16x16x32_bf16 v[184:187], a[212:215], a[228:231], v[184:187]
    ds_read_b128 a[184:187], v18 offset:1344
    v_lshlrev_b32_e64 v62, 16, v62
    v_mfma_f32_16x16x32_bf16 v[184:187], a[216:219], a[224:227], v[184:187]
    v_mul_f32_e64 v62, v62, v25
    v_mfma_f32_16x16x32_bf16 v[188:191], a[192:195], a[252:255], v[188:191]
    ds_read2_b64 a[156:159], v13 offset0:240 offset1:241
    v_mul_f32_e64 v63, v63, v25
    v_mfma_f32_16x16x32_bf16 v[188:191], a[196:199], a[248:251], v[188:191]
    v_cvt_pk_bf16_f32 v55, v62, v63
    v_add_f32_e64 v60, v152, v26
    v_mfma_f32_16x16x32_bf16 v[188:191], a[200:203], a[244:247], v[188:191]
    ds_read_b128 a[188:191], v18 offset:832
    v_mfma_f32_16x16x32_bf16 v[188:191], a[204:207], a[240:243], v[188:191]
    v_add_f32_e64 v61, v153, v26
    v_cvt_pk_bf16_f32 v60, v60, v61
    v_mfma_f32_16x16x32_bf16 v[188:191], a[208:211], a[236:239], v[188:191]
    v_and_b32 v61, 0xffff0000, v60
    v_mfma_f32_16x16x32_bf16 v[188:191], a[212:215], a[232:235], v[188:191]
    v_lshlrev_b32 v60, 16, v60
    v_mul_f32 v60, v60, v27
    v_mfma_f32_16x16x32_bf16 v[188:191], a[216:219], a[228:231], v[188:191]
    v_mul_f32_e64 v61, v61, v27
    v_mfma_f32_16x16x32_bf16 v[188:191], a[220:223], a[224:227], v[188:191]
    v_cvt_pk_bf16_f32 v56, v60, v61
    v_mfma_f32_16x16x32_bf16 v[160:163], a[128:131], a[160:163], v[160:163]
    ds_read2_b64 a[192:195], v12 offset0:56 offset1:57
    v_add_f32 v62, v154, v26
    s_waitcnt lgkmcnt(7)
    v_mfma_f32_16x16x32_bf16 v[164:167], a[128:131], a[164:167], v[164:167]
    v_add_f32_e64 v63, v155, v26
    v_cvt_pk_bf16_f32 v62, v62, v63
    v_mfma_f32_16x16x32_bf16 v[164:167], a[132:135], a[160:163], v[164:167]
    ds_read_b128 a[224:227], v18 offset:4480
    v_and_b32 v63, 0xffff0000, v62
    v_mfma_f32_16x16x32_bf16 v[168:171], a[128:131], a[168:171], v[168:171]
    v_lshlrev_b32 v62, 16, v62
    v_mul_f32 v62, v62, v27
    v_mfma_f32_16x16x32_bf16 v[168:171], a[132:135], a[164:167], v[168:171]
    ds_read2_b64 a[196:199], v12 offset0:120 offset1:121
    v_mul_f32_e64 v63, v63, v27
    v_mfma_f32_16x16x32_bf16 v[168:171], a[136:139], a[160:163], v[168:171]
    v_cvt_pk_bf16_f32 v57, v62, v63
    v_add_f32_e64 v60, v156, v26
    v_mfma_f32_16x16x32_bf16 v[172:175], a[128:131], a[172:175], v[172:175]
    ds_read_b128 a[228:231], v18 offset:3968
    v_add_f32_e64 v61, v157, v26
    v_mfma_f32_16x16x32_bf16 v[172:175], a[132:135], a[168:171], v[172:175]
    v_cvt_pk_bf16_f32 v60, v60, v61
    v_mfma_f32_16x16x32_bf16 v[172:175], a[136:139], a[164:167], v[172:175]
    ds_read2_b64 a[200:203], v12 offset0:184 offset1:185
    v_and_b32 v61, 0xffff0000, v60
    v_mfma_f32_16x16x32_bf16 v[172:175], a[140:143], a[160:163], v[172:175]
    v_lshlrev_b32 v60, 16, v60
    v_mul_f32 v60, v60, v27
    v_mfma_f32_16x16x32_bf16 v[176:179], a[128:131], a[176:179], v[176:179]
    ds_read_b128 a[232:235], v18 offset:3456
    v_mul_f32_e64 v61, v61, v27
    v_mfma_f32_16x16x32_bf16 v[176:179], a[132:135], a[172:175], v[176:179]
    v_cvt_pk_bf16_f32 v58, v60, v61
    v_add_f32_e64 v62, v158, v26
    v_mfma_f32_16x16x32_bf16 v[176:179], a[136:139], a[168:171], v[176:179]
    ds_read2_b64 a[204:207], v12 offset0:248 offset1:249
    v_add_f32_e64 v63, v159, v26
    v_mfma_f32_16x16x32_bf16 v[176:179], a[140:143], a[164:167], v[176:179]
    v_cvt_pk_bf16_f32 v62, v62, v63
    v_and_b32 v63, 0xffff0000, v62
    v_mfma_f32_16x16x32_bf16 v[176:179], a[144:147], a[160:163], v[176:179]
    ds_read_b128 a[236:239], v18 offset:2944
    v_lshlrev_b32 v62, 16, v62
    s_waitcnt lgkmcnt(6)
    v_mfma_f32_16x16x32_bf16 v[180:183], a[128:131], a[180:183], v[180:183]
    v_mul_f32_e64 v62, v62, v27
    v_mfma_f32_16x16x32_bf16 v[180:183], a[132:135], a[176:179], v[180:183]
    ds_read2_b64 a[208:211], v13 offset0:56 offset1:57
    v_mul_f32_e64 v63, v63, v27
    v_mfma_f32_16x16x32_bf16 v[180:183], a[136:139], a[172:175], v[180:183]
    v_cvt_pk_bf16_f32 v59, v62, v63
    v_lshrrev_b32_e64 v35, 3, v1
    v_mfma_f32_16x16x32_bf16 v[180:183], a[140:143], a[168:171], v[180:183]
    ds_read_b128 a[240:243], v18 offset:2432
    v_lshlrev_b32_e64 v35, 12, v35
    v_mfma_f32_16x16x32_bf16 v[180:183], a[144:147], a[164:167], v[180:183]
    v_and_b32_e64 v30, 7, v1
    v_lshl_add_u32 v35, v30, 4, v35
    v_mfma_f32_16x16x32_bf16 v[180:183], a[148:151], a[160:163], v[180:183]
    ds_read2_b64 a[212:215], v13 offset0:120 offset1:121
    s_lshl_b32 s32, s27, 17
    v_mfma_f32_16x16x32_bf16 v[184:187], a[128:131], a[184:187], v[184:187]
    s_lshl_b32 s4, s28, 5
    s_add_u32 s32, s32, s4
    v_mfma_f32_16x16x32_bf16 v[184:187], a[132:135], a[180:183], v[184:187]
    ds_read_b128 a[244:247], v18 offset:1920
    v_mfma_f32_16x16x32_bf16 v[184:187], a[136:139], a[176:179], v[184:187]
    s_add_u32 s32, s32, 0x1c00000
    v_lshrrev_b32 v34, 2, v1
    v_mfma_f32_16x16x32_bf16 v[184:187], a[140:143], a[172:175], v[184:187]
    ds_read2_b64 a[216:219], v13 offset0:184 offset1:185
    v_lshlrev_b32_e64 v34, 7, v34
    v_mfma_f32_16x16x32_bf16 v[184:187], a[144:147], a[168:171], v[184:187]
    v_and_b32_e64 v30, 3, v1
    v_lshl_add_u32 v34, v30, 3, v34
    v_mfma_f32_16x16x32_bf16 v[184:187], a[148:151], a[164:167], v[184:187]
    ds_read_b128 a[248:251], v18 offset:1408
    s_lshl_b32 s33, s3, 12
    v_mfma_f32_16x16x32_bf16 v[184:187], a[152:155], a[160:163], v[184:187]
    s_add_u32 s33, s33, 0x22800
    v_add_u32 v34, s33, v34
    v_mfma_f32_16x16x32_bf16 v[188:191], a[128:131], a[188:191], v[188:191]
    ds_read2_b64 a[220:223], v13 offset0:248 offset1:249
    v_and_b32_e64 v30, 1, v11
    v_mfma_f32_16x16x32_bf16 v[188:191], a[132:135], a[184:187], v[188:191]
    v_lshrrev_b32_e64 v31, 1, v11
    v_mfma_f32_16x16x32_bf16 v[188:191], a[136:139], a[180:183], v[188:191]
    ds_read_b128 a[252:255], v18 offset:896
    v_lshl_add_u32 v30, v30, 1, v31
    v_mfma_f32_16x16x32_bf16 v[188:191], a[140:143], a[176:179], v[188:191]
    v_lshl_add_u32 v15, v30, 4, v15
    s_mov_b32 s8, s56
    v_mfma_f32_16x16x32_bf16 v[188:191], a[144:147], a[172:175], v[188:191]
    s_mov_b32 s9, s57
    s_mov_b32 s10, 0x400000
    v_mfma_f32_16x16x32_bf16 v[188:191], a[148:151], a[168:171], v[188:191]
    s_mov_b32 s11, 0x00020000
    v_lshlrev_b32_e64 v29, 5, v10
    v_mfma_f32_16x16x32_bf16 v[188:191], a[152:155], a[164:167], v[188:191]
    v_lshl_add_u32 v29, v11, 3, v29
    s_lshl_b32 s71, s24, 12
    v_mfma_f32_16x16x32_bf16 v[188:191], a[156:159], a[160:163], v[188:191]
    s_add_u32 s71, s71, 0x1c00000
    s_waitcnt lgkmcnt(0)
    s_barrier
    v_mfma_f32_16x16x32_bf16 v[160:163], a[192:195], a[224:227], v[160:163]
    ds_read_b64_tr_b16 v[64:65], v36 offset:0
    v_mfma_f32_16x16x32_bf16 v[164:167], a[192:195], a[228:231], v[164:167]
    v_mfma_f32_16x16x32_bf16 v[164:167], a[196:199], a[224:227], v[164:167]
    ds_read_b64_tr_b16 v[66:67], v36 offset:1024
    v_mfma_f32_16x16x32_bf16 v[168:171], a[192:195], a[232:235], v[168:171]
    v_mfma_f32_16x16x32_bf16 v[168:171], a[196:199], a[228:231], v[168:171]
    ds_read_b64_tr_b16 v[68:69], v36 offset:8192
    v_mfma_f32_16x16x32_bf16 v[168:171], a[200:203], a[224:227], v[168:171]
    v_mfma_f32_16x16x32_bf16 v[172:175], a[192:195], a[236:239], v[172:175]
    ds_read_b64_tr_b16 v[70:71], v36 offset:9216
    v_mfma_f32_16x16x32_bf16 v[172:175], a[196:199], a[232:235], v[172:175]
    v_mfma_f32_16x16x32_bf16 v[172:175], a[200:203], a[228:231], v[172:175]
    ds_read_b64_tr_b16 v[72:73], v37 offset:0
    v_mfma_f32_16x16x32_bf16 v[172:175], a[204:207], a[224:227], v[172:175]
    v_mfma_f32_16x16x32_bf16 v[176:179], a[192:195], a[240:243], v[176:179]
    ds_read_b64_tr_b16 v[74:75], v37 offset:1024
    v_mfma_f32_16x16x32_bf16 v[176:179], a[196:199], a[236:239], v[176:179]
    v_mfma_f32_16x16x32_bf16 v[176:179], a[200:203], a[232:235], v[176:179]
    ds_read_b64_tr_b16 v[76:77], v37 offset:8192
    v_mfma_f32_16x16x32_bf16 v[176:179], a[204:207], a[228:231], v[176:179]
    v_mfma_f32_16x16x32_bf16 v[176:179], a[208:211], a[224:227], v[176:179]
    ds_read_b64_tr_b16 v[78:79], v37 offset:9216
    v_mfma_f32_16x16x32_bf16 v[180:183], a[192:195], a[244:247], v[180:183]
    v_mfma_f32_16x16x32_bf16 v[180:183], a[196:199], a[240:243], v[180:183]
    ds_read_b64_tr_b16 v[80:81], v36 offset:16384
    v_mfma_f32_16x16x32_bf16 v[180:183], a[200:203], a[236:239], v[180:183]
    v_mfma_f32_16x16x32_bf16 v[180:183], a[204:207], a[232:235], v[180:183]
    ds_read_b64_tr_b16 v[82:83], v36 offset:17408
    v_mfma_f32_16x16x32_bf16 v[180:183], a[208:211], a[228:231], v[180:183]
    v_mfma_f32_16x16x32_bf16 v[180:183], a[212:215], a[224:227], v[180:183]
    ds_read_b64_tr_b16 v[84:85], v36 offset:24576
    v_mfma_f32_16x16x32_bf16 v[184:187], a[192:195], a[248:251], v[184:187]
    v_mfma_f32_16x16x32_bf16 v[184:187], a[196:199], a[244:247], v[184:187]
    ds_read_b64_tr_b16 v[86:87], v36 offset:25600
    v_mfma_f32_16x16x32_bf16 v[184:187], a[200:203], a[240:243], v[184:187]
    v_mfma_f32_16x16x32_bf16 v[184:187], a[204:207], a[236:239], v[184:187]
    ds_read_b64_tr_b16 v[88:89], v37 offset:16384
    v_mfma_f32_16x16x32_bf16 v[184:187], a[208:211], a[232:235], v[184:187]
    v_mfma_f32_16x16x32_bf16 v[184:187], a[212:215], a[228:231], v[184:187]
    ds_read_b64_tr_b16 v[90:91], v37 offset:17408
    v_mfma_f32_16x16x32_bf16 v[184:187], a[216:219], a[224:227], v[184:187]
    v_mfma_f32_16x16x32_bf16 v[188:191], a[192:195], a[252:255], v[188:191]
    ds_read_b64_tr_b16 v[92:93], v37 offset:24576
    v_mfma_f32_16x16x32_bf16 v[188:191], a[196:199], a[248:251], v[188:191]
    v_mfma_f32_16x16x32_bf16 v[188:191], a[200:203], a[244:247], v[188:191]
    ds_read_b64_tr_b16 v[94:95], v37 offset:25600
    v_mfma_f32_16x16x32_bf16 v[188:191], a[204:207], a[240:243], v[188:191]
    v_mfma_f32_16x16x32_bf16 v[188:191], a[208:211], a[236:239], v[188:191]
    v_mfma_f32_16x16x32_bf16 v[188:191], a[212:215], a[232:235], v[188:191]
    v_mfma_f32_16x16x32_bf16 v[188:191], a[216:219], a[228:231], v[188:191]
    v_mfma_f32_16x16x32_bf16 v[188:191], a[220:223], a[224:227], v[188:191]
    v_cvt_pk_bf16_f32 v96, v160, v161
    v_cvt_pk_bf16_f32 v97, v162, v163
    buffer_store_dwordx2 v[96:97], v29, s[64:67], s71 offen offset:0 sc1
    v_cvt_pk_bf16_f32 v98, v164, v165
    v_cvt_pk_bf16_f32 v99, v166, v167
    buffer_store_dwordx2 v[98:99], v29, s[64:67], s71 offen offset:512 sc1
    v_cvt_pk_bf16_f32 v100, v168, v169
    v_cvt_pk_bf16_f32 v101, v170, v171
    buffer_store_dwordx2 v[100:101], v29, s[64:67], s71 offen offset:1024 sc1
    v_cvt_pk_bf16_f32 v102, v172, v173
    v_cvt_pk_bf16_f32 v103, v174, v175
    buffer_store_dwordx2 v[102:103], v29, s[64:67], s71 offen offset:1536 sc1
    v_cvt_pk_bf16_f32 v104, v176, v177
    v_cvt_pk_bf16_f32 v105, v178, v179
    buffer_store_dwordx2 v[104:105], v29, s[64:67], s71 offen offset:2048 sc1
    v_cvt_pk_bf16_f32 v106, v180, v181
    v_cvt_pk_bf16_f32 v107, v182, v183
    buffer_store_dwordx2 v[106:107], v29, s[64:67], s71 offen offset:2560 sc1
    v_cvt_pk_bf16_f32 v108, v184, v185
    v_cvt_pk_bf16_f32 v109, v186, v187
    buffer_store_dwordx2 v[108:109], v29, s[64:67], s71 offen offset:3072 sc1
    v_cvt_pk_bf16_f32 v110, v188, v189
    v_cvt_pk_bf16_f32 v111, v190, v191
    buffer_store_dwordx2 v[110:111], v29, s[64:67], s71 offen offset:3584 sc1
    buffer_load_dword v32, v33, s[64:67], s34 offen sc1
    s_waitcnt vmcnt(0)
    v_cmp_ne_u32 vcc, 0, v32
    s_nop 0
    s_cmp_eq_u64 vcc, -1
    s_cbranch_scc0 HG_SLOW
HG_OK:
    s_lshl_b32 s78, s16, 16
    s_add_u32 s78, s78, s29
    buffer_load_dwordx4 a[0:3], v14, s[64:67], s78 offen offset:0 sc1
    buffer_load_dwordx4 a[4:7], v14, s[64:67], s78 offen offset:1024 sc1
    buffer_load_dwordx4 a[8:11], v14, s[64:67], s78 offen offset:2048 sc1
    buffer_load_dwordx4 a[12:15], v14, s[64:67], s78 offen offset:3072 sc1
    s_add_u32 s78, s78, 16384
    buffer_load_dwordx4 a[16:19], v14, s[64:67], s78 offen offset:0 sc1
    buffer_load_dwordx4 a[20:23], v14, s[64:67], s78 offen offset:1024 sc1
    buffer_load_dwordx4 a[24:27], v14, s[64:67], s78 offen offset:2048 sc1
    buffer_load_dwordx4 a[28:31], v14, s[64:67], s78 offen offset:3072 sc1
    s_add_u32 s78, s78, 16384
    buffer_load_dwordx4 a[32:35], v14, s[64:67], s78 offen offset:0 sc1
    buffer_load_dwordx4 a[36:39], v14, s[64:67], s78 offen offset:1024 sc1
    buffer_load_dwordx4 a[40:43], v14, s[64:67], s78 offen offset:2048 sc1
    buffer_load_dwordx4 a[44:47], v14, s[64:67], s78 offen offset:3072 sc1
    s_add_u32 s78, s78, 16384
    buffer_load_dwordx4 a[48:51], v14, s[64:67], s78 offen offset:0 sc1
    buffer_load_dwordx4 a[52:55], v14, s[64:67], s78 offen offset:1024 sc1
    buffer_load_dwordx4 a[56:59], v14, s[64:67], s78 offen offset:2048 sc1
    buffer_load_dwordx4 a[60:63], v14, s[64:67], s78 offen offset:3072 sc1
    s_branch G2_GO
RDY_SLOW:
    s_mov_b32 s68, 0x40000
RDY_SPIN:
    s_sleep 2
    buffer_load_dword v32, v4, s[20:23], 0 offen sc1
    s_waitcnt vmcnt(0)
    v_cmp_ne_u32 vcc, 0, v32
    s_nop 0
    s_cmp_eq_u64 vcc, -1
    s_cbranch_scc1 RDY_OK
    s_sub_u32 s68, s68, 1
    s_cbranch_scc0 RDY_SPIN
    s_branch RDY_OK
CS_SLOW:
    s_mov_b32 s68, 0x40000
CS_SPIN:
    s_sleep 2
    buffer_load_dword v32, v33, s[64:67], 0 offen sc1
    s_waitcnt vmcnt(0)
    v_cmp_ne_u32 vcc, 0, v32
    s_nop 0
    s_cmp_eq_u64 vcc, -1
    s_cbranch_scc1 CS_OK
    s_sub_u32 s68, s68, 1
    s_cbranch_scc0 CS_SPIN
    s_branch CS_OK
UF_SLOW:
    s_mov_b32 s68, 0x40000
UF_SPIN:
    s_sleep 2
    buffer_load_dword v36, v4, s[64:67], s34 offen sc1
    s_waitcnt vmcnt(0)
    v_cmp_ne_u32 vcc, 0, v36
    s_nop 0
    s_cmp_eq_u64 vcc, -1
    s_cbranch_scc1 UF_OK
    s_sub_u32 s68, s68, 1
    s_cbranch_scc0 UF_SPIN
    s_branch UF_OK
HG_SLOW:
    s_mov_b32 s68, 0x40000
HG_SPIN:
    s_sleep 2
    buffer_load_dword v32, v33, s[64:67], s34 offen sc1
    s_waitcnt vmcnt(0)
    v_cmp_ne_u32 vcc, 0, v32
    s_nop 0
    s_cmp_eq_u64 vcc, -1
    s_cbranch_scc1 HG_OK
    s_sub_u32 s68, s68, 1
    s_cbranch_scc0 HG_SPIN
    s_branch HG_OK
YF_SLOW:
    s_mov_b32 s68, 0x40000
YF_SPIN:
    s_sleep 2
    buffer_load_dword v32, v33, s[64:67], s34 offen sc1
    s_waitcnt vmcnt(0)
    v_cmp_ne_u32 vcc, 0, v32
    s_nop 0
    s_cmp_eq_u64 vcc, -1
    s_cbranch_scc1 YF_OK
    s_sub_u32 s68, s68, 1
    s_cbranch_scc0 YF_SPIN
    s_branch YF_OK
XF_SLOW:
    s_mov_b32 s68, 0x40000
XF_SPIN:
    s_sleep 0
    buffer_load_dword v32, v33, s[64:67], 0 offen sc1
    s_waitcnt vmcnt(0)
    v_cmp_ne_u32 vcc, 0, v32
    s_nop 0
    s_cmp_eq_u64 vcc, -1
    s_cbranch_scc1 XF_OK
    s_sub_u32 s68, s68, 1
    s_cbranch_scc0 XF_SPIN
    s_branch XF_OK
RDZ_SLOW:
    s_mov_b32 s68, 0x40000
RDZ_SPIN:
    s_sleep 2
    buffer_load_dword v13, v4, s[20:23], 0 offen sc1
    s_waitcnt vmcnt(0)
    v_cmp_ne_u32 vcc, 0, v13
    s_nop 0
    s_cmp_eq_u64 vcc, -1
    s_cbranch_scc1 RDZ_OK
    s_sub_u32 s68, s68, 1
    s_cbranch_scc0 RDZ_SPIN
    s_branch RDZ_OK
UG_SLOW:
    s_mov_b32 s68, 0x40000
UG_SPIN:
    s_sleep 2
    buffer_load_dword v36, v4, s[64:67], s34 offen sc1
    s_waitcnt vmcnt(0)
    v_cmp_ne_u32 vcc, 0, v36
    s_nop 0
    s_cmp_eq_u64 vcc, -1
    s_cbranch_scc1 UG_OK
    s_sub_u32 s68, s68, 1
    s_cbranch_scc0 UG_SPIN
    s_branch UG_OK
SIDE:
    s_sub_u32 s62, s2, 224
    s_getpc_b64 s[12:13]
CW_1:
    s_sub_u32 s12, s12, CW_1-parallel_sum__ssm_conv_h3__swiglu_ffn__prompt_kernel
    s_subb_u32 s13, s13, 0
    s_mov_b32 s14, CODE_END-parallel_sum__ssm_conv_h3__swiglu_ffn__prompt_kernel
    s_mov_b32 s15, 0x00020000
    s_bfe_u32 s4, s2, 0x20003
    s_lshl_b32 s4, s4, 2
    s_add_u32 s4, s4, s3
    s_lshl_b32 s4, s4, 10
    buffer_load_dwordx4 v[28:31], v14, s[12:15], s4 offen
    s_add_u32 s4, s4, 0x4000
    buffer_load_dwordx4 v[28:31], v14, s[12:15], s4 offen
    s_add_u32 s4, s4, 0x4000
    buffer_load_dwordx4 v[28:31], v14, s[12:15], s4 offen
    s_add_u32 s4, s4, 0x4000
    buffer_load_dwordx4 v[28:31], v14, s[12:15], s4 offen
    s_add_u32 s4, s4, 0x4000
    buffer_load_dwordx4 v[28:31], v14, s[12:15], s4 offen
    s_add_u32 s4, s4, 0x4000
    s_waitcnt lgkmcnt(0)
    s_mov_b64 s[48:49], s[8:9]
    s_mov_b32 s64, s60
    s_mov_b32 s65, s61
    s_mov_b32 s66, 0x4000000
    s_mov_b32 s67, 0x00020000
    s_mov_b32 s8, s36
    s_mov_b32 s9, s37
    s_mov_b32 s10, 0x400000
    s_mov_b32 s11, 0x00020000
    s_mov_b32 s12, s38
    s_mov_b32 s13, s39
    s_mov_b32 s14, 0x400000
    s_mov_b32 s15, 0x00020000
    s_mov_b32 s16, s40
    s_mov_b32 s17, s41
    s_mov_b32 s18, 0x400000
    s_mov_b32 s19, 0x00020000
    s_mov_b32 s24, s42
    s_mov_b32 s25, s43
    s_mov_b32 s26, 0x2000
    s_mov_b32 s27, 0x00020000
    s_mov_b32 s20, s58
    s_mov_b32 s21, s59
    s_mov_b32 s22, 0x100
    s_mov_b32 s23, 0x00020000
    s_mov_b32 s76, s44
    s_mov_b32 s77, s45
    s_mov_b32 s78, 0x400000
    s_mov_b32 s79, 0x00020000
SD_NOTLB:
    s_lshl_b32 s28, s62, 6
    s_lshl_b32 s4, s3, 4
    s_add_u32 s28, s28, s4
    s_lshl_b32 s30, s28, 11
    s_cmp_eq_u32 s62, 0
    s_cbranch_scc0 SD_NOZ
    v_mov_b32 v32, 0
    v_mov_b32 v33, 0
    v_mov_b32 v34, 0
    v_mov_b32 v35, 0
    s_mul_i32 s4, s3, 9216
    s_add_u32 s4, s4, 0x1020000
    buffer_store_dwordx4 v[32:35], v14, s[64:67], s4 offen sc1
    s_add_u32 s4, s4, 1024
    buffer_store_dwordx4 v[32:35], v14, s[64:67], s4 offen sc1
    s_add_u32 s4, s4, 1024
    buffer_store_dwordx4 v[32:35], v14, s[64:67], s4 offen sc1
    s_add_u32 s4, s4, 1024
    buffer_store_dwordx4 v[32:35], v14, s[64:67], s4 offen sc1
    s_add_u32 s4, s4, 1024
    buffer_store_dwordx4 v[32:35], v14, s[64:67], s4 offen sc1
    s_add_u32 s4, s4, 1024
    buffer_store_dwordx4 v[32:35], v14, s[64:67], s4 offen sc1
    s_add_u32 s4, s4, 1024
    buffer_store_dwordx4 v[32:35], v14, s[64:67], s4 offen sc1
    s_add_u32 s4, s4, 1024
    buffer_store_dwordx4 v[32:35], v14, s[64:67], s4 offen sc1
    s_add_u32 s4, s4, 1024
    buffer_store_dwordx4 v[32:35], v14, s[64:67], s4 offen sc1
    s_add_u32 s4, s4, 1024
    s_waitcnt vmcnt(0)
    s_barrier
    s_mov_b64 exec, 1
    buffer_store_dword v5, v4, s[20:23], 0 offen sc1
    s_mov_b64 exec, -1
SD_NOZ:
    s_and_b32 s63, s62, 1
    s_lshl_b32 s4, s63, 10
    v_add_u32_e64 v16, s4, v14
    v_xor_b32 v17, 0x400, v16
    s_sub_u32 s31, s30, 8192
    s_cselect_b32 s31, 0x40000000, s31
    s_add_u32 s5, s30, 0x0
    buffer_load_dwordx4 v[128:131], v14, s[8:11], s5 offen offset:0
    s_add_u32 s5, s30, 0x0
    buffer_load_dwordx4 v[132:135], v14, s[8:11], s5 offen offset:1024
    s_add_u32 s5, s30, 0x0
    buffer_load_dwordx4 v[136:139], v14, s[8:11], s5 offen offset:2048
    s_add_u32 s5, s30, 0x0
    buffer_load_dwordx4 v[140:143], v14, s[8:11], s5 offen offset:3072
    s_add_u32 s5, s30, 0x1000
    buffer_load_dwordx4 v[144:147], v14, s[8:11], s5 offen offset:0
    s_add_u32 s5, s30, 0x1000
    buffer_load_dwordx4 v[148:151], v14, s[8:11], s5 offen offset:1024
    s_add_u32 s5, s30, 0x1000
    buffer_load_dwordx4 v[152:155], v14, s[8:11], s5 offen offset:2048
    s_add_u32 s5, s30, 0x1000
    buffer_load_dwordx4 v[156:159], v14, s[8:11], s5 offen offset:3072
    s_add_u32 s5, s30, 0x2000
    buffer_load_dwordx4 v[160:163], v14, s[8:11], s5 offen offset:0
    s_add_u32 s5, s30, 0x2000
    buffer_load_dwordx4 v[164:167], v14, s[8:11], s5 offen offset:1024
    s_add_u32 s5, s30, 0x2000
    buffer_load_dwordx4 v[168:171], v14, s[8:11], s5 offen offset:2048
    s_add_u32 s5, s30, 0x2000
    buffer_load_dwordx4 v[172:175], v14, s[8:11], s5 offen offset:3072
    s_add_u32 s5, s30, 0x3000
    buffer_load_dwordx4 v[176:179], v14, s[8:11], s5 offen offset:0
    s_add_u32 s5, s30, 0x3000
    buffer_load_dwordx4 v[180:183], v14, s[8:11], s5 offen offset:1024
    s_add_u32 s5, s30, 0x3000
    buffer_load_dwordx4 v[184:187], v14, s[8:11], s5 offen offset:2048
    s_add_u32 s5, s30, 0x3000
    buffer_load_dwordx4 v[188:191], v14, s[8:11], s5 offen offset:3072
    s_lshr_b32 s80, s28, 5
    s_lshl_b32 s80, s80, 5
    s_bfe_u32 s81, s28, 0x40001
    s_add_u32 s80, s80, s81
    s_lshl_b32 s80, s80, 3
    s_add_u32 s80, s80, 0x1000000
    s_lshl_b32 s74, s62, 2
    s_add_u32 s74, s74, s3
    s_lshl_b32 s75, s74, 12
    s_lshl_b32 s74, s74, 2
    s_add_u32 s74, s74, 0x1022000
    v_mov_b32 v24, 0
    v_mov_b32 v25, 0
    v_mov_b32 v26, 0
    v_mov_b32 v27, 0
    s_lshr_b32 s4, s75, 2
    s_add_u32 s4, s4, 0x1040000
    buffer_store_dwordx4 v[24:27], v14, s[64:67], s4 offen sc1
    s_lshl_b32 s4, s3, 1
    s_sub_u32 s4, 6, s4
    v_and_b32 v22, 7, v1
    v_xor_b32 v21, s4, v22
    v_lshlrev_b32 v18, 10, v1
    v_xor_b32 v19, 1, v21
    v_lshl_add_u32 v19, v19, 4, v18
    v_lshl_add_u32 v18, v21, 4, v18
    v_lshrrev_b32_e64 v23, 3, v1
    v_mul_u32_u24 v21, 4224, v23
    v_lshl_add_u32 v21, v22, 4, v21
    v_lshlrev_b32 v20, 7, v23
    s_lshl_b32 s4, s3, 14
    v_add_u32_e64 v20, s4, v20
    v_lshl_add_u32 v20, v22, 4, v20
    s_mul_i32 s71, s3, 540672
    s_lshl_b32 s4, s62, 7
    s_sub_u32 s71, s71, s4
    s_add_u32 s71, s71, 0x1400f80
    buffer_load_dword v13, v4, s[20:23], 0 offen sc1
    s_add_u32 s5, s30, 0x4000
    buffer_load_dwordx4 v[192:195], v14, s[8:11], s5 offen offset:0
    s_waitcnt vmcnt(18)
    v_lshlrev_b32 v32, 16, v128
    v_and_b32 v33, 0xffff0000, v128
    v_lshlrev_b32_e64 v34, 16, v129
    v_and_b32 v35, 0xffff0000, v129
    v_lshlrev_b32_e64 v36, 16, v130
    v_and_b32 v37, 0xffff0000, v130
    v_lshlrev_b32_e64 v38, 16, v131
    v_and_b32 v39, 0xffff0000, v131
    s_waitcnt vmcnt(17)
    v_lshlrev_b32 v40, 16, v132
    v_and_b32 v41, 0xffff0000, v132
    v_lshlrev_b32_e64 v42, 16, v133
    v_and_b32 v43, 0xffff0000, v133
    v_lshlrev_b32_e64 v44, 16, v134
    v_and_b32 v45, 0xffff0000, v134
    v_lshlrev_b32_e64 v46, 16, v135
    v_and_b32 v47, 0xffff0000, v135
    s_waitcnt vmcnt(16)
    v_lshlrev_b32 v48, 16, v136
    v_and_b32 v49, 0xffff0000, v136
    v_lshlrev_b32_e64 v50, 16, v137
    v_and_b32 v51, 0xffff0000, v137
    v_lshlrev_b32_e64 v52, 16, v138
    v_and_b32 v53, 0xffff0000, v138
    v_lshlrev_b32_e64 v54, 16, v139
    s_add_u32 s5, s30, 0x4000
    buffer_load_dwordx4 v[196:199], v14, s[8:11], s5 offen offset:1024
    v_and_b32 v55, 0xffff0000, v139
    s_waitcnt vmcnt(16)
    v_lshlrev_b32 v56, 16, v140
    v_and_b32 v57, 0xffff0000, v140
    v_lshlrev_b32_e64 v58, 16, v141
    v_and_b32 v59, 0xffff0000, v141
    v_lshlrev_b32_e64 v60, 16, v142
    v_and_b32 v61, 0xffff0000, v142
    v_lshlrev_b32_e64 v62, 16, v143
    v_and_b32 v63, 0xffff0000, v143
    s_waitcnt vmcnt(15)
    v_lshlrev_b32 v64, 16, v144
    v_and_b32 v65, 0xffff0000, v144
    v_lshlrev_b32_e64 v66, 16, v145
    v_and_b32 v67, 0xffff0000, v145
    v_lshlrev_b32_e64 v68, 16, v146
    v_and_b32 v69, 0xffff0000, v146
    v_lshlrev_b32_e64 v70, 16, v147
    v_and_b32 v71, 0xffff0000, v147
    s_waitcnt vmcnt(14)
    v_lshlrev_b32 v72, 16, v148
    v_and_b32 v73, 0xffff0000, v148
    v_lshlrev_b32_e64 v74, 16, v149
    v_and_b32 v75, 0xffff0000, v149
    v_lshlrev_b32_e64 v76, 16, v150
    s_add_u32 s5, s30, 0x4000
    buffer_load_dwordx4 v[200:203], v14, s[8:11], s5 offen offset:2048
    v_and_b32 v77, 0xffff0000, v150
    v_lshlrev_b32_e64 v78, 16, v151
    v_and_b32 v79, 0xffff0000, v151
    s_waitcnt vmcnt(14)
    v_lshlrev_b32 v80, 16, v152
    v_and_b32 v81, 0xffff0000, v152
    v_lshlrev_b32_e64 v82, 16, v153
    v_and_b32 v83, 0xffff0000, v153
    v_lshlrev_b32_e64 v84, 16, v154
    v_and_b32 v85, 0xffff0000, v154
    v_lshlrev_b32_e64 v86, 16, v155
    v_and_b32 v87, 0xffff0000, v155
    s_waitcnt vmcnt(13)
    v_lshlrev_b32 v88, 16, v156
    v_and_b32 v89, 0xffff0000, v156
    v_lshlrev_b32_e64 v90, 16, v157
    v_and_b32 v91, 0xffff0000, v157
    v_lshlrev_b32_e64 v92, 16, v158
    v_and_b32 v93, 0xffff0000, v158
    v_lshlrev_b32_e64 v94, 16, v159
    v_and_b32 v95, 0xffff0000, v159
    v_pk_add_f32 v[96:97], v[32:33], v[34:35]
    v_pk_add_f32 v[98:99], v[48:49], v[50:51]
    v_pk_add_f32 v[100:101], v[64:65], v[66:67]
    s_add_u32 s5, s30, 0x4000
    buffer_load_dwordx4 v[204:207], v14, s[8:11], s5 offen offset:3072
    v_pk_add_f32 v[102:103], v[80:81], v[82:83]
    v_pk_add_f32 v[96:97], v[96:97], v[36:37]
    v_pk_add_f32 v[98:99], v[98:99], v[52:53]
    v_pk_add_f32 v[100:101], v[100:101], v[68:69]
    v_pk_add_f32 v[102:103], v[102:103], v[84:85]
    v_pk_add_f32 v[96:97], v[96:97], v[38:39]
    v_pk_add_f32 v[98:99], v[98:99], v[54:55]
    v_pk_add_f32 v[100:101], v[100:101], v[70:71]
    v_pk_add_f32 v[102:103], v[102:103], v[86:87]
    v_pk_add_f32 v[96:97], v[96:97], v[40:41]
    v_pk_add_f32 v[98:99], v[98:99], v[56:57]
    v_pk_add_f32 v[100:101], v[100:101], v[72:73]
    v_pk_add_f32 v[102:103], v[102:103], v[88:89]
    v_pk_add_f32 v[96:97], v[96:97], v[42:43]
    v_pk_add_f32 v[98:99], v[98:99], v[58:59]
    v_pk_add_f32 v[100:101], v[100:101], v[74:75]
    v_pk_add_f32 v[102:103], v[102:103], v[90:91]
    v_pk_add_f32 v[96:97], v[96:97], v[44:45]
    v_pk_add_f32 v[98:99], v[98:99], v[60:61]
    v_pk_add_f32 v[100:101], v[100:101], v[76:77]
    v_pk_add_f32 v[102:103], v[102:103], v[92:93]
    v_pk_add_f32 v[96:97], v[96:97], v[46:47]
    s_add_u32 s5, s30, 0x5000
    buffer_load_dwordx4 v[208:211], v14, s[8:11], s5 offen offset:0
    v_pk_add_f32 v[98:99], v[98:99], v[62:63]
    v_pk_add_f32 v[100:101], v[100:101], v[78:79]
    v_pk_add_f32 v[102:103], v[102:103], v[94:95]
    v_add_f32 v104, v96, v97
    v_add_f32 v105, v98, v99
    v_add_f32 v106, v100, v101
    v_add_f32 v107, v102, v103
    v_add_f32_dpp v104, v104, v104 quad_perm:[1,0,3,2] row_mask:0xf bank_mask:0xf
    v_add_f32_dpp v105, v105, v105 quad_perm:[1,0,3,2] row_mask:0xf bank_mask:0xf
    v_add_f32_dpp v106, v106, v106 quad_perm:[1,0,3,2] row_mask:0xf bank_mask:0xf
    v_add_f32_dpp v107, v107, v107 quad_perm:[1,0,3,2] row_mask:0xf bank_mask:0xf
    v_add_f32_dpp v104, v104, v104 quad_perm:[2,3,0,1] row_mask:0xf bank_mask:0xf
    v_add_f32_dpp v105, v105, v105 quad_perm:[2,3,0,1] row_mask:0xf bank_mask:0xf
    v_add_f32_dpp v106, v106, v106 quad_perm:[2,3,0,1] row_mask:0xf bank_mask:0xf
    v_add_f32_dpp v107, v107, v107 quad_perm:[2,3,0,1] row_mask:0xf bank_mask:0xf
    v_add_f32_dpp v104, v104, v104 row_half_mirror row_mask:0xf bank_mask:0xf
    v_add_f32_dpp v105, v105, v105 row_half_mirror row_mask:0xf bank_mask:0xf
    v_add_f32_dpp v106, v106, v106 row_half_mirror row_mask:0xf bank_mask:0xf
    v_add_f32_dpp v107, v107, v107 row_half_mirror row_mask:0xf bank_mask:0xf
    v_add_f32_dpp v104, v104, v104 row_mirror row_mask:0xf bank_mask:0xf
    v_add_f32_dpp v105, v105, v105 row_mirror row_mask:0xf bank_mask:0xf
    v_add_f32_dpp v106, v106, v106 row_mirror row_mask:0xf bank_mask:0xf
    s_add_u32 s5, s30, 0x5000
    buffer_load_dwordx4 v[212:215], v14, s[8:11], s5 offen offset:1024
    v_add_f32_dpp v107, v107, v107 row_mirror row_mask:0xf bank_mask:0xf
    v_mov_b32 v108, v104
    v_mov_b32 v109, v105
    v_mov_b32 v110, v106
    v_mov_b32 v111, v107
    v_permlane16_swap_b32 v104, v108
    v_permlane16_swap_b32 v105, v109
    v_permlane16_swap_b32 v106, v110
    v_permlane16_swap_b32 v107, v111
    v_add_f32 v104, v104, v108
    v_add_f32 v105, v105, v109
    v_add_f32 v106, v106, v110
    v_add_f32 v107, v107, v111
    v_mov_b32 v108, v104
    v_mov_b32 v109, v105
    v_mov_b32 v110, v106
    v_mov_b32 v111, v107
    v_permlane32_swap_b32 v104, v108
    v_permlane32_swap_b32 v105, v109
    v_permlane32_swap_b32 v106, v110
    v_permlane32_swap_b32 v107, v111
    v_add_f32_e64 v104, v104, v108
    s_add_u32 s5, s30, 0x5000
    buffer_load_dwordx4 v[216:219], v14, s[8:11], s5 offen offset:2048
    v_add_f32 v105, v105, v109
    v_add_f32 v106, v106, v110
    v_add_f32_e64 v107, v107, v111
    v_mul_f32 v112, 0xba800000, v104
    v_mul_f32 v113, 0xba800000, v105
    v_mul_f32 v114, 0xba800000, v106
    v_mul_f32 v115, 0xba800000, v107
    v_pk_add_f32 v[32:33], v[32:33], v[112:113] op_sel:[0,0] op_sel_hi:[1,0]
    v_pk_add_f32 v[48:49], v[48:49], v[112:113] op_sel:[0,1] op_sel_hi:[1,1]
    v_pk_add_f32 v[64:65], v[64:65], v[114:115] op_sel:[0,0] op_sel_hi:[1,0]
    v_pk_add_f32 v[80:81], v[80:81], v[114:115] op_sel:[0,1] op_sel_hi:[1,1]
    v_pk_mul_f32 v[96:97], v[32:33], v[32:33]
    v_pk_mul_f32 v[98:99], v[48:49], v[48:49]
    v_pk_mul_f32 v[100:101], v[64:65], v[64:65]
    v_pk_mul_f32 v[102:103], v[80:81], v[80:81]
    v_pk_add_f32 v[34:35], v[34:35], v[112:113] op_sel:[0,0] op_sel_hi:[1,0]
    v_pk_add_f32 v[50:51], v[50:51], v[112:113] op_sel:[0,1] op_sel_hi:[1,1]
    v_pk_add_f32 v[66:67], v[66:67], v[114:115] op_sel:[0,0] op_sel_hi:[1,0]
    v_pk_add_f32 v[82:83], v[82:83], v[114:115] op_sel:[0,1] op_sel_hi:[1,1]
    v_pk_fma_f32 v[96:97], v[34:35], v[34:35], v[96:97]
    v_pk_fma_f32 v[98:99], v[50:51], v[50:51], v[98:99]
    v_pk_fma_f32 v[100:101], v[66:67], v[66:67], v[100:101]
    v_pk_fma_f32 v[102:103], v[82:83], v[82:83], v[102:103]
    s_add_u32 s5, s30, 0x5000
    buffer_load_dwordx4 v[220:223], v14, s[8:11], s5 offen offset:3072
    v_pk_add_f32 v[36:37], v[36:37], v[112:113] op_sel:[0,0] op_sel_hi:[1,0]
    v_pk_add_f32 v[52:53], v[52:53], v[112:113] op_sel:[0,1] op_sel_hi:[1,1]
    v_pk_add_f32 v[68:69], v[68:69], v[114:115] op_sel:[0,0] op_sel_hi:[1,0]
    v_pk_add_f32 v[84:85], v[84:85], v[114:115] op_sel:[0,1] op_sel_hi:[1,1]
    v_pk_fma_f32 v[96:97], v[36:37], v[36:37], v[96:97]
    v_pk_fma_f32 v[98:99], v[52:53], v[52:53], v[98:99]
    v_pk_fma_f32 v[100:101], v[68:69], v[68:69], v[100:101]
    v_pk_fma_f32 v[102:103], v[84:85], v[84:85], v[102:103]
    v_pk_add_f32 v[38:39], v[38:39], v[112:113] op_sel:[0,0] op_sel_hi:[1,0]
    v_pk_add_f32 v[54:55], v[54:55], v[112:113] op_sel:[0,1] op_sel_hi:[1,1]
    v_pk_add_f32 v[70:71], v[70:71], v[114:115] op_sel:[0,0] op_sel_hi:[1,0]
    v_pk_add_f32 v[86:87], v[86:87], v[114:115] op_sel:[0,1] op_sel_hi:[1,1]
    v_pk_fma_f32 v[96:97], v[38:39], v[38:39], v[96:97]
    v_pk_fma_f32 v[98:99], v[54:55], v[54:55], v[98:99]
    v_pk_fma_f32 v[100:101], v[70:71], v[70:71], v[100:101]
    v_pk_fma_f32 v[102:103], v[86:87], v[86:87], v[102:103]
    v_pk_add_f32 v[40:41], v[40:41], v[112:113] op_sel:[0,0] op_sel_hi:[1,0]
    v_pk_add_f32 v[56:57], v[56:57], v[112:113] op_sel:[0,1] op_sel_hi:[1,1]
    v_pk_add_f32 v[72:73], v[72:73], v[114:115] op_sel:[0,0] op_sel_hi:[1,0]
    v_pk_add_f32 v[88:89], v[88:89], v[114:115] op_sel:[0,1] op_sel_hi:[1,1]
    v_pk_fma_f32 v[96:97], v[40:41], v[40:41], v[96:97]
    v_pk_fma_f32 v[98:99], v[56:57], v[56:57], v[98:99]
    s_add_u32 s5, s30, 0x6000
    buffer_load_dwordx4 v[224:227], v14, s[8:11], s5 offen offset:0
    v_pk_fma_f32 v[100:101], v[72:73], v[72:73], v[100:101]
    v_pk_fma_f32 v[102:103], v[88:89], v[88:89], v[102:103]
    v_pk_add_f32 v[42:43], v[42:43], v[112:113] op_sel:[0,0] op_sel_hi:[1,0]
    v_pk_add_f32 v[58:59], v[58:59], v[112:113] op_sel:[0,1] op_sel_hi:[1,1]
    v_pk_add_f32 v[74:75], v[74:75], v[114:115] op_sel:[0,0] op_sel_hi:[1,0]
    v_pk_add_f32 v[90:91], v[90:91], v[114:115] op_sel:[0,1] op_sel_hi:[1,1]
    v_pk_fma_f32 v[96:97], v[42:43], v[42:43], v[96:97]
    v_pk_fma_f32 v[98:99], v[58:59], v[58:59], v[98:99]
    v_pk_fma_f32 v[100:101], v[74:75], v[74:75], v[100:101]
    v_pk_fma_f32 v[102:103], v[90:91], v[90:91], v[102:103]
    v_pk_add_f32 v[44:45], v[44:45], v[112:113] op_sel:[0,0] op_sel_hi:[1,0]
    v_pk_add_f32 v[60:61], v[60:61], v[112:113] op_sel:[0,1] op_sel_hi:[1,1]
    v_pk_add_f32 v[76:77], v[76:77], v[114:115] op_sel:[0,0] op_sel_hi:[1,0]
    v_pk_add_f32 v[92:93], v[92:93], v[114:115] op_sel:[0,1] op_sel_hi:[1,1]
    v_pk_fma_f32 v[96:97], v[44:45], v[44:45], v[96:97]
    v_pk_fma_f32 v[98:99], v[60:61], v[60:61], v[98:99]
    v_pk_fma_f32 v[100:101], v[76:77], v[76:77], v[100:101]
    v_pk_fma_f32 v[102:103], v[92:93], v[92:93], v[102:103]
    v_pk_add_f32 v[46:47], v[46:47], v[112:113] op_sel:[0,0] op_sel_hi:[1,0]
    v_pk_add_f32 v[62:63], v[62:63], v[112:113] op_sel:[0,1] op_sel_hi:[1,1]
    v_pk_add_f32 v[78:79], v[78:79], v[114:115] op_sel:[0,0] op_sel_hi:[1,0]
    v_pk_add_f32 v[94:95], v[94:95], v[114:115] op_sel:[0,1] op_sel_hi:[1,1]
    s_add_u32 s5, s30, 0x6000
    buffer_load_dwordx4 v[228:231], v14, s[8:11], s5 offen offset:1024
    v_pk_fma_f32 v[96:97], v[46:47], v[46:47], v[96:97]
    v_pk_fma_f32 v[98:99], v[62:63], v[62:63], v[98:99]
    v_pk_fma_f32 v[100:101], v[78:79], v[78:79], v[100:101]
    v_pk_fma_f32 v[102:103], v[94:95], v[94:95], v[102:103]
    v_add_f32 v104, v96, v97
    v_add_f32 v105, v98, v99
    v_add_f32 v106, v100, v101
    v_add_f32 v107, v102, v103
    v_add_f32_dpp v104, v104, v104 quad_perm:[1,0,3,2] row_mask:0xf bank_mask:0xf
    v_add_f32_dpp v105, v105, v105 quad_perm:[1,0,3,2] row_mask:0xf bank_mask:0xf
    v_add_f32_dpp v106, v106, v106 quad_perm:[1,0,3,2] row_mask:0xf bank_mask:0xf
    v_add_f32_dpp v107, v107, v107 quad_perm:[1,0,3,2] row_mask:0xf bank_mask:0xf
    v_add_f32_dpp v104, v104, v104 quad_perm:[2,3,0,1] row_mask:0xf bank_mask:0xf
    v_add_f32_dpp v105, v105, v105 quad_perm:[2,3,0,1] row_mask:0xf bank_mask:0xf
    v_add_f32_dpp v106, v106, v106 quad_perm:[2,3,0,1] row_mask:0xf bank_mask:0xf
    v_add_f32_dpp v107, v107, v107 quad_perm:[2,3,0,1] row_mask:0xf bank_mask:0xf
    v_add_f32_dpp v104, v104, v104 row_half_mirror row_mask:0xf bank_mask:0xf
    v_add_f32_dpp v105, v105, v105 row_half_mirror row_mask:0xf bank_mask:0xf
    v_add_f32_dpp v106, v106, v106 row_half_mirror row_mask:0xf bank_mask:0xf
    v_add_f32_dpp v107, v107, v107 row_half_mirror row_mask:0xf bank_mask:0xf
    v_add_f32_dpp v104, v104, v104 row_mirror row_mask:0xf bank_mask:0xf
    v_add_f32_dpp v105, v105, v105 row_mirror row_mask:0xf bank_mask:0xf
    s_add_u32 s5, s30, 0x6000
    buffer_load_dwordx4 v[232:235], v14, s[8:11], s5 offen offset:2048
    v_add_f32_dpp v106, v106, v106 row_mirror row_mask:0xf bank_mask:0xf
    v_add_f32_dpp v107, v107, v107 row_mirror row_mask:0xf bank_mask:0xf
    v_mov_b32 v108, v104
    v_mov_b32 v109, v105
    v_mov_b32 v110, v106
    v_mov_b32 v111, v107
    v_permlane16_swap_b32 v104, v108
    v_permlane16_swap_b32 v105, v109
    v_permlane16_swap_b32 v106, v110
    v_permlane16_swap_b32 v107, v111
    v_add_f32 v104, v104, v108
    v_add_f32 v105, v105, v109
    v_add_f32 v106, v106, v110
    v_add_f32 v107, v107, v111
    v_mov_b32 v108, v104
    v_mov_b32 v109, v105
    v_mov_b32 v110, v106
    v_mov_b32 v111, v107
    v_permlane32_swap_b32 v104, v108
    v_permlane32_swap_b32 v105, v109
    v_permlane32_swap_b32 v106, v110
    v_permlane32_swap_b32 v107, v111
    s_add_u32 s5, s30, 0x6000
    buffer_load_dwordx4 v[236:239], v14, s[8:11], s5 offen offset:3072
    v_add_f32 v104, v104, v108
    v_add_f32 v105, v105, v109
    v_add_f32 v106, v106, v110
    v_add_f32 v107, v107, v111
    v_mul_f32 v104, 0x3a800000, v104
    v_mul_f32 v105, 0x3a800000, v105
    v_mul_f32 v106, 0x3a800000, v106
    v_mul_f32 v107, 0x3a800000, v107
    v_cvt_pk_bf16_f32 v108, v112, v104
    v_cvt_pk_bf16_f32 v109, v113, v105
    v_cvt_pk_bf16_f32 v110, v114, v106
    v_cvt_pk_bf16_f32 v111, v115, v107
    v_lshlrev_b32 v116, 16, v108
    v_lshlrev_b32 v120, 16, v109
    v_lshlrev_b32 v118, 16, v110
    v_lshlrev_b32 v122, 16, v111
    v_and_b32 v104, 0xffff0000, v108
    v_and_b32 v105, 0xffff0000, v109
    v_and_b32 v106, 0xffff0000, v110
    v_and_b32 v107, 0xffff0000, v111
    v_add_f32 v104, 0x3727c5ac, v104
    v_add_f32 v105, 0x3727c5ac, v105
    s_add_u32 s5, s30, 0x7000
    buffer_load_dwordx4 v[240:243], v14, s[8:11], s5 offen offset:0
    v_add_f32 v106, 0x3727c5ac, v106
    v_add_f32 v107, 0x3727c5ac, v107
    v_cvt_pk_bf16_f32 v104, v104, v104
    v_cvt_pk_bf16_f32 v105, v105, v105
    v_cvt_pk_bf16_f32 v106, v106, v106
    v_cvt_pk_bf16_f32 v107, v107, v107
    v_and_b32 v104, 0xffff0000, v104
    v_and_b32 v105, 0xffff0000, v105
    v_and_b32 v106, 0xffff0000, v106
    v_and_b32 v107, 0xffff0000, v107
    v_sqrt_f32 v104, v104
    v_sqrt_f32 v105, v105
    v_sqrt_f32 v106, v106
    v_sqrt_f32 v107, v107
    v_cvt_pk_bf16_f32 v104, v104, v104
    v_cvt_pk_bf16_f32 v105, v105, v105
    v_cvt_pk_bf16_f32 v106, v106, v106
    v_cvt_pk_bf16_f32 v107, v107, v107
    v_and_b32 v117, 0xffff0000, v104
    v_and_b32 v121, 0xffff0000, v105
    v_and_b32 v119, 0xffff0000, v106
    v_and_b32 v123, 0xffff0000, v107
    s_mov_b64 exec, 1
    buffer_store_dwordx4 v[116:119], v4, s[64:67], s80 offen offset:0 sc1
    buffer_store_dwordx4 v[120:123], v4, s[64:67], s80 offen offset:128 sc1
    s_mov_b64 exec, -1
    s_add_u32 s5, s30, 0x7000
    buffer_load_dwordx4 v[244:247], v14, s[8:11], s5 offen offset:1024
    s_waitcnt vmcnt(25)
    v_lshlrev_b32 v32, 16, v160
    v_and_b32 v33, 0xffff0000, v160
    v_lshlrev_b32_e64 v34, 16, v161
    v_and_b32 v35, 0xffff0000, v161
    v_lshlrev_b32_e64 v36, 16, v162
    v_and_b32 v37, 0xffff0000, v162
    v_lshlrev_b32_e64 v38, 16, v163
    v_and_b32 v39, 0xffff0000, v163
    s_waitcnt vmcnt(24)
    v_lshlrev_b32 v40, 16, v164
    v_and_b32 v41, 0xffff0000, v164
    v_lshlrev_b32_e64 v42, 16, v165
    v_and_b32 v43, 0xffff0000, v165
    v_lshlrev_b32_e64 v44, 16, v166
    v_and_b32 v45, 0xffff0000, v166
    v_lshlrev_b32_e64 v46, 16, v167
    v_and_b32 v47, 0xffff0000, v167
    s_waitcnt vmcnt(23)
    v_lshlrev_b32 v48, 16, v168
    v_and_b32 v49, 0xffff0000, v168
    v_lshlrev_b32_e64 v50, 16, v169
    v_and_b32 v51, 0xffff0000, v169
    v_lshlrev_b32_e64 v52, 16, v170
    v_and_b32 v53, 0xffff0000, v170
    v_lshlrev_b32_e64 v54, 16, v171
    s_add_u32 s5, s30, 0x7000
    buffer_load_dwordx4 v[248:251], v14, s[8:11], s5 offen offset:2048
    v_and_b32 v55, 0xffff0000, v171
    s_waitcnt vmcnt(23)
    v_lshlrev_b32 v56, 16, v172
    v_and_b32 v57, 0xffff0000, v172
    v_lshlrev_b32_e64 v58, 16, v173
    v_and_b32 v59, 0xffff0000, v173
    v_lshlrev_b32_e64 v60, 16, v174
    v_and_b32 v61, 0xffff0000, v174
    v_lshlrev_b32_e64 v62, 16, v175
    v_and_b32 v63, 0xffff0000, v175
    s_waitcnt vmcnt(22)
    v_lshlrev_b32 v64, 16, v176
    v_and_b32 v65, 0xffff0000, v176
    v_lshlrev_b32_e64 v66, 16, v177
    v_and_b32 v67, 0xffff0000, v177
    v_lshlrev_b32_e64 v68, 16, v178
    v_and_b32 v69, 0xffff0000, v178
    v_lshlrev_b32_e64 v70, 16, v179
    v_and_b32 v71, 0xffff0000, v179
    s_waitcnt vmcnt(21)
    v_lshlrev_b32 v72, 16, v180
    v_and_b32 v73, 0xffff0000, v180
    v_lshlrev_b32_e64 v74, 16, v181
    v_and_b32 v75, 0xffff0000, v181
    v_lshlrev_b32_e64 v76, 16, v182
    s_add_u32 s5, s30, 0x7000
    buffer_load_dwordx4 v[252:255], v14, s[8:11], s5 offen offset:3072
    v_and_b32 v77, 0xffff0000, v182
    v_lshlrev_b32_e64 v78, 16, v183
    v_and_b32 v79, 0xffff0000, v183
    s_waitcnt vmcnt(21)
    v_lshlrev_b32 v80, 16, v184
    v_and_b32 v81, 0xffff0000, v184
    v_lshlrev_b32_e64 v82, 16, v185
    v_and_b32 v83, 0xffff0000, v185
    v_lshlrev_b32_e64 v84, 16, v186
    v_and_b32 v85, 0xffff0000, v186
    v_lshlrev_b32_e64 v86, 16, v187
    v_and_b32 v87, 0xffff0000, v187
    s_waitcnt vmcnt(20)
    v_lshlrev_b32 v88, 16, v188
    v_and_b32 v89, 0xffff0000, v188
    v_lshlrev_b32_e64 v90, 16, v189
    v_and_b32 v91, 0xffff0000, v189
    v_lshlrev_b32_e64 v92, 16, v190
    v_and_b32 v93, 0xffff0000, v190
    v_lshlrev_b32_e64 v94, 16, v191
    v_and_b32 v95, 0xffff0000, v191
    v_pk_add_f32 v[96:97], v[32:33], v[34:35]
    v_pk_add_f32 v[98:99], v[48:49], v[50:51]
    v_pk_add_f32 v[100:101], v[64:65], v[66:67]
    v_lshlrev_b32_e64 v15, 2, v16
    buffer_load_dwordx4 a[216:219], v15, s[24:27], 0 offen offset:0
    buffer_load_dwordx4 a[220:223], v15, s[24:27], 0 offen offset:16
    buffer_load_dwordx4 a[224:227], v15, s[24:27], 0 offen offset:32
    buffer_load_dwordx4 a[228:231], v15, s[24:27], 0 offen offset:48
    v_pk_add_f32 v[102:103], v[80:81], v[82:83]
    v_pk_add_f32 v[96:97], v[96:97], v[36:37]
    v_pk_add_f32 v[98:99], v[98:99], v[52:53]
    v_pk_add_f32 v[100:101], v[100:101], v[68:69]
    v_pk_add_f32 v[102:103], v[102:103], v[84:85]
    v_pk_add_f32 v[96:97], v[96:97], v[38:39]
    v_pk_add_f32 v[98:99], v[98:99], v[54:55]
    v_pk_add_f32 v[100:101], v[100:101], v[70:71]
    v_pk_add_f32 v[102:103], v[102:103], v[86:87]
    v_pk_add_f32 v[96:97], v[96:97], v[40:41]
    v_pk_add_f32 v[98:99], v[98:99], v[56:57]
    v_pk_add_f32 v[100:101], v[100:101], v[72:73]
    v_pk_add_f32 v[102:103], v[102:103], v[88:89]
    v_pk_add_f32 v[96:97], v[96:97], v[42:43]
    v_pk_add_f32 v[98:99], v[98:99], v[58:59]
    v_pk_add_f32 v[100:101], v[100:101], v[74:75]
    v_pk_add_f32 v[102:103], v[102:103], v[90:91]
    v_pk_add_f32 v[96:97], v[96:97], v[44:45]
    v_pk_add_f32 v[98:99], v[98:99], v[60:61]
    v_pk_add_f32 v[100:101], v[100:101], v[76:77]
    v_pk_add_f32 v[102:103], v[102:103], v[92:93]
    v_pk_add_f32 v[96:97], v[96:97], v[46:47]
    s_add_u32 s5, s31, 0x0
    buffer_load_dwordx4 a[0:3], v16, s[12:15], s5 offen offset:2048 nt
    v_pk_add_f32 v[98:99], v[98:99], v[62:63]
    v_pk_add_f32 v[100:101], v[100:101], v[78:79]
    v_pk_add_f32 v[102:103], v[102:103], v[94:95]
    v_add_f32 v104, v96, v97
    v_add_f32 v105, v98, v99
    v_add_f32 v106, v100, v101
    v_add_f32_e64 v107, v102, v103
    v_add_f32_dpp v104, v104, v104 quad_perm:[1,0,3,2] row_mask:0xf bank_mask:0xf
    v_add_f32_dpp v105, v105, v105 quad_perm:[1,0,3,2] row_mask:0xf bank_mask:0xf
    v_add_f32_dpp v106, v106, v106 quad_perm:[1,0,3,2] row_mask:0xf bank_mask:0xf
    v_add_f32_dpp v107, v107, v107 quad_perm:[1,0,3,2] row_mask:0xf bank_mask:0xf
    v_add_f32_dpp v104, v104, v104 quad_perm:[2,3,0,1] row_mask:0xf bank_mask:0xf
    v_add_f32_dpp v105, v105, v105 quad_perm:[2,3,0,1] row_mask:0xf bank_mask:0xf
    v_add_f32_dpp v106, v106, v106 quad_perm:[2,3,0,1] row_mask:0xf bank_mask:0xf
    v_add_f32_dpp v107, v107, v107 quad_perm:[2,3,0,1] row_mask:0xf bank_mask:0xf
    v_add_f32_dpp v104, v104, v104 row_half_mirror row_mask:0xf bank_mask:0xf
    v_add_f32_dpp v105, v105, v105 row_half_mirror row_mask:0xf bank_mask:0xf
    v_add_f32_dpp v106, v106, v106 row_half_mirror row_mask:0xf bank_mask:0xf
    v_add_f32_dpp v107, v107, v107 row_half_mirror row_mask:0xf bank_mask:0xf
    v_add_f32_dpp v104, v104, v104 row_mirror row_mask:0xf bank_mask:0xf
    v_add_f32_dpp v105, v105, v105 row_mirror row_mask:0xf bank_mask:0xf
    v_add_f32_dpp v106, v106, v106 row_mirror row_mask:0xf bank_mask:0xf
    s_add_u32 s5, s31, 0x1000
    buffer_load_dwordx4 a[4:7], v16, s[12:15], s5 offen offset:0 nt
    v_add_f32_dpp v107, v107, v107 row_mirror row_mask:0xf bank_mask:0xf
    v_mov_b32 v108, v104
    v_mov_b32 v109, v105
    v_mov_b32 v110, v106
    v_mov_b32 v111, v107
    v_permlane16_swap_b32 v104, v108
    v_permlane16_swap_b32 v105, v109
    v_permlane16_swap_b32 v106, v110
    v_permlane16_swap_b32 v107, v111
    v_add_f32 v104, v104, v108
    v_add_f32 v105, v105, v109
    v_add_f32 v106, v106, v110
    v_add_f32 v107, v107, v111
    v_mov_b32 v108, v104
    v_mov_b32 v109, v105
    v_mov_b32 v110, v106
    v_mov_b32 v111, v107
    v_permlane32_swap_b32 v104, v108
    v_permlane32_swap_b32 v105, v109
    v_permlane32_swap_b32 v106, v110
    v_permlane32_swap_b32 v107, v111
    v_add_f32_e64 v104, v104, v108
    s_add_u32 s5, s31, 0x1000
    buffer_load_dwordx4 a[8:11], v16, s[12:15], s5 offen offset:2048 nt
    v_add_f32 v105, v105, v109
    v_add_f32 v106, v106, v110
    v_add_f32_e64 v107, v107, v111
    v_mul_f32 v112, 0xba800000, v104
    v_mul_f32 v113, 0xba800000, v105
    v_mul_f32 v114, 0xba800000, v106
    v_mul_f32 v115, 0xba800000, v107
    v_pk_add_f32 v[32:33], v[32:33], v[112:113] op_sel:[0,0] op_sel_hi:[1,0]
    v_pk_add_f32 v[48:49], v[48:49], v[112:113] op_sel:[0,1] op_sel_hi:[1,1]
    v_pk_add_f32 v[64:65], v[64:65], v[114:115] op_sel:[0,0] op_sel_hi:[1,0]
    v_pk_add_f32 v[80:81], v[80:81], v[114:115] op_sel:[0,1] op_sel_hi:[1,1]
    v_pk_mul_f32 v[96:97], v[32:33], v[32:33]
    v_pk_mul_f32 v[98:99], v[48:49], v[48:49]
    v_pk_mul_f32 v[100:101], v[64:65], v[64:65]
    v_pk_mul_f32 v[102:103], v[80:81], v[80:81]
    v_pk_add_f32 v[34:35], v[34:35], v[112:113] op_sel:[0,0] op_sel_hi:[1,0]
    v_pk_add_f32 v[50:51], v[50:51], v[112:113] op_sel:[0,1] op_sel_hi:[1,1]
    v_pk_add_f32 v[66:67], v[66:67], v[114:115] op_sel:[0,0] op_sel_hi:[1,0]
    v_pk_add_f32 v[82:83], v[82:83], v[114:115] op_sel:[0,1] op_sel_hi:[1,1]
    v_pk_fma_f32 v[96:97], v[34:35], v[34:35], v[96:97]
    v_pk_fma_f32 v[98:99], v[50:51], v[50:51], v[98:99]
    v_pk_fma_f32 v[100:101], v[66:67], v[66:67], v[100:101]
    v_pk_fma_f32 v[102:103], v[82:83], v[82:83], v[102:103]
    s_add_u32 s5, s30, 0x0
    buffer_load_dwordx4 a[12:15], v16, s[12:15], s5 offen offset:0 nt
    v_pk_add_f32 v[36:37], v[36:37], v[112:113] op_sel:[0,0] op_sel_hi:[1,0]
    v_pk_add_f32 v[52:53], v[52:53], v[112:113] op_sel:[0,1] op_sel_hi:[1,1]
    v_pk_add_f32 v[68:69], v[68:69], v[114:115] op_sel:[0,0] op_sel_hi:[1,0]
    v_pk_add_f32 v[84:85], v[84:85], v[114:115] op_sel:[0,1] op_sel_hi:[1,1]
    v_pk_fma_f32 v[96:97], v[36:37], v[36:37], v[96:97]
    v_pk_fma_f32 v[98:99], v[52:53], v[52:53], v[98:99]
    v_pk_fma_f32 v[100:101], v[68:69], v[68:69], v[100:101]
    v_pk_fma_f32 v[102:103], v[84:85], v[84:85], v[102:103]
    v_pk_add_f32 v[38:39], v[38:39], v[112:113] op_sel:[0,0] op_sel_hi:[1,0]
    v_pk_add_f32 v[54:55], v[54:55], v[112:113] op_sel:[0,1] op_sel_hi:[1,1]
    v_pk_add_f32 v[70:71], v[70:71], v[114:115] op_sel:[0,0] op_sel_hi:[1,0]
    v_pk_add_f32 v[86:87], v[86:87], v[114:115] op_sel:[0,1] op_sel_hi:[1,1]
    v_pk_fma_f32 v[96:97], v[38:39], v[38:39], v[96:97]
    v_pk_fma_f32 v[98:99], v[54:55], v[54:55], v[98:99]
    v_pk_fma_f32 v[100:101], v[70:71], v[70:71], v[100:101]
    v_pk_fma_f32 v[102:103], v[86:87], v[86:87], v[102:103]
    v_pk_add_f32 v[40:41], v[40:41], v[112:113] op_sel:[0,0] op_sel_hi:[1,0]
    v_pk_add_f32 v[56:57], v[56:57], v[112:113] op_sel:[0,1] op_sel_hi:[1,1]
    v_pk_add_f32 v[72:73], v[72:73], v[114:115] op_sel:[0,0] op_sel_hi:[1,0]
    v_pk_add_f32 v[88:89], v[88:89], v[114:115] op_sel:[0,1] op_sel_hi:[1,1]
    v_pk_fma_f32 v[96:97], v[40:41], v[40:41], v[96:97]
    v_pk_fma_f32 v[98:99], v[56:57], v[56:57], v[98:99]
    s_add_u32 s5, s30, 0x0
    buffer_load_dwordx4 a[76:79], v16, s[16:19], s5 offen offset:0 nt
    v_pk_fma_f32 v[100:101], v[72:73], v[72:73], v[100:101]
    v_pk_fma_f32 v[102:103], v[88:89], v[88:89], v[102:103]
    v_pk_add_f32 v[42:43], v[42:43], v[112:113] op_sel:[0,0] op_sel_hi:[1,0]
    v_pk_add_f32 v[58:59], v[58:59], v[112:113] op_sel:[0,1] op_sel_hi:[1,1]
    v_pk_add_f32 v[74:75], v[74:75], v[114:115] op_sel:[0,0] op_sel_hi:[1,0]
    v_pk_add_f32 v[90:91], v[90:91], v[114:115] op_sel:[0,1] op_sel_hi:[1,1]
    v_pk_fma_f32 v[96:97], v[42:43], v[42:43], v[96:97]
    v_pk_fma_f32 v[98:99], v[58:59], v[58:59], v[98:99]
    v_pk_fma_f32 v[100:101], v[74:75], v[74:75], v[100:101]
    v_pk_fma_f32 v[102:103], v[90:91], v[90:91], v[102:103]
    v_pk_add_f32 v[44:45], v[44:45], v[112:113] op_sel:[0,0] op_sel_hi:[1,0]
    v_pk_add_f32 v[60:61], v[60:61], v[112:113] op_sel:[0,1] op_sel_hi:[1,1]
    v_pk_add_f32 v[76:77], v[76:77], v[114:115] op_sel:[0,0] op_sel_hi:[1,0]
    v_pk_add_f32 v[92:93], v[92:93], v[114:115] op_sel:[0,1] op_sel_hi:[1,1]
    v_pk_fma_f32 v[96:97], v[44:45], v[44:45], v[96:97]
    v_pk_fma_f32 v[98:99], v[60:61], v[60:61], v[98:99]
    v_pk_fma_f32 v[100:101], v[76:77], v[76:77], v[100:101]
    v_pk_fma_f32 v[102:103], v[92:93], v[92:93], v[102:103]
    v_pk_add_f32 v[46:47], v[46:47], v[112:113] op_sel:[0,0] op_sel_hi:[1,0]
    v_pk_add_f32 v[62:63], v[62:63], v[112:113] op_sel:[0,1] op_sel_hi:[1,1]
    v_pk_add_f32 v[78:79], v[78:79], v[114:115] op_sel:[0,0] op_sel_hi:[1,0]
    v_pk_add_f32 v[94:95], v[94:95], v[114:115] op_sel:[0,1] op_sel_hi:[1,1]
    s_add_u32 s5, s30, 0x0
    buffer_load_dwordx4 a[16:19], v16, s[12:15], s5 offen offset:2048 nt
    v_pk_fma_f32 v[96:97], v[46:47], v[46:47], v[96:97]
    v_pk_fma_f32 v[98:99], v[62:63], v[62:63], v[98:99]
    v_pk_fma_f32 v[100:101], v[78:79], v[78:79], v[100:101]
    v_pk_fma_f32 v[102:103], v[94:95], v[94:95], v[102:103]
    v_add_f32 v104, v96, v97
    v_add_f32 v105, v98, v99
    v_add_f32 v106, v100, v101
    v_add_f32_e64 v107, v102, v103
    v_add_f32_dpp v104, v104, v104 quad_perm:[1,0,3,2] row_mask:0xf bank_mask:0xf
    v_add_f32_dpp v105, v105, v105 quad_perm:[1,0,3,2] row_mask:0xf bank_mask:0xf
    v_add_f32_dpp v106, v106, v106 quad_perm:[1,0,3,2] row_mask:0xf bank_mask:0xf
    v_add_f32_dpp v107, v107, v107 quad_perm:[1,0,3,2] row_mask:0xf bank_mask:0xf
    v_add_f32_dpp v104, v104, v104 quad_perm:[2,3,0,1] row_mask:0xf bank_mask:0xf
    v_add_f32_dpp v105, v105, v105 quad_perm:[2,3,0,1] row_mask:0xf bank_mask:0xf
    v_add_f32_dpp v106, v106, v106 quad_perm:[2,3,0,1] row_mask:0xf bank_mask:0xf
    v_add_f32_dpp v107, v107, v107 quad_perm:[2,3,0,1] row_mask:0xf bank_mask:0xf
    v_add_f32_dpp v104, v104, v104 row_half_mirror row_mask:0xf bank_mask:0xf
    v_add_f32_dpp v105, v105, v105 row_half_mirror row_mask:0xf bank_mask:0xf
    v_add_f32_dpp v106, v106, v106 row_half_mirror row_mask:0xf bank_mask:0xf
    v_add_f32_dpp v107, v107, v107 row_half_mirror row_mask:0xf bank_mask:0xf
    v_add_f32_dpp v104, v104, v104 row_mirror row_mask:0xf bank_mask:0xf
    v_add_f32_dpp v105, v105, v105 row_mirror row_mask:0xf bank_mask:0xf
    s_add_u32 s5, s30, 0x0
    buffer_load_dwordx4 a[80:83], v16, s[16:19], s5 offen offset:2048 nt
    v_add_f32_dpp v106, v106, v106 row_mirror row_mask:0xf bank_mask:0xf
    v_add_f32_dpp v107, v107, v107 row_mirror row_mask:0xf bank_mask:0xf
    v_mov_b32 v108, v104
    v_mov_b32 v109, v105
    v_mov_b32 v110, v106
    v_mov_b32 v111, v107
    v_permlane16_swap_b32 v104, v108
    v_permlane16_swap_b32 v105, v109
    v_permlane16_swap_b32 v106, v110
    v_permlane16_swap_b32 v107, v111
    v_add_f32 v104, v104, v108
    v_add_f32 v105, v105, v109
    v_add_f32 v106, v106, v110
    v_add_f32 v107, v107, v111
    v_mov_b32 v108, v104
    v_mov_b32 v109, v105
    v_mov_b32 v110, v106
    v_mov_b32_e64 v111, v107
    v_permlane32_swap_b32 v104, v108
    v_permlane32_swap_b32 v105, v109
    v_permlane32_swap_b32 v106, v110
    v_permlane32_swap_b32 v107, v111
    s_add_u32 s5, s30, 0x1000
    buffer_load_dwordx4 a[20:23], v16, s[12:15], s5 offen offset:0 nt
    v_add_f32 v104, v104, v108
    v_add_f32 v105, v105, v109
    v_add_f32 v106, v106, v110
    v_add_f32 v107, v107, v111
    v_mul_f32 v104, 0x3a800000, v104
    v_mul_f32 v105, 0x3a800000, v105
    v_mul_f32 v106, 0x3a800000, v106
    v_mul_f32 v107, 0x3a800000, v107
    v_cvt_pk_bf16_f32 v108, v112, v104
    v_cvt_pk_bf16_f32 v109, v113, v105
    v_cvt_pk_bf16_f32 v110, v114, v106
    v_cvt_pk_bf16_f32 v111, v115, v107
    v_lshlrev_b32 v116, 16, v108
    v_lshlrev_b32 v120, 16, v109
    v_lshlrev_b32 v118, 16, v110
    v_lshlrev_b32 v122, 16, v111
    v_and_b32 v104, 0xffff0000, v108
    v_and_b32 v105, 0xffff0000, v109
    v_and_b32 v106, 0xffff0000, v110
    v_and_b32 v107, 0xffff0000, v111
    v_add_f32 v104, 0x3727c5ac, v104
    v_add_f32 v105, 0x3727c5ac, v105
    s_add_u32 s5, s30, 0x1000
    buffer_load_dwordx4 a[84:87], v16, s[16:19], s5 offen offset:0 nt
    v_add_f32 v106, 0x3727c5ac, v106
    v_add_f32 v107, 0x3727c5ac, v107
    v_cvt_pk_bf16_f32 v104, v104, v104
    v_cvt_pk_bf16_f32 v105, v105, v105
    v_cvt_pk_bf16_f32 v106, v106, v106
    v_cvt_pk_bf16_f32 v107, v107, v107
    v_and_b32 v104, 0xffff0000, v104
    v_and_b32 v105, 0xffff0000, v105
    v_and_b32 v106, 0xffff0000, v106
    v_and_b32 v107, 0xffff0000, v107
    v_sqrt_f32 v104, v104
    v_sqrt_f32 v105, v105
    v_sqrt_f32 v106, v106
    v_sqrt_f32 v107, v107
    v_cvt_pk_bf16_f32 v104, v104, v104
    v_cvt_pk_bf16_f32 v105, v105, v105
    v_cvt_pk_bf16_f32 v106, v106, v106
    v_cvt_pk_bf16_f32 v107, v107, v107
    v_and_b32 v117, 0xffff0000, v104
    v_and_b32 v121, 0xffff0000, v105
    v_and_b32 v119, 0xffff0000, v106
    v_and_b32 v123, 0xffff0000, v107
    s_mov_b64 exec, 1
    buffer_store_dwordx4 v[116:119], v4, s[64:67], s80 offen offset:16 sc1
    buffer_store_dwordx4 v[120:123], v4, s[64:67], s80 offen offset:144 sc1
    s_mov_b64 exec, -1
    s_add_u32 s5, s30, 0x1000
    buffer_load_dwordx4 a[24:27], v16, s[12:15], s5 offen offset:2048 nt
    s_waitcnt vmcnt(33)
    v_lshlrev_b32 v32, 16, v192
    v_and_b32 v33, 0xffff0000, v192
    v_lshlrev_b32_e64 v34, 16, v193
    v_and_b32 v35, 0xffff0000, v193
    v_lshlrev_b32_e64 v36, 16, v194
    v_and_b32 v37, 0xffff0000, v194
    v_lshlrev_b32_e64 v38, 16, v195
    v_and_b32 v39, 0xffff0000, v195
    s_waitcnt vmcnt(32)
    v_lshlrev_b32 v40, 16, v196
    v_and_b32 v41, 0xffff0000, v196
    v_lshlrev_b32_e64 v42, 16, v197
    v_and_b32 v43, 0xffff0000, v197
    v_lshlrev_b32_e64 v44, 16, v198
    v_and_b32 v45, 0xffff0000, v198
    v_lshlrev_b32_e64 v46, 16, v199
    v_and_b32 v47, 0xffff0000, v199
    s_waitcnt vmcnt(31)
    v_lshlrev_b32 v48, 16, v200
    v_and_b32 v49, 0xffff0000, v200
    v_lshlrev_b32_e64 v50, 16, v201
    v_and_b32 v51, 0xffff0000, v201
    v_lshlrev_b32_e64 v52, 16, v202
    v_and_b32 v53, 0xffff0000, v202
    v_lshlrev_b32_e64 v54, 16, v203
    s_add_u32 s5, s30, 0x1000
    buffer_load_dwordx4 a[88:91], v16, s[16:19], s5 offen offset:2048 nt
    v_and_b32 v55, 0xffff0000, v203
    s_waitcnt vmcnt(31)
    v_lshlrev_b32 v56, 16, v204
    v_and_b32 v57, 0xffff0000, v204
    v_lshlrev_b32_e64 v58, 16, v205
    v_and_b32 v59, 0xffff0000, v205
    v_lshlrev_b32_e64 v60, 16, v206
    v_and_b32 v61, 0xffff0000, v206
    v_lshlrev_b32_e64 v62, 16, v207
    v_and_b32 v63, 0xffff0000, v207
    s_waitcnt vmcnt(30)
    v_lshlrev_b32 v64, 16, v208
    v_and_b32 v65, 0xffff0000, v208
    v_lshlrev_b32_e64 v66, 16, v209
    v_and_b32 v67, 0xffff0000, v209
    v_lshlrev_b32_e64 v68, 16, v210
    v_and_b32 v69, 0xffff0000, v210
    v_lshlrev_b32_e64 v70, 16, v211
    v_and_b32 v71, 0xffff0000, v211
    s_waitcnt vmcnt(29)
    v_lshlrev_b32 v72, 16, v212
    v_and_b32 v73, 0xffff0000, v212
    v_lshlrev_b32_e64 v74, 16, v213
    v_and_b32 v75, 0xffff0000, v213
    v_lshlrev_b32_e64 v76, 16, v214
    s_add_u32 s5, s30, 0x2000
    buffer_load_dwordx4 a[28:31], v16, s[12:15], s5 offen offset:0 nt
    v_and_b32 v77, 0xffff0000, v214
    v_lshlrev_b32_e64 v78, 16, v215
    v_and_b32 v79, 0xffff0000, v215
    s_waitcnt vmcnt(29)
    v_lshlrev_b32 v80, 16, v216
    v_and_b32 v81, 0xffff0000, v216
    v_lshlrev_b32_e64 v82, 16, v217
    v_and_b32 v83, 0xffff0000, v217
    v_lshlrev_b32_e64 v84, 16, v218
    v_and_b32 v85, 0xffff0000, v218
    v_lshlrev_b32_e64 v86, 16, v219
    v_and_b32 v87, 0xffff0000, v219
    s_waitcnt vmcnt(28)
    v_lshlrev_b32 v88, 16, v220
    v_and_b32 v89, 0xffff0000, v220
    v_lshlrev_b32_e64 v90, 16, v221
    v_and_b32 v91, 0xffff0000, v221
    v_lshlrev_b32_e64 v92, 16, v222
    v_and_b32 v93, 0xffff0000, v222
    v_lshlrev_b32_e64 v94, 16, v223
    v_and_b32 v95, 0xffff0000, v223
    v_pk_add_f32 v[96:97], v[32:33], v[34:35]
    v_pk_add_f32 v[98:99], v[48:49], v[50:51]
    v_pk_add_f32 v[100:101], v[64:65], v[66:67]
    s_add_u32 s5, s30, 0x2000
    buffer_load_dwordx4 a[92:95], v16, s[16:19], s5 offen offset:0 nt
    v_pk_add_f32 v[102:103], v[80:81], v[82:83]
    v_pk_add_f32 v[96:97], v[96:97], v[36:37]
    v_pk_add_f32 v[98:99], v[98:99], v[52:53]
    v_pk_add_f32 v[100:101], v[100:101], v[68:69]
    v_pk_add_f32 v[102:103], v[102:103], v[84:85]
    v_pk_add_f32 v[96:97], v[96:97], v[38:39]
    v_pk_add_f32 v[98:99], v[98:99], v[54:55]
    v_pk_add_f32 v[100:101], v[100:101], v[70:71]
    v_pk_add_f32 v[102:103], v[102:103], v[86:87]
    v_pk_add_f32 v[96:97], v[96:97], v[40:41]
    v_pk_add_f32 v[98:99], v[98:99], v[56:57]
    v_pk_add_f32 v[100:101], v[100:101], v[72:73]
    v_pk_add_f32 v[102:103], v[102:103], v[88:89]
    v_pk_add_f32 v[96:97], v[96:97], v[42:43]
    v_pk_add_f32 v[98:99], v[98:99], v[58:59]
    v_pk_add_f32 v[100:101], v[100:101], v[74:75]
    v_pk_add_f32 v[102:103], v[102:103], v[90:91]
    v_pk_add_f32 v[96:97], v[96:97], v[44:45]
    v_pk_add_f32 v[98:99], v[98:99], v[60:61]
    v_pk_add_f32 v[100:101], v[100:101], v[76:77]
    v_pk_add_f32 v[102:103], v[102:103], v[92:93]
    v_pk_add_f32 v[96:97], v[96:97], v[46:47]
    s_add_u32 s5, s30, 0x2000
    buffer_load_dwordx4 a[32:35], v16, s[12:15], s5 offen offset:2048 nt
    v_pk_add_f32 v[98:99], v[98:99], v[62:63]
    v_pk_add_f32 v[100:101], v[100:101], v[78:79]
    v_pk_add_f32 v[102:103], v[102:103], v[94:95]
    v_add_f32 v104, v96, v97
    v_add_f32 v105, v98, v99
    v_add_f32 v106, v100, v101
    v_add_f32 v107, v102, v103
    v_add_f32_dpp v104, v104, v104 quad_perm:[1,0,3,2] row_mask:0xf bank_mask:0xf
    v_add_f32_dpp v105, v105, v105 quad_perm:[1,0,3,2] row_mask:0xf bank_mask:0xf
    v_add_f32_dpp v106, v106, v106 quad_perm:[1,0,3,2] row_mask:0xf bank_mask:0xf
    v_add_f32_dpp v107, v107, v107 quad_perm:[1,0,3,2] row_mask:0xf bank_mask:0xf
    v_add_f32_dpp v104, v104, v104 quad_perm:[2,3,0,1] row_mask:0xf bank_mask:0xf
    v_add_f32_dpp v105, v105, v105 quad_perm:[2,3,0,1] row_mask:0xf bank_mask:0xf
    v_add_f32_dpp v106, v106, v106 quad_perm:[2,3,0,1] row_mask:0xf bank_mask:0xf
    v_add_f32_dpp v107, v107, v107 quad_perm:[2,3,0,1] row_mask:0xf bank_mask:0xf
    v_add_f32_dpp v104, v104, v104 row_half_mirror row_mask:0xf bank_mask:0xf
    v_add_f32_dpp v105, v105, v105 row_half_mirror row_mask:0xf bank_mask:0xf
    v_add_f32_dpp v106, v106, v106 row_half_mirror row_mask:0xf bank_mask:0xf
    v_add_f32_dpp v107, v107, v107 row_half_mirror row_mask:0xf bank_mask:0xf
    v_add_f32_dpp v104, v104, v104 row_mirror row_mask:0xf bank_mask:0xf
    v_add_f32_dpp v105, v105, v105 row_mirror row_mask:0xf bank_mask:0xf
    v_add_f32_dpp v106, v106, v106 row_mirror row_mask:0xf bank_mask:0xf
    s_add_u32 s5, s30, 0x2000
    buffer_load_dwordx4 a[96:99], v16, s[16:19], s5 offen offset:2048 nt
    v_add_f32_dpp v107, v107, v107 row_mirror row_mask:0xf bank_mask:0xf
    v_mov_b32 v108, v104
    v_mov_b32 v109, v105
    v_mov_b32 v110, v106
    v_mov_b32 v111, v107
    v_permlane16_swap_b32 v104, v108
    v_permlane16_swap_b32 v105, v109
    v_permlane16_swap_b32 v106, v110
    v_permlane16_swap_b32 v107, v111
    v_add_f32 v104, v104, v108
    v_add_f32 v105, v105, v109
    v_add_f32 v106, v106, v110
    v_add_f32 v107, v107, v111
    v_mov_b32 v108, v104
    v_mov_b32 v109, v105
    v_mov_b32 v110, v106
    v_mov_b32 v111, v107
    v_permlane32_swap_b32 v104, v108
    v_permlane32_swap_b32 v105, v109
    v_permlane32_swap_b32 v106, v110
    v_permlane32_swap_b32 v107, v111
    v_add_f32_e64 v104, v104, v108
    s_add_u32 s5, s30, 0x3000
    buffer_load_dwordx4 a[36:39], v16, s[12:15], s5 offen offset:0 nt
    v_add_f32 v105, v105, v109
    v_add_f32 v106, v106, v110
    v_add_f32_e64 v107, v107, v111
    v_mul_f32 v112, 0xba800000, v104
    v_mul_f32 v113, 0xba800000, v105
    v_mul_f32 v114, 0xba800000, v106
    v_mul_f32 v115, 0xba800000, v107
    v_pk_add_f32 v[32:33], v[32:33], v[112:113] op_sel:[0,0] op_sel_hi:[1,0]
    v_pk_add_f32 v[48:49], v[48:49], v[112:113] op_sel:[0,1] op_sel_hi:[1,1]
    v_pk_add_f32 v[64:65], v[64:65], v[114:115] op_sel:[0,0] op_sel_hi:[1,0]
    v_pk_add_f32 v[80:81], v[80:81], v[114:115] op_sel:[0,1] op_sel_hi:[1,1]
    v_pk_mul_f32 v[96:97], v[32:33], v[32:33]
    v_pk_mul_f32 v[98:99], v[48:49], v[48:49]
    v_pk_mul_f32 v[100:101], v[64:65], v[64:65]
    v_pk_mul_f32 v[102:103], v[80:81], v[80:81]
    v_pk_add_f32 v[34:35], v[34:35], v[112:113] op_sel:[0,0] op_sel_hi:[1,0]
    v_pk_add_f32 v[50:51], v[50:51], v[112:113] op_sel:[0,1] op_sel_hi:[1,1]
    v_pk_add_f32 v[66:67], v[66:67], v[114:115] op_sel:[0,0] op_sel_hi:[1,0]
    v_pk_add_f32 v[82:83], v[82:83], v[114:115] op_sel:[0,1] op_sel_hi:[1,1]
    v_pk_fma_f32 v[96:97], v[34:35], v[34:35], v[96:97]
    v_pk_fma_f32 v[98:99], v[50:51], v[50:51], v[98:99]
    v_pk_fma_f32 v[100:101], v[66:67], v[66:67], v[100:101]
    v_pk_fma_f32 v[102:103], v[82:83], v[82:83], v[102:103]
    s_add_u32 s5, s30, 0x3000
    buffer_load_dwordx4 a[100:103], v16, s[16:19], s5 offen offset:0 nt
    v_pk_add_f32 v[36:37], v[36:37], v[112:113] op_sel:[0,0] op_sel_hi:[1,0]
    v_pk_add_f32 v[52:53], v[52:53], v[112:113] op_sel:[0,1] op_sel_hi:[1,1]
    v_pk_add_f32 v[68:69], v[68:69], v[114:115] op_sel:[0,0] op_sel_hi:[1,0]
    v_pk_add_f32 v[84:85], v[84:85], v[114:115] op_sel:[0,1] op_sel_hi:[1,1]
    v_pk_fma_f32 v[96:97], v[36:37], v[36:37], v[96:97]
    v_pk_fma_f32 v[98:99], v[52:53], v[52:53], v[98:99]
    v_pk_fma_f32 v[100:101], v[68:69], v[68:69], v[100:101]
    v_pk_fma_f32 v[102:103], v[84:85], v[84:85], v[102:103]
    v_pk_add_f32 v[38:39], v[38:39], v[112:113] op_sel:[0,0] op_sel_hi:[1,0]
    v_pk_add_f32 v[54:55], v[54:55], v[112:113] op_sel:[0,1] op_sel_hi:[1,1]
    v_pk_add_f32 v[70:71], v[70:71], v[114:115] op_sel:[0,0] op_sel_hi:[1,0]
    v_pk_add_f32 v[86:87], v[86:87], v[114:115] op_sel:[0,1] op_sel_hi:[1,1]
    v_pk_fma_f32 v[96:97], v[38:39], v[38:39], v[96:97]
    v_pk_fma_f32 v[98:99], v[54:55], v[54:55], v[98:99]
    v_pk_fma_f32 v[100:101], v[70:71], v[70:71], v[100:101]
    v_pk_fma_f32 v[102:103], v[86:87], v[86:87], v[102:103]
    v_pk_add_f32 v[40:41], v[40:41], v[112:113] op_sel:[0,0] op_sel_hi:[1,0]
    v_pk_add_f32 v[56:57], v[56:57], v[112:113] op_sel:[0,1] op_sel_hi:[1,1]
    v_pk_add_f32 v[72:73], v[72:73], v[114:115] op_sel:[0,0] op_sel_hi:[1,0]
    v_pk_add_f32 v[88:89], v[88:89], v[114:115] op_sel:[0,1] op_sel_hi:[1,1]
    v_pk_fma_f32 v[96:97], v[40:41], v[40:41], v[96:97]
    v_pk_fma_f32 v[98:99], v[56:57], v[56:57], v[98:99]
    s_add_u32 s5, s30, 0x3000
    buffer_load_dwordx4 a[40:43], v16, s[12:15], s5 offen offset:2048 nt
    v_pk_fma_f32 v[100:101], v[72:73], v[72:73], v[100:101]
    v_pk_fma_f32 v[102:103], v[88:89], v[88:89], v[102:103]
    v_pk_add_f32 v[42:43], v[42:43], v[112:113] op_sel:[0,0] op_sel_hi:[1,0]
    v_pk_add_f32 v[58:59], v[58:59], v[112:113] op_sel:[0,1] op_sel_hi:[1,1]
    v_pk_add_f32 v[74:75], v[74:75], v[114:115] op_sel:[0,0] op_sel_hi:[1,0]
    v_pk_add_f32 v[90:91], v[90:91], v[114:115] op_sel:[0,1] op_sel_hi:[1,1]
    v_pk_fma_f32 v[96:97], v[42:43], v[42:43], v[96:97]
    v_pk_fma_f32 v[98:99], v[58:59], v[58:59], v[98:99]
    v_pk_fma_f32 v[100:101], v[74:75], v[74:75], v[100:101]
    v_pk_fma_f32 v[102:103], v[90:91], v[90:91], v[102:103]
    v_pk_add_f32 v[44:45], v[44:45], v[112:113] op_sel:[0,0] op_sel_hi:[1,0]
    v_pk_add_f32 v[60:61], v[60:61], v[112:113] op_sel:[0,1] op_sel_hi:[1,1]
    v_pk_add_f32 v[76:77], v[76:77], v[114:115] op_sel:[0,0] op_sel_hi:[1,0]
    v_pk_add_f32 v[92:93], v[92:93], v[114:115] op_sel:[0,1] op_sel_hi:[1,1]
    v_pk_fma_f32 v[96:97], v[44:45], v[44:45], v[96:97]
    v_pk_fma_f32 v[98:99], v[60:61], v[60:61], v[98:99]
    v_pk_fma_f32 v[100:101], v[76:77], v[76:77], v[100:101]
    v_pk_fma_f32 v[102:103], v[92:93], v[92:93], v[102:103]
    v_pk_add_f32 v[46:47], v[46:47], v[112:113] op_sel:[0,0] op_sel_hi:[1,0]
    v_pk_add_f32 v[62:63], v[62:63], v[112:113] op_sel:[0,1] op_sel_hi:[1,1]
    v_pk_add_f32 v[78:79], v[78:79], v[114:115] op_sel:[0,0] op_sel_hi:[1,0]
    v_pk_add_f32 v[94:95], v[94:95], v[114:115] op_sel:[0,1] op_sel_hi:[1,1]
    s_add_u32 s5, s30, 0x3000
    buffer_load_dwordx4 a[104:107], v16, s[16:19], s5 offen offset:2048 nt
    v_pk_fma_f32 v[96:97], v[46:47], v[46:47], v[96:97]
    v_pk_fma_f32 v[98:99], v[62:63], v[62:63], v[98:99]
    v_pk_fma_f32 v[100:101], v[78:79], v[78:79], v[100:101]
    v_pk_fma_f32 v[102:103], v[94:95], v[94:95], v[102:103]
    v_add_f32 v104, v96, v97
    v_add_f32 v105, v98, v99
    v_add_f32 v106, v100, v101
    v_add_f32 v107, v102, v103
    v_add_f32_dpp v104, v104, v104 quad_perm:[1,0,3,2] row_mask:0xf bank_mask:0xf
    v_add_f32_dpp v105, v105, v105 quad_perm:[1,0,3,2] row_mask:0xf bank_mask:0xf
    v_add_f32_dpp v106, v106, v106 quad_perm:[1,0,3,2] row_mask:0xf bank_mask:0xf
    v_add_f32_dpp v107, v107, v107 quad_perm:[1,0,3,2] row_mask:0xf bank_mask:0xf
    v_add_f32_dpp v104, v104, v104 quad_perm:[2,3,0,1] row_mask:0xf bank_mask:0xf
    v_add_f32_dpp v105, v105, v105 quad_perm:[2,3,0,1] row_mask:0xf bank_mask:0xf
    v_add_f32_dpp v106, v106, v106 quad_perm:[2,3,0,1] row_mask:0xf bank_mask:0xf
    v_add_f32_dpp v107, v107, v107 quad_perm:[2,3,0,1] row_mask:0xf bank_mask:0xf
    v_add_f32_dpp v104, v104, v104 row_half_mirror row_mask:0xf bank_mask:0xf
    v_add_f32_dpp v105, v105, v105 row_half_mirror row_mask:0xf bank_mask:0xf
    v_add_f32_dpp v106, v106, v106 row_half_mirror row_mask:0xf bank_mask:0xf
    v_add_f32_dpp v107, v107, v107 row_half_mirror row_mask:0xf bank_mask:0xf
    v_add_f32_dpp v104, v104, v104 row_mirror row_mask:0xf bank_mask:0xf
    v_add_f32_dpp v105, v105, v105 row_mirror row_mask:0xf bank_mask:0xf
    s_add_u32 s5, s30, 0x4000
    buffer_load_dwordx4 a[44:47], v16, s[12:15], s5 offen offset:0 nt
    v_add_f32_dpp v106, v106, v106 row_mirror row_mask:0xf bank_mask:0xf
    v_add_f32_dpp v107, v107, v107 row_mirror row_mask:0xf bank_mask:0xf
    v_mov_b32 v108, v104
    v_mov_b32 v109, v105
    v_mov_b32 v110, v106
    v_mov_b32 v111, v107
    v_permlane16_swap_b32 v104, v108
    v_permlane16_swap_b32 v105, v109
    v_permlane16_swap_b32 v106, v110
    v_permlane16_swap_b32 v107, v111
    v_add_f32 v104, v104, v108
    v_add_f32 v105, v105, v109
    v_add_f32 v106, v106, v110
    v_add_f32 v107, v107, v111
    v_mov_b32 v108, v104
    v_mov_b32 v109, v105
    v_mov_b32 v110, v106
    v_mov_b32 v111, v107
    v_permlane32_swap_b32 v104, v108
    v_permlane32_swap_b32 v105, v109
    v_permlane32_swap_b32 v106, v110
    v_permlane32_swap_b32 v107, v111
    s_add_u32 s5, s30, 0x4000
    buffer_load_dwordx4 a[108:111], v16, s[16:19], s5 offen offset:0 nt
    v_add_f32 v104, v104, v108
    v_add_f32 v105, v105, v109
    v_add_f32 v106, v106, v110
    v_add_f32 v107, v107, v111
    v_mul_f32 v104, 0x3a800000, v104
    v_mul_f32 v105, 0x3a800000, v105
    v_mul_f32 v106, 0x3a800000, v106
    v_mul_f32 v107, 0x3a800000, v107
    v_cvt_pk_bf16_f32 v108, v112, v104
    v_cvt_pk_bf16_f32 v109, v113, v105
    v_cvt_pk_bf16_f32 v110, v114, v106
    v_cvt_pk_bf16_f32 v111, v115, v107
    v_lshlrev_b32 v116, 16, v108
    v_lshlrev_b32 v120, 16, v109
    v_lshlrev_b32 v118, 16, v110
    v_lshlrev_b32 v122, 16, v111
    v_and_b32 v104, 0xffff0000, v108
    v_and_b32 v105, 0xffff0000, v109
    v_and_b32 v106, 0xffff0000, v110
    v_and_b32 v107, 0xffff0000, v111
    v_add_f32 v104, 0x3727c5ac, v104
    v_add_f32 v105, 0x3727c5ac, v105
    s_add_u32 s5, s30, 0x4000
    buffer_load_dwordx4 a[48:51], v16, s[12:15], s5 offen offset:2048 nt
    v_add_f32 v106, 0x3727c5ac, v106
    v_add_f32 v107, 0x3727c5ac, v107
    v_cvt_pk_bf16_f32 v104, v104, v104
    v_cvt_pk_bf16_f32 v105, v105, v105
    v_cvt_pk_bf16_f32 v106, v106, v106
    v_cvt_pk_bf16_f32 v107, v107, v107
    v_and_b32 v104, 0xffff0000, v104
    v_and_b32 v105, 0xffff0000, v105
    v_and_b32 v106, 0xffff0000, v106
    v_and_b32 v107, 0xffff0000, v107
    v_sqrt_f32 v104, v104
    v_sqrt_f32 v105, v105
    v_sqrt_f32 v106, v106
    v_sqrt_f32 v107, v107
    v_cvt_pk_bf16_f32 v104, v104, v104
    v_cvt_pk_bf16_f32 v105, v105, v105
    v_cvt_pk_bf16_f32 v106, v106, v106
    v_cvt_pk_bf16_f32 v107, v107, v107
    v_and_b32 v117, 0xffff0000, v104
    v_and_b32 v121, 0xffff0000, v105
    v_and_b32 v119, 0xffff0000, v106
    v_and_b32 v123, 0xffff0000, v107
    s_mov_b64 exec, 1
    buffer_store_dwordx4 v[116:119], v4, s[64:67], s80 offen offset:32 sc1
    buffer_store_dwordx4 v[120:123], v4, s[64:67], s80 offen offset:160 sc1
    s_mov_b64 exec, -1
    s_add_u32 s5, s30, 0x4000
    buffer_load_dwordx4 a[112:115], v16, s[16:19], s5 offen offset:2048 nt
    s_waitcnt vmcnt(40)
    v_lshlrev_b32 v32, 16, v224
    v_and_b32 v33, 0xffff0000, v224
    v_lshlrev_b32_e64 v34, 16, v225
    v_and_b32 v35, 0xffff0000, v225
    v_lshlrev_b32_e64 v36, 16, v226
    v_and_b32 v37, 0xffff0000, v226
    v_lshlrev_b32_e64 v38, 16, v227
    v_and_b32 v39, 0xffff0000, v227
    s_waitcnt vmcnt(39)
    v_lshlrev_b32 v40, 16, v228
    v_and_b32 v41, 0xffff0000, v228
    v_lshlrev_b32_e64 v42, 16, v229
    v_and_b32 v43, 0xffff0000, v229
    v_lshlrev_b32_e64 v44, 16, v230
    v_and_b32 v45, 0xffff0000, v230
    v_lshlrev_b32_e64 v46, 16, v231
    v_and_b32 v47, 0xffff0000, v231
    s_waitcnt vmcnt(38)
    v_lshlrev_b32 v48, 16, v232
    v_and_b32 v49, 0xffff0000, v232
    v_lshlrev_b32_e64 v50, 16, v233
    v_and_b32 v51, 0xffff0000, v233
    v_lshlrev_b32_e64 v52, 16, v234
    v_and_b32 v53, 0xffff0000, v234
    v_lshlrev_b32_e64 v54, 16, v235
    s_add_u32 s5, s30, 0x5000
    buffer_load_dwordx4 a[52:55], v16, s[12:15], s5 offen offset:0 nt
    v_and_b32 v55, 0xffff0000, v235
    s_waitcnt vmcnt(38)
    v_lshlrev_b32 v56, 16, v236
    v_and_b32 v57, 0xffff0000, v236
    v_lshlrev_b32_e64 v58, 16, v237
    v_and_b32 v59, 0xffff0000, v237
    v_lshlrev_b32_e64 v60, 16, v238
    v_and_b32 v61, 0xffff0000, v238
    v_lshlrev_b32_e64 v62, 16, v239
    v_and_b32 v63, 0xffff0000, v239
    s_waitcnt vmcnt(37)
    v_lshlrev_b32 v64, 16, v240
    v_and_b32 v65, 0xffff0000, v240
    v_lshlrev_b32_e64 v66, 16, v241
    v_and_b32 v67, 0xffff0000, v241
    v_lshlrev_b32_e64 v68, 16, v242
    v_and_b32 v69, 0xffff0000, v242
    v_lshlrev_b32_e64 v70, 16, v243
    v_and_b32 v71, 0xffff0000, v243
    s_waitcnt vmcnt(34)
    v_lshlrev_b32 v72, 16, v244
    v_and_b32 v73, 0xffff0000, v244
    v_lshlrev_b32_e64 v74, 16, v245
    v_and_b32 v75, 0xffff0000, v245
    v_lshlrev_b32_e64 v76, 16, v246
    s_add_u32 s5, s30, 0x5000
    buffer_load_dwordx4 a[116:119], v16, s[16:19], s5 offen offset:0 nt
    v_and_b32 v77, 0xffff0000, v246
    v_lshlrev_b32_e64 v78, 16, v247
    v_and_b32 v79, 0xffff0000, v247
    s_waitcnt vmcnt(34)
    v_lshlrev_b32 v80, 16, v248
    v_and_b32 v81, 0xffff0000, v248
    v_lshlrev_b32_e64 v82, 16, v249
    v_and_b32 v83, 0xffff0000, v249
    v_lshlrev_b32_e64 v84, 16, v250
    v_and_b32 v85, 0xffff0000, v250
    v_lshlrev_b32_e64 v86, 16, v251
    v_and_b32 v87, 0xffff0000, v251
    s_waitcnt vmcnt(33)
    v_lshlrev_b32 v88, 16, v252
    v_and_b32 v89, 0xffff0000, v252
    v_lshlrev_b32_e64 v90, 16, v253
    v_and_b32 v91, 0xffff0000, v253
    v_lshlrev_b32_e64 v92, 16, v254
    v_and_b32 v93, 0xffff0000, v254
    v_lshlrev_b32_e64 v94, 16, v255
    v_and_b32 v95, 0xffff0000, v255
    v_pk_add_f32 v[96:97], v[32:33], v[34:35]
    v_pk_add_f32 v[98:99], v[48:49], v[50:51]
    v_pk_add_f32 v[100:101], v[64:65], v[66:67]
    s_add_u32 s5, s30, 0x5000
    buffer_load_dwordx4 a[56:59], v16, s[12:15], s5 offen offset:2048 nt
    v_pk_add_f32 v[102:103], v[80:81], v[82:83]
    v_pk_add_f32 v[96:97], v[96:97], v[36:37]
    v_pk_add_f32 v[98:99], v[98:99], v[52:53]
    v_pk_add_f32 v[100:101], v[100:101], v[68:69]
    v_pk_add_f32 v[102:103], v[102:103], v[84:85]
    v_pk_add_f32 v[96:97], v[96:97], v[38:39]
    v_pk_add_f32 v[98:99], v[98:99], v[54:55]
    v_pk_add_f32 v[100:101], v[100:101], v[70:71]
    v_pk_add_f32 v[102:103], v[102:103], v[86:87]
    v_pk_add_f32 v[96:97], v[96:97], v[40:41]
    v_pk_add_f32 v[98:99], v[98:99], v[56:57]
    v_pk_add_f32 v[100:101], v[100:101], v[72:73]
    v_pk_add_f32 v[102:103], v[102:103], v[88:89]
    v_pk_add_f32 v[96:97], v[96:97], v[42:43]
    v_pk_add_f32 v[98:99], v[98:99], v[58:59]
    v_pk_add_f32 v[100:101], v[100:101], v[74:75]
    v_pk_add_f32 v[102:103], v[102:103], v[90:91]
    v_pk_add_f32 v[96:97], v[96:97], v[44:45]
    v_pk_add_f32 v[98:99], v[98:99], v[60:61]
    v_pk_add_f32 v[100:101], v[100:101], v[76:77]
    v_pk_add_f32 v[102:103], v[102:103], v[92:93]
    v_pk_add_f32 v[96:97], v[96:97], v[46:47]
    s_add_u32 s5, s30, 0x5000
    buffer_load_dwordx4 a[120:123], v16, s[16:19], s5 offen offset:2048 nt
    v_pk_add_f32 v[98:99], v[98:99], v[62:63]
    v_pk_add_f32 v[100:101], v[100:101], v[78:79]
    v_pk_add_f32 v[102:103], v[102:103], v[94:95]
    v_add_f32 v104, v96, v97
    v_add_f32 v105, v98, v99
    v_add_f32 v106, v100, v101
    v_add_f32 v107, v102, v103
    v_add_f32_dpp v104, v104, v104 quad_perm:[1,0,3,2] row_mask:0xf bank_mask:0xf
    v_add_f32_dpp v105, v105, v105 quad_perm:[1,0,3,2] row_mask:0xf bank_mask:0xf
    v_add_f32_dpp v106, v106, v106 quad_perm:[1,0,3,2] row_mask:0xf bank_mask:0xf
    v_add_f32_dpp v107, v107, v107 quad_perm:[1,0,3,2] row_mask:0xf bank_mask:0xf
    v_add_f32_dpp v104, v104, v104 quad_perm:[2,3,0,1] row_mask:0xf bank_mask:0xf
    v_add_f32_dpp v105, v105, v105 quad_perm:[2,3,0,1] row_mask:0xf bank_mask:0xf
    v_add_f32_dpp v106, v106, v106 quad_perm:[2,3,0,1] row_mask:0xf bank_mask:0xf
    v_add_f32_dpp v107, v107, v107 quad_perm:[2,3,0,1] row_mask:0xf bank_mask:0xf
    v_add_f32_dpp v104, v104, v104 row_half_mirror row_mask:0xf bank_mask:0xf
    v_add_f32_dpp v105, v105, v105 row_half_mirror row_mask:0xf bank_mask:0xf
    v_add_f32_dpp v106, v106, v106 row_half_mirror row_mask:0xf bank_mask:0xf
    v_add_f32_dpp v107, v107, v107 row_half_mirror row_mask:0xf bank_mask:0xf
    v_add_f32_dpp v104, v104, v104 row_mirror row_mask:0xf bank_mask:0xf
    v_add_f32_dpp v105, v105, v105 row_mirror row_mask:0xf bank_mask:0xf
    v_add_f32_dpp v106, v106, v106 row_mirror row_mask:0xf bank_mask:0xf
    s_add_u32 s5, s30, 0x6000
    buffer_load_dwordx4 a[60:63], v16, s[12:15], s5 offen offset:0 nt
    v_add_f32_dpp v107, v107, v107 row_mirror row_mask:0xf bank_mask:0xf
    v_mov_b32 v108, v104
    v_mov_b32 v109, v105
    v_mov_b32 v110, v106
    v_mov_b32 v111, v107
    v_permlane16_swap_b32 v104, v108
    v_permlane16_swap_b32 v105, v109
    v_permlane16_swap_b32 v106, v110
    v_permlane16_swap_b32 v107, v111
    v_add_f32 v104, v104, v108
    v_add_f32 v105, v105, v109
    v_add_f32 v106, v106, v110
    v_add_f32 v107, v107, v111
    v_mov_b32 v108, v104
    v_mov_b32 v109, v105
    v_mov_b32 v110, v106
    v_mov_b32 v111, v107
    v_permlane32_swap_b32 v104, v108
    v_permlane32_swap_b32 v105, v109
    v_permlane32_swap_b32 v106, v110
    v_permlane32_swap_b32 v107, v111
    v_add_f32_e64 v104, v104, v108
    s_add_u32 s5, s30, 0x6000
    buffer_load_dwordx4 a[124:127], v16, s[16:19], s5 offen offset:0 nt
    v_add_f32 v105, v105, v109
    v_add_f32 v106, v106, v110
    v_add_f32_e64 v107, v107, v111
    v_mul_f32 v112, 0xba800000, v104
    v_mul_f32 v113, 0xba800000, v105
    v_mul_f32 v114, 0xba800000, v106
    v_mul_f32 v115, 0xba800000, v107
    v_pk_add_f32 v[32:33], v[32:33], v[112:113] op_sel:[0,0] op_sel_hi:[1,0]
    v_pk_add_f32 v[48:49], v[48:49], v[112:113] op_sel:[0,1] op_sel_hi:[1,1]
    v_pk_add_f32 v[64:65], v[64:65], v[114:115] op_sel:[0,0] op_sel_hi:[1,0]
    v_pk_add_f32 v[80:81], v[80:81], v[114:115] op_sel:[0,1] op_sel_hi:[1,1]
    v_pk_mul_f32 v[96:97], v[32:33], v[32:33]
    v_pk_mul_f32 v[98:99], v[48:49], v[48:49]
    v_pk_mul_f32 v[100:101], v[64:65], v[64:65]
    v_pk_mul_f32 v[102:103], v[80:81], v[80:81]
    v_pk_add_f32 v[34:35], v[34:35], v[112:113] op_sel:[0,0] op_sel_hi:[1,0]
    v_pk_add_f32 v[50:51], v[50:51], v[112:113] op_sel:[0,1] op_sel_hi:[1,1]
    v_pk_add_f32 v[66:67], v[66:67], v[114:115] op_sel:[0,0] op_sel_hi:[1,0]
    v_pk_add_f32 v[82:83], v[82:83], v[114:115] op_sel:[0,1] op_sel_hi:[1,1]
    v_pk_fma_f32 v[96:97], v[34:35], v[34:35], v[96:97]
    v_pk_fma_f32 v[98:99], v[50:51], v[50:51], v[98:99]
    v_pk_fma_f32 v[100:101], v[66:67], v[66:67], v[100:101]
    v_pk_fma_f32 v[102:103], v[82:83], v[82:83], v[102:103]
    s_add_u32 s5, s30, 0x6000
    buffer_load_dwordx4 a[64:67], v16, s[12:15], s5 offen offset:2048 nt
    v_pk_add_f32 v[36:37], v[36:37], v[112:113] op_sel:[0,0] op_sel_hi:[1,0]
    v_pk_add_f32 v[52:53], v[52:53], v[112:113] op_sel:[0,1] op_sel_hi:[1,1]
    v_pk_add_f32 v[68:69], v[68:69], v[114:115] op_sel:[0,0] op_sel_hi:[1,0]
    v_pk_add_f32 v[84:85], v[84:85], v[114:115] op_sel:[0,1] op_sel_hi:[1,1]
    v_pk_fma_f32 v[96:97], v[36:37], v[36:37], v[96:97]
    v_pk_fma_f32 v[98:99], v[52:53], v[52:53], v[98:99]
    v_pk_fma_f32 v[100:101], v[68:69], v[68:69], v[100:101]
    v_pk_fma_f32 v[102:103], v[84:85], v[84:85], v[102:103]
    v_pk_add_f32 v[38:39], v[38:39], v[112:113] op_sel:[0,0] op_sel_hi:[1,0]
    v_pk_add_f32 v[54:55], v[54:55], v[112:113] op_sel:[0,1] op_sel_hi:[1,1]
    v_pk_add_f32 v[70:71], v[70:71], v[114:115] op_sel:[0,0] op_sel_hi:[1,0]
    v_pk_add_f32 v[86:87], v[86:87], v[114:115] op_sel:[0,1] op_sel_hi:[1,1]
    v_pk_fma_f32 v[96:97], v[38:39], v[38:39], v[96:97]
    v_pk_fma_f32 v[98:99], v[54:55], v[54:55], v[98:99]
    v_pk_fma_f32 v[100:101], v[70:71], v[70:71], v[100:101]
    v_pk_fma_f32 v[102:103], v[86:87], v[86:87], v[102:103]
    v_pk_add_f32 v[40:41], v[40:41], v[112:113] op_sel:[0,0] op_sel_hi:[1,0]
    v_pk_add_f32 v[56:57], v[56:57], v[112:113] op_sel:[0,1] op_sel_hi:[1,1]
    v_pk_add_f32 v[72:73], v[72:73], v[114:115] op_sel:[0,0] op_sel_hi:[1,0]
    v_pk_add_f32 v[88:89], v[88:89], v[114:115] op_sel:[0,1] op_sel_hi:[1,1]
    v_pk_fma_f32 v[96:97], v[40:41], v[40:41], v[96:97]
    v_pk_fma_f32 v[98:99], v[56:57], v[56:57], v[98:99]
    s_add_u32 s5, s30, 0x6000
    buffer_load_dwordx4 a[128:131], v16, s[16:19], s5 offen offset:2048 nt
    v_pk_fma_f32 v[100:101], v[72:73], v[72:73], v[100:101]
    v_pk_fma_f32 v[102:103], v[88:89], v[88:89], v[102:103]
    v_pk_add_f32 v[42:43], v[42:43], v[112:113] op_sel:[0,0] op_sel_hi:[1,0]
    v_pk_add_f32 v[58:59], v[58:59], v[112:113] op_sel:[0,1] op_sel_hi:[1,1]
    v_pk_add_f32 v[74:75], v[74:75], v[114:115] op_sel:[0,0] op_sel_hi:[1,0]
    v_pk_add_f32 v[90:91], v[90:91], v[114:115] op_sel:[0,1] op_sel_hi:[1,1]
    v_pk_fma_f32 v[96:97], v[42:43], v[42:43], v[96:97]
    v_pk_fma_f32 v[98:99], v[58:59], v[58:59], v[98:99]
    v_pk_fma_f32 v[100:101], v[74:75], v[74:75], v[100:101]
    v_pk_fma_f32 v[102:103], v[90:91], v[90:91], v[102:103]
    v_pk_add_f32 v[44:45], v[44:45], v[112:113] op_sel:[0,0] op_sel_hi:[1,0]
    v_pk_add_f32 v[60:61], v[60:61], v[112:113] op_sel:[0,1] op_sel_hi:[1,1]
    v_pk_add_f32 v[76:77], v[76:77], v[114:115] op_sel:[0,0] op_sel_hi:[1,0]
    v_pk_add_f32 v[92:93], v[92:93], v[114:115] op_sel:[0,1] op_sel_hi:[1,1]
    v_pk_fma_f32 v[96:97], v[44:45], v[44:45], v[96:97]
    v_pk_fma_f32 v[98:99], v[60:61], v[60:61], v[98:99]
    v_pk_fma_f32 v[100:101], v[76:77], v[76:77], v[100:101]
    v_pk_fma_f32 v[102:103], v[92:93], v[92:93], v[102:103]
    v_pk_add_f32 v[46:47], v[46:47], v[112:113] op_sel:[0,0] op_sel_hi:[1,0]
    v_pk_add_f32 v[62:63], v[62:63], v[112:113] op_sel:[0,1] op_sel_hi:[1,1]
    v_pk_add_f32 v[78:79], v[78:79], v[114:115] op_sel:[0,0] op_sel_hi:[1,0]
    v_pk_add_f32 v[94:95], v[94:95], v[114:115] op_sel:[0,1] op_sel_hi:[1,1]
    s_add_u32 s5, s30, 0x7000
    buffer_load_dwordx4 a[68:71], v16, s[12:15], s5 offen offset:0 nt
    v_pk_fma_f32 v[96:97], v[46:47], v[46:47], v[96:97]
    v_pk_fma_f32 v[98:99], v[62:63], v[62:63], v[98:99]
    v_pk_fma_f32 v[100:101], v[78:79], v[78:79], v[100:101]
    v_pk_fma_f32 v[102:103], v[94:95], v[94:95], v[102:103]
    v_add_f32 v104, v96, v97
    v_add_f32 v105, v98, v99
    v_add_f32 v106, v100, v101
    v_add_f32 v107, v102, v103
    v_add_f32_dpp v104, v104, v104 quad_perm:[1,0,3,2] row_mask:0xf bank_mask:0xf
    v_add_f32_dpp v105, v105, v105 quad_perm:[1,0,3,2] row_mask:0xf bank_mask:0xf
    v_add_f32_dpp v106, v106, v106 quad_perm:[1,0,3,2] row_mask:0xf bank_mask:0xf
    v_add_f32_dpp v107, v107, v107 quad_perm:[1,0,3,2] row_mask:0xf bank_mask:0xf
    v_add_f32_dpp v104, v104, v104 quad_perm:[2,3,0,1] row_mask:0xf bank_mask:0xf
    v_add_f32_dpp v105, v105, v105 quad_perm:[2,3,0,1] row_mask:0xf bank_mask:0xf
    v_add_f32_dpp v106, v106, v106 quad_perm:[2,3,0,1] row_mask:0xf bank_mask:0xf
    v_add_f32_dpp v107, v107, v107 quad_perm:[2,3,0,1] row_mask:0xf bank_mask:0xf
    v_add_f32_dpp v104, v104, v104 row_half_mirror row_mask:0xf bank_mask:0xf
    v_add_f32_dpp v105, v105, v105 row_half_mirror row_mask:0xf bank_mask:0xf
    v_add_f32_dpp v106, v106, v106 row_half_mirror row_mask:0xf bank_mask:0xf
    v_add_f32_dpp v107, v107, v107 row_half_mirror row_mask:0xf bank_mask:0xf
    v_add_f32_dpp v104, v104, v104 row_mirror row_mask:0xf bank_mask:0xf
    v_add_f32_dpp v105, v105, v105 row_mirror row_mask:0xf bank_mask:0xf
    s_add_u32 s5, s30, 0x7000
    buffer_load_dwordx4 a[132:135], v16, s[16:19], s5 offen offset:0 nt
    v_add_f32_dpp v106, v106, v106 row_mirror row_mask:0xf bank_mask:0xf
    v_add_f32_dpp v107, v107, v107 row_mirror row_mask:0xf bank_mask:0xf
    v_mov_b32 v108, v104
    v_mov_b32 v109, v105
    v_mov_b32 v110, v106
    v_mov_b32 v111, v107
    v_permlane16_swap_b32 v104, v108
    v_permlane16_swap_b32 v105, v109
    v_permlane16_swap_b32 v106, v110
    v_permlane16_swap_b32 v107, v111
    v_add_f32 v104, v104, v108
    v_add_f32 v105, v105, v109
    v_add_f32 v106, v106, v110
    v_add_f32 v107, v107, v111
    v_mov_b32 v108, v104
    v_mov_b32 v109, v105
    v_mov_b32 v110, v106
    v_mov_b32 v111, v107
    v_permlane32_swap_b32 v104, v108
    v_permlane32_swap_b32 v105, v109
    v_permlane32_swap_b32 v106, v110
    v_permlane32_swap_b32 v107, v111
    s_add_u32 s5, s30, 0x7000
    buffer_load_dwordx4 a[72:75], v16, s[12:15], s5 offen offset:2048 nt
    v_add_f32 v104, v104, v108
    v_add_f32 v105, v105, v109
    v_add_f32 v106, v106, v110
    v_add_f32 v107, v107, v111
    v_mul_f32 v104, 0x3a800000, v104
    v_mul_f32 v105, 0x3a800000, v105
    v_mul_f32 v106, 0x3a800000, v106
    v_mul_f32 v107, 0x3a800000, v107
    v_cvt_pk_bf16_f32 v108, v112, v104
    v_cvt_pk_bf16_f32 v109, v113, v105
    v_cvt_pk_bf16_f32 v110, v114, v106
    v_cvt_pk_bf16_f32 v111, v115, v107
    v_lshlrev_b32 v116, 16, v108
    v_lshlrev_b32 v120, 16, v109
    v_lshlrev_b32 v118, 16, v110
    v_lshlrev_b32 v122, 16, v111
    v_and_b32 v104, 0xffff0000, v108
    v_and_b32 v105, 0xffff0000, v109
    v_and_b32 v106, 0xffff0000, v110
    v_and_b32 v107, 0xffff0000, v111
    v_add_f32 v104, 0x3727c5ac, v104
    v_add_f32 v105, 0x3727c5ac, v105
    s_add_u32 s5, s30, 0x7000
    buffer_load_dwordx4 a[136:139], v16, s[16:19], s5 offen offset:2048 nt
    v_add_f32 v106, 0x3727c5ac, v106
    v_add_f32 v107, 0x3727c5ac, v107
    v_cvt_pk_bf16_f32 v104, v104, v104
    v_cvt_pk_bf16_f32 v105, v105, v105
    v_cvt_pk_bf16_f32 v106, v106, v106
    v_cvt_pk_bf16_f32 v107, v107, v107
    v_and_b32 v104, 0xffff0000, v104
    v_and_b32 v105, 0xffff0000, v105
    v_and_b32 v106, 0xffff0000, v106
    v_and_b32 v107, 0xffff0000, v107
    v_sqrt_f32 v104, v104
    v_sqrt_f32 v105, v105
    v_sqrt_f32 v106, v106
    v_sqrt_f32 v107, v107
    v_cvt_pk_bf16_f32 v104, v104, v104
    v_cvt_pk_bf16_f32 v105, v105, v105
    v_cvt_pk_bf16_f32 v106, v106, v106
    v_cvt_pk_bf16_f32 v107, v107, v107
    v_and_b32 v117, 0xffff0000, v104
    v_and_b32 v121, 0xffff0000, v105
    v_and_b32 v119, 0xffff0000, v106
    v_and_b32 v123, 0xffff0000, v107
    s_mov_b64 exec, 1
    buffer_store_dwordx4 v[116:119], v4, s[64:67], s80 offen offset:48 sc1
    buffer_store_dwordx4 v[120:123], v4, s[64:67], s80 offen offset:176 sc1
    s_mov_b64 exec, -1
    v_lshlrev_b32_e64 v15, 2, v17
    buffer_load_dwordx4 a[232:235], v15, s[24:27], 0 offen offset:0
    buffer_load_dwordx4 a[236:239], v15, s[24:27], 0 offen offset:16
    buffer_load_dwordx4 a[240:243], v15, s[24:27], 0 offen offset:32
    buffer_load_dwordx4 a[244:247], v15, s[24:27], 0 offen offset:48
    s_waitcnt vmcnt(48)
    v_accvgpr_read_b32 v24, a216
    v_accvgpr_read_b32 v25, a217
    v_accvgpr_read_b32 v26, a218
    v_accvgpr_read_b32 v27, a219
    v_lshlrev_b32 v32, 16, v24
    v_and_b32 v40, 0xffff0000, v24
    v_lshlrev_b32_e64 v48, 16, v25
    v_and_b32 v56, 0xffff0000, v25
    v_lshlrev_b32_e64 v33, 16, v26
    v_and_b32 v41, 0xffff0000, v26
    v_lshlrev_b32_e64 v49, 16, v27
    v_and_b32 v57, 0xffff0000, v27
    s_waitcnt vmcnt(47)
    v_accvgpr_read_b32 v24, a220
    v_accvgpr_read_b32 v25, a221
    v_accvgpr_read_b32 v26, a222
    v_accvgpr_read_b32 v27, a223
    v_lshlrev_b32 v34, 16, v24
    v_and_b32 v42, 0xffff0000, v24
    v_lshlrev_b32_e64 v50, 16, v25
    v_and_b32 v58, 0xffff0000, v25
    v_lshlrev_b32_e64 v35, 16, v26
    v_and_b32 v43, 0xffff0000, v26
    v_lshlrev_b32_e64 v51, 16, v27
    v_and_b32 v59, 0xffff0000, v27
    s_waitcnt vmcnt(46)
    v_accvgpr_read_b32 v24, a224
    v_accvgpr_read_b32 v25, a225
    v_accvgpr_read_b32 v26, a226
    v_accvgpr_read_b32 v27, a227
    v_lshlrev_b32 v36, 16, v24
    v_and_b32 v44, 0xffff0000, v24
    v_lshlrev_b32_e64 v52, 16, v25
    v_and_b32 v60, 0xffff0000, v25
    v_lshlrev_b32_e64 v37, 16, v26
    v_and_b32 v45, 0xffff0000, v26
    v_lshlrev_b32_e64 v53, 16, v27
    v_and_b32 v61, 0xffff0000, v27
    s_waitcnt vmcnt(45)
    v_accvgpr_read_b32 v24, a228
    v_accvgpr_read_b32 v25, a229
    v_accvgpr_read_b32 v26, a230
    v_accvgpr_read_b32 v27, a231
    v_lshlrev_b32 v38, 16, v24
    v_and_b32 v46, 0xffff0000, v24
    v_lshlrev_b32_e64 v54, 16, v25
    v_and_b32 v62, 0xffff0000, v25
    v_lshlrev_b32_e64 v39, 16, v26
    v_and_b32 v47, 0xffff0000, v26
    v_lshlrev_b32_e64 v55, 16, v27
    v_and_b32 v63, 0xffff0000, v27
    s_waitcnt vmcnt(44)
    v_accvgpr_read_b32 v24, a0
    v_accvgpr_read_b32 v25, a1
    v_accvgpr_read_b32 v26, a2
    v_accvgpr_read_b32 v27, a3
    v_lshlrev_b32 v64, 16, v24
    v_and_b32 v65, 0xffff0000, v24
    v_lshlrev_b32_e64 v66, 16, v25
    v_and_b32 v67, 0xffff0000, v25
    v_lshlrev_b32_e64 v68, 16, v26
    v_and_b32 v69, 0xffff0000, v26
    v_lshlrev_b32_e64 v70, 16, v27
    v_and_b32 v71, 0xffff0000, v27
    s_waitcnt vmcnt(43)
    v_accvgpr_read_b32 v24, a4
    v_accvgpr_read_b32 v25, a5
    v_accvgpr_read_b32 v26, a6
    v_accvgpr_read_b32 v27, a7
    v_lshlrev_b32 v72, 16, v24
    v_and_b32 v73, 0xffff0000, v24
    v_lshlrev_b32_e64 v74, 16, v25
    v_and_b32 v75, 0xffff0000, v25
    v_lshlrev_b32_e64 v76, 16, v26
    v_and_b32 v77, 0xffff0000, v26
    v_lshlrev_b32_e64 v78, 16, v27
    v_and_b32 v79, 0xffff0000, v27
    s_waitcnt vmcnt(42)
    v_accvgpr_read_b32 v24, a8
    v_accvgpr_read_b32 v25, a9
    v_accvgpr_read_b32 v26, a10
    v_accvgpr_read_b32 v27, a11
    v_lshlrev_b32 v80, 16, v24
    v_and_b32 v81, 0xffff0000, v24
    v_lshlrev_b32_e64 v82, 16, v25
    v_and_b32 v83, 0xffff0000, v25
    v_lshlrev_b32_e64 v84, 16, v26
    v_and_b32 v85, 0xffff0000, v26
    v_lshlrev_b32_e64 v86, 16, v27
    v_and_b32 v87, 0xffff0000, v27
    s_waitcnt vmcnt(41)
    v_accvgpr_read_b32 v24, a12
    v_accvgpr_read_b32 v25, a13
    v_accvgpr_read_b32 v26, a14
    v_accvgpr_read_b32 v27, a15
    v_lshlrev_b32 v88, 16, v24
    v_and_b32 v89, 0xffff0000, v24
    v_lshlrev_b32_e64 v90, 16, v25
    v_and_b32 v91, 0xffff0000, v25
    v_lshlrev_b32_e64 v92, 16, v26
    v_and_b32 v93, 0xffff0000, v26
    v_lshlrev_b32_e64 v94, 16, v27
    v_and_b32 v95, 0xffff0000, v27
    s_add_u32 s5, s31, 0x0
    buffer_load_dwordx4 a[140:143], v17, s[12:15], s5 offen offset:2048 nt
    s_add_u32 s5, s31, 0x1000
    buffer_load_dwordx4 a[144:147], v17, s[12:15], s5 offen offset:0 nt
    v_pk_mul_f32 v[96:97], v[64:65], v[56:57]
    v_pk_mul_f32 v[98:99], v[66:67], v[58:59]
    v_pk_mul_f32 v[100:101], v[68:69], v[60:61]
    v_pk_mul_f32 v[102:103], v[70:71], v[62:63]
    s_waitcnt vmcnt(42)
    v_accvgpr_read_b32 v24, a76
    v_accvgpr_read_b32 v25, a77
    v_accvgpr_read_b32 v26, a78
    v_accvgpr_read_b32 v27, a79
    v_lshlrev_b32_e64 v104, 16, v24
    v_and_b32 v105, 0xffff0000, v24
    v_lshlrev_b32_e64 v106, 16, v25
    v_and_b32 v107, 0xffff0000, v25
    v_lshlrev_b32_e64 v108, 16, v26
    v_and_b32 v109, 0xffff0000, v26
    v_lshlrev_b32_e64 v110, 16, v27
    v_and_b32 v111, 0xffff0000, v27
    v_pk_fma_f32 v[96:97], v[72:73], v[48:49], v[96:97]
    v_pk_fma_f32 v[98:99], v[74:75], v[50:51], v[98:99]
    v_pk_fma_f32 v[100:101], v[76:77], v[52:53], v[100:101]
    v_pk_fma_f32 v[102:103], v[78:79], v[54:55], v[102:103]
    v_pk_fma_f32 v[96:97], v[80:81], v[40:41], v[96:97]
    v_pk_fma_f32 v[98:99], v[82:83], v[42:43], v[98:99]
    v_pk_fma_f32 v[100:101], v[84:85], v[44:45], v[100:101]
    v_pk_fma_f32 v[102:103], v[86:87], v[46:47], v[102:103]
    v_pk_fma_f32 v[96:97], v[88:89], v[32:33], v[96:97]
    v_pk_fma_f32 v[98:99], v[90:91], v[34:35], v[98:99]
    v_pk_fma_f32 v[100:101], v[92:93], v[36:37], v[100:101]
    v_pk_fma_f32 v[102:103], v[94:95], v[38:39], v[102:103]
    v_pk_mul_f32 v[112:113], v[104:105], v[96:97]
    v_pk_mul_f32 v[114:115], v[106:107], v[98:99]
    v_pk_mul_f32 v[116:117], v[108:109], v[100:101]
    v_pk_mul_f32 v[118:119], v[110:111], v[102:103]
    s_waitcnt vmcnt(41)
    v_accvgpr_read_b32 v24, a16
    v_accvgpr_read_b32 v25, a17
    v_accvgpr_read_b32 v26, a18
    v_accvgpr_read_b32 v27, a19
    v_lshlrev_b32 v64, 16, v24
    v_and_b32 v65, 0xffff0000, v24
    v_lshlrev_b32_e64 v66, 16, v25
    v_and_b32 v67, 0xffff0000, v25
    v_lshlrev_b32_e64 v68, 16, v26
    v_and_b32 v69, 0xffff0000, v26
    v_lshlrev_b32_e64 v70, 16, v27
    v_and_b32 v71, 0xffff0000, v27
    s_add_u32 s5, s31, 0x1000
    buffer_load_dwordx4 a[148:151], v17, s[12:15], s5 offen offset:2048 nt
    s_add_u32 s5, s30, 0x0
    buffer_load_dwordx4 a[152:155], v17, s[12:15], s5 offen offset:0 nt
    v_pk_mul_f32 v[96:97], v[72:73], v[56:57]
    v_pk_mul_f32 v[98:99], v[74:75], v[58:59]
    v_pk_mul_f32 v[100:101], v[76:77], v[60:61]
    v_pk_mul_f32 v[102:103], v[78:79], v[62:63]
    s_waitcnt vmcnt(42)
    v_accvgpr_read_b32 v24, a80
    v_accvgpr_read_b32 v25, a81
    v_accvgpr_read_b32 v26, a82
    v_accvgpr_read_b32 v27, a83
    v_lshlrev_b32_e64 v104, 16, v24
    v_and_b32 v105, 0xffff0000, v24
    v_lshlrev_b32_e64 v106, 16, v25
    v_and_b32 v107, 0xffff0000, v25
    v_lshlrev_b32_e64 v108, 16, v26
    v_and_b32 v109, 0xffff0000, v26
    v_lshlrev_b32_e64 v110, 16, v27
    v_and_b32 v111, 0xffff0000, v27
    v_pk_fma_f32 v[96:97], v[80:81], v[48:49], v[96:97]
    v_pk_fma_f32 v[98:99], v[82:83], v[50:51], v[98:99]
    v_pk_fma_f32 v[100:101], v[84:85], v[52:53], v[100:101]
    v_pk_fma_f32 v[102:103], v[86:87], v[54:55], v[102:103]
    v_pk_fma_f32 v[96:97], v[88:89], v[40:41], v[96:97]
    v_pk_fma_f32 v[98:99], v[90:91], v[42:43], v[98:99]
    v_pk_fma_f32 v[100:101], v[92:93], v[44:45], v[100:101]
    v_pk_fma_f32 v[102:103], v[94:95], v[46:47], v[102:103]
    v_pk_fma_f32 v[96:97], v[64:65], v[32:33], v[96:97]
    v_pk_fma_f32 v[98:99], v[66:67], v[34:35], v[98:99]
    v_pk_fma_f32 v[100:101], v[68:69], v[36:37], v[100:101]
    v_pk_fma_f32 v[102:103], v[70:71], v[38:39], v[102:103]
    v_pk_mul_f32 v[120:121], v[104:105], v[96:97]
    v_pk_mul_f32 v[122:123], v[106:107], v[98:99]
    v_pk_mul_f32 v[124:125], v[108:109], v[100:101]
    v_pk_mul_f32 v[126:127], v[110:111], v[102:103]
    v_cvt_pk_bf16_f32 v135, v120, v112
    v_cvt_pk_bf16_f32 v143, v121, v113
    v_cvt_pk_bf16_f32 v151, v122, v114
    v_cvt_pk_bf16_f32 v159, v123, v115
    v_cvt_pk_bf16_f32 v167, v124, v116
    v_cvt_pk_bf16_f32 v175, v125, v117
    v_cvt_pk_bf16_f32 v183, v126, v118
    v_cvt_pk_bf16_f32 v191, v127, v119
    s_waitcnt vmcnt(41)
    v_accvgpr_read_b32 v24, a20
    v_accvgpr_read_b32 v25, a21
    v_accvgpr_read_b32 v26, a22
    v_accvgpr_read_b32 v27, a23
    v_lshlrev_b32 v72, 16, v24
    v_and_b32 v73, 0xffff0000, v24
    v_lshlrev_b32_e64 v74, 16, v25
    v_and_b32 v75, 0xffff0000, v25
    v_lshlrev_b32_e64 v76, 16, v26
    v_and_b32 v77, 0xffff0000, v26
    v_lshlrev_b32_e64 v78, 16, v27
    v_and_b32 v79, 0xffff0000, v27
    s_add_u32 s5, s30, 0x0
    buffer_load_dwordx4 v[192:195], v17, s[16:19], s5 offen offset:0 nt
    s_add_u32 s5, s30, 0x0
    buffer_load_dwordx4 a[156:159], v17, s[12:15], s5 offen offset:2048 nt
    v_pk_mul_f32 v[96:97], v[80:81], v[56:57]
    v_pk_mul_f32 v[98:99], v[82:83], v[58:59]
    v_pk_mul_f32 v[100:101], v[84:85], v[60:61]
    v_pk_mul_f32 v[102:103], v[86:87], v[62:63]
    s_waitcnt vmcnt(42)
    v_accvgpr_read_b32 v24, a84
    v_accvgpr_read_b32 v25, a85
    v_accvgpr_read_b32 v26, a86
    v_accvgpr_read_b32 v27, a87
    v_lshlrev_b32 v104, 16, v24
    v_and_b32 v105, 0xffff0000, v24
    v_lshlrev_b32_e64 v106, 16, v25
    v_and_b32 v107, 0xffff0000, v25
    v_lshlrev_b32_e64 v108, 16, v26
    v_and_b32 v109, 0xffff0000, v26
    v_lshlrev_b32_e64 v110, 16, v27
    v_and_b32 v111, 0xffff0000, v27
    v_pk_fma_f32 v[96:97], v[88:89], v[48:49], v[96:97]
    v_pk_fma_f32 v[98:99], v[90:91], v[50:51], v[98:99]
    v_pk_fma_f32 v[100:101], v[92:93], v[52:53], v[100:101]
    v_pk_fma_f32 v[102:103], v[94:95], v[54:55], v[102:103]
    v_pk_fma_f32 v[96:97], v[64:65], v[40:41], v[96:97]
    v_pk_fma_f32 v[98:99], v[66:67], v[42:43], v[98:99]
    v_pk_fma_f32 v[100:101], v[68:69], v[44:45], v[100:101]
    v_pk_fma_f32 v[102:103], v[70:71], v[46:47], v[102:103]
    v_pk_fma_f32 v[96:97], v[72:73], v[32:33], v[96:97]
    v_pk_fma_f32 v[98:99], v[74:75], v[34:35], v[98:99]
    v_pk_fma_f32 v[100:101], v[76:77], v[36:37], v[100:101]
    v_pk_fma_f32 v[102:103], v[78:79], v[38:39], v[102:103]
    v_pk_mul_f32 v[112:113], v[104:105], v[96:97]
    v_pk_mul_f32 v[114:115], v[106:107], v[98:99]
    v_pk_mul_f32 v[116:117], v[108:109], v[100:101]
    v_pk_mul_f32 v[118:119], v[110:111], v[102:103]
    s_waitcnt vmcnt(39)
    v_accvgpr_read_b32 v24, a24
    v_accvgpr_read_b32 v25, a25
    v_accvgpr_read_b32 v26, a26
    v_accvgpr_read_b32 v27, a27
    v_lshlrev_b32 v80, 16, v24
    v_and_b32 v81, 0xffff0000, v24
    v_lshlrev_b32_e64 v82, 16, v25
    v_and_b32 v83, 0xffff0000, v25
    v_lshlrev_b32_e64 v84, 16, v26
    v_and_b32 v85, 0xffff0000, v26
    v_lshlrev_b32_e64 v86, 16, v27
    v_and_b32 v87, 0xffff0000, v27
    s_add_u32 s5, s30, 0x0
    buffer_load_dwordx4 v[196:199], v17, s[16:19], s5 offen offset:2048 nt
    s_add_u32 s5, s30, 0x1000
    buffer_load_dwordx4 a[160:163], v17, s[12:15], s5 offen offset:0 nt
    v_pk_mul_f32 v[96:97], v[88:89], v[56:57]
    v_pk_mul_f32 v[98:99], v[90:91], v[58:59]
    v_pk_mul_f32 v[100:101], v[92:93], v[60:61]
    v_pk_mul_f32 v[102:103], v[94:95], v[62:63]
    s_waitcnt vmcnt(40)
    v_accvgpr_read_b32 v24, a88
    v_accvgpr_read_b32 v25, a89
    v_accvgpr_read_b32 v26, a90
    v_accvgpr_read_b32 v27, a91
    v_lshlrev_b32_e64 v104, 16, v24
    v_and_b32 v105, 0xffff0000, v24
    v_lshlrev_b32_e64 v106, 16, v25
    v_and_b32 v107, 0xffff0000, v25
    v_lshlrev_b32_e64 v108, 16, v26
    v_and_b32 v109, 0xffff0000, v26
    v_lshlrev_b32_e64 v110, 16, v27
    v_and_b32 v111, 0xffff0000, v27
    v_pk_fma_f32 v[96:97], v[64:65], v[48:49], v[96:97]
    v_pk_fma_f32 v[98:99], v[66:67], v[50:51], v[98:99]
    v_pk_fma_f32 v[100:101], v[68:69], v[52:53], v[100:101]
    v_pk_fma_f32 v[102:103], v[70:71], v[54:55], v[102:103]
    v_pk_fma_f32 v[96:97], v[72:73], v[40:41], v[96:97]
    v_pk_fma_f32 v[98:99], v[74:75], v[42:43], v[98:99]
    v_pk_fma_f32 v[100:101], v[76:77], v[44:45], v[100:101]
    v_pk_fma_f32 v[102:103], v[78:79], v[46:47], v[102:103]
    v_pk_fma_f32 v[96:97], v[80:81], v[32:33], v[96:97]
    v_pk_fma_f32 v[98:99], v[82:83], v[34:35], v[98:99]
    v_pk_fma_f32 v[100:101], v[84:85], v[36:37], v[100:101]
    v_pk_fma_f32 v[102:103], v[86:87], v[38:39], v[102:103]
    v_pk_mul_f32 v[120:121], v[104:105], v[96:97]
    v_pk_mul_f32 v[122:123], v[106:107], v[98:99]
    v_pk_mul_f32 v[124:125], v[108:109], v[100:101]
    v_pk_mul_f32 v[126:127], v[110:111], v[102:103]
    v_cvt_pk_bf16_f32 v134, v120, v112
    v_cvt_pk_bf16_f32 v142, v121, v113
    v_cvt_pk_bf16_f32 v150, v122, v114
    v_cvt_pk_bf16_f32 v158, v123, v115
    v_cvt_pk_bf16_f32 v166, v124, v116
    v_cvt_pk_bf16_f32 v174, v125, v117
    v_cvt_pk_bf16_f32 v182, v126, v118
    v_cvt_pk_bf16_f32 v190, v127, v119
    s_waitcnt vmcnt(39)
    v_accvgpr_read_b32 v24, a28
    v_accvgpr_read_b32 v25, a29
    v_accvgpr_read_b32 v26, a30
    v_accvgpr_read_b32 v27, a31
    v_lshlrev_b32 v88, 16, v24
    v_and_b32 v89, 0xffff0000, v24
    v_lshlrev_b32_e64 v90, 16, v25
    v_and_b32 v91, 0xffff0000, v25
    v_lshlrev_b32_e64 v92, 16, v26
    v_and_b32 v93, 0xffff0000, v26
    v_lshlrev_b32_e64 v94, 16, v27
    v_and_b32 v95, 0xffff0000, v27
    s_add_u32 s5, s30, 0x1000
    buffer_load_dwordx4 v[200:203], v17, s[16:19], s5 offen offset:0 nt
    s_add_u32 s5, s30, 0x1000
    buffer_load_dwordx4 a[164:167], v17, s[12:15], s5 offen offset:2048 nt
    v_pk_mul_f32 v[96:97], v[64:65], v[56:57]
    v_pk_mul_f32 v[98:99], v[66:67], v[58:59]
    v_pk_mul_f32 v[100:101], v[68:69], v[60:61]
    v_pk_mul_f32 v[102:103], v[70:71], v[62:63]
    s_waitcnt vmcnt(40)
    v_accvgpr_read_b32 v24, a92
    v_accvgpr_read_b32 v25, a93
    v_accvgpr_read_b32 v26, a94
    v_accvgpr_read_b32 v27, a95
    v_lshlrev_b32 v104, 16, v24
    v_and_b32 v105, 0xffff0000, v24
    v_lshlrev_b32_e64 v106, 16, v25
    v_and_b32 v107, 0xffff0000, v25
    v_lshlrev_b32_e64 v108, 16, v26
    v_and_b32 v109, 0xffff0000, v26
    v_lshlrev_b32_e64 v110, 16, v27
    v_and_b32 v111, 0xffff0000, v27
    v_pk_fma_f32 v[96:97], v[72:73], v[48:49], v[96:97]
    v_pk_fma_f32 v[98:99], v[74:75], v[50:51], v[98:99]
    v_pk_fma_f32 v[100:101], v[76:77], v[52:53], v[100:101]
    v_pk_fma_f32 v[102:103], v[78:79], v[54:55], v[102:103]
    v_pk_fma_f32 v[96:97], v[80:81], v[40:41], v[96:97]
    v_pk_fma_f32 v[98:99], v[82:83], v[42:43], v[98:99]
    v_pk_fma_f32 v[100:101], v[84:85], v[44:45], v[100:101]
    v_pk_fma_f32 v[102:103], v[86:87], v[46:47], v[102:103]
    v_pk_fma_f32 v[96:97], v[88:89], v[32:33], v[96:97]
    v_pk_fma_f32 v[98:99], v[90:91], v[34:35], v[98:99]
    v_pk_fma_f32 v[100:101], v[92:93], v[36:37], v[100:101]
    v_pk_fma_f32 v[102:103], v[94:95], v[38:39], v[102:103]
    v_pk_mul_f32 v[112:113], v[104:105], v[96:97]
    v_pk_mul_f32 v[114:115], v[106:107], v[98:99]
    v_pk_mul_f32 v[116:117], v[108:109], v[100:101]
    v_pk_mul_f32 v[118:119], v[110:111], v[102:103]
    s_waitcnt vmcnt(39)
    v_accvgpr_read_b32 v24, a32
    v_accvgpr_read_b32 v25, a33
    v_accvgpr_read_b32 v26, a34
    v_accvgpr_read_b32 v27, a35
    v_lshlrev_b32 v64, 16, v24
    v_and_b32 v65, 0xffff0000, v24
    v_lshlrev_b32_e64 v66, 16, v25
    v_and_b32 v67, 0xffff0000, v25
    v_lshlrev_b32_e64 v68, 16, v26
    v_and_b32 v69, 0xffff0000, v26
    v_lshlrev_b32_e64 v70, 16, v27
    v_and_b32 v71, 0xffff0000, v27
    s_add_u32 s5, s30, 0x1000
    buffer_load_dwordx4 v[204:207], v17, s[16:19], s5 offen offset:2048 nt
    s_add_u32 s5, s30, 0x2000
    buffer_load_dwordx4 a[168:171], v17, s[12:15], s5 offen offset:0 nt
    s_add_u32 s5, s30, 0x2000
    buffer_load_dwordx4 v[208:211], v17, s[16:19], s5 offen offset:0 nt
    v_pk_mul_f32 v[96:97], v[72:73], v[56:57]
    v_pk_mul_f32 v[98:99], v[74:75], v[58:59]
    v_pk_mul_f32 v[100:101], v[76:77], v[60:61]
    v_pk_mul_f32 v[102:103], v[78:79], v[62:63]
    s_waitcnt vmcnt(41)
    v_accvgpr_read_b32 v24, a96
    v_accvgpr_read_b32 v25, a97
    v_accvgpr_read_b32 v26, a98
    v_accvgpr_read_b32 v27, a99
    v_lshlrev_b32 v104, 16, v24
    v_and_b32 v105, 0xffff0000, v24
    v_lshlrev_b32_e64 v106, 16, v25
    v_and_b32 v107, 0xffff0000, v25
    v_lshlrev_b32_e64 v108, 16, v26
    v_and_b32 v109, 0xffff0000, v26
    v_lshlrev_b32_e64 v110, 16, v27
    v_and_b32 v111, 0xffff0000, v27
    v_pk_fma_f32 v[96:97], v[80:81], v[48:49], v[96:97]
    v_pk_fma_f32 v[98:99], v[82:83], v[50:51], v[98:99]
    v_pk_fma_f32 v[100:101], v[84:85], v[52:53], v[100:101]
    v_pk_fma_f32 v[102:103], v[86:87], v[54:55], v[102:103]
    v_pk_fma_f32 v[96:97], v[88:89], v[40:41], v[96:97]
    v_pk_fma_f32 v[98:99], v[90:91], v[42:43], v[98:99]
    v_pk_fma_f32 v[100:101], v[92:93], v[44:45], v[100:101]
    v_pk_fma_f32 v[102:103], v[94:95], v[46:47], v[102:103]
    v_pk_fma_f32 v[96:97], v[64:65], v[32:33], v[96:97]
    v_pk_fma_f32 v[98:99], v[66:67], v[34:35], v[98:99]
    v_pk_fma_f32 v[100:101], v[68:69], v[36:37], v[100:101]
    v_pk_fma_f32 v[102:103], v[70:71], v[38:39], v[102:103]
    v_pk_mul_f32 v[120:121], v[104:105], v[96:97]
    v_pk_mul_f32 v[122:123], v[106:107], v[98:99]
    v_pk_mul_f32 v[124:125], v[108:109], v[100:101]
    v_pk_mul_f32 v[126:127], v[110:111], v[102:103]
    v_cvt_pk_bf16_f32 v133, v120, v112
    v_cvt_pk_bf16_f32 v141, v121, v113
    v_cvt_pk_bf16_f32 v149, v122, v114
    v_cvt_pk_bf16_f32 v157, v123, v115
    v_cvt_pk_bf16_f32 v165, v124, v116
    v_cvt_pk_bf16_f32 v173, v125, v117
    v_cvt_pk_bf16_f32 v181, v126, v118
    v_cvt_pk_bf16_f32 v189, v127, v119
    s_waitcnt vmcnt(40)
    v_accvgpr_read_b32 v24, a36
    v_accvgpr_read_b32 v25, a37
    v_accvgpr_read_b32 v26, a38
    v_accvgpr_read_b32 v27, a39
    v_lshlrev_b32 v72, 16, v24
    v_and_b32 v73, 0xffff0000, v24
    v_lshlrev_b32_e64 v74, 16, v25
    v_and_b32 v75, 0xffff0000, v25
    v_lshlrev_b32_e64 v76, 16, v26
    v_and_b32 v77, 0xffff0000, v26
    v_lshlrev_b32_e64 v78, 16, v27
    v_and_b32 v79, 0xffff0000, v27
    s_add_u32 s5, s30, 0x2000
    buffer_load_dwordx4 a[172:175], v17, s[12:15], s5 offen offset:2048 nt
    s_add_u32 s5, s30, 0x2000
    buffer_load_dwordx4 v[212:215], v17, s[16:19], s5 offen offset:2048 nt
    v_pk_mul_f32 v[96:97], v[80:81], v[56:57]
    v_pk_mul_f32 v[98:99], v[82:83], v[58:59]
    v_pk_mul_f32 v[100:101], v[84:85], v[60:61]
    v_pk_mul_f32 v[102:103], v[86:87], v[62:63]
    s_waitcnt vmcnt(41)
    v_accvgpr_read_b32 v24, a100
    v_accvgpr_read_b32 v25, a101
    v_accvgpr_read_b32 v26, a102
    v_accvgpr_read_b32 v27, a103
    v_lshlrev_b32 v104, 16, v24
    v_and_b32 v105, 0xffff0000, v24
    v_lshlrev_b32_e64 v106, 16, v25
    v_and_b32 v107, 0xffff0000, v25
    v_lshlrev_b32_e64 v108, 16, v26
    v_and_b32 v109, 0xffff0000, v26
    v_lshlrev_b32_e64 v110, 16, v27
    v_and_b32 v111, 0xffff0000, v27
    v_pk_fma_f32 v[96:97], v[88:89], v[48:49], v[96:97]
    v_pk_fma_f32 v[98:99], v[90:91], v[50:51], v[98:99]
    v_pk_fma_f32 v[100:101], v[92:93], v[52:53], v[100:101]
    v_pk_fma_f32 v[102:103], v[94:95], v[54:55], v[102:103]
    v_pk_fma_f32 v[96:97], v[64:65], v[40:41], v[96:97]
    v_pk_fma_f32 v[98:99], v[66:67], v[42:43], v[98:99]
    v_pk_fma_f32 v[100:101], v[68:69], v[44:45], v[100:101]
    v_pk_fma_f32 v[102:103], v[70:71], v[46:47], v[102:103]
    v_pk_fma_f32 v[96:97], v[72:73], v[32:33], v[96:97]
    v_pk_fma_f32 v[98:99], v[74:75], v[34:35], v[98:99]
    v_pk_fma_f32 v[100:101], v[76:77], v[36:37], v[100:101]
    v_pk_fma_f32 v[102:103], v[78:79], v[38:39], v[102:103]
    v_pk_mul_f32 v[112:113], v[104:105], v[96:97]
    v_pk_mul_f32 v[114:115], v[106:107], v[98:99]
    v_pk_mul_f32 v[116:117], v[108:109], v[100:101]
    v_pk_mul_f32 v[118:119], v[110:111], v[102:103]
    s_waitcnt vmcnt(40)
    v_accvgpr_read_b32 v24, a40
    v_accvgpr_read_b32 v25, a41
    v_accvgpr_read_b32 v26, a42
    v_accvgpr_read_b32 v27, a43
    v_lshlrev_b32 v80, 16, v24
    v_and_b32 v81, 0xffff0000, v24
    v_lshlrev_b32_e64 v82, 16, v25
    v_and_b32 v83, 0xffff0000, v25
    v_lshlrev_b32_e64 v84, 16, v26
    v_and_b32 v85, 0xffff0000, v26
    v_lshlrev_b32_e64 v86, 16, v27
    v_and_b32 v87, 0xffff0000, v27
    s_add_u32 s5, s30, 0x3000
    buffer_load_dwordx4 a[176:179], v17, s[12:15], s5 offen offset:0 nt
    s_add_u32 s5, s30, 0x3000
    buffer_load_dwordx4 v[216:219], v17, s[16:19], s5 offen offset:0 nt
    v_pk_mul_f32 v[96:97], v[88:89], v[56:57]
    v_pk_mul_f32 v[98:99], v[90:91], v[58:59]
    v_pk_mul_f32 v[100:101], v[92:93], v[60:61]
    v_pk_mul_f32 v[102:103], v[94:95], v[62:63]
    s_waitcnt vmcnt(41)
    v_accvgpr_read_b32 v24, a104
    v_accvgpr_read_b32 v25, a105
    v_accvgpr_read_b32 v26, a106
    v_accvgpr_read_b32 v27, a107
    v_lshlrev_b32 v104, 16, v24
    v_and_b32 v105, 0xffff0000, v24
    v_lshlrev_b32_e64 v106, 16, v25
    v_and_b32 v107, 0xffff0000, v25
    v_lshlrev_b32_e64 v108, 16, v26
    v_and_b32 v109, 0xffff0000, v26
    v_lshlrev_b32_e64 v110, 16, v27
    v_and_b32 v111, 0xffff0000, v27
    v_pk_fma_f32 v[96:97], v[64:65], v[48:49], v[96:97]
    v_pk_fma_f32 v[98:99], v[66:67], v[50:51], v[98:99]
    v_pk_fma_f32 v[100:101], v[68:69], v[52:53], v[100:101]
    v_pk_fma_f32 v[102:103], v[70:71], v[54:55], v[102:103]
    v_pk_fma_f32 v[96:97], v[72:73], v[40:41], v[96:97]
    v_pk_fma_f32 v[98:99], v[74:75], v[42:43], v[98:99]
    v_pk_fma_f32 v[100:101], v[76:77], v[44:45], v[100:101]
    v_pk_fma_f32 v[102:103], v[78:79], v[46:47], v[102:103]
    v_pk_fma_f32 v[96:97], v[80:81], v[32:33], v[96:97]
    v_pk_fma_f32 v[98:99], v[82:83], v[34:35], v[98:99]
    v_pk_fma_f32 v[100:101], v[84:85], v[36:37], v[100:101]
    v_pk_fma_f32 v[102:103], v[86:87], v[38:39], v[102:103]
    v_pk_mul_f32 v[120:121], v[104:105], v[96:97]
    v_pk_mul_f32 v[122:123], v[106:107], v[98:99]
    v_pk_mul_f32 v[124:125], v[108:109], v[100:101]
    v_pk_mul_f32 v[126:127], v[110:111], v[102:103]
    v_cvt_pk_bf16_f32 v132, v120, v112
    v_cvt_pk_bf16_f32 v140, v121, v113
    v_cvt_pk_bf16_f32 v148, v122, v114
    v_cvt_pk_bf16_f32 v156, v123, v115
    v_cvt_pk_bf16_f32 v164, v124, v116
    v_cvt_pk_bf16_f32 v172, v125, v117
    v_cvt_pk_bf16_f32 v180, v126, v118
    v_cvt_pk_bf16_f32 v188, v127, v119
    s_waitcnt vmcnt(40)
    v_accvgpr_read_b32 v24, a44
    v_accvgpr_read_b32 v25, a45
    v_accvgpr_read_b32 v26, a46
    v_accvgpr_read_b32 v27, a47
    v_lshlrev_b32 v88, 16, v24
    v_and_b32 v89, 0xffff0000, v24
    v_lshlrev_b32_e64 v90, 16, v25
    v_and_b32 v91, 0xffff0000, v25
    v_lshlrev_b32_e64 v92, 16, v26
    v_and_b32 v93, 0xffff0000, v26
    v_lshlrev_b32_e64 v94, 16, v27
    v_and_b32 v95, 0xffff0000, v27
    s_add_u32 s5, s30, 0x3000
    buffer_load_dwordx4 a[180:183], v17, s[12:15], s5 offen offset:2048 nt
    s_add_u32 s5, s30, 0x3000
    buffer_load_dwordx4 v[220:223], v17, s[16:19], s5 offen offset:2048 nt
    v_pk_mul_f32 v[96:97], v[64:65], v[56:57]
    v_pk_mul_f32 v[98:99], v[66:67], v[58:59]
    v_pk_mul_f32 v[100:101], v[68:69], v[60:61]
    v_pk_mul_f32 v[102:103], v[70:71], v[62:63]
    s_waitcnt vmcnt(41)
    v_accvgpr_read_b32 v24, a108
    v_accvgpr_read_b32 v25, a109
    v_accvgpr_read_b32 v26, a110
    v_accvgpr_read_b32 v27, a111
    v_lshlrev_b32 v104, 16, v24
    v_and_b32 v105, 0xffff0000, v24
    v_lshlrev_b32_e64 v106, 16, v25
    v_and_b32 v107, 0xffff0000, v25
    v_lshlrev_b32_e64 v108, 16, v26
    v_and_b32 v109, 0xffff0000, v26
    v_lshlrev_b32_e64 v110, 16, v27
    v_and_b32 v111, 0xffff0000, v27
    v_pk_fma_f32 v[96:97], v[72:73], v[48:49], v[96:97]
    v_pk_fma_f32 v[98:99], v[74:75], v[50:51], v[98:99]
    v_pk_fma_f32 v[100:101], v[76:77], v[52:53], v[100:101]
    v_pk_fma_f32 v[102:103], v[78:79], v[54:55], v[102:103]
    v_pk_fma_f32 v[96:97], v[80:81], v[40:41], v[96:97]
    v_pk_fma_f32 v[98:99], v[82:83], v[42:43], v[98:99]
    v_pk_fma_f32 v[100:101], v[84:85], v[44:45], v[100:101]
    v_pk_fma_f32 v[102:103], v[86:87], v[46:47], v[102:103]
    v_pk_fma_f32 v[96:97], v[88:89], v[32:33], v[96:97]
    v_pk_fma_f32 v[98:99], v[90:91], v[34:35], v[98:99]
    v_pk_fma_f32 v[100:101], v[92:93], v[36:37], v[100:101]
    v_pk_fma_f32 v[102:103], v[94:95], v[38:39], v[102:103]
    v_pk_mul_f32 v[112:113], v[104:105], v[96:97]
    v_pk_mul_f32 v[114:115], v[106:107], v[98:99]
    v_pk_mul_f32 v[116:117], v[108:109], v[100:101]
    v_pk_mul_f32 v[118:119], v[110:111], v[102:103]
    s_waitcnt vmcnt(40)
    v_accvgpr_read_b32 v24, a48
    v_accvgpr_read_b32 v25, a49
    v_accvgpr_read_b32 v26, a50
    v_accvgpr_read_b32 v27, a51
    v_lshlrev_b32 v64, 16, v24
    v_and_b32 v65, 0xffff0000, v24
    v_lshlrev_b32_e64 v66, 16, v25
    v_and_b32 v67, 0xffff0000, v25
    v_lshlrev_b32_e64 v68, 16, v26
    v_and_b32 v69, 0xffff0000, v26
    v_lshlrev_b32_e64 v70, 16, v27
    v_and_b32 v71, 0xffff0000, v27
    s_add_u32 s5, s30, 0x4000
    buffer_load_dwordx4 a[184:187], v17, s[12:15], s5 offen offset:0 nt
    s_add_u32 s5, s30, 0x4000
    buffer_load_dwordx4 v[224:227], v17, s[16:19], s5 offen offset:0 nt
    v_pk_mul_f32 v[96:97], v[72:73], v[56:57]
    v_pk_mul_f32 v[98:99], v[74:75], v[58:59]
    v_pk_mul_f32 v[100:101], v[76:77], v[60:61]
    v_pk_mul_f32 v[102:103], v[78:79], v[62:63]
    s_waitcnt vmcnt(39)
    v_accvgpr_read_b32 v24, a112
    v_accvgpr_read_b32 v25, a113
    v_accvgpr_read_b32 v26, a114
    v_accvgpr_read_b32 v27, a115
    v_lshlrev_b32 v104, 16, v24
    v_and_b32 v105, 0xffff0000, v24
    v_lshlrev_b32_e64 v106, 16, v25
    v_and_b32 v107, 0xffff0000, v25
    v_lshlrev_b32_e64 v108, 16, v26
    v_and_b32 v109, 0xffff0000, v26
    v_lshlrev_b32_e64 v110, 16, v27
    v_and_b32 v111, 0xffff0000, v27
    v_pk_fma_f32 v[96:97], v[80:81], v[48:49], v[96:97]
    v_pk_fma_f32 v[98:99], v[82:83], v[50:51], v[98:99]
    v_pk_fma_f32 v[100:101], v[84:85], v[52:53], v[100:101]
    v_pk_fma_f32 v[102:103], v[86:87], v[54:55], v[102:103]
    v_pk_fma_f32 v[96:97], v[88:89], v[40:41], v[96:97]
    v_pk_fma_f32 v[98:99], v[90:91], v[42:43], v[98:99]
    v_pk_fma_f32 v[100:101], v[92:93], v[44:45], v[100:101]
    v_pk_fma_f32 v[102:103], v[94:95], v[46:47], v[102:103]
    v_pk_fma_f32 v[96:97], v[64:65], v[32:33], v[96:97]
    v_pk_fma_f32 v[98:99], v[66:67], v[34:35], v[98:99]
    v_pk_fma_f32 v[100:101], v[68:69], v[36:37], v[100:101]
    v_pk_fma_f32 v[102:103], v[70:71], v[38:39], v[102:103]
    v_pk_mul_f32 v[120:121], v[104:105], v[96:97]
    v_pk_mul_f32 v[122:123], v[106:107], v[98:99]
    v_pk_mul_f32 v[124:125], v[108:109], v[100:101]
    v_pk_mul_f32 v[126:127], v[110:111], v[102:103]
    v_cvt_pk_bf16_f32 v131, v120, v112
    v_cvt_pk_bf16_f32 v139, v121, v113
    v_cvt_pk_bf16_f32 v147, v122, v114
    v_cvt_pk_bf16_f32 v155, v123, v115
    v_cvt_pk_bf16_f32 v163, v124, v116
    v_cvt_pk_bf16_f32 v171, v125, v117
    v_cvt_pk_bf16_f32 v179, v126, v118
    v_cvt_pk_bf16_f32 v187, v127, v119
    s_waitcnt vmcnt(38)
    v_accvgpr_read_b32 v24, a52
    v_accvgpr_read_b32 v25, a53
    v_accvgpr_read_b32 v26, a54
    v_accvgpr_read_b32 v27, a55
    v_lshlrev_b32 v72, 16, v24
    v_and_b32 v73, 0xffff0000, v24
    v_lshlrev_b32_e64 v74, 16, v25
    v_and_b32 v75, 0xffff0000, v25
    v_lshlrev_b32_e64 v76, 16, v26
    v_and_b32 v77, 0xffff0000, v26
    v_lshlrev_b32_e64 v78, 16, v27
    v_and_b32 v79, 0xffff0000, v27
    s_add_u32 s5, s30, 0x4000
    buffer_load_dwordx4 a[188:191], v17, s[12:15], s5 offen offset:2048 nt
    s_add_u32 s5, s30, 0x4000
    buffer_load_dwordx4 v[228:231], v17, s[16:19], s5 offen offset:2048 nt
    s_add_u32 s5, s30, 0x5000
    buffer_load_dwordx4 a[192:195], v17, s[12:15], s5 offen offset:0 nt
    v_pk_mul_f32 v[96:97], v[80:81], v[56:57]
    v_pk_mul_f32 v[98:99], v[82:83], v[58:59]
    v_pk_mul_f32 v[100:101], v[84:85], v[60:61]
    v_pk_mul_f32 v[102:103], v[86:87], v[62:63]
    s_waitcnt vmcnt(40)
    v_accvgpr_read_b32 v24, a116
    v_accvgpr_read_b32 v25, a117
    v_accvgpr_read_b32 v26, a118
    v_accvgpr_read_b32 v27, a119
    v_lshlrev_b32 v104, 16, v24
    v_and_b32 v105, 0xffff0000, v24
    v_lshlrev_b32_e64 v106, 16, v25
    v_and_b32 v107, 0xffff0000, v25
    v_lshlrev_b32_e64 v108, 16, v26
    v_and_b32 v109, 0xffff0000, v26
    v_lshlrev_b32_e64 v110, 16, v27
    v_and_b32 v111, 0xffff0000, v27
    v_pk_fma_f32 v[96:97], v[88:89], v[48:49], v[96:97]
    v_pk_fma_f32 v[98:99], v[90:91], v[50:51], v[98:99]
    v_pk_fma_f32 v[100:101], v[92:93], v[52:53], v[100:101]
    v_pk_fma_f32 v[102:103], v[94:95], v[54:55], v[102:103]
    v_pk_fma_f32 v[96:97], v[64:65], v[40:41], v[96:97]
    v_pk_fma_f32 v[98:99], v[66:67], v[42:43], v[98:99]
    v_pk_fma_f32 v[100:101], v[68:69], v[44:45], v[100:101]
    v_pk_fma_f32 v[102:103], v[70:71], v[46:47], v[102:103]
    v_pk_fma_f32 v[96:97], v[72:73], v[32:33], v[96:97]
    v_pk_fma_f32 v[98:99], v[74:75], v[34:35], v[98:99]
    v_pk_fma_f32 v[100:101], v[76:77], v[36:37], v[100:101]
    v_pk_fma_f32 v[102:103], v[78:79], v[38:39], v[102:103]
    v_pk_mul_f32 v[112:113], v[104:105], v[96:97]
    v_pk_mul_f32 v[114:115], v[106:107], v[98:99]
    v_pk_mul_f32 v[116:117], v[108:109], v[100:101]
    v_pk_mul_f32 v[118:119], v[110:111], v[102:103]
    s_waitcnt vmcnt(39)
    v_accvgpr_read_b32 v24, a56
    v_accvgpr_read_b32 v25, a57
    v_accvgpr_read_b32 v26, a58
    v_accvgpr_read_b32 v27, a59
    v_lshlrev_b32 v80, 16, v24
    v_and_b32 v81, 0xffff0000, v24
    v_lshlrev_b32_e64 v82, 16, v25
    v_and_b32 v83, 0xffff0000, v25
    v_lshlrev_b32_e64 v84, 16, v26
    v_and_b32 v85, 0xffff0000, v26
    v_lshlrev_b32_e64 v86, 16, v27
    v_and_b32 v87, 0xffff0000, v27
    s_add_u32 s5, s30, 0x5000
    buffer_load_dwordx4 v[232:235], v17, s[16:19], s5 offen offset:0 nt
    s_add_u32 s5, s30, 0x5000
    buffer_load_dwordx4 a[196:199], v17, s[12:15], s5 offen offset:2048 nt
    v_pk_mul_f32 v[96:97], v[88:89], v[56:57]
    v_pk_mul_f32 v[98:99], v[90:91], v[58:59]
    v_pk_mul_f32 v[100:101], v[92:93], v[60:61]
    v_pk_mul_f32 v[102:103], v[94:95], v[62:63]
    s_waitcnt vmcnt(40)
    v_accvgpr_read_b32 v24, a120
    v_accvgpr_read_b32 v25, a121
    v_accvgpr_read_b32 v26, a122
    v_accvgpr_read_b32 v27, a123
    v_lshlrev_b32 v104, 16, v24
    v_and_b32 v105, 0xffff0000, v24
    v_lshlrev_b32_e64 v106, 16, v25
    v_and_b32 v107, 0xffff0000, v25
    v_lshlrev_b32_e64 v108, 16, v26
    v_and_b32 v109, 0xffff0000, v26
    v_lshlrev_b32_e64 v110, 16, v27
    v_and_b32 v111, 0xffff0000, v27
    v_pk_fma_f32 v[96:97], v[64:65], v[48:49], v[96:97]
    v_pk_fma_f32 v[98:99], v[66:67], v[50:51], v[98:99]
    v_pk_fma_f32 v[100:101], v[68:69], v[52:53], v[100:101]
    v_pk_fma_f32 v[102:103], v[70:71], v[54:55], v[102:103]
    v_pk_fma_f32 v[96:97], v[72:73], v[40:41], v[96:97]
    v_pk_fma_f32 v[98:99], v[74:75], v[42:43], v[98:99]
    v_pk_fma_f32 v[100:101], v[76:77], v[44:45], v[100:101]
    v_pk_fma_f32 v[102:103], v[78:79], v[46:47], v[102:103]
    v_pk_fma_f32 v[96:97], v[80:81], v[32:33], v[96:97]
    v_pk_fma_f32 v[98:99], v[82:83], v[34:35], v[98:99]
    v_pk_fma_f32 v[100:101], v[84:85], v[36:37], v[100:101]
    v_pk_fma_f32 v[102:103], v[86:87], v[38:39], v[102:103]
    v_pk_mul_f32 v[120:121], v[104:105], v[96:97]
    v_pk_mul_f32 v[122:123], v[106:107], v[98:99]
    v_pk_mul_f32 v[124:125], v[108:109], v[100:101]
    v_pk_mul_f32 v[126:127], v[110:111], v[102:103]
    v_cvt_pk_bf16_f32 v130, v120, v112
    v_cvt_pk_bf16_f32 v138, v121, v113
    v_cvt_pk_bf16_f32 v146, v122, v114
    v_cvt_pk_bf16_f32 v154, v123, v115
    v_cvt_pk_bf16_f32 v162, v124, v116
    v_cvt_pk_bf16_f32 v170, v125, v117
    v_cvt_pk_bf16_f32 v178, v126, v118
    v_cvt_pk_bf16_f32 v186, v127, v119
    s_waitcnt vmcnt(39)
    v_accvgpr_read_b32 v24, a60
    v_accvgpr_read_b32 v25, a61
    v_accvgpr_read_b32 v26, a62
    v_accvgpr_read_b32 v27, a63
    v_lshlrev_b32 v88, 16, v24
    v_and_b32 v89, 0xffff0000, v24
    v_lshlrev_b32_e64 v90, 16, v25
    v_and_b32 v91, 0xffff0000, v25
    v_lshlrev_b32_e64 v92, 16, v26
    v_and_b32 v93, 0xffff0000, v26
    v_lshlrev_b32_e64 v94, 16, v27
    v_and_b32 v95, 0xffff0000, v27
    s_add_u32 s5, s30, 0x5000
    buffer_load_dwordx4 v[236:239], v17, s[16:19], s5 offen offset:2048 nt
    s_add_u32 s5, s30, 0x6000
    buffer_load_dwordx4 a[200:203], v17, s[12:15], s5 offen offset:0 nt
    v_pk_mul_f32 v[96:97], v[64:65], v[56:57]
    v_pk_mul_f32 v[98:99], v[66:67], v[58:59]
    v_pk_mul_f32 v[100:101], v[68:69], v[60:61]
    v_pk_mul_f32 v[102:103], v[70:71], v[62:63]
    s_waitcnt vmcnt(40)
    v_accvgpr_read_b32 v24, a124
    v_accvgpr_read_b32 v25, a125
    v_accvgpr_read_b32 v26, a126
    v_accvgpr_read_b32 v27, a127
    v_lshlrev_b32 v104, 16, v24
    v_and_b32 v105, 0xffff0000, v24
    v_lshlrev_b32_e64 v106, 16, v25
    v_and_b32 v107, 0xffff0000, v25
    v_lshlrev_b32_e64 v108, 16, v26
    v_and_b32 v109, 0xffff0000, v26
    v_lshlrev_b32_e64 v110, 16, v27
    v_and_b32 v111, 0xffff0000, v27
    v_pk_fma_f32 v[96:97], v[72:73], v[48:49], v[96:97]
    v_pk_fma_f32 v[98:99], v[74:75], v[50:51], v[98:99]
    v_pk_fma_f32 v[100:101], v[76:77], v[52:53], v[100:101]
    v_pk_fma_f32 v[102:103], v[78:79], v[54:55], v[102:103]
    v_pk_fma_f32 v[96:97], v[80:81], v[40:41], v[96:97]
    v_pk_fma_f32 v[98:99], v[82:83], v[42:43], v[98:99]
    v_pk_fma_f32 v[100:101], v[84:85], v[44:45], v[100:101]
    v_pk_fma_f32 v[102:103], v[86:87], v[46:47], v[102:103]
    v_pk_fma_f32 v[96:97], v[88:89], v[32:33], v[96:97]
    v_pk_fma_f32 v[98:99], v[90:91], v[34:35], v[98:99]
    v_pk_fma_f32 v[100:101], v[92:93], v[36:37], v[100:101]
    v_pk_fma_f32 v[102:103], v[94:95], v[38:39], v[102:103]
    v_pk_mul_f32 v[112:113], v[104:105], v[96:97]
    v_pk_mul_f32 v[114:115], v[106:107], v[98:99]
    v_pk_mul_f32 v[116:117], v[108:109], v[100:101]
    v_pk_mul_f32 v[118:119], v[110:111], v[102:103]
    s_waitcnt vmcnt(39)
    v_accvgpr_read_b32 v24, a64
    v_accvgpr_read_b32 v25, a65
    v_accvgpr_read_b32 v26, a66
    v_accvgpr_read_b32 v27, a67
    v_lshlrev_b32 v64, 16, v24
    v_and_b32 v65, 0xffff0000, v24
    v_lshlrev_b32_e64 v66, 16, v25
    v_and_b32 v67, 0xffff0000, v25
    v_lshlrev_b32_e64 v68, 16, v26
    v_and_b32 v69, 0xffff0000, v26
    v_lshlrev_b32_e64 v70, 16, v27
    v_and_b32 v71, 0xffff0000, v27
    s_add_u32 s5, s30, 0x6000
    buffer_load_dwordx4 v[240:243], v17, s[16:19], s5 offen offset:0 nt
    s_add_u32 s5, s30, 0x6000
    buffer_load_dwordx4 a[204:207], v17, s[12:15], s5 offen offset:2048 nt
    v_pk_mul_f32 v[96:97], v[72:73], v[56:57]
    v_pk_mul_f32 v[98:99], v[74:75], v[58:59]
    v_pk_mul_f32 v[100:101], v[76:77], v[60:61]
    v_pk_mul_f32 v[102:103], v[78:79], v[62:63]
    s_waitcnt vmcnt(40)
    v_accvgpr_read_b32 v24, a128
    v_accvgpr_read_b32 v25, a129
    v_accvgpr_read_b32 v26, a130
    v_accvgpr_read_b32 v27, a131
    v_lshlrev_b32 v104, 16, v24
    v_and_b32 v105, 0xffff0000, v24
    v_lshlrev_b32_e64 v106, 16, v25
    v_and_b32 v107, 0xffff0000, v25
    v_lshlrev_b32_e64 v108, 16, v26
    v_and_b32 v109, 0xffff0000, v26
    v_lshlrev_b32_e64 v110, 16, v27
    v_and_b32 v111, 0xffff0000, v27
    v_pk_fma_f32 v[96:97], v[80:81], v[48:49], v[96:97]
    v_pk_fma_f32 v[98:99], v[82:83], v[50:51], v[98:99]
    v_pk_fma_f32 v[100:101], v[84:85], v[52:53], v[100:101]
    v_pk_fma_f32 v[102:103], v[86:87], v[54:55], v[102:103]
    v_pk_fma_f32 v[96:97], v[88:89], v[40:41], v[96:97]
    v_pk_fma_f32 v[98:99], v[90:91], v[42:43], v[98:99]
    v_pk_fma_f32 v[100:101], v[92:93], v[44:45], v[100:101]
    v_pk_fma_f32 v[102:103], v[94:95], v[46:47], v[102:103]
    v_pk_fma_f32 v[96:97], v[64:65], v[32:33], v[96:97]
    v_pk_fma_f32 v[98:99], v[66:67], v[34:35], v[98:99]
    v_pk_fma_f32 v[100:101], v[68:69], v[36:37], v[100:101]
    v_pk_fma_f32 v[102:103], v[70:71], v[38:39], v[102:103]
    v_pk_mul_f32 v[120:121], v[104:105], v[96:97]
    v_pk_mul_f32 v[122:123], v[106:107], v[98:99]
    v_pk_mul_f32 v[124:125], v[108:109], v[100:101]
    v_pk_mul_f32 v[126:127], v[110:111], v[102:103]
    v_cvt_pk_bf16_f32 v129, v120, v112
    v_cvt_pk_bf16_f32 v137, v121, v113
    v_cvt_pk_bf16_f32 v145, v122, v114
    v_cvt_pk_bf16_f32 v153, v123, v115
    v_cvt_pk_bf16_f32 v161, v124, v116
    v_cvt_pk_bf16_f32 v169, v125, v117
    v_cvt_pk_bf16_f32 v177, v126, v118
    v_cvt_pk_bf16_f32 v185, v127, v119
    s_waitcnt vmcnt(39)
    v_accvgpr_read_b32 v24, a68
    v_accvgpr_read_b32 v25, a69
    v_accvgpr_read_b32 v26, a70
    v_accvgpr_read_b32 v27, a71
    v_lshlrev_b32 v72, 16, v24
    v_and_b32 v73, 0xffff0000, v24
    v_lshlrev_b32_e64 v74, 16, v25
    v_and_b32 v75, 0xffff0000, v25
    v_lshlrev_b32_e64 v76, 16, v26
    v_and_b32 v77, 0xffff0000, v26
    v_lshlrev_b32_e64 v78, 16, v27
    v_and_b32 v79, 0xffff0000, v27
    s_add_u32 s5, s30, 0x6000
    buffer_load_dwordx4 v[244:247], v17, s[16:19], s5 offen offset:2048 nt
    s_add_u32 s5, s30, 0x7000
    buffer_load_dwordx4 a[208:211], v17, s[12:15], s5 offen offset:0 nt
    v_pk_mul_f32 v[96:97], v[80:81], v[56:57]
    v_pk_mul_f32 v[98:99], v[82:83], v[58:59]
    v_pk_mul_f32 v[100:101], v[84:85], v[60:61]
    v_pk_mul_f32 v[102:103], v[86:87], v[62:63]
    s_waitcnt vmcnt(40)
    v_accvgpr_read_b32 v24, a132
    v_accvgpr_read_b32 v25, a133
    v_accvgpr_read_b32 v26, a134
    v_accvgpr_read_b32 v27, a135
    v_lshlrev_b32 v104, 16, v24
    v_and_b32 v105, 0xffff0000, v24
    v_lshlrev_b32_e64 v106, 16, v25
    v_and_b32 v107, 0xffff0000, v25
    v_lshlrev_b32_e64 v108, 16, v26
    v_and_b32 v109, 0xffff0000, v26
    v_lshlrev_b32_e64 v110, 16, v27
    v_and_b32 v111, 0xffff0000, v27
    v_pk_fma_f32 v[96:97], v[88:89], v[48:49], v[96:97]
    v_pk_fma_f32 v[98:99], v[90:91], v[50:51], v[98:99]
    v_pk_fma_f32 v[100:101], v[92:93], v[52:53], v[100:101]
    v_pk_fma_f32 v[102:103], v[94:95], v[54:55], v[102:103]
    v_pk_fma_f32 v[96:97], v[64:65], v[40:41], v[96:97]
    v_pk_fma_f32 v[98:99], v[66:67], v[42:43], v[98:99]
    v_pk_fma_f32 v[100:101], v[68:69], v[44:45], v[100:101]
    v_pk_fma_f32 v[102:103], v[70:71], v[46:47], v[102:103]
    v_pk_fma_f32 v[96:97], v[72:73], v[32:33], v[96:97]
    v_pk_fma_f32 v[98:99], v[74:75], v[34:35], v[98:99]
    v_pk_fma_f32 v[100:101], v[76:77], v[36:37], v[100:101]
    v_pk_fma_f32 v[102:103], v[78:79], v[38:39], v[102:103]
    v_pk_mul_f32 v[112:113], v[104:105], v[96:97]
    v_pk_mul_f32 v[114:115], v[106:107], v[98:99]
    v_pk_mul_f32 v[116:117], v[108:109], v[100:101]
    v_pk_mul_f32 v[118:119], v[110:111], v[102:103]
    s_waitcnt vmcnt(39)
    v_accvgpr_read_b32 v24, a72
    v_accvgpr_read_b32 v25, a73
    v_accvgpr_read_b32 v26, a74
    v_accvgpr_read_b32 v27, a75
    v_lshlrev_b32 v80, 16, v24
    v_and_b32 v81, 0xffff0000, v24
    v_lshlrev_b32_e64 v82, 16, v25
    v_and_b32 v83, 0xffff0000, v25
    v_lshlrev_b32_e64 v84, 16, v26
    v_and_b32 v85, 0xffff0000, v26
    v_lshlrev_b32_e64 v86, 16, v27
    v_and_b32 v87, 0xffff0000, v27
    s_add_u32 s5, s30, 0x7000
    buffer_load_dwordx4 v[248:251], v17, s[16:19], s5 offen offset:0 nt
    s_add_u32 s5, s30, 0x7000
    buffer_load_dwordx4 a[212:215], v17, s[12:15], s5 offen offset:2048 nt
    s_add_u32 s5, s30, 0x7000
    buffer_load_dwordx4 v[252:255], v17, s[16:19], s5 offen offset:2048 nt
    v_pk_mul_f32 v[96:97], v[88:89], v[56:57]
    v_pk_mul_f32 v[98:99], v[90:91], v[58:59]
    v_pk_mul_f32 v[100:101], v[92:93], v[60:61]
    v_pk_mul_f32 v[102:103], v[94:95], v[62:63]
    s_waitcnt vmcnt(41)
    v_accvgpr_read_b32 v24, a136
    v_accvgpr_read_b32 v25, a137
    v_accvgpr_read_b32 v26, a138
    v_accvgpr_read_b32 v27, a139
    v_lshlrev_b32 v104, 16, v24
    v_and_b32 v105, 0xffff0000, v24
    v_lshlrev_b32_e64 v106, 16, v25
    v_and_b32 v107, 0xffff0000, v25
    v_lshlrev_b32_e64 v108, 16, v26
    v_and_b32 v109, 0xffff0000, v26
    v_lshlrev_b32_e64 v110, 16, v27
    v_and_b32 v111, 0xffff0000, v27
    v_pk_fma_f32 v[96:97], v[64:65], v[48:49], v[96:97]
    v_pk_fma_f32 v[98:99], v[66:67], v[50:51], v[98:99]
    v_pk_fma_f32 v[100:101], v[68:69], v[52:53], v[100:101]
    v_pk_fma_f32 v[102:103], v[70:71], v[54:55], v[102:103]
    v_pk_fma_f32 v[96:97], v[72:73], v[40:41], v[96:97]
    v_pk_fma_f32 v[98:99], v[74:75], v[42:43], v[98:99]
    v_pk_fma_f32 v[100:101], v[76:77], v[44:45], v[100:101]
    v_pk_fma_f32 v[102:103], v[78:79], v[46:47], v[102:103]
    v_pk_fma_f32 v[96:97], v[80:81], v[32:33], v[96:97]
    v_pk_fma_f32 v[98:99], v[82:83], v[34:35], v[98:99]
    v_pk_fma_f32 v[100:101], v[84:85], v[36:37], v[100:101]
    v_pk_fma_f32 v[102:103], v[86:87], v[38:39], v[102:103]
    v_pk_mul_f32 v[120:121], v[104:105], v[96:97]
    v_pk_mul_f32 v[122:123], v[106:107], v[98:99]
    v_pk_mul_f32 v[124:125], v[108:109], v[100:101]
    v_pk_mul_f32 v[126:127], v[110:111], v[102:103]
    v_cvt_pk_bf16_f32 v128, v120, v112
    v_cvt_pk_bf16_f32 v136, v121, v113
    v_cvt_pk_bf16_f32 v144, v122, v114
    v_cvt_pk_bf16_f32 v152, v123, v115
    v_cvt_pk_bf16_f32 v160, v124, v116
    v_cvt_pk_bf16_f32 v168, v125, v117
    v_cvt_pk_bf16_f32 v176, v126, v118
    v_cvt_pk_bf16_f32 v184, v127, v119
    ds_write_b128 v18, v[128:131] offset:0
    ds_write_b128 v19, v[132:135] offset:0
    ds_write_b128 v18, v[136:139] offset:128
    ds_write_b128 v19, v[140:143] offset:128
    ds_write_b128 v18, v[144:147] offset:256
    ds_write_b128 v19, v[148:151] offset:256
    ds_write_b128 v18, v[152:155] offset:384
    ds_write_b128 v19, v[156:159] offset:384
    ds_write_b128 v18, v[160:163] offset:512
    ds_write_b128 v19, v[164:167] offset:512
    ds_write_b128 v18, v[168:171] offset:640
    ds_write_b128 v19, v[172:175] offset:640
    ds_write_b128 v18, v[176:179] offset:768
    ds_write_b128 v19, v[180:183] offset:768
    ds_write_b128 v18, v[184:187] offset:896
    ds_write_b128 v19, v[188:191] offset:896
    s_waitcnt lgkmcnt(0)
    s_barrier
    v_xor_b32_e64 v23, 0, v20
    ds_read_b128 v[128:131], v23 offset:0
    v_xor_b32_e64 v23, 16, v20
    ds_read_b128 v[132:135], v23 offset:1024
    v_xor_b32_e64 v23, 32, v20
    ds_read_b128 v[136:139], v23 offset:2048
    v_xor_b32_e64 v23, 48, v20
    ds_read_b128 v[140:143], v23 offset:3072
    v_xor_b32_e64 v23, 64, v20
    ds_read_b128 v[144:147], v23 offset:4096
    v_xor_b32 v23, 80, v20
    ds_read_b128 v[148:151], v23 offset:5120
    v_xor_b32 v23, 96, v20
    ds_read_b128 v[152:155], v23 offset:6144
    v_xor_b32 v23, 112, v20
    ds_read_b128 v[156:159], v23 offset:7168
    v_xor_b32_e64 v23, 0, v20
    ds_read_b128 v[160:163], v23 offset:8192
    v_xor_b32_e64 v23, 16, v20
    ds_read_b128 v[164:167], v23 offset:9216
    v_xor_b32_e64 v23, 32, v20
    ds_read_b128 v[168:171], v23 offset:10240
    v_xor_b32_e64 v23, 48, v20
    ds_read_b128 v[172:175], v23 offset:11264
    v_xor_b32_e64 v23, 64, v20
    ds_read_b128 v[176:179], v23 offset:12288
    v_xor_b32 v23, 80, v20
    ds_read_b128 v[180:183], v23 offset:13312
    v_xor_b32 v23, 96, v20
    ds_read_b128 v[184:187], v23 offset:14336
    v_xor_b32 v23, 112, v20
    ds_read_b128 v[188:191], v23 offset:15360
    s_xor_b32 s4, s63, 0
    s_mul_i32 s4, s4, 0x210000
    s_add_u32 s4, s4, s71
    s_waitcnt lgkmcnt(15)
    buffer_store_dwordx4 v[128:131], v21, s[64:67], s4 offen sc1
    s_add_u32 s4, s4, 0x8400
    s_waitcnt lgkmcnt(14)
    buffer_store_dwordx4 v[132:135], v21, s[64:67], s4 offen sc1
    s_add_u32 s4, s4, 0x8400
    s_waitcnt lgkmcnt(13)
    buffer_store_dwordx4 v[136:139], v21, s[64:67], s4 offen sc1
    s_add_u32 s4, s4, 0x8400
    s_waitcnt lgkmcnt(12)
    buffer_store_dwordx4 v[140:143], v21, s[64:67], s4 offen sc1
    s_add_u32 s4, s4, 0x8400
    s_waitcnt lgkmcnt(11)
    buffer_store_dwordx4 v[144:147], v21, s[64:67], s4 offen sc1
    s_add_u32 s4, s4, 0x8400
    s_waitcnt lgkmcnt(10)
    buffer_store_dwordx4 v[148:151], v21, s[64:67], s4 offen sc1
    s_add_u32 s4, s4, 0x8400
    s_waitcnt lgkmcnt(9)
    buffer_store_dwordx4 v[152:155], v21, s[64:67], s4 offen sc1
    s_add_u32 s4, s4, 0x8400
    s_waitcnt lgkmcnt(8)
    buffer_store_dwordx4 v[156:159], v21, s[64:67], s4 offen sc1
    s_add_u32 s4, s4, 0x8400
    s_waitcnt lgkmcnt(7)
    buffer_store_dwordx4 v[160:163], v21, s[64:67], s4 offen sc1
    s_add_u32 s4, s4, 0x8400
    s_waitcnt lgkmcnt(6)
    buffer_store_dwordx4 v[164:167], v21, s[64:67], s4 offen sc1
    s_add_u32 s4, s4, 0x8400
    s_waitcnt lgkmcnt(5)
    buffer_store_dwordx4 v[168:171], v21, s[64:67], s4 offen sc1
    s_add_u32 s4, s4, 0x8400
    s_waitcnt lgkmcnt(4)
    buffer_store_dwordx4 v[172:175], v21, s[64:67], s4 offen sc1
    s_add_u32 s4, s4, 0x8400
    s_waitcnt lgkmcnt(3)
    buffer_store_dwordx4 v[176:179], v21, s[64:67], s4 offen sc1
    s_add_u32 s4, s4, 0x8400
    s_waitcnt lgkmcnt(2)
    buffer_store_dwordx4 v[180:183], v21, s[64:67], s4 offen sc1
    s_add_u32 s4, s4, 0x8400
    s_waitcnt lgkmcnt(1)
    buffer_store_dwordx4 v[184:187], v21, s[64:67], s4 offen sc1
    s_add_u32 s4, s4, 0x8400
    s_waitcnt lgkmcnt(0)
    buffer_store_dwordx4 v[188:191], v21, s[64:67], s4 offen sc1
    v_cmp_ne_u32 vcc, 0, v13
    s_nop 0
    s_cmp_eq_u64 vcc, -1
    s_cbranch_scc0 RDZ_SLOW
RDZ_OK:
    s_waitcnt vmcnt(55)
    s_mov_b64 exec, 1
    buffer_store_dword v5, v4, s[64:67], s74 offen sc1
    s_mov_b64 exec, -1
    s_waitcnt vmcnt(55)
    v_accvgpr_read_b32 v24, a232
    v_accvgpr_read_b32 v25, a233
    v_accvgpr_read_b32 v26, a234
    v_accvgpr_read_b32 v27, a235
    v_lshlrev_b32_e64 v32, 16, v24
    v_and_b32 v40, 0xffff0000, v24
    v_lshlrev_b32_e64 v48, 16, v25
    v_and_b32 v56, 0xffff0000, v25
    v_lshlrev_b32_e64 v33, 16, v26
    v_and_b32 v41, 0xffff0000, v26
    v_lshlrev_b32_e64 v49, 16, v27
    v_and_b32 v57, 0xffff0000, v27
    s_waitcnt vmcnt(54)
    v_accvgpr_read_b32 v24, a236
    v_accvgpr_read_b32 v25, a237
    v_accvgpr_read_b32 v26, a238
    v_accvgpr_read_b32 v27, a239
    v_lshlrev_b32 v34, 16, v24
    v_and_b32 v42, 0xffff0000, v24
    v_lshlrev_b32_e64 v50, 16, v25
    v_and_b32 v58, 0xffff0000, v25
    v_lshlrev_b32_e64 v35, 16, v26
    v_and_b32 v43, 0xffff0000, v26
    v_lshlrev_b32_e64 v51, 16, v27
    v_and_b32 v59, 0xffff0000, v27
    s_waitcnt vmcnt(53)
    v_accvgpr_read_b32 v24, a240
    v_accvgpr_read_b32 v25, a241
    v_accvgpr_read_b32 v26, a242
    v_accvgpr_read_b32 v27, a243
    v_lshlrev_b32 v36, 16, v24
    v_and_b32 v44, 0xffff0000, v24
    v_lshlrev_b32_e64 v52, 16, v25
    v_and_b32 v60, 0xffff0000, v25
    v_lshlrev_b32_e64 v37, 16, v26
    v_and_b32 v45, 0xffff0000, v26
    v_lshlrev_b32_e64 v53, 16, v27
    v_and_b32 v61, 0xffff0000, v27
    s_waitcnt vmcnt(52)
    v_accvgpr_read_b32 v24, a244
    v_accvgpr_read_b32 v25, a245
    v_accvgpr_read_b32 v26, a246
    v_accvgpr_read_b32 v27, a247
    v_lshlrev_b32 v38, 16, v24
    v_and_b32 v46, 0xffff0000, v24
    v_lshlrev_b32_e64 v54, 16, v25
    v_and_b32 v62, 0xffff0000, v25
    v_lshlrev_b32_e64 v39, 16, v26
    v_and_b32 v47, 0xffff0000, v26
    v_lshlrev_b32_e64 v55, 16, v27
    v_and_b32 v63, 0xffff0000, v27
    s_waitcnt vmcnt(51)
    v_accvgpr_read_b32 v24, a140
    v_accvgpr_read_b32 v25, a141
    v_accvgpr_read_b32 v26, a142
    v_accvgpr_read_b32 v27, a143
    v_lshlrev_b32 v64, 16, v24
    v_and_b32 v65, 0xffff0000, v24
    v_lshlrev_b32_e64 v66, 16, v25
    v_and_b32 v67, 0xffff0000, v25
    v_lshlrev_b32_e64 v68, 16, v26
    v_and_b32 v69, 0xffff0000, v26
    v_lshlrev_b32_e64 v70, 16, v27
    v_and_b32 v71, 0xffff0000, v27
    s_waitcnt vmcnt(50)
    v_accvgpr_read_b32 v24, a144
    v_accvgpr_read_b32 v25, a145
    v_accvgpr_read_b32 v26, a146
    v_accvgpr_read_b32 v27, a147
    v_lshlrev_b32 v72, 16, v24
    v_and_b32 v73, 0xffff0000, v24
    v_lshlrev_b32_e64 v74, 16, v25
    v_and_b32 v75, 0xffff0000, v25
    v_lshlrev_b32_e64 v76, 16, v26
    v_and_b32 v77, 0xffff0000, v26
    v_lshlrev_b32_e64 v78, 16, v27
    v_and_b32 v79, 0xffff0000, v27
    s_waitcnt vmcnt(49)
    v_accvgpr_read_b32 v24, a148
    v_accvgpr_read_b32 v25, a149
    v_accvgpr_read_b32 v26, a150
    v_accvgpr_read_b32 v27, a151
    v_lshlrev_b32 v80, 16, v24
    v_and_b32 v81, 0xffff0000, v24
    v_lshlrev_b32_e64 v82, 16, v25
    v_and_b32 v83, 0xffff0000, v25
    v_lshlrev_b32_e64 v84, 16, v26
    v_and_b32 v85, 0xffff0000, v26
    v_lshlrev_b32_e64 v86, 16, v27
    v_and_b32 v87, 0xffff0000, v27
    s_waitcnt vmcnt(48)
    v_accvgpr_read_b32 v24, a152
    v_accvgpr_read_b32 v25, a153
    v_accvgpr_read_b32 v26, a154
    v_accvgpr_read_b32 v27, a155
    v_lshlrev_b32 v88, 16, v24
    v_and_b32 v89, 0xffff0000, v24
    v_lshlrev_b32_e64 v90, 16, v25
    v_and_b32 v91, 0xffff0000, v25
    v_lshlrev_b32_e64 v92, 16, v26
    v_and_b32 v93, 0xffff0000, v26
    v_lshlrev_b32_e64 v94, 16, v27
    v_and_b32 v95, 0xffff0000, v27
    s_add_u32 s5, s75, 0x0
    buffer_load_dwordx4 v[28:31], v14, s[76:79], s5 offen offset:0
    s_add_u32 s5, s75, 0x0
    buffer_load_dwordx4 v[28:31], v14, s[76:79], s5 offen offset:1024
    v_pk_mul_f32 v[96:97], v[64:65], v[56:57]
    v_pk_mul_f32 v[98:99], v[66:67], v[58:59]
    v_pk_mul_f32 v[100:101], v[68:69], v[60:61]
    v_pk_mul_f32 v[102:103], v[70:71], v[62:63]
    s_waitcnt vmcnt(49)
    v_lshlrev_b32 v104, 16, v192
    v_and_b32 v105, 0xffff0000, v192
    v_lshlrev_b32_e64 v106, 16, v193
    v_and_b32 v107, 0xffff0000, v193
    v_lshlrev_b32_e64 v108, 16, v194
    v_and_b32 v109, 0xffff0000, v194
    v_lshlrev_b32_e64 v110, 16, v195
    v_and_b32 v111, 0xffff0000, v195
    v_pk_fma_f32 v[96:97], v[72:73], v[48:49], v[96:97]
    v_pk_fma_f32 v[98:99], v[74:75], v[50:51], v[98:99]
    v_pk_fma_f32 v[100:101], v[76:77], v[52:53], v[100:101]
    v_pk_fma_f32 v[102:103], v[78:79], v[54:55], v[102:103]
    v_pk_fma_f32 v[96:97], v[80:81], v[40:41], v[96:97]
    v_pk_fma_f32 v[98:99], v[82:83], v[42:43], v[98:99]
    v_pk_fma_f32 v[100:101], v[84:85], v[44:45], v[100:101]
    v_pk_fma_f32 v[102:103], v[86:87], v[46:47], v[102:103]
    v_pk_fma_f32 v[96:97], v[88:89], v[32:33], v[96:97]
    v_pk_fma_f32 v[98:99], v[90:91], v[34:35], v[98:99]
    v_pk_fma_f32 v[100:101], v[92:93], v[36:37], v[100:101]
    v_pk_fma_f32 v[102:103], v[94:95], v[38:39], v[102:103]
    v_pk_mul_f32 v[112:113], v[104:105], v[96:97]
    v_pk_mul_f32 v[114:115], v[106:107], v[98:99]
    v_pk_mul_f32 v[116:117], v[108:109], v[100:101]
    v_pk_mul_f32 v[118:119], v[110:111], v[102:103]
    s_waitcnt vmcnt(48)
    v_accvgpr_read_b32 v24, a156
    v_accvgpr_read_b32 v25, a157
    v_accvgpr_read_b32 v26, a158
    v_accvgpr_read_b32 v27, a159
    v_lshlrev_b32 v64, 16, v24
    v_and_b32 v65, 0xffff0000, v24
    v_lshlrev_b32_e64 v66, 16, v25
    v_and_b32 v67, 0xffff0000, v25
    v_lshlrev_b32_e64 v68, 16, v26
    v_and_b32 v69, 0xffff0000, v26
    v_lshlrev_b32_e64 v70, 16, v27
    v_and_b32 v71, 0xffff0000, v27
    s_add_u32 s5, s75, 0x0
    buffer_load_dwordx4 v[28:31], v14, s[76:79], s5 offen offset:2048
    s_add_u32 s5, s75, 0x0
    buffer_load_dwordx4 v[28:31], v14, s[76:79], s5 offen offset:3072
    v_pk_mul_f32 v[96:97], v[72:73], v[56:57]
    v_pk_mul_f32 v[98:99], v[74:75], v[58:59]
    v_pk_mul_f32 v[100:101], v[76:77], v[60:61]
    v_pk_mul_f32 v[102:103], v[78:79], v[62:63]
    s_waitcnt vmcnt(49)
    v_lshlrev_b32 v104, 16, v196
    v_and_b32 v105, 0xffff0000, v196
    v_lshlrev_b32_e64 v106, 16, v197
    v_and_b32 v107, 0xffff0000, v197
    v_lshlrev_b32_e64 v108, 16, v198
    v_and_b32 v109, 0xffff0000, v198
    v_lshlrev_b32_e64 v110, 16, v199
    v_and_b32 v111, 0xffff0000, v199
    v_pk_fma_f32 v[96:97], v[80:81], v[48:49], v[96:97]
    v_pk_fma_f32 v[98:99], v[82:83], v[50:51], v[98:99]
    v_pk_fma_f32 v[100:101], v[84:85], v[52:53], v[100:101]
    v_pk_fma_f32 v[102:103], v[86:87], v[54:55], v[102:103]
    v_pk_fma_f32 v[96:97], v[88:89], v[40:41], v[96:97]
    v_pk_fma_f32 v[98:99], v[90:91], v[42:43], v[98:99]
    v_pk_fma_f32 v[100:101], v[92:93], v[44:45], v[100:101]
    v_pk_fma_f32 v[102:103], v[94:95], v[46:47], v[102:103]
    v_pk_fma_f32 v[96:97], v[64:65], v[32:33], v[96:97]
    v_pk_fma_f32 v[98:99], v[66:67], v[34:35], v[98:99]
    v_pk_fma_f32 v[100:101], v[68:69], v[36:37], v[100:101]
    v_pk_fma_f32 v[102:103], v[70:71], v[38:39], v[102:103]
    v_pk_mul_f32 v[120:121], v[104:105], v[96:97]
    v_pk_mul_f32 v[122:123], v[106:107], v[98:99]
    v_pk_mul_f32 v[124:125], v[108:109], v[100:101]
    v_pk_mul_f32 v[126:127], v[110:111], v[102:103]
    v_cvt_pk_bf16_f32 v135, v120, v112
    v_cvt_pk_bf16_f32 v143, v121, v113
    v_cvt_pk_bf16_f32 v151, v122, v114
    v_cvt_pk_bf16_f32 v159, v123, v115
    v_cvt_pk_bf16_f32 v167, v124, v116
    v_cvt_pk_bf16_f32 v175, v125, v117
    v_cvt_pk_bf16_f32 v183, v126, v118
    v_cvt_pk_bf16_f32 v191, v127, v119
    s_waitcnt vmcnt(48)
    v_accvgpr_read_b32 v24, a160
    v_accvgpr_read_b32 v25, a161
    v_accvgpr_read_b32 v26, a162
    v_accvgpr_read_b32 v27, a163
    v_lshlrev_b32 v72, 16, v24
    v_and_b32 v73, 0xffff0000, v24
    v_lshlrev_b32_e64 v74, 16, v25
    v_and_b32 v75, 0xffff0000, v25
    v_lshlrev_b32_e64 v76, 16, v26
    v_and_b32 v77, 0xffff0000, v26
    v_lshlrev_b32_e64 v78, 16, v27
    v_and_b32 v79, 0xffff0000, v27
    s_add_u32 s5, s75, 0x80000
    buffer_load_dwordx4 v[28:31], v14, s[76:79], s5 offen offset:0
    s_add_u32 s5, s75, 0x80000
    buffer_load_dwordx4 v[28:31], v14, s[76:79], s5 offen offset:1024
    v_pk_mul_f32 v[96:97], v[80:81], v[56:57]
    v_pk_mul_f32 v[98:99], v[82:83], v[58:59]
    v_pk_mul_f32 v[100:101], v[84:85], v[60:61]
    v_pk_mul_f32 v[102:103], v[86:87], v[62:63]
    s_waitcnt vmcnt(49)
    v_lshlrev_b32 v104, 16, v200
    v_and_b32 v105, 0xffff0000, v200
    v_lshlrev_b32_e64 v106, 16, v201
    v_and_b32 v107, 0xffff0000, v201
    v_lshlrev_b32_e64 v108, 16, v202
    v_and_b32 v109, 0xffff0000, v202
    v_lshlrev_b32_e64 v110, 16, v203
    v_and_b32 v111, 0xffff0000, v203
    v_pk_fma_f32 v[96:97], v[88:89], v[48:49], v[96:97]
    v_pk_fma_f32 v[98:99], v[90:91], v[50:51], v[98:99]
    v_pk_fma_f32 v[100:101], v[92:93], v[52:53], v[100:101]
    v_pk_fma_f32 v[102:103], v[94:95], v[54:55], v[102:103]
    v_pk_fma_f32 v[96:97], v[64:65], v[40:41], v[96:97]
    v_pk_fma_f32 v[98:99], v[66:67], v[42:43], v[98:99]
    v_pk_fma_f32 v[100:101], v[68:69], v[44:45], v[100:101]
    v_pk_fma_f32 v[102:103], v[70:71], v[46:47], v[102:103]
    v_pk_fma_f32 v[96:97], v[72:73], v[32:33], v[96:97]
    v_pk_fma_f32 v[98:99], v[74:75], v[34:35], v[98:99]
    v_pk_fma_f32 v[100:101], v[76:77], v[36:37], v[100:101]
    v_pk_fma_f32 v[102:103], v[78:79], v[38:39], v[102:103]
    v_pk_mul_f32 v[112:113], v[104:105], v[96:97]
    v_pk_mul_f32 v[114:115], v[106:107], v[98:99]
    v_pk_mul_f32 v[116:117], v[108:109], v[100:101]
    v_pk_mul_f32 v[118:119], v[110:111], v[102:103]
    s_waitcnt vmcnt(48)
    v_accvgpr_read_b32 v24, a164
    v_accvgpr_read_b32 v25, a165
    v_accvgpr_read_b32 v26, a166
    v_accvgpr_read_b32 v27, a167
    v_lshlrev_b32 v80, 16, v24
    v_and_b32 v81, 0xffff0000, v24
    v_lshlrev_b32_e64 v82, 16, v25
    v_and_b32 v83, 0xffff0000, v25
    v_lshlrev_b32_e64 v84, 16, v26
    v_and_b32 v85, 0xffff0000, v26
    v_lshlrev_b32_e64 v86, 16, v27
    v_and_b32 v87, 0xffff0000, v27
    s_add_u32 s5, s75, 0x80000
    buffer_load_dwordx4 v[28:31], v14, s[76:79], s5 offen offset:2048
    s_add_u32 s5, s75, 0x80000
    buffer_load_dwordx4 v[28:31], v14, s[76:79], s5 offen offset:3072
    v_pk_mul_f32 v[96:97], v[88:89], v[56:57]
    v_pk_mul_f32 v[98:99], v[90:91], v[58:59]
    v_pk_mul_f32 v[100:101], v[92:93], v[60:61]
    v_pk_mul_f32 v[102:103], v[94:95], v[62:63]
    s_waitcnt vmcnt(49)
    v_lshlrev_b32 v104, 16, v204
    v_and_b32 v105, 0xffff0000, v204
    v_lshlrev_b32_e64 v106, 16, v205
    v_and_b32 v107, 0xffff0000, v205
    v_lshlrev_b32_e64 v108, 16, v206
    v_and_b32 v109, 0xffff0000, v206
    v_lshlrev_b32_e64 v110, 16, v207
    v_and_b32 v111, 0xffff0000, v207
    v_pk_fma_f32 v[96:97], v[64:65], v[48:49], v[96:97]
    v_pk_fma_f32 v[98:99], v[66:67], v[50:51], v[98:99]
    v_pk_fma_f32 v[100:101], v[68:69], v[52:53], v[100:101]
    v_pk_fma_f32 v[102:103], v[70:71], v[54:55], v[102:103]
    v_pk_fma_f32 v[96:97], v[72:73], v[40:41], v[96:97]
    v_pk_fma_f32 v[98:99], v[74:75], v[42:43], v[98:99]
    v_pk_fma_f32 v[100:101], v[76:77], v[44:45], v[100:101]
    v_pk_fma_f32 v[102:103], v[78:79], v[46:47], v[102:103]
    v_pk_fma_f32 v[96:97], v[80:81], v[32:33], v[96:97]
    v_pk_fma_f32 v[98:99], v[82:83], v[34:35], v[98:99]
    v_pk_fma_f32 v[100:101], v[84:85], v[36:37], v[100:101]
    v_pk_fma_f32 v[102:103], v[86:87], v[38:39], v[102:103]
    v_pk_mul_f32 v[120:121], v[104:105], v[96:97]
    v_pk_mul_f32 v[122:123], v[106:107], v[98:99]
    v_pk_mul_f32 v[124:125], v[108:109], v[100:101]
    v_pk_mul_f32 v[126:127], v[110:111], v[102:103]
    v_cvt_pk_bf16_f32 v134, v120, v112
    v_cvt_pk_bf16_f32 v142, v121, v113
    v_cvt_pk_bf16_f32 v150, v122, v114
    v_cvt_pk_bf16_f32 v158, v123, v115
    v_cvt_pk_bf16_f32 v166, v124, v116
    v_cvt_pk_bf16_f32 v174, v125, v117
    v_cvt_pk_bf16_f32 v182, v126, v118
    v_cvt_pk_bf16_f32 v190, v127, v119
    s_waitcnt vmcnt(48)
    v_accvgpr_read_b32 v24, a168
    v_accvgpr_read_b32 v25, a169
    v_accvgpr_read_b32 v26, a170
    v_accvgpr_read_b32 v27, a171
    v_lshlrev_b32 v88, 16, v24
    v_and_b32 v89, 0xffff0000, v24
    v_lshlrev_b32_e64 v90, 16, v25
    v_and_b32 v91, 0xffff0000, v25
    v_lshlrev_b32_e64 v92, 16, v26
    v_and_b32 v93, 0xffff0000, v26
    v_lshlrev_b32_e64 v94, 16, v27
    v_and_b32 v95, 0xffff0000, v27
    s_add_u32 s5, s75, 0x100000
    buffer_load_dwordx4 v[28:31], v14, s[76:79], s5 offen offset:0
    s_add_u32 s5, s75, 0x100000
    buffer_load_dwordx4 v[28:31], v14, s[76:79], s5 offen offset:1024
    v_pk_mul_f32 v[96:97], v[64:65], v[56:57]
    v_pk_mul_f32 v[98:99], v[66:67], v[58:59]
    v_pk_mul_f32 v[100:101], v[68:69], v[60:61]
    v_pk_mul_f32 v[102:103], v[70:71], v[62:63]
    s_waitcnt vmcnt(49)
    v_lshlrev_b32 v104, 16, v208
    v_and_b32 v105, 0xffff0000, v208
    v_lshlrev_b32_e64 v106, 16, v209
    v_and_b32 v107, 0xffff0000, v209
    v_lshlrev_b32_e64 v108, 16, v210
    v_and_b32 v109, 0xffff0000, v210
    v_lshlrev_b32_e64 v110, 16, v211
    v_and_b32 v111, 0xffff0000, v211
    v_pk_fma_f32 v[96:97], v[72:73], v[48:49], v[96:97]
    v_pk_fma_f32 v[98:99], v[74:75], v[50:51], v[98:99]
    v_pk_fma_f32 v[100:101], v[76:77], v[52:53], v[100:101]
    v_pk_fma_f32 v[102:103], v[78:79], v[54:55], v[102:103]
    v_pk_fma_f32 v[96:97], v[80:81], v[40:41], v[96:97]
    v_pk_fma_f32 v[98:99], v[82:83], v[42:43], v[98:99]
    v_pk_fma_f32 v[100:101], v[84:85], v[44:45], v[100:101]
    v_pk_fma_f32 v[102:103], v[86:87], v[46:47], v[102:103]
    v_pk_fma_f32 v[96:97], v[88:89], v[32:33], v[96:97]
    v_pk_fma_f32 v[98:99], v[90:91], v[34:35], v[98:99]
    v_pk_fma_f32 v[100:101], v[92:93], v[36:37], v[100:101]
    v_pk_fma_f32 v[102:103], v[94:95], v[38:39], v[102:103]
    v_pk_mul_f32 v[112:113], v[104:105], v[96:97]
    v_pk_mul_f32 v[114:115], v[106:107], v[98:99]
    v_pk_mul_f32 v[116:117], v[108:109], v[100:101]
    v_pk_mul_f32 v[118:119], v[110:111], v[102:103]
    s_waitcnt vmcnt(48)
    v_accvgpr_read_b32 v24, a172
    v_accvgpr_read_b32 v25, a173
    v_accvgpr_read_b32 v26, a174
    v_accvgpr_read_b32 v27, a175
    v_lshlrev_b32 v64, 16, v24
    v_and_b32 v65, 0xffff0000, v24
    v_lshlrev_b32_e64 v66, 16, v25
    v_and_b32 v67, 0xffff0000, v25
    v_lshlrev_b32_e64 v68, 16, v26
    v_and_b32 v69, 0xffff0000, v26
    v_lshlrev_b32_e64 v70, 16, v27
    v_and_b32 v71, 0xffff0000, v27
    s_add_u32 s5, s75, 0x100000
    buffer_load_dwordx4 v[28:31], v14, s[76:79], s5 offen offset:2048
    s_add_u32 s5, s75, 0x100000
    buffer_load_dwordx4 v[28:31], v14, s[76:79], s5 offen offset:3072
    v_pk_mul_f32 v[96:97], v[72:73], v[56:57]
    v_pk_mul_f32 v[98:99], v[74:75], v[58:59]
    v_pk_mul_f32 v[100:101], v[76:77], v[60:61]
    v_pk_mul_f32 v[102:103], v[78:79], v[62:63]
    s_waitcnt vmcnt(49)
    v_lshlrev_b32 v104, 16, v212
    v_and_b32 v105, 0xffff0000, v212
    v_lshlrev_b32_e64 v106, 16, v213
    v_and_b32 v107, 0xffff0000, v213
    v_lshlrev_b32_e64 v108, 16, v214
    v_and_b32 v109, 0xffff0000, v214
    v_lshlrev_b32_e64 v110, 16, v215
    v_and_b32 v111, 0xffff0000, v215
    v_pk_fma_f32 v[96:97], v[80:81], v[48:49], v[96:97]
    v_pk_fma_f32 v[98:99], v[82:83], v[50:51], v[98:99]
    v_pk_fma_f32 v[100:101], v[84:85], v[52:53], v[100:101]
    v_pk_fma_f32 v[102:103], v[86:87], v[54:55], v[102:103]
    v_pk_fma_f32 v[96:97], v[88:89], v[40:41], v[96:97]
    v_pk_fma_f32 v[98:99], v[90:91], v[42:43], v[98:99]
    v_pk_fma_f32 v[100:101], v[92:93], v[44:45], v[100:101]
    v_pk_fma_f32 v[102:103], v[94:95], v[46:47], v[102:103]
    v_pk_fma_f32 v[96:97], v[64:65], v[32:33], v[96:97]
    v_pk_fma_f32 v[98:99], v[66:67], v[34:35], v[98:99]
    v_pk_fma_f32 v[100:101], v[68:69], v[36:37], v[100:101]
    v_pk_fma_f32 v[102:103], v[70:71], v[38:39], v[102:103]
    v_pk_mul_f32 v[120:121], v[104:105], v[96:97]
    v_pk_mul_f32 v[122:123], v[106:107], v[98:99]
    v_pk_mul_f32 v[124:125], v[108:109], v[100:101]
    v_pk_mul_f32 v[126:127], v[110:111], v[102:103]
    v_cvt_pk_bf16_f32 v133, v120, v112
    v_cvt_pk_bf16_f32 v141, v121, v113
    v_cvt_pk_bf16_f32 v149, v122, v114
    v_cvt_pk_bf16_f32 v157, v123, v115
    v_cvt_pk_bf16_f32 v165, v124, v116
    v_cvt_pk_bf16_f32 v173, v125, v117
    v_cvt_pk_bf16_f32 v181, v126, v118
    v_cvt_pk_bf16_f32 v189, v127, v119
    s_waitcnt vmcnt(48)
    v_accvgpr_read_b32 v24, a176
    v_accvgpr_read_b32 v25, a177
    v_accvgpr_read_b32 v26, a178
    v_accvgpr_read_b32 v27, a179
    v_lshlrev_b32 v72, 16, v24
    v_and_b32 v73, 0xffff0000, v24
    v_lshlrev_b32_e64 v74, 16, v25
    v_and_b32 v75, 0xffff0000, v25
    v_lshlrev_b32_e64 v76, 16, v26
    v_and_b32 v77, 0xffff0000, v26
    v_lshlrev_b32_e64 v78, 16, v27
    v_and_b32 v79, 0xffff0000, v27
    s_add_u32 s5, s75, 0x180000
    buffer_load_dwordx4 v[28:31], v14, s[76:79], s5 offen offset:0
    s_add_u32 s5, s75, 0x180000
    buffer_load_dwordx4 v[28:31], v14, s[76:79], s5 offen offset:1024
    v_pk_mul_f32 v[96:97], v[80:81], v[56:57]
    v_pk_mul_f32 v[98:99], v[82:83], v[58:59]
    v_pk_mul_f32 v[100:101], v[84:85], v[60:61]
    v_pk_mul_f32 v[102:103], v[86:87], v[62:63]
    s_waitcnt vmcnt(49)
    v_lshlrev_b32 v104, 16, v216
    v_and_b32 v105, 0xffff0000, v216
    v_lshlrev_b32_e64 v106, 16, v217
    v_and_b32 v107, 0xffff0000, v217
    v_lshlrev_b32_e64 v108, 16, v218
    v_and_b32 v109, 0xffff0000, v218
    v_lshlrev_b32_e64 v110, 16, v219
    v_and_b32 v111, 0xffff0000, v219
    v_pk_fma_f32 v[96:97], v[88:89], v[48:49], v[96:97]
    v_pk_fma_f32 v[98:99], v[90:91], v[50:51], v[98:99]
    v_pk_fma_f32 v[100:101], v[92:93], v[52:53], v[100:101]
    v_pk_fma_f32 v[102:103], v[94:95], v[54:55], v[102:103]
    v_pk_fma_f32 v[96:97], v[64:65], v[40:41], v[96:97]
    v_pk_fma_f32 v[98:99], v[66:67], v[42:43], v[98:99]
    v_pk_fma_f32 v[100:101], v[68:69], v[44:45], v[100:101]
    v_pk_fma_f32 v[102:103], v[70:71], v[46:47], v[102:103]
    v_pk_fma_f32 v[96:97], v[72:73], v[32:33], v[96:97]
    v_pk_fma_f32 v[98:99], v[74:75], v[34:35], v[98:99]
    v_pk_fma_f32 v[100:101], v[76:77], v[36:37], v[100:101]
    v_pk_fma_f32 v[102:103], v[78:79], v[38:39], v[102:103]
    v_pk_mul_f32 v[112:113], v[104:105], v[96:97]
    v_pk_mul_f32 v[114:115], v[106:107], v[98:99]
    v_pk_mul_f32 v[116:117], v[108:109], v[100:101]
    v_pk_mul_f32 v[118:119], v[110:111], v[102:103]
    s_waitcnt vmcnt(48)
    v_accvgpr_read_b32 v24, a180
    v_accvgpr_read_b32 v25, a181
    v_accvgpr_read_b32 v26, a182
    v_accvgpr_read_b32 v27, a183
    v_lshlrev_b32 v80, 16, v24
    v_and_b32 v81, 0xffff0000, v24
    v_lshlrev_b32_e64 v82, 16, v25
    v_and_b32 v83, 0xffff0000, v25
    v_lshlrev_b32_e64 v84, 16, v26
    v_and_b32 v85, 0xffff0000, v26
    v_lshlrev_b32_e64 v86, 16, v27
    v_and_b32 v87, 0xffff0000, v27
    s_add_u32 s5, s75, 0x180000
    buffer_load_dwordx4 v[28:31], v14, s[76:79], s5 offen offset:2048
    s_add_u32 s5, s75, 0x180000
    buffer_load_dwordx4 v[28:31], v14, s[76:79], s5 offen offset:3072
    v_pk_mul_f32 v[96:97], v[88:89], v[56:57]
    v_pk_mul_f32 v[98:99], v[90:91], v[58:59]
    v_pk_mul_f32 v[100:101], v[92:93], v[60:61]
    v_pk_mul_f32 v[102:103], v[94:95], v[62:63]
    s_waitcnt vmcnt(49)
    v_lshlrev_b32 v104, 16, v220
    v_and_b32 v105, 0xffff0000, v220
    v_lshlrev_b32_e64 v106, 16, v221
    v_and_b32 v107, 0xffff0000, v221
    v_lshlrev_b32_e64 v108, 16, v222
    v_and_b32 v109, 0xffff0000, v222
    v_lshlrev_b32_e64 v110, 16, v223
    v_and_b32 v111, 0xffff0000, v223
    v_pk_fma_f32 v[96:97], v[64:65], v[48:49], v[96:97]
    v_pk_fma_f32 v[98:99], v[66:67], v[50:51], v[98:99]
    v_pk_fma_f32 v[100:101], v[68:69], v[52:53], v[100:101]
    v_pk_fma_f32 v[102:103], v[70:71], v[54:55], v[102:103]
    v_pk_fma_f32 v[96:97], v[72:73], v[40:41], v[96:97]
    v_pk_fma_f32 v[98:99], v[74:75], v[42:43], v[98:99]
    v_pk_fma_f32 v[100:101], v[76:77], v[44:45], v[100:101]
    v_pk_fma_f32 v[102:103], v[78:79], v[46:47], v[102:103]
    v_pk_fma_f32 v[96:97], v[80:81], v[32:33], v[96:97]
    v_pk_fma_f32 v[98:99], v[82:83], v[34:35], v[98:99]
    v_pk_fma_f32 v[100:101], v[84:85], v[36:37], v[100:101]
    v_pk_fma_f32 v[102:103], v[86:87], v[38:39], v[102:103]
    v_pk_mul_f32 v[120:121], v[104:105], v[96:97]
    v_pk_mul_f32 v[122:123], v[106:107], v[98:99]
    v_pk_mul_f32 v[124:125], v[108:109], v[100:101]
    v_pk_mul_f32 v[126:127], v[110:111], v[102:103]
    v_cvt_pk_bf16_f32 v132, v120, v112
    v_cvt_pk_bf16_f32 v140, v121, v113
    v_cvt_pk_bf16_f32 v148, v122, v114
    v_cvt_pk_bf16_f32 v156, v123, v115
    v_cvt_pk_bf16_f32 v164, v124, v116
    v_cvt_pk_bf16_f32 v172, v125, v117
    v_cvt_pk_bf16_f32 v180, v126, v118
    v_cvt_pk_bf16_f32 v188, v127, v119
    s_waitcnt vmcnt(48)
    v_accvgpr_read_b32 v24, a184
    v_accvgpr_read_b32 v25, a185
    v_accvgpr_read_b32 v26, a186
    v_accvgpr_read_b32 v27, a187
    v_lshlrev_b32 v88, 16, v24
    v_and_b32 v89, 0xffff0000, v24
    v_lshlrev_b32_e64 v90, 16, v25
    v_and_b32 v91, 0xffff0000, v25
    v_lshlrev_b32_e64 v92, 16, v26
    v_and_b32 v93, 0xffff0000, v26
    v_lshlrev_b32_e64 v94, 16, v27
    v_and_b32 v95, 0xffff0000, v27
    s_add_u32 s5, s75, 0x200000
    buffer_load_dwordx4 v[28:31], v14, s[76:79], s5 offen offset:0
    s_add_u32 s5, s75, 0x200000
    buffer_load_dwordx4 v[28:31], v14, s[76:79], s5 offen offset:1024
    v_pk_mul_f32 v[96:97], v[64:65], v[56:57]
    v_pk_mul_f32 v[98:99], v[66:67], v[58:59]
    v_pk_mul_f32 v[100:101], v[68:69], v[60:61]
    v_pk_mul_f32 v[102:103], v[70:71], v[62:63]
    s_waitcnt vmcnt(49)
    v_lshlrev_b32 v104, 16, v224
    v_and_b32 v105, 0xffff0000, v224
    v_lshlrev_b32_e64 v106, 16, v225
    v_and_b32 v107, 0xffff0000, v225
    v_lshlrev_b32_e64 v108, 16, v226
    v_and_b32 v109, 0xffff0000, v226
    v_lshlrev_b32_e64 v110, 16, v227
    v_and_b32 v111, 0xffff0000, v227
    v_pk_fma_f32 v[96:97], v[72:73], v[48:49], v[96:97]
    v_pk_fma_f32 v[98:99], v[74:75], v[50:51], v[98:99]
    v_pk_fma_f32 v[100:101], v[76:77], v[52:53], v[100:101]
    v_pk_fma_f32 v[102:103], v[78:79], v[54:55], v[102:103]
    v_pk_fma_f32 v[96:97], v[80:81], v[40:41], v[96:97]
    v_pk_fma_f32 v[98:99], v[82:83], v[42:43], v[98:99]
    v_pk_fma_f32 v[100:101], v[84:85], v[44:45], v[100:101]
    v_pk_fma_f32 v[102:103], v[86:87], v[46:47], v[102:103]
    v_pk_fma_f32 v[96:97], v[88:89], v[32:33], v[96:97]
    v_pk_fma_f32 v[98:99], v[90:91], v[34:35], v[98:99]
    v_pk_fma_f32 v[100:101], v[92:93], v[36:37], v[100:101]
    v_pk_fma_f32 v[102:103], v[94:95], v[38:39], v[102:103]
    v_pk_mul_f32 v[112:113], v[104:105], v[96:97]
    v_pk_mul_f32 v[114:115], v[106:107], v[98:99]
    v_pk_mul_f32 v[116:117], v[108:109], v[100:101]
    v_pk_mul_f32 v[118:119], v[110:111], v[102:103]
    s_waitcnt vmcnt(48)
    v_accvgpr_read_b32 v24, a188
    v_accvgpr_read_b32 v25, a189
    v_accvgpr_read_b32 v26, a190
    v_accvgpr_read_b32 v27, a191
    v_lshlrev_b32 v64, 16, v24
    v_and_b32 v65, 0xffff0000, v24
    v_lshlrev_b32_e64 v66, 16, v25
    v_and_b32 v67, 0xffff0000, v25
    v_lshlrev_b32_e64 v68, 16, v26
    v_and_b32 v69, 0xffff0000, v26
    v_lshlrev_b32_e64 v70, 16, v27
    v_and_b32 v71, 0xffff0000, v27
    s_add_u32 s5, s75, 0x200000
    buffer_load_dwordx4 v[28:31], v14, s[76:79], s5 offen offset:2048
    s_add_u32 s5, s75, 0x200000
    buffer_load_dwordx4 v[28:31], v14, s[76:79], s5 offen offset:3072
    v_pk_mul_f32 v[96:97], v[72:73], v[56:57]
    v_pk_mul_f32 v[98:99], v[74:75], v[58:59]
    v_pk_mul_f32 v[100:101], v[76:77], v[60:61]
    v_pk_mul_f32 v[102:103], v[78:79], v[62:63]
    s_waitcnt vmcnt(49)
    v_lshlrev_b32 v104, 16, v228
    v_and_b32 v105, 0xffff0000, v228
    v_lshlrev_b32_e64 v106, 16, v229
    v_and_b32 v107, 0xffff0000, v229
    v_lshlrev_b32_e64 v108, 16, v230
    v_and_b32 v109, 0xffff0000, v230
    v_lshlrev_b32_e64 v110, 16, v231
    v_and_b32 v111, 0xffff0000, v231
    v_pk_fma_f32 v[96:97], v[80:81], v[48:49], v[96:97]
    v_pk_fma_f32 v[98:99], v[82:83], v[50:51], v[98:99]
    v_pk_fma_f32 v[100:101], v[84:85], v[52:53], v[100:101]
    v_pk_fma_f32 v[102:103], v[86:87], v[54:55], v[102:103]
    v_pk_fma_f32 v[96:97], v[88:89], v[40:41], v[96:97]
    v_pk_fma_f32 v[98:99], v[90:91], v[42:43], v[98:99]
    v_pk_fma_f32 v[100:101], v[92:93], v[44:45], v[100:101]
    v_pk_fma_f32 v[102:103], v[94:95], v[46:47], v[102:103]
    v_pk_fma_f32 v[96:97], v[64:65], v[32:33], v[96:97]
    v_pk_fma_f32 v[98:99], v[66:67], v[34:35], v[98:99]
    v_pk_fma_f32 v[100:101], v[68:69], v[36:37], v[100:101]
    v_pk_fma_f32 v[102:103], v[70:71], v[38:39], v[102:103]
    v_pk_mul_f32 v[120:121], v[104:105], v[96:97]
    v_pk_mul_f32 v[122:123], v[106:107], v[98:99]
    v_pk_mul_f32 v[124:125], v[108:109], v[100:101]
    v_pk_mul_f32 v[126:127], v[110:111], v[102:103]
    v_cvt_pk_bf16_f32 v131, v120, v112
    v_cvt_pk_bf16_f32 v139, v121, v113
    v_cvt_pk_bf16_f32 v147, v122, v114
    v_cvt_pk_bf16_f32 v155, v123, v115
    v_cvt_pk_bf16_f32 v163, v124, v116
    v_cvt_pk_bf16_f32 v171, v125, v117
    v_cvt_pk_bf16_f32 v179, v126, v118
    v_cvt_pk_bf16_f32 v187, v127, v119
    s_waitcnt vmcnt(48)
    v_accvgpr_read_b32 v24, a192
    v_accvgpr_read_b32 v25, a193
    v_accvgpr_read_b32 v26, a194
    v_accvgpr_read_b32 v27, a195
    v_lshlrev_b32 v72, 16, v24
    v_and_b32 v73, 0xffff0000, v24
    v_lshlrev_b32_e64 v74, 16, v25
    v_and_b32 v75, 0xffff0000, v25
    v_lshlrev_b32_e64 v76, 16, v26
    v_and_b32 v77, 0xffff0000, v26
    v_lshlrev_b32_e64 v78, 16, v27
    v_and_b32 v79, 0xffff0000, v27
    s_add_u32 s5, s75, 0x280000
    buffer_load_dwordx4 v[28:31], v14, s[76:79], s5 offen offset:0
    s_add_u32 s5, s75, 0x280000
    buffer_load_dwordx4 v[28:31], v14, s[76:79], s5 offen offset:1024
    v_pk_mul_f32 v[96:97], v[80:81], v[56:57]
    v_pk_mul_f32 v[98:99], v[82:83], v[58:59]
    v_pk_mul_f32 v[100:101], v[84:85], v[60:61]
    v_pk_mul_f32 v[102:103], v[86:87], v[62:63]
    s_waitcnt vmcnt(49)
    v_lshlrev_b32 v104, 16, v232
    v_and_b32 v105, 0xffff0000, v232
    v_lshlrev_b32_e64 v106, 16, v233
    v_and_b32 v107, 0xffff0000, v233
    v_lshlrev_b32_e64 v108, 16, v234
    v_and_b32 v109, 0xffff0000, v234
    v_lshlrev_b32_e64 v110, 16, v235
    v_and_b32 v111, 0xffff0000, v235
    v_pk_fma_f32 v[96:97], v[88:89], v[48:49], v[96:97]
    v_pk_fma_f32 v[98:99], v[90:91], v[50:51], v[98:99]
    v_pk_fma_f32 v[100:101], v[92:93], v[52:53], v[100:101]
    v_pk_fma_f32 v[102:103], v[94:95], v[54:55], v[102:103]
    v_pk_fma_f32 v[96:97], v[64:65], v[40:41], v[96:97]
    v_pk_fma_f32 v[98:99], v[66:67], v[42:43], v[98:99]
    v_pk_fma_f32 v[100:101], v[68:69], v[44:45], v[100:101]
    v_pk_fma_f32 v[102:103], v[70:71], v[46:47], v[102:103]
    v_pk_fma_f32 v[96:97], v[72:73], v[32:33], v[96:97]
    v_pk_fma_f32 v[98:99], v[74:75], v[34:35], v[98:99]
    v_pk_fma_f32 v[100:101], v[76:77], v[36:37], v[100:101]
    v_pk_fma_f32 v[102:103], v[78:79], v[38:39], v[102:103]
    v_pk_mul_f32 v[112:113], v[104:105], v[96:97]
    v_pk_mul_f32 v[114:115], v[106:107], v[98:99]
    v_pk_mul_f32 v[116:117], v[108:109], v[100:101]
    v_pk_mul_f32 v[118:119], v[110:111], v[102:103]
    s_waitcnt vmcnt(48)
    v_accvgpr_read_b32 v24, a196
    v_accvgpr_read_b32 v25, a197
    v_accvgpr_read_b32 v26, a198
    v_accvgpr_read_b32 v27, a199
    v_lshlrev_b32 v80, 16, v24
    v_and_b32 v81, 0xffff0000, v24
    v_lshlrev_b32_e64 v82, 16, v25
    v_and_b32 v83, 0xffff0000, v25
    v_lshlrev_b32_e64 v84, 16, v26
    v_and_b32 v85, 0xffff0000, v26
    v_lshlrev_b32_e64 v86, 16, v27
    v_and_b32 v87, 0xffff0000, v27
    s_add_u32 s5, s75, 0x280000
    buffer_load_dwordx4 v[28:31], v14, s[76:79], s5 offen offset:2048
    s_add_u32 s5, s75, 0x280000
    buffer_load_dwordx4 v[28:31], v14, s[76:79], s5 offen offset:3072
    v_pk_mul_f32 v[96:97], v[88:89], v[56:57]
    v_pk_mul_f32 v[98:99], v[90:91], v[58:59]
    v_pk_mul_f32 v[100:101], v[92:93], v[60:61]
    v_pk_mul_f32 v[102:103], v[94:95], v[62:63]
    s_waitcnt vmcnt(49)
    v_lshlrev_b32 v104, 16, v236
    v_and_b32 v105, 0xffff0000, v236
    v_lshlrev_b32_e64 v106, 16, v237
    v_and_b32 v107, 0xffff0000, v237
    v_lshlrev_b32_e64 v108, 16, v238
    v_and_b32 v109, 0xffff0000, v238
    v_lshlrev_b32_e64 v110, 16, v239
    v_and_b32 v111, 0xffff0000, v239
    v_pk_fma_f32 v[96:97], v[64:65], v[48:49], v[96:97]
    v_pk_fma_f32 v[98:99], v[66:67], v[50:51], v[98:99]
    v_pk_fma_f32 v[100:101], v[68:69], v[52:53], v[100:101]
    v_pk_fma_f32 v[102:103], v[70:71], v[54:55], v[102:103]
    v_pk_fma_f32 v[96:97], v[72:73], v[40:41], v[96:97]
    v_pk_fma_f32 v[98:99], v[74:75], v[42:43], v[98:99]
    v_pk_fma_f32 v[100:101], v[76:77], v[44:45], v[100:101]
    v_pk_fma_f32 v[102:103], v[78:79], v[46:47], v[102:103]
    v_pk_fma_f32 v[96:97], v[80:81], v[32:33], v[96:97]
    v_pk_fma_f32 v[98:99], v[82:83], v[34:35], v[98:99]
    v_pk_fma_f32 v[100:101], v[84:85], v[36:37], v[100:101]
    v_pk_fma_f32 v[102:103], v[86:87], v[38:39], v[102:103]
    v_pk_mul_f32 v[120:121], v[104:105], v[96:97]
    v_pk_mul_f32 v[122:123], v[106:107], v[98:99]
    v_pk_mul_f32 v[124:125], v[108:109], v[100:101]
    v_pk_mul_f32 v[126:127], v[110:111], v[102:103]
    v_cvt_pk_bf16_f32 v130, v120, v112
    v_cvt_pk_bf16_f32 v138, v121, v113
    v_cvt_pk_bf16_f32 v146, v122, v114
    v_cvt_pk_bf16_f32 v154, v123, v115
    v_cvt_pk_bf16_f32 v162, v124, v116
    v_cvt_pk_bf16_f32 v170, v125, v117
    v_cvt_pk_bf16_f32 v178, v126, v118
    v_cvt_pk_bf16_f32 v186, v127, v119
    s_waitcnt vmcnt(48)
    v_accvgpr_read_b32 v24, a200
    v_accvgpr_read_b32 v25, a201
    v_accvgpr_read_b32 v26, a202
    v_accvgpr_read_b32 v27, a203
    v_lshlrev_b32 v88, 16, v24
    v_and_b32 v89, 0xffff0000, v24
    v_lshlrev_b32_e64 v90, 16, v25
    v_and_b32 v91, 0xffff0000, v25
    v_lshlrev_b32_e64 v92, 16, v26
    v_and_b32 v93, 0xffff0000, v26
    v_lshlrev_b32_e64 v94, 16, v27
    v_and_b32 v95, 0xffff0000, v27
    s_add_u32 s5, s75, 0x300000
    buffer_load_dwordx4 v[28:31], v14, s[76:79], s5 offen offset:0
    s_add_u32 s5, s75, 0x300000
    buffer_load_dwordx4 v[28:31], v14, s[76:79], s5 offen offset:1024
    v_pk_mul_f32 v[96:97], v[64:65], v[56:57]
    v_pk_mul_f32 v[98:99], v[66:67], v[58:59]
    v_pk_mul_f32 v[100:101], v[68:69], v[60:61]
    v_pk_mul_f32 v[102:103], v[70:71], v[62:63]
    s_waitcnt vmcnt(49)
    v_lshlrev_b32 v104, 16, v240
    v_and_b32 v105, 0xffff0000, v240
    v_lshlrev_b32_e64 v106, 16, v241
    v_and_b32 v107, 0xffff0000, v241
    v_lshlrev_b32_e64 v108, 16, v242
    v_and_b32 v109, 0xffff0000, v242
    v_lshlrev_b32_e64 v110, 16, v243
    v_and_b32 v111, 0xffff0000, v243
    v_pk_fma_f32 v[96:97], v[72:73], v[48:49], v[96:97]
    v_pk_fma_f32 v[98:99], v[74:75], v[50:51], v[98:99]
    v_pk_fma_f32 v[100:101], v[76:77], v[52:53], v[100:101]
    v_pk_fma_f32 v[102:103], v[78:79], v[54:55], v[102:103]
    v_pk_fma_f32 v[96:97], v[80:81], v[40:41], v[96:97]
    v_pk_fma_f32 v[98:99], v[82:83], v[42:43], v[98:99]
    v_pk_fma_f32 v[100:101], v[84:85], v[44:45], v[100:101]
    v_pk_fma_f32 v[102:103], v[86:87], v[46:47], v[102:103]
    v_pk_fma_f32 v[96:97], v[88:89], v[32:33], v[96:97]
    v_pk_fma_f32 v[98:99], v[90:91], v[34:35], v[98:99]
    v_pk_fma_f32 v[100:101], v[92:93], v[36:37], v[100:101]
    v_pk_fma_f32 v[102:103], v[94:95], v[38:39], v[102:103]
    v_pk_mul_f32 v[112:113], v[104:105], v[96:97]
    v_pk_mul_f32 v[114:115], v[106:107], v[98:99]
    v_pk_mul_f32 v[116:117], v[108:109], v[100:101]
    v_pk_mul_f32 v[118:119], v[110:111], v[102:103]
    s_waitcnt vmcnt(48)
    v_accvgpr_read_b32 v24, a204
    v_accvgpr_read_b32 v25, a205
    v_accvgpr_read_b32 v26, a206
    v_accvgpr_read_b32 v27, a207
    v_lshlrev_b32 v64, 16, v24
    v_and_b32 v65, 0xffff0000, v24
    v_lshlrev_b32_e64 v66, 16, v25
    v_and_b32 v67, 0xffff0000, v25
    v_lshlrev_b32_e64 v68, 16, v26
    v_and_b32 v69, 0xffff0000, v26
    v_lshlrev_b32_e64 v70, 16, v27
    v_and_b32 v71, 0xffff0000, v27
    s_add_u32 s5, s75, 0x300000
    buffer_load_dwordx4 v[28:31], v14, s[76:79], s5 offen offset:2048
    s_add_u32 s5, s75, 0x300000
    buffer_load_dwordx4 v[28:31], v14, s[76:79], s5 offen offset:3072
    v_pk_mul_f32 v[96:97], v[72:73], v[56:57]
    v_pk_mul_f32 v[98:99], v[74:75], v[58:59]
    v_pk_mul_f32 v[100:101], v[76:77], v[60:61]
    v_pk_mul_f32 v[102:103], v[78:79], v[62:63]
    s_waitcnt vmcnt(49)
    v_lshlrev_b32 v104, 16, v244
    v_and_b32 v105, 0xffff0000, v244
    v_lshlrev_b32_e64 v106, 16, v245
    v_and_b32 v107, 0xffff0000, v245
    v_lshlrev_b32_e64 v108, 16, v246
    v_and_b32 v109, 0xffff0000, v246
    v_lshlrev_b32_e64 v110, 16, v247
    v_and_b32 v111, 0xffff0000, v247
    v_pk_fma_f32 v[96:97], v[80:81], v[48:49], v[96:97]
    v_pk_fma_f32 v[98:99], v[82:83], v[50:51], v[98:99]
    v_pk_fma_f32 v[100:101], v[84:85], v[52:53], v[100:101]
    v_pk_fma_f32 v[102:103], v[86:87], v[54:55], v[102:103]
    v_pk_fma_f32 v[96:97], v[88:89], v[40:41], v[96:97]
    v_pk_fma_f32 v[98:99], v[90:91], v[42:43], v[98:99]
    v_pk_fma_f32 v[100:101], v[92:93], v[44:45], v[100:101]
    v_pk_fma_f32 v[102:103], v[94:95], v[46:47], v[102:103]
    v_pk_fma_f32 v[96:97], v[64:65], v[32:33], v[96:97]
    v_pk_fma_f32 v[98:99], v[66:67], v[34:35], v[98:99]
    v_pk_fma_f32 v[100:101], v[68:69], v[36:37], v[100:101]
    v_pk_fma_f32 v[102:103], v[70:71], v[38:39], v[102:103]
    v_pk_mul_f32 v[120:121], v[104:105], v[96:97]
    v_pk_mul_f32 v[122:123], v[106:107], v[98:99]
    v_pk_mul_f32 v[124:125], v[108:109], v[100:101]
    v_pk_mul_f32 v[126:127], v[110:111], v[102:103]
    v_cvt_pk_bf16_f32 v129, v120, v112
    v_cvt_pk_bf16_f32 v137, v121, v113
    v_cvt_pk_bf16_f32 v145, v122, v114
    v_cvt_pk_bf16_f32 v153, v123, v115
    v_cvt_pk_bf16_f32 v161, v124, v116
    v_cvt_pk_bf16_f32 v169, v125, v117
    v_cvt_pk_bf16_f32 v177, v126, v118
    v_cvt_pk_bf16_f32 v185, v127, v119
    s_waitcnt vmcnt(48)
    v_accvgpr_read_b32 v24, a208
    v_accvgpr_read_b32 v25, a209
    v_accvgpr_read_b32 v26, a210
    v_accvgpr_read_b32 v27, a211
    v_lshlrev_b32 v72, 16, v24
    v_and_b32 v73, 0xffff0000, v24
    v_lshlrev_b32_e64 v74, 16, v25
    v_and_b32 v75, 0xffff0000, v25
    v_lshlrev_b32_e64 v76, 16, v26
    v_and_b32 v77, 0xffff0000, v26
    v_lshlrev_b32_e64 v78, 16, v27
    v_and_b32 v79, 0xffff0000, v27
    s_add_u32 s5, s75, 0x380000
    buffer_load_dwordx4 v[28:31], v14, s[76:79], s5 offen offset:0
    s_add_u32 s5, s75, 0x380000
    buffer_load_dwordx4 v[28:31], v14, s[76:79], s5 offen offset:1024
    v_pk_mul_f32 v[96:97], v[80:81], v[56:57]
    v_pk_mul_f32 v[98:99], v[82:83], v[58:59]
    v_pk_mul_f32 v[100:101], v[84:85], v[60:61]
    v_pk_mul_f32 v[102:103], v[86:87], v[62:63]
    s_waitcnt vmcnt(49)
    v_lshlrev_b32 v104, 16, v248
    v_and_b32 v105, 0xffff0000, v248
    v_lshlrev_b32_e64 v106, 16, v249
    v_and_b32 v107, 0xffff0000, v249
    v_lshlrev_b32_e64 v108, 16, v250
    v_and_b32 v109, 0xffff0000, v250
    v_lshlrev_b32_e64 v110, 16, v251
    v_and_b32 v111, 0xffff0000, v251
    v_pk_fma_f32 v[96:97], v[88:89], v[48:49], v[96:97]
    v_pk_fma_f32 v[98:99], v[90:91], v[50:51], v[98:99]
    v_pk_fma_f32 v[100:101], v[92:93], v[52:53], v[100:101]
    v_pk_fma_f32 v[102:103], v[94:95], v[54:55], v[102:103]
    v_pk_fma_f32 v[96:97], v[64:65], v[40:41], v[96:97]
    v_pk_fma_f32 v[98:99], v[66:67], v[42:43], v[98:99]
    v_pk_fma_f32 v[100:101], v[68:69], v[44:45], v[100:101]
    v_pk_fma_f32 v[102:103], v[70:71], v[46:47], v[102:103]
    v_pk_fma_f32 v[96:97], v[72:73], v[32:33], v[96:97]
    v_pk_fma_f32 v[98:99], v[74:75], v[34:35], v[98:99]
    v_pk_fma_f32 v[100:101], v[76:77], v[36:37], v[100:101]
    v_pk_fma_f32 v[102:103], v[78:79], v[38:39], v[102:103]
    v_pk_mul_f32 v[112:113], v[104:105], v[96:97]
    v_pk_mul_f32 v[114:115], v[106:107], v[98:99]
    v_pk_mul_f32 v[116:117], v[108:109], v[100:101]
    v_pk_mul_f32 v[118:119], v[110:111], v[102:103]
    s_waitcnt vmcnt(48)
    v_accvgpr_read_b32 v24, a212
    v_accvgpr_read_b32 v25, a213
    v_accvgpr_read_b32 v26, a214
    v_accvgpr_read_b32 v27, a215
    v_lshlrev_b32 v80, 16, v24
    v_and_b32 v81, 0xffff0000, v24
    v_lshlrev_b32_e64 v82, 16, v25
    v_and_b32 v83, 0xffff0000, v25
    v_lshlrev_b32_e64 v84, 16, v26
    v_and_b32 v85, 0xffff0000, v26
    v_lshlrev_b32_e64 v86, 16, v27
    v_and_b32 v87, 0xffff0000, v27
    s_add_u32 s5, s75, 0x380000
    buffer_load_dwordx4 v[28:31], v14, s[76:79], s5 offen offset:2048
    s_add_u32 s5, s75, 0x380000
    buffer_load_dwordx4 v[28:31], v14, s[76:79], s5 offen offset:3072
    v_pk_mul_f32 v[96:97], v[88:89], v[56:57]
    v_pk_mul_f32 v[98:99], v[90:91], v[58:59]
    v_pk_mul_f32 v[100:101], v[92:93], v[60:61]
    v_pk_mul_f32 v[102:103], v[94:95], v[62:63]
    s_waitcnt vmcnt(49)
    v_lshlrev_b32 v104, 16, v252
    v_and_b32 v105, 0xffff0000, v252
    v_lshlrev_b32_e64 v106, 16, v253
    v_and_b32 v107, 0xffff0000, v253
    v_lshlrev_b32_e64 v108, 16, v254
    v_and_b32 v109, 0xffff0000, v254
    v_lshlrev_b32_e64 v110, 16, v255
    v_and_b32 v111, 0xffff0000, v255
    v_pk_fma_f32 v[96:97], v[64:65], v[48:49], v[96:97]
    v_pk_fma_f32 v[98:99], v[66:67], v[50:51], v[98:99]
    v_pk_fma_f32 v[100:101], v[68:69], v[52:53], v[100:101]
    v_pk_fma_f32 v[102:103], v[70:71], v[54:55], v[102:103]
    v_pk_fma_f32 v[96:97], v[72:73], v[40:41], v[96:97]
    v_pk_fma_f32 v[98:99], v[74:75], v[42:43], v[98:99]
    v_pk_fma_f32 v[100:101], v[76:77], v[44:45], v[100:101]
    v_pk_fma_f32 v[102:103], v[78:79], v[46:47], v[102:103]
    v_pk_fma_f32 v[96:97], v[80:81], v[32:33], v[96:97]
    v_pk_fma_f32 v[98:99], v[82:83], v[34:35], v[98:99]
    v_pk_fma_f32 v[100:101], v[84:85], v[36:37], v[100:101]
    v_pk_fma_f32 v[102:103], v[86:87], v[38:39], v[102:103]
    v_pk_mul_f32 v[120:121], v[104:105], v[96:97]
    v_pk_mul_f32 v[122:123], v[106:107], v[98:99]
    v_pk_mul_f32 v[124:125], v[108:109], v[100:101]
    v_pk_mul_f32 v[126:127], v[110:111], v[102:103]
    v_cvt_pk_bf16_f32 v128, v120, v112
    v_cvt_pk_bf16_f32 v136, v121, v113
    v_cvt_pk_bf16_f32 v144, v122, v114
    v_cvt_pk_bf16_f32 v152, v123, v115
    v_cvt_pk_bf16_f32 v160, v124, v116
    v_cvt_pk_bf16_f32 v168, v125, v117
    v_cvt_pk_bf16_f32 v176, v126, v118
    v_cvt_pk_bf16_f32 v184, v127, v119
    v_add_u32 v18, 0x10000, v18
    v_add_u32 v19, 0x10000, v19
    v_add_u32 v20, 0x10000, v20
    ds_write_b128 v18, v[128:131] offset:0
    ds_write_b128 v19, v[132:135] offset:0
    ds_write_b128 v18, v[136:139] offset:128
    ds_write_b128 v19, v[140:143] offset:128
    ds_write_b128 v18, v[144:147] offset:256
    ds_write_b128 v19, v[148:151] offset:256
    ds_write_b128 v18, v[152:155] offset:384
    ds_write_b128 v19, v[156:159] offset:384
    ds_write_b128 v18, v[160:163] offset:512
    ds_write_b128 v19, v[164:167] offset:512
    ds_write_b128 v18, v[168:171] offset:640
    ds_write_b128 v19, v[172:175] offset:640
    ds_write_b128 v18, v[176:179] offset:768
    ds_write_b128 v19, v[180:183] offset:768
    ds_write_b128 v18, v[184:187] offset:896
    ds_write_b128 v19, v[188:191] offset:896
    s_waitcnt lgkmcnt(0)
    s_barrier
    v_xor_b32_e64 v23, 0, v20
    ds_read_b128 v[128:131], v23 offset:0
    v_xor_b32_e64 v23, 16, v20
    ds_read_b128 v[132:135], v23 offset:1024
    v_xor_b32_e64 v23, 32, v20
    ds_read_b128 v[136:139], v23 offset:2048
    v_xor_b32_e64 v23, 48, v20
    ds_read_b128 v[140:143], v23 offset:3072
    v_xor_b32_e64 v23, 64, v20
    ds_read_b128 v[144:147], v23 offset:4096
    v_xor_b32 v23, 80, v20
    ds_read_b128 v[148:151], v23 offset:5120
    v_xor_b32 v23, 96, v20
    ds_read_b128 v[152:155], v23 offset:6144
    v_xor_b32 v23, 112, v20
    ds_read_b128 v[156:159], v23 offset:7168
    v_xor_b32_e64 v23, 0, v20
    ds_read_b128 v[160:163], v23 offset:8192
    v_xor_b32_e64 v23, 16, v20
    ds_read_b128 v[164:167], v23 offset:9216
    v_xor_b32_e64 v23, 32, v20
    ds_read_b128 v[168:171], v23 offset:10240
    v_xor_b32_e64 v23, 48, v20
    ds_read_b128 v[172:175], v23 offset:11264
    v_xor_b32_e64 v23, 64, v20
    ds_read_b128 v[176:179], v23 offset:12288
    v_xor_b32 v23, 80, v20
    ds_read_b128 v[180:183], v23 offset:13312
    v_xor_b32 v23, 96, v20
    ds_read_b128 v[184:187], v23 offset:14336
    v_xor_b32 v23, 112, v20
    ds_read_b128 v[188:191], v23 offset:15360
    s_xor_b32 s4, s63, 1
    s_mul_i32 s4, s4, 0x210000
    s_add_u32 s4, s4, s71
    s_waitcnt lgkmcnt(15)
    buffer_store_dwordx4 v[128:131], v21, s[64:67], s4 offen sc1
    s_add_u32 s4, s4, 0x8400
    s_waitcnt lgkmcnt(14)
    buffer_store_dwordx4 v[132:135], v21, s[64:67], s4 offen sc1
    s_add_u32 s4, s4, 0x8400
    s_waitcnt lgkmcnt(13)
    buffer_store_dwordx4 v[136:139], v21, s[64:67], s4 offen sc1
    s_add_u32 s4, s4, 0x8400
    s_waitcnt lgkmcnt(12)
    buffer_store_dwordx4 v[140:143], v21, s[64:67], s4 offen sc1
    s_add_u32 s4, s4, 0x8400
    s_waitcnt lgkmcnt(11)
    buffer_store_dwordx4 v[144:147], v21, s[64:67], s4 offen sc1
    s_add_u32 s4, s4, 0x8400
    s_waitcnt lgkmcnt(10)
    buffer_store_dwordx4 v[148:151], v21, s[64:67], s4 offen sc1
    s_add_u32 s4, s4, 0x8400
    s_waitcnt lgkmcnt(9)
    buffer_store_dwordx4 v[152:155], v21, s[64:67], s4 offen sc1
    s_add_u32 s4, s4, 0x8400
    s_waitcnt lgkmcnt(8)
    buffer_store_dwordx4 v[156:159], v21, s[64:67], s4 offen sc1
    s_add_u32 s4, s4, 0x8400
    s_waitcnt lgkmcnt(7)
    buffer_store_dwordx4 v[160:163], v21, s[64:67], s4 offen sc1
    s_add_u32 s4, s4, 0x8400
    s_waitcnt lgkmcnt(6)
    buffer_store_dwordx4 v[164:167], v21, s[64:67], s4 offen sc1
    s_add_u32 s4, s4, 0x8400
    s_waitcnt lgkmcnt(5)
    buffer_store_dwordx4 v[168:171], v21, s[64:67], s4 offen sc1
    s_add_u32 s4, s4, 0x8400
    s_waitcnt lgkmcnt(4)
    buffer_store_dwordx4 v[172:175], v21, s[64:67], s4 offen sc1
    s_add_u32 s4, s4, 0x8400
    s_waitcnt lgkmcnt(3)
    buffer_store_dwordx4 v[176:179], v21, s[64:67], s4 offen sc1
    s_add_u32 s4, s4, 0x8400
    s_waitcnt lgkmcnt(2)
    buffer_store_dwordx4 v[180:183], v21, s[64:67], s4 offen sc1
    s_add_u32 s4, s4, 0x8400
    s_waitcnt vmcnt(62) lgkmcnt(1)
    buffer_store_dwordx4 v[184:187], v21, s[64:67], s4 offen sc1
    s_add_u32 s4, s4, 0x8400
    s_waitcnt vmcnt(62) lgkmcnt(0)
    buffer_store_dwordx4 v[188:191], v21, s[64:67], s4 offen sc1
    s_waitcnt vmcnt(0)
    v_mov_b32 v24, 1
    s_mov_b64 exec, 1
    buffer_atomic_add v24, v4, s[20:23], 0 offen offset:4 sc0 sc1
    s_mov_b64 exec, -1
    s_waitcnt vmcnt(0)
    v_readfirstlane_b32 s4, v24
    s_nop 0
    s_and_b32 s4, s4, 127
    s_cmp_eq_u32 s4, 127
    s_cbranch_scc0 SD_NOLAST
    v_lshlrev_b32_e64 v24, 7, v1
    s_mov_b32 s4, 0x1023000
    buffer_store_dword v5, v24, s[64:67], s4 offen sc1
SD_NOLAST:
    s_getpc_b64 s[8:9]
CW_2:
    s_sub_u32 s8, s8, CW_2-parallel_sum__ssm_conv_h3__swiglu_ffn__prompt_kernel
    s_subb_u32 s9, s9, 0
    s_mov_b32 s10, CODE_END-parallel_sum__ssm_conv_h3__swiglu_ffn__prompt_kernel
    s_mov_b32 s11, 0x00020000
    s_bfe_u32 s4, s2, 0x20003
    s_lshl_b32 s4, s4, 2
    s_add_u32 s4, s4, s3
    s_lshl_b32 s4, s4, 10
    buffer_load_dwordx4 v[28:31], v14, s[8:11], s4 offen
    s_add_u32 s4, s4, 0x4000
    buffer_load_dwordx4 v[28:31], v14, s[8:11], s4 offen
    s_add_u32 s4, s4, 0x4000
    buffer_load_dwordx4 v[28:31], v14, s[8:11], s4 offen
    s_add_u32 s4, s4, 0x4000
    buffer_load_dwordx4 v[28:31], v14, s[8:11], s4 offen
    s_add_u32 s4, s4, 0x4000
    buffer_load_dwordx4 v[28:31], v14, s[8:11], s4 offen
    s_add_u32 s4, s4, 0x4000
    s_mov_b32 s73, s75
    s_barrier
    s_lshl_b32 s24, s2, 2
    s_add_u32 s24, s24, s3
    s_lshl_b32 s4, s24, 12
    s_add_u32 s8, s44, s4
    s_addc_u32 s9, s45, 0
    s_movk_i32 s10, 4096
    s_mov_b32 s11, 0x00020000
    s_mov_b32 s16, s46
    s_mov_b32 s17, s47
    s_mov_b32 s18, 0x800
    s_mov_b32 s19, 0x00020000
    s_mov_b32 s12, s54
    s_mov_b32 s13, s55
    s_mov_b32 s14, 0x700000
    s_mov_b32 s15, 0x00020000
    s_mul_i32 s25, s3, 18432
    s_add_u32 s25, s25, 0x10800
    s_and_b32 s4, s2, 1
    s_lshl_b32 s4, s4, 2
    s_bfe_u32 s5, s2, 0x20003
    s_add_u32 s26, s4, s5
    s_lshr_b32 s4, s2, 5
    s_bfe_u32 s35, s2, 0x20001
    s_lshl_b32 s27, s4, 2
    s_add_u32 s27, s27, s35
    s_lshl_b32 s4, s4, 8
    s_lshl_b32 s5, s3, 16
    s_add_u32 s30, s4, s5
    s_lshl_b32 s4, s3, 2
    s_lshl_b32 s28, s26, 4
    s_add_u32 s28, s28, s4
    s_mul_i32 s5, s26, 1792
    s_add_u32 s4, s4, s5
    s_lshl_b32 s29, s4, 10
    s_lshl_b32 s31, s3, 13
    s_lshl_b32 s4, s27, 6
    s_lshl_b32 s72, s28, 15
    s_add_u32 s72, s72, s4
    s_add_u32 s77, s72, 0x10000
    v_lshrrev_b32 v16, 4, v1
    v_and_b32 v17, 15, v1
    v_lshlrev_b32 v18, 1, v16
    v_xor_b32 v17, v17, v18
    v_lshlrev_b32 v17, 4, v17
    v_lshl_add_u32 v6, v16, 11, v17
    v_xor_b32 v17, 0x80, v6
    v_add_u32 v7, 0x1c00, v6
    v_add_u32 v8, 0x3800, v17
    v_add_u32 v9, 0x5400, v17
    v_subrev_u32 v16, 16, v1
    v_lshlrev_b32 v16, 2, v16
    v_min_u32 v22, 0x40000000, v16
    v_subrev_u32 v16, 15, v1
    v_lshlrev_b32_e64 v16, 2, v16
    v_min_u32 v23, 0x40000000, v16
    s_lshl_b32 s4, s24, 1
    buffer_load_ushort v2, v4, s[16:19], s4 offen
    v_and_b32 v15, 15, v1
    v_lshlrev_b32 v15, 12, v15
    v_lshrrev_b32_e64 v3, 4, v1
    v_lshl_add_u32 v3, v3, 3, v15
    s_lshl_b32 s4, s24, 10
    s_add_u32 s4, s4, 0x280000
    buffer_load_dwordx4 v[88:91], v14, s[12:15], s4 offen
    s_add_u32 s4, s4, 0x380000
    buffer_load_dwordx4 v[88:91], v14, s[12:15], s4 offen
    s_lshr_b32 s75, s2, 5
    s_bfe_u32 s81, s2, 0x20003
    s_lshl_b32 s81, s81, 1
    s_add_u32 s75, s75, s81
    s_mov_b32 s75, 0
    s_lshl_b32 s6, s75, 3
    s_lshr_b64 s[4:5], s[48:49], s6
    s_and_b32 s16, s4, 31
    s_add_u32 s75, s75, 1
    s_cmp_eq_u32 s75, 7
    s_cselect_b32 s75, 0, s75
    s_lshl_b32 s6, s75, 3
    s_lshr_b64 s[4:5], s[48:49], s6
    s_and_b32 s17, s4, 31
    s_add_u32 s75, s75, 1
    s_cmp_eq_u32 s75, 7
    s_cselect_b32 s75, 0, s75
    s_mov_b32 s20, s36
    s_mov_b32 s21, s37
    s_mov_b32 s22, 0x400000
    s_mov_b32 s23, 0x00020000
    v_and_b32 v10, 15, v1
    v_lshrrev_b32_e64 v11, 4, v1
    v_lshl_add_u32 v12, v11, 2, v10
    v_add_u32 v12, 1, v12
    s_waitcnt vmcnt(3)
    v_and_b32 v29, 1, v12
    v_sub_u32 v12, v12, v29
    v_lshlrev_b32_e64 v12, 2, v12
    v_mul_u32_u24 v29, 4416, v29
    v_add3_u32 v12, v12, v29, s25
    v_add_u32 v12, 9216, v12
    v_add_u32 v13, 0x800, v12
    v_lshrrev_b32 v29, 1, v10
    v_lshlrev_b32 v29, 6, v29
    v_lshlrev_b32 v18, 4, v11
    v_sub_u32 v18, v18, v29
    v_and_b32_e64 v29, 1, v10
    v_mul_u32_u24 v29, 4576, v29
    v_add3_u32 v18, v18, v29, s25
    v_mov_b32 v92, 0
    v_mov_b32 v93, 0
    v_mov_b32 v94, 0
    v_mov_b32 v95, 0
    v_add_u32_e64 v29, s25, v14
    s_mov_b64 exec, 0x0fffffff
    ds_write_b128 v29, v[92:95] offset:4096
    ds_write_b128 v29, v[92:95] offset:8672
    s_mov_b64 exec, -1
    v_sub_u32 v19, 15, v10
    v_lshlrev_b32_e64 v17, 2, v11
    v_sub_u32 v19, v19, v17
    v_cmp_eq_u32 vcc, 0, v19
    s_waitcnt vmcnt(2)
    s_nop 0
    v_cndmask_b32 v92, 0, v2, vcc
    v_cmp_eq_u32 vcc, 1, v19
    s_nop 1
    v_cndmask_b32 v93, 0, v2, vcc
    v_cmp_eq_u32 vcc, 2, v19
    s_nop 1
    v_cndmask_b32 v94, 0, v2, vcc
    v_cmp_eq_u32 vcc, 3, v19
    s_nop 1
    v_cndmask_b32 v95, 0, v2, vcc
    s_add_u32 m0, s25, 9216
    s_movk_i32 s80, 192
    buffer_load_dword v22, s[8:11], 0 offen lds
    s_add_u32 m0, s25, 9472
    s_nop 0
    buffer_load_dwordx4 v14, s[8:11], s80 offen offset:0  lds
    buffer_load_dwordx4 v14, s[8:11], s80 offen offset:1024  lds
    buffer_load_dwordx4 v14, s[8:11], s80 offen offset:2048  lds
    buffer_load_dwordx4 v14, s[8:11], s80 offen offset:3072  lds
    s_add_u32 m0, s25, 13632
    s_movk_i32 s80, 196
    buffer_load_dword v23, s[8:11], 0 offen lds
    s_add_u32 m0, s25, 13888
    s_nop 0
    buffer_load_dwordx4 v14, s[8:11], s80 offen offset:0  lds
    buffer_load_dwordx4 v14, s[8:11], s80 offen offset:1024  lds
    buffer_load_dwordx4 v14, s[8:11], s80 offen offset:2048  lds
    buffer_load_dwordx4 v14, s[8:11], s80 offen offset:3072  lds
    s_add_u32 s4, s73, 0x0
    buffer_load_dwordx4 v[72:75], v14, s[12:15], s4 offen offset:0
    buffer_load_dwordx4 v[72:75], v14, s[12:15], s4 offen offset:1024
    buffer_load_dwordx4 v[72:75], v14, s[12:15], s4 offen offset:2048
    buffer_load_dwordx4 v[72:75], v14, s[12:15], s4 offen offset:3072
    s_add_u32 s4, s73, 0x380000
    buffer_load_dwordx4 v[72:75], v14, s[12:15], s4 offen offset:0
    buffer_load_dwordx4 v[72:75], v14, s[12:15], s4 offen offset:1024
    buffer_load_dwordx4 v[72:75], v14, s[12:15], s4 offen offset:2048
    buffer_load_dwordx4 v[72:75], v14, s[12:15], s4 offen offset:3072
    s_add_u32 s4, s73, 0x80000
    buffer_load_dwordx4 v[72:75], v14, s[12:15], s4 offen offset:0
    buffer_load_dwordx4 v[72:75], v14, s[12:15], s4 offen offset:1024
    buffer_load_dwordx4 v[72:75], v14, s[12:15], s4 offen offset:2048
    buffer_load_dwordx4 v[72:75], v14, s[12:15], s4 offen offset:3072
    s_add_u32 s4, s73, 0x400000
    buffer_load_dwordx4 v[72:75], v14, s[12:15], s4 offen offset:0
    buffer_load_dwordx4 v[72:75], v14, s[12:15], s4 offen offset:1024
    buffer_load_dwordx4 v[72:75], v14, s[12:15], s4 offen offset:2048
    buffer_load_dwordx4 v[72:75], v14, s[12:15], s4 offen offset:3072
    s_add_u32 s4, s73, 0x100000
    buffer_load_dwordx4 v[72:75], v14, s[12:15], s4 offen offset:0
    buffer_load_dwordx4 v[72:75], v14, s[12:15], s4 offen offset:1024
    buffer_load_dwordx4 v[72:75], v14, s[12:15], s4 offen offset:2048
    buffer_load_dwordx4 v[72:75], v14, s[12:15], s4 offen offset:3072
    s_add_u32 s4, s73, 0x480000
    buffer_load_dwordx4 v[72:75], v14, s[12:15], s4 offen offset:0
    buffer_load_dwordx4 v[72:75], v14, s[12:15], s4 offen offset:1024
    buffer_load_dwordx4 v[72:75], v14, s[12:15], s4 offen offset:2048
    buffer_load_dwordx4 v[72:75], v14, s[12:15], s4 offen offset:3072
    s_and_b32 s34, s2, 63
    s_lshl_b32 s34, s34, 7
    s_add_u32 s34, s34, 0x1023000
    buffer_load_dword v36, v4, s[64:67], s34 offen sc1
    s_add_u32 s4, s73, 0x180000
    buffer_load_dwordx4 v[72:75], v14, s[12:15], s4 offen offset:0
    buffer_load_dwordx4 v[72:75], v14, s[12:15], s4 offen offset:1024
    buffer_load_dwordx4 v[72:75], v14, s[12:15], s4 offen offset:2048
    buffer_load_dwordx4 v[72:75], v14, s[12:15], s4 offen offset:3072
    s_add_u32 s4, s73, 0x500000
    buffer_load_dwordx4 v[72:75], v14, s[12:15], s4 offen offset:0
    buffer_load_dwordx4 v[72:75], v14, s[12:15], s4 offen offset:1024
    buffer_load_dwordx4 v[72:75], v14, s[12:15], s4 offen offset:2048
    buffer_load_dwordx4 v[72:75], v14, s[12:15], s4 offen offset:3072
    s_add_u32 s4, s73, 0x200000
    buffer_load_dwordx4 v[72:75], v14, s[12:15], s4 offen offset:0
    buffer_load_dwordx4 v[72:75], v14, s[12:15], s4 offen offset:1024
    buffer_load_dwordx4 v[72:75], v14, s[12:15], s4 offen offset:2048
    buffer_load_dwordx4 v[72:75], v14, s[12:15], s4 offen offset:3072
    s_add_u32 s4, s73, 0x580000
    buffer_load_dwordx4 v[72:75], v14, s[12:15], s4 offen offset:0
    buffer_load_dwordx4 v[72:75], v14, s[12:15], s4 offen offset:1024
    buffer_load_dwordx4 v[72:75], v14, s[12:15], s4 offen offset:2048
    buffer_load_dwordx4 v[72:75], v14, s[12:15], s4 offen offset:3072
    s_waitcnt vmcnt(16)
    v_cmp_ne_u32 vcc, 0, v36
    s_nop 0
    s_cmp_eq_u64 vcc, -1
    s_cbranch_scc0 UG_SLOW
UG_OK:
    s_mul_i32 s71, s24, 4224
    s_add_u32 s71, s71, 0x1400000
    s_add_u32 m0, s25, 4576
    s_nop 0
    buffer_load_dwordx4 v14, s[64:67], s71 offen offset:0 sc1 lds
    buffer_load_dwordx4 v14, s[64:67], s71 offen offset:1024 sc1 lds
    buffer_load_dwordx4 v14, s[64:67], s71 offen offset:2048 sc1 lds
    buffer_load_dwordx4 v14, s[64:67], s71 offen offset:3072 sc1 lds
    v_and_b32 v28, 15, v1
    v_lshlrev_b32 v28, 3, v28
    s_lshl_b32 s81, s28, 7
    s_add_u32 s81, s81, 0x1000000
    buffer_load_dwordx2 v[20:21], v28, s[64:67], s81 offen offset:0 sc1
    buffer_load_dwordx2 v[30:31], v28, s[64:67], s81 offen offset:128 sc1
    buffer_load_dwordx2 v[24:25], v28, s[64:67], s81 offen offset:256 sc1
    buffer_load_dwordx2 v[26:27], v28, s[64:67], s81 offen offset:384 sc1
    s_lshl_b32 s79, s16, 18
    s_add_u32 m0, s31, 0x0
    s_add_u32 s79, s79, s30
    buffer_load_dwordx4 v6, s[12:15], s79 offen offset:0 lds
    buffer_load_dwordx4 v7, s[12:15], s79 offen offset:1024 lds
    buffer_load_dwordx4 v8, s[12:15], s79 offen offset:2048 lds
    buffer_load_dwordx4 v9, s[12:15], s79 offen offset:3072 lds
    s_add_u32 m0, s31, 0x1000
    s_add_u32 s79, s79, 0x8000
    buffer_load_dwordx4 v6, s[12:15], s79 offen offset:0 lds
    buffer_load_dwordx4 v7, s[12:15], s79 offen offset:1024 lds
    buffer_load_dwordx4 v8, s[12:15], s79 offen offset:2048 lds
    buffer_load_dwordx4 v9, s[12:15], s79 offen offset:3072 lds
    s_lshl_b32 s79, s17, 18
    s_add_u32 m0, s31, 0x8000
    s_add_u32 s79, s79, s30
    buffer_load_dwordx4 v6, s[12:15], s79 offen offset:0 lds
    buffer_load_dwordx4 v7, s[12:15], s79 offen offset:1024 lds
    buffer_load_dwordx4 v8, s[12:15], s79 offen offset:2048 lds
    buffer_load_dwordx4 v9, s[12:15], s79 offen offset:3072 lds
    s_waitcnt vmcnt(16)
    ds_read_b128 v[96:99], v29 offset:4576
    ds_read_b32 v76, v29 offset:4592
    ds_read_b128 v[100:103], v29 offset:5600
    ds_read_b32 v77, v29 offset:5616
    ds_read_b128 v[104:107], v29 offset:6624
    ds_read_b32 v78, v29 offset:6640
    ds_read_b128 v[108:111], v29 offset:7648
    ds_read_b32 v79, v29 offset:7664
    s_waitcnt lgkmcnt(7)
    v_alignbit_b32 v80, v97, v96, 16
    v_alignbit_b32 v81, v98, v97, 16
    v_alignbit_b32 v82, v99, v98, 16
    s_waitcnt lgkmcnt(6)
    v_alignbit_b32 v83, v76, v99, 16
    ds_write_b128 v29, v[80:83] offset:0
    s_waitcnt lgkmcnt(6)
    v_alignbit_b32 v84, v101, v100, 16
    v_alignbit_b32 v85, v102, v101, 16
    v_alignbit_b32 v86, v103, v102, 16
    s_waitcnt lgkmcnt(5)
    v_alignbit_b32 v87, v77, v103, 16
    ds_write_b128 v29, v[84:87] offset:1024
    s_waitcnt lgkmcnt(5)
    v_alignbit_b32 v80, v105, v104, 16
    v_alignbit_b32 v81, v106, v105, 16
    v_alignbit_b32 v82, v107, v106, 16
    s_waitcnt lgkmcnt(4)
    v_alignbit_b32 v83, v78, v107, 16
    ds_write_b128 v29, v[80:83] offset:2048
    s_waitcnt lgkmcnt(4)
    v_alignbit_b32 v84, v109, v108, 16
    v_alignbit_b32 v85, v110, v109, 16
    v_alignbit_b32 v86, v111, v110, 16
    s_waitcnt lgkmcnt(3)
    v_alignbit_b32 v87, v79, v111, 16
    ds_write_b128 v29, v[84:87] offset:3072
    ds_read2_b64 a[128:131], v12 offset0:0 offset1:1
    ds_read_b128 a[160:163], v18 offset:4032
    ds_read2_b64 a[132:135], v12 offset0:64 offset1:65
    ds_read_b128 a[164:167], v18 offset:3520
    ds_read2_b64 a[136:139], v12 offset0:128 offset1:129
    ds_read_b128 a[168:171], v18 offset:3008
    ds_read2_b64 a[140:143], v12 offset0:192 offset1:193
    ds_read_b128 a[172:175], v18 offset:2496
    ds_read2_b64 a[144:147], v13 offset0:0 offset1:1
    ds_read_b128 a[176:179], v18 offset:1984
    ds_read2_b64 a[148:151], v13 offset0:64 offset1:65
    ds_read_b128 a[180:183], v18 offset:1472
    ds_read2_b64 a[152:155], v13 offset0:128 offset1:129
    ds_read_b128 a[184:187], v18 offset:960
    ds_read2_b64 a[156:159], v13 offset0:192 offset1:193
    ds_read_b128 a[188:191], v18 offset:448
    s_mov_b32 s73, 0
    s_branch GAP
CODE_END:

.section .rodata,"a"
.p2align 6
.amdhsa_kernel parallel_sum__ssm_conv_h3__swiglu_ffn__prompt_kernel
  .amdhsa_next_free_vgpr 512
  .amdhsa_next_free_sgpr 102
  .amdhsa_accum_offset 256
  .amdhsa_group_segment_fixed_size 0
  .amdhsa_kernarg_size 104
  .amdhsa_user_sgpr_count 2
  .amdhsa_user_sgpr_kernarg_segment_ptr 1
  .amdhsa_system_sgpr_workgroup_id_x 1
.end_amdhsa_kernel
```
